```python
import torch

def _softmax(x, axis=-1):
    return torch.softmax(x, dim=axis)
def _gelu(x):
    return torch.nn.functional.gelu(x, approximate="tanh")
def _silu(x):
    return torch.nn.functional.silu(x)
def _sigmoid(x):
    return torch.sigmoid(x)
def _layernorm(x, axis=-1, eps=1e-5):
    m = x.mean(dim=axis, keepdim=True)
    v = x.var(dim=axis, keepdim=True, unbiased=False)
    return (x - m) / torch.sqrt(v + eps)
def _scatter_add(tgt, idx, src, axis=0):
    return tgt.clone().index_add_(axis, idx, src)
def _segment_sum(src, seg, n):
    out = torch.zeros((n,) + src.shape[1:], dtype=src.dtype)
    return out.index_add_(0, seg, src)
def _pad(x, pw):
    flat = tuple(v for pair in reversed(pw) for v in pair)
    return torch.nn.functional.pad(x, flat)

kernel_name = 'recurrent_scan__compressed_kv_cla__dense_activation_squared_relu__prompt'

def setup_inputs():

    _w = (lambda a: (lambda t: t.to(torch.bfloat16) if t.is_floating_point() else t)(torch.as_tensor(a)))
    def _A_setup():
        B, H, Sq, Sk, D, M = 1, 32, 2048, 2048, 128, 512
        Dc = 4 * D
        return {
            "x": _w((lambda *s: torch.randn(*s, dtype=torch.bfloat16) * 0.05)(B, Sq, M)),
            "c_kv": _w((lambda *s: torch.randn(*s, dtype=torch.bfloat16) * 0.2)(B, Sk, Dc)),
            "w_q": _w((lambda *s: torch.randn(*s, dtype=torch.bfloat16) * 3.2)(M, H, D) * (M ** -0.5)),
            "w_uk": _w((lambda *s: torch.randn(*s, dtype=torch.bfloat16) * 3.2)(Dc, H, D) * (Dc ** -0.5)),
            "w_uv": _w((lambda *s: torch.randn(*s, dtype=torch.bfloat16) * 0.2)(Dc, H, D) * (Dc ** -0.5)),
            "w_o": _w((lambda *s: torch.randn(*s, dtype=torch.bfloat16) * 0.2)(H, D, M) * ((H * D) ** -0.5)),
        }
    _A_in = _A_setup()

    def _B_setup():
        B, S, D, F = 1, 2048, 512, 1792
        return {
            "x": _w((lambda *s: torch.randn(*s, dtype=torch.bfloat16) * 0.05)(B, S, D)),
            "w1": _w((lambda *s: torch.randn(*s, dtype=torch.bfloat16) * 0.1)(D, F)),
            "b1": _w((lambda *s: torch.randn(*s, dtype=torch.bfloat16) * 0.8)(F)),
            "w2": _w((lambda *s: torch.randn(*s, dtype=torch.bfloat16) * 0.1)(F, D)),
            "b2": _w((lambda *s: torch.randn(*s, dtype=torch.bfloat16) * 6.4)(D)),
        }
    _B_in = _B_setup()

    return {
        "A_x": _A_in["x"],
        "A_c_kv": _A_in["c_kv"],
        "A_w_q": _A_in["w_q"],
        "A_w_uk": _A_in["w_uk"],
        "A_w_uv": _A_in["w_uv"],
        "A_w_o": _A_in["w_o"],
        "B_x": _B_in["x"],
        "B_w1": _B_in["w1"],
        "B_b1": _B_in["b1"],
        "B_w2": _B_in["w2"],
        "B_b2": _B_in["b2"],
    }

def reference(A_x, A_c_kv, A_w_q, A_w_uk, A_w_uv, A_w_o, B_x, B_w1, B_b1, B_w2, B_b2):
    def _A_ref(x, c_kv, w_q, w_uk, w_uv, w_o):
        B, Sq, M = x.shape[0], x.shape[1], x.shape[2]
        Sk = c_kv.shape[1]
        H, D = w_q.shape[1], w_q.shape[2]
        q = torch.einsum("bqm,mhd->bhqd", x, w_q)
        k = torch.einsum("bkc,chd->bhkd", c_kv, w_uk)
        v = torch.einsum("bkc,chd->bhkd", c_kv, w_uv)
        scores = torch.einsum("bhqd,bhkd->bhqk", q, k) * (D ** -0.5)
        off = Sk - Sq
        qi = torch.arange(Sq)[:, None]
        kj = torch.arange(Sk)[None, :]
        cmask = kj <= (qi + off)
        scores = torch.where(cmask[None, None], scores, -1e9)
        p = _softmax(scores, axis=-1)
        ctx = torch.einsum("bhqk,bhkd->bhqd", p, v)
        return torch.einsum("bhqd,hdm->bqm", ctx, w_o)

    def _B_ref(x, w1, b1, w2, b2):
        h = torch.einsum("bsd,df->bsf", x, w1) + b1
        zero = torch.zeros_like(h)
        r = torch.where(h > zero, h, zero)
        h = r * r
        out = torch.einsum("bsf,fd->bsd", h, w2) + b2
        return out

    x = A_x
    xn = _layernorm(x, axis=-1)
    s = _A_ref(xn, A_c_kv, A_w_q, A_w_uk, A_w_uv, A_w_o)
    g = _silu(_B_ref(xn, B_w1, B_b1, B_w2, B_b2))
    return x + s * g
```

```asm
; @launch grid=(256,1,1) block=(512,1,1) lds=163840
.amdgcn_target "amdgcn-amd-amdhsa--gfx950"
.text
  .globl recurrent_scan__compressed_kv_cla__dense_activation_squared_relu__prompt_kernel
  .p2align 8
  .type recurrent_scan__compressed_kv_cla__dense_activation_squared_relu__prompt_kernel,@function
recurrent_scan__compressed_kv_cla__dense_activation_squared_relu__prompt_kernel:
  s_cmp_ge_u32 s2, 256
  s_cbranch_scc1 L_recurrent_scan__compressed_kv_cla__dense_activation_squared_relu__prompt_kernel_end
  s_load_dwordx16 s[4:19], s[0:1], 0
  s_load_dwordx8 s[20:27], s[0:1], 64
  s_load_dwordx4 s[28:31], s[0:1], 96
  s_getpc_b64 s[60:61]
  s_lshr_b32 s62, s2, 3
  v_lshl_add_u32 v2, s62, 9, v0
  v_lshrrev_b32 v2, 4, v2
  v_min_u32 v2, 545, v2
  v_lshlrev_b32 v2, 7, v2
  global_load_dword v31, v2, s[60:61]
  v_lshrrev_b32 v2, 6, v0
  v_and_b32 v1, 63, v0
  v_readfirstlane_b32 s56, v2
  s_and_b32 s57, s2, 7
  s_lshl_b32 s57, s57, 2
  s_lshr_b32 s60, s2, 3
  s_and_b32 s60, s60, 3
  s_add_u32 s57, s57, s60
  s_lshr_b32 s58, s2, 5
  s_and_b32 s59, s56, 3
  v_lshlrev_b32 v14, 4, v1
  s_lshl_b32 s77, s2, 3
  s_lshl_b32 s61, s59, 1
  s_add_u32 s77, s77, s61
  s_lshl_b32 s77, s77, 10
  s_cmp_ge_u32 s56, 4
  s_cbranch_scc0 LF0_K
  s_waitcnt lgkmcnt(0)
  s_mov_b32 s32, s4
  s_mov_b32 s33, s5
  s_mov_b32 s34, 0x200000
  s_mov_b32 s35, 0x20000
  buffer_load_dwordx4 v[128:131], v14, s[32:35], s77 offen offset:0
  buffer_load_dwordx4 v[144:147], v14, s[32:35], s77 offen offset:1024
  s_mov_b32 s36, s6
  s_mov_b32 s37, s7
  s_mov_b32 s38, 0x200000
  s_mov_b32 s39, 0x20000
  s_mov_b32 s40, s10
  s_mov_b32 s41, s11
  s_mov_b32 s42, 0x400000
  s_mov_b32 s43, 0x20000
  s_mov_b32 s48, s12
  s_mov_b32 s49, s13
  s_mov_b32 s50, 0x400000
  s_mov_b32 s51, 0x20000
  v_lshrrev_b32 v16, 2, v1
  v_and_b32 v17, 7, v16
  v_max_u32 v17, 1, v17
  v_and_b32 v16, 8, v16
  v_add_u32 v16, v16, v17
  v_lshlrev_b32 v16, 7, v16
  buffer_load_dword v31, v16, s[36:39], s77 offen
  s_branch LF0_V
LF0_K:
  s_and_b32 s62, s56, 1
  s_lshl_b32 s63, s62, 2
  v_and_b32 v20, 7, v1
  v_lshrrev_b32 v21, 4, v1
  v_xor_b32 v20, v20, v21
  v_xor_b32 v20, s63, v20
  v_lshlrev_b32 v20, 4, v20
  v_lshrrev_b32 v22, 3, v1
  v_lshl_add_u32 v2, v22, 10, v20
  s_lshl_b32 s63, s58, 18
  v_add_u32 v2, s63, v2
  s_lshr_b32 s63, s56, 1
  s_lshl_b32 s74, s63, 4
  s_add_u32 s74, s74, s62
  s_lshl_b32 s80, s74, 10
  s_lshl_b32 s64, s74, 13
  s_and_b32 s75, s57, 3
  s_lshl_b32 s75, s75, 15
  s_add_u32 s61, s75, 114688
  s_and_b32 s61, s61, 0x1ffff
  s_add_u32 s71, s64, s61
  s_add_u32 s61, s75, 98304
  s_and_b32 s61, s61, 0x1ffff
  s_add_u32 s70, s64, s61
  s_add_u32 s61, s75, 81920
  s_and_b32 s61, s61, 0x1ffff
  s_add_u32 s69, s64, s61
  s_add_u32 s61, s75, 65536
  s_and_b32 s61, s61, 0x1ffff
  s_add_u32 s68, s64, s61
  s_add_u32 s61, s75, 49152
  s_and_b32 s61, s61, 0x1ffff
  s_add_u32 s67, s64, s61
  s_add_u32 s61, s75, 32768
  s_and_b32 s61, s61, 0x1ffff
  s_add_u32 s66, s64, s61
  s_add_u32 s61, s75, 16384
  s_and_b32 s61, s61, 0x1ffff
  s_add_u32 s65, s64, s61
  s_add_u32 s61, s75, 0
  s_and_b32 s61, s61, 0x1ffff
  s_add_u32 s64, s64, s61
  s_lshl_b32 s74, s62, 3
  v_lshlrev_b32 v22, 1, v21
  v_and_b32 v20, 15, v1
  v_xor_b32 v20, v20, v22
  v_xor_b32 v20, s74, v20
  v_lshlrev_b32 v20, 4, v20
  v_lshl_add_u32 v3, v21, 13, v20
  s_lshl_b32 s74, s57, 8
  v_add_u32 v3, s74, v3
  s_lshl_b32 s63, s63, 3
  s_lshl_b32 s74, s62, 1
  s_add_u32 s63, s63, s74
  s_lshl_b32 s72, s63, 15
  s_xor_b32 s61, s58, 3
  s_and_b32 s75, s61, 1
  s_and_b32 s61, s61, 2
  s_lshl_b32 s61, s61, 1
  s_add_u32 s61, s61, s75
  s_lshl_b32 s61, s61, 15
  s_add_u32 s79, s72, s61
  s_xor_b32 s61, s58, 2
  s_and_b32 s75, s61, 1
  s_and_b32 s61, s61, 2
  s_lshl_b32 s61, s61, 1
  s_add_u32 s61, s61, s75
  s_lshl_b32 s61, s61, 15
  s_add_u32 s78, s72, s61
  s_xor_b32 s61, s58, 1
  s_and_b32 s75, s61, 1
  s_and_b32 s61, s61, 2
  s_lshl_b32 s61, s61, 1
  s_add_u32 s61, s61, s75
  s_lshl_b32 s61, s61, 15
  s_add_u32 s73, s72, s61
  s_xor_b32 s61, s58, 0
  s_and_b32 s75, s61, 1
  s_and_b32 s61, s61, 2
  s_lshl_b32 s61, s61, 1
  s_add_u32 s61, s61, s75
  s_lshl_b32 s61, s61, 15
  s_add_u32 s72, s72, s61
  s_and_b32 s61, s58, 4
  s_lshl_b32 s61, s61, 12
  s_add_u32 s81, s61, 65536
  s_xor_b32 s80, s81, 16384
  s_waitcnt lgkmcnt(0)
  s_mov_b32 s36, s6
  s_mov_b32 s37, s7
  s_mov_b32 s38, 0x200000
  s_mov_b32 s39, 0x20000
  s_mov_b32 s40, s10
  s_mov_b32 s41, s11
  s_mov_b32 s42, 0x400000
  s_mov_b32 s43, 0x20000
  s_mov_b32 s48, s12
  s_mov_b32 s49, s13
  s_mov_b32 s50, 0x400000
  s_mov_b32 s51, 0x20000
  s_cmp_ge_u32 s58, 4
  s_cselect_b64 s[40:41], s[12:13], s[10:11]
  s_cselect_b64 s[48:49], s[10:11], s[12:13]
  s_lshr_b32 m0, s64, 3
  s_nop 0
  buffer_load_dwordx4 v2, s[36:39], s64 offen lds
  s_lshr_b32 m0, s72, 5
  s_add_u32 m0, m0, s81
  s_nop 0
  buffer_load_dwordx4 v3, s[40:43], s72 offen lds
  s_lshr_b32 m0, s65, 3
  s_nop 0
  buffer_load_dwordx4 v2, s[36:39], s65 offen lds
  s_lshr_b32 m0, s73, 5
  s_add_u32 m0, m0, s81
  s_nop 0
  buffer_load_dwordx4 v3, s[40:43], s73 offen lds
  s_lshr_b32 m0, s66, 3
  s_nop 0
  buffer_load_dwordx4 v2, s[36:39], s66 offen lds
  s_lshr_b32 m0, s78, 5
  s_add_u32 m0, m0, s81
  s_nop 0
  buffer_load_dwordx4 v3, s[40:43], s78 offen lds
  s_lshr_b32 m0, s67, 3
  s_nop 0
  buffer_load_dwordx4 v2, s[36:39], s67 offen lds
  s_lshr_b32 m0, s79, 5
  s_add_u32 m0, m0, s81
  s_nop 0
  buffer_load_dwordx4 v3, s[40:43], s79 offen lds
  s_lshr_b32 m0, s68, 3
  s_nop 0
  buffer_load_dwordx4 v2, s[36:39], s68 offen lds
  s_lshr_b32 m0, s72, 5
  s_add_u32 m0, m0, s80
  s_nop 0
  buffer_load_dwordx4 v3, s[48:51], s72 offen lds
  s_lshr_b32 m0, s69, 3
  s_nop 0
  buffer_load_dwordx4 v2, s[36:39], s69 offen lds
  s_lshr_b32 m0, s73, 5
  s_add_u32 m0, m0, s80
  s_nop 0
  buffer_load_dwordx4 v3, s[48:51], s73 offen lds
  s_lshr_b32 m0, s70, 3
  s_nop 0
  buffer_load_dwordx4 v2, s[36:39], s70 offen lds
  s_lshr_b32 m0, s78, 5
  s_add_u32 m0, m0, s80
  s_nop 0
  buffer_load_dwordx4 v3, s[48:51], s78 offen lds
  s_lshr_b32 m0, s71, 3
  s_nop 0
  buffer_load_dwordx4 v2, s[36:39], s71 offen lds
  s_lshr_b32 m0, s79, 5
  s_add_u32 m0, m0, s80
  s_nop 0
  buffer_load_dwordx4 v3, s[48:51], s79 offen lds
  v_add_u32 v2, 128, v2
  s_xor_b32 s81, s81, 32768
  v_add_u32 v3, 0x80000, v3
  s_xor_b32 s80, s80, 32768
  s_branch LF1_K
LF0_V:
  v_lshrrev_b32 v2, 2, v1
  v_lshlrev_b32 v2, 10, v2
  s_and_b32 s62, s57, 3
  s_lshl_b32 s62, s62, 2
  s_add_u32 s62, s62, s59
  s_lshl_b32 s62, s62, 14
  s_lshl_b32 s63, s58, 18
  s_add_u32 s64, s62, s63
  v_and_b32 v3, 32, v1
  v_lshlrev_b32 v3, 8, v3
  v_and_b32 v20, 16, v1
  v_lshl_add_u32 v3, v20, 3, v3
  s_lshl_b32 s62, s58, 2
  s_add_u32 s62, s62, s59
  s_lshl_b32 s62, s62, 14
  s_lshl_b32 s63, s57, 8
  s_add_u32 s65, s62, s63
  s_sub_u32 s62, 15, s58
  s_cmp_lt_u32 s56, 4
  s_cselect_b32 s62, s58, s62
  s_lshl_b32 s62, s62, 2
  s_add_u32 s62, s62, s59
  s_lshl_b32 s76, s62, 5
  v_and_b32 v20, 15, v1
  v_lshrrev_b32 v21, 4, v1
  v_lshrrev_b32 v22, 1, v20
  v_xor_b32 v22, v22, v21
  v_lshlrev_b32 v22, 4, v22
  v_lshl_add_u32 v22, v20, 7, v22
  s_lshl_b32 s63, s59, 13
  v_add_u32 v4, s63, v22
  v_xor_b32 v5, 64, v4
  v_lshrrev_b32 v22, 2, v20
  v_and_b32 v23, 1, v21
  v_lshl_add_u32 v23, v23, 2, v22
  v_lshl_add_u32 v22, v21, 3, v22
  v_lshlrev_b32 v22, 8, v22
  v_and_b32 v24, 3, v1
  v_lshl_add_u32 v22, v24, 3, v22
  s_lshr_b32 s74, s56, 2
  s_lshl_b32 s74, s74, 14
  s_add_u32 s74, s74, 65536
  v_add_u32 v22, s74, v22
  v_xor_b32 v24, 0, v23
  v_lshl_add_u32 v6, v24, 5, v22
  v_xor_b32 v24, 1, v23
  v_lshl_add_u32 v7, v24, 5, v22
  v_xor_b32 v24, 2, v23
  v_lshl_add_u32 v8, v24, 5, v22
  v_xor_b32 v24, 3, v23
  v_lshl_add_u32 v9, v24, 5, v22
  v_xor_b32 v24, 4, v23
  v_lshl_add_u32 v10, v24, 5, v22
  v_xor_b32 v24, 5, v23
  v_lshl_add_u32 v11, v24, 5, v22
  v_xor_b32 v24, 6, v23
  v_lshl_add_u32 v12, v24, 5, v22
  v_xor_b32 v24, 7, v23
  v_lshl_add_u32 v13, v24, 5, v22
  s_mov_b32 s44, s30
  s_mov_b32 s45, s31
  s_mov_b32 s46, 0x2900000
  s_mov_b32 s47, 0x20000
  s_add_u32 s88, s30, 0x5900000
  s_addc_u32 s89, s31, 0
  s_mov_b32 s90, 0x40000
  s_mov_b32 s91, 0x20000
  s_lshl_b32 s60, s59, 5
  s_add_u32 s60, s60, 131072
  v_lshlrev_b32 v30, 7, v1
  v_add_u32 v30, s60, v30
  s_waitcnt vmcnt(2)
  v_lshlrev_b32 v132, 16, v128
  s_waitcnt vmcnt(1)
  v_lshlrev_b32 v148, 16, v144
  v_and_b32 v133, 0xffff0000, v128
  v_and_b32 v149, 0xffff0000, v144
  v_lshlrev_b32 v134, 16, v129
  v_lshlrev_b32 v150, 16, v145
  v_and_b32 v135, 0xffff0000, v129
  v_and_b32 v151, 0xffff0000, v145
  v_lshlrev_b32 v136, 16, v130
  v_lshlrev_b32 v152, 16, v146
  v_and_b32 v137, 0xffff0000, v130
  v_and_b32 v153, 0xffff0000, v146
  v_lshlrev_b32 v138, 16, v131
  v_lshlrev_b32 v154, 16, v147
  v_and_b32 v139, 0xffff0000, v131
  v_and_b32 v155, 0xffff0000, v147
  v_add_f32 v128, v132, v133
  v_add_f32 v144, v148, v149
  v_add_f32 v129, v134, v135
  v_add_f32 v145, v150, v151
  v_add_f32 v130, v136, v137
  v_add_f32 v146, v152, v153
  v_add_f32 v131, v138, v139
  v_add_f32 v147, v154, v155
  v_add_f32 v128, v128, v129
  v_add_f32 v144, v144, v145
  v_add_f32 v130, v130, v131
  v_add_f32 v146, v146, v147
  v_add_f32 v140, v128, v130
  v_add_f32 v156, v144, v146
  s_nop 0
  v_add_f32_dpp v140, v140, v140 row_ror:8 row_mask:0xf bank_mask:0xf
  v_add_f32_dpp v156, v156, v156 row_ror:8 row_mask:0xf bank_mask:0xf
  s_nop 0
  v_add_f32_dpp v140, v140, v140 row_ror:4 row_mask:0xf bank_mask:0xf
  v_add_f32_dpp v156, v156, v156 row_ror:4 row_mask:0xf bank_mask:0xf
  s_nop 0
  v_add_f32_dpp v140, v140, v140 row_ror:2 row_mask:0xf bank_mask:0xf
  v_add_f32_dpp v156, v156, v156 row_ror:2 row_mask:0xf bank_mask:0xf
  s_nop 0
  v_add_f32_dpp v140, v140, v140 row_ror:1 row_mask:0xf bank_mask:0xf
  v_add_f32_dpp v156, v156, v156 row_ror:1 row_mask:0xf bank_mask:0xf
  v_mov_b32 v141, v140
  v_mov_b32 v157, v156
  s_nop 0
  v_permlane16_swap_b32 v140, v141
  v_permlane16_swap_b32 v156, v157
  v_add_f32 v140, v140, v141
  v_add_f32 v156, v156, v157
  v_mov_b32 v141, v140
  v_mov_b32 v157, v156
  s_nop 0
  v_permlane32_swap_b32 v140, v141
  v_permlane32_swap_b32 v156, v157
  v_add_f32 v140, v140, v141
  v_add_f32 v156, v156, v157
  v_mul_f32 v140, 0x3b000000, v140
  v_mul_f32 v156, 0x3b000000, v156
  v_sub_f32 v128, v132, v140
  v_sub_f32 v144, v148, v156
  v_sub_f32 v129, v133, v140
  v_sub_f32 v145, v149, v156
  v_sub_f32 v130, v134, v140
  v_sub_f32 v146, v150, v156
  v_sub_f32 v131, v135, v140
  v_sub_f32 v147, v151, v156
  v_mul_f32 v142, v128, v128
  v_mul_f32 v158, v144, v144
  v_mul_f32 v143, v129, v129
  v_mul_f32 v159, v145, v145
  v_fmac_f32 v142, v130, v130
  v_fmac_f32 v158, v146, v146
  v_fmac_f32 v143, v131, v131
  v_fmac_f32 v159, v147, v147
  v_sub_f32 v128, v136, v140
  v_sub_f32 v144, v152, v156
  v_sub_f32 v129, v137, v140
  v_sub_f32 v145, v153, v156
  v_sub_f32 v130, v138, v140
  v_sub_f32 v146, v154, v156
  v_sub_f32 v131, v139, v140
  v_sub_f32 v147, v155, v156
  v_fmac_f32 v142, v128, v128
  v_fmac_f32 v158, v144, v144
  v_fmac_f32 v143, v129, v129
  v_fmac_f32 v159, v145, v145
  v_fmac_f32 v142, v130, v130
  v_fmac_f32 v158, v146, v146
  v_fmac_f32 v143, v131, v131
  v_fmac_f32 v159, v147, v147
  v_add_f32 v142, v142, v143
  v_add_f32 v158, v158, v159
  s_nop 0
  v_add_f32_dpp v142, v142, v142 row_ror:8 row_mask:0xf bank_mask:0xf
  v_add_f32_dpp v158, v158, v158 row_ror:8 row_mask:0xf bank_mask:0xf
  s_nop 0
  v_add_f32_dpp v142, v142, v142 row_ror:4 row_mask:0xf bank_mask:0xf
  v_add_f32_dpp v158, v158, v158 row_ror:4 row_mask:0xf bank_mask:0xf
  s_nop 0
  v_add_f32_dpp v142, v142, v142 row_ror:2 row_mask:0xf bank_mask:0xf
  v_add_f32_dpp v158, v158, v158 row_ror:2 row_mask:0xf bank_mask:0xf
  s_nop 0
  v_add_f32_dpp v142, v142, v142 row_ror:1 row_mask:0xf bank_mask:0xf
  v_add_f32_dpp v158, v158, v158 row_ror:1 row_mask:0xf bank_mask:0xf
  v_mov_b32 v141, v142
  v_mov_b32 v157, v158
  s_nop 0
  v_permlane16_swap_b32 v142, v141
  v_permlane16_swap_b32 v158, v157
  v_add_f32 v142, v142, v141
  v_add_f32 v158, v158, v157
  v_mov_b32 v141, v142
  v_mov_b32 v157, v158
  s_nop 0
  v_permlane32_swap_b32 v142, v141
  v_permlane32_swap_b32 v158, v157
  v_add_f32 v142, v142, v141
  v_add_f32 v158, v158, v157
  v_mul_f32 v142, 0x3b000000, v142
  v_mul_f32 v158, 0x3b000000, v158
  v_cvt_pk_bf16_f32 v140, v140, v140
  v_cvt_pk_bf16_f32 v156, v156, v156
  v_lshlrev_b32 v140, 16, v140
  v_lshlrev_b32 v156, 16, v156
  v_cvt_pk_bf16_f32 v142, v142, v142
  v_cvt_pk_bf16_f32 v158, v158, v158
  v_lshlrev_b32 v142, 16, v142
  v_lshlrev_b32 v158, 16, v158
  v_add_f32 v142, 0x3727c5ac, v142
  v_add_f32 v158, 0x3727c5ac, v158
  v_cvt_pk_bf16_f32 v142, v142, v142
  v_cvt_pk_bf16_f32 v158, v158, v158
  v_lshlrev_b32 v142, 16, v142
  v_lshlrev_b32 v158, 16, v158
  v_sqrt_f32 v142, v142
  v_sqrt_f32 v158, v158
  v_cvt_pk_bf16_f32 v142, v142, v142
  v_cvt_pk_bf16_f32 v158, v158, v158
  v_lshlrev_b32 v142, 16, v142
  v_lshlrev_b32 v158, 16, v158
  v_rcp_f32 v142, v142
  v_rcp_f32 v158, v158
  v_sub_f32 v132, v132, v140
  v_sub_f32 v148, v148, v156
  v_sub_f32 v133, v133, v140
  v_sub_f32 v149, v149, v156
  v_sub_f32 v134, v134, v140
  v_sub_f32 v150, v150, v156
  v_sub_f32 v135, v135, v140
  v_sub_f32 v151, v151, v156
  v_sub_f32 v136, v136, v140
  v_sub_f32 v152, v152, v156
  v_sub_f32 v137, v137, v140
  v_sub_f32 v153, v153, v156
  v_sub_f32 v138, v138, v140
  v_sub_f32 v154, v154, v156
  v_sub_f32 v139, v139, v140
  v_sub_f32 v155, v155, v156
  v_cvt_pk_bf16_f32 v128, v132, v133
  v_cvt_pk_bf16_f32 v144, v148, v149
  v_cvt_pk_bf16_f32 v129, v134, v135
  v_cvt_pk_bf16_f32 v145, v150, v151
  v_cvt_pk_bf16_f32 v130, v136, v137
  v_cvt_pk_bf16_f32 v146, v152, v153
  v_cvt_pk_bf16_f32 v131, v138, v139
  v_cvt_pk_bf16_f32 v147, v154, v155
  v_lshlrev_b32 v132, 16, v128
  v_lshlrev_b32 v148, 16, v144
  v_and_b32 v133, 0xffff0000, v128
  v_and_b32 v149, 0xffff0000, v144
  v_lshlrev_b32 v134, 16, v129
  v_lshlrev_b32 v150, 16, v145
  v_and_b32 v135, 0xffff0000, v129
  v_and_b32 v151, 0xffff0000, v145
  v_lshlrev_b32 v136, 16, v130
  v_lshlrev_b32 v152, 16, v146
  v_and_b32 v137, 0xffff0000, v130
  v_and_b32 v153, 0xffff0000, v146
  v_lshlrev_b32 v138, 16, v131
  v_lshlrev_b32 v154, 16, v147
  v_and_b32 v139, 0xffff0000, v131
  v_and_b32 v155, 0xffff0000, v147
  v_mul_f32 v132, v132, v142
  v_mul_f32 v148, v148, v158
  v_mul_f32 v133, v133, v142
  v_mul_f32 v149, v149, v158
  v_mul_f32 v134, v134, v142
  v_mul_f32 v150, v150, v158
  v_mul_f32 v135, v135, v142
  v_mul_f32 v151, v151, v158
  v_mul_f32 v136, v136, v142
  v_mul_f32 v152, v152, v158
  v_mul_f32 v137, v137, v142
  v_mul_f32 v153, v153, v158
  v_mul_f32 v138, v138, v142
  v_mul_f32 v154, v154, v158
  v_mul_f32 v139, v139, v142
  v_mul_f32 v155, v155, v158
  v_cvt_pk_bf16_f32 v128, v132, v133
  v_cvt_pk_bf16_f32 v144, v148, v149
  v_cvt_pk_bf16_f32 v129, v134, v135
  v_cvt_pk_bf16_f32 v145, v150, v151
  v_cvt_pk_bf16_f32 v130, v136, v137
  v_cvt_pk_bf16_f32 v146, v152, v153
  v_cvt_pk_bf16_f32 v131, v138, v139
  v_cvt_pk_bf16_f32 v147, v154, v155
  ds_write_b128 v30, v[128:131] offset:0
  ds_write_b128 v30, v[144:147] offset:16
  s_waitcnt lgkmcnt(0)
  s_barrier
  ds_read_b128 v[32:35], v4 offset:0
  ds_read_b128 v[36:39], v4 offset:2048
  ds_read_b128 v[40:43], v4 offset:4096
  ds_read_b128 v[44:47], v4 offset:6144
  ds_read_b64_tr_b16 v[48:49], v6 offset:0
  ds_read_b64_tr_b16 v[50:51], v6 offset:1024
  ds_read_b64_tr_b16 v[52:53], v7 offset:0
  ds_read_b64_tr_b16 v[54:55], v7 offset:1024
  ds_read_b64_tr_b16 v[56:57], v8 offset:0
  ds_read_b64_tr_b16 v[58:59], v8 offset:1024
  ds_read_b64_tr_b16 v[60:61], v9 offset:0
  ds_read_b64_tr_b16 v[62:63], v9 offset:1024
  ds_read_b64_tr_b16 v[64:65], v10 offset:0
  ds_read_b64_tr_b16 v[66:67], v10 offset:1024
  ds_read_b64_tr_b16 v[68:69], v11 offset:0
  ds_read_b64_tr_b16 v[70:71], v11 offset:1024
  ds_read_b64_tr_b16 v[72:73], v12 offset:0
  ds_read_b64_tr_b16 v[74:75], v12 offset:1024
  ds_read_b64_tr_b16 v[76:77], v13 offset:0
  ds_read_b64_tr_b16 v[78:79], v13 offset:1024
  s_waitcnt lgkmcnt(0)
  v_mfma_f32_16x16x32_bf16 v[128:131], v[32:35], v[48:51], 0
  ds_read_b128 v[80:83], v5 offset:0
  s_add_u32 s62, s64, 256
  buffer_load_dword v31, v2, s[36:39], s62 offen
  s_add_u32 s62, s65, 1048576
  buffer_load_dword v31, v3, s[40:43], s62 offen
  buffer_load_dword v31, v3, s[48:51], s62 offen
  v_min_u32 v24, 7, v1
  v_lshlrev_b32 v24, 7, v24
  v_mov_b32 v25, 0
  s_lshl_b32 s63, s2, 10
  s_cmp_eq_u32 s56, 4
  s_cselect_b32 s63, s63, 0x40000
  buffer_store_dword v25, v24, s[88:91], s63 offen sc1
  v_mfma_f32_16x16x32_bf16 v[132:135], v[36:39], v[48:51], 0
  ds_read_b128 v[84:87], v5 offset:2048
  v_mfma_f32_16x16x32_bf16 v[136:139], v[40:43], v[48:51], 0
  ds_read_b128 v[88:91], v5 offset:4096
  s_lshl_b32 s60, s56, 10
  v_mfma_f32_16x16x32_bf16 v[140:143], v[44:47], v[48:51], 0
  ds_read_b128 v[92:95], v5 offset:6144
  s_add_u32 s60, s60, 131072
  v_mfma_f32_16x16x32_bf16 v[156:159], v[44:47], v[52:55], 0
  v_add_u32 v20, s60, v14
  v_mfma_f32_16x16x32_bf16 v[152:155], v[40:43], v[52:55], 0
  ds_read_b64_tr_b16 v[96:97], v6 offset:8192
  ds_read_b128 v[16:19], v20
  v_mfma_f32_16x16x32_bf16 v[148:151], v[36:39], v[52:55], 0
  ds_read_b64_tr_b16 v[98:99], v6 offset:9216
  s_lshl_b32 s61, s2, 3
  v_mfma_f32_16x16x32_bf16 v[144:147], v[32:35], v[52:55], 0
  ds_read_b64_tr_b16 v[100:101], v7 offset:8192
  s_add_u32 s61, s61, s56
  v_mfma_f32_16x16x32_bf16 v[160:163], v[32:35], v[56:59], 0
  ds_read_b64_tr_b16 v[102:103], v7 offset:9216
  s_lshl_b32 s61, s61, 10
  v_mfma_f32_16x16x32_bf16 v[164:167], v[36:39], v[56:59], 0
  v_mfma_f32_16x16x32_bf16 v[168:171], v[40:43], v[56:59], 0
  ds_read_b64_tr_b16 v[104:105], v8 offset:8192
  s_add_u32 s62, s64, 384
  v_mfma_f32_16x16x32_bf16 v[172:175], v[44:47], v[56:59], 0
  ds_read_b64_tr_b16 v[106:107], v8 offset:9216
  v_mfma_f32_16x16x32_bf16 v[188:191], v[44:47], v[60:63], 0
  ds_read_b64_tr_b16 v[108:109], v9 offset:8192
  v_mfma_f32_16x16x32_bf16 v[184:187], v[40:43], v[60:63], 0
  ds_read_b64_tr_b16 v[110:111], v9 offset:9216
  v_mfma_f32_16x16x32_bf16 v[180:183], v[36:39], v[60:63], 0
  buffer_load_dword v31, v2, s[36:39], s62 offen
  s_waitcnt lgkmcnt(7)
  buffer_store_dwordx4 v[16:19], v14, s[44:47], s61 offen sc1
  v_mfma_f32_16x16x32_bf16 v[176:179], v[32:35], v[60:63], 0
  ds_read_b64_tr_b16 v[112:113], v10 offset:8192
  v_mfma_f32_16x16x32_bf16 v[192:195], v[32:35], v[64:67], 0
  ds_read_b64_tr_b16 v[114:115], v10 offset:9216
  v_mfma_f32_16x16x32_bf16 v[196:199], v[36:39], v[64:67], 0
  ds_read_b64_tr_b16 v[116:117], v11 offset:8192
  v_mfma_f32_16x16x32_bf16 v[200:203], v[40:43], v[64:67], 0
  ds_read_b64_tr_b16 v[118:119], v11 offset:9216
  s_add_u32 s62, s65, 1572864
  v_mfma_f32_16x16x32_bf16 v[204:207], v[44:47], v[64:67], 0
  v_mfma_f32_16x16x32_bf16 v[220:223], v[44:47], v[68:71], 0
  ds_read_b64_tr_b16 v[120:121], v12 offset:8192
  v_mfma_f32_16x16x32_bf16 v[216:219], v[40:43], v[68:71], 0
  ds_read_b64_tr_b16 v[122:123], v12 offset:9216
  v_mfma_f32_16x16x32_bf16 v[212:215], v[36:39], v[68:71], 0
  ds_read_b64_tr_b16 v[124:125], v13 offset:8192
  v_mfma_f32_16x16x32_bf16 v[208:211], v[32:35], v[68:71], 0
  ds_read_b64_tr_b16 v[126:127], v13 offset:9216
  buffer_load_dword v31, v3, s[40:43], s62 offen
  v_mfma_f32_16x16x32_bf16 v[224:227], v[32:35], v[72:75], 0
  v_mfma_f32_16x16x32_bf16 v[228:231], v[36:39], v[72:75], 0
  v_mfma_f32_16x16x32_bf16 v[232:235], v[40:43], v[72:75], 0
  v_mfma_f32_16x16x32_bf16 v[236:239], v[44:47], v[72:75], 0
  buffer_load_dword v31, v3, s[48:51], s62 offen
  v_mfma_f32_16x16x32_bf16 v[252:255], v[44:47], v[76:79], 0
  v_mfma_f32_16x16x32_bf16 v[248:251], v[40:43], v[76:79], 0
  v_mfma_f32_16x16x32_bf16 v[244:247], v[36:39], v[76:79], 0
  v_mfma_f32_16x16x32_bf16 v[240:243], v[32:35], v[76:79], 0
  s_waitcnt lgkmcnt(0)
  s_barrier
  v_mfma_f32_16x16x32_bf16 v[128:131], v[80:83], v[96:99], v[128:131]
  ds_read_b128 v[32:35], v4 offset:32768
  v_mfma_f32_16x16x32_bf16 v[132:135], v[84:87], v[96:99], v[132:135]
  ds_read_b128 v[36:39], v4 offset:34816
  v_mfma_f32_16x16x32_bf16 v[136:139], v[88:91], v[96:99], v[136:139]
  ds_read_b128 v[40:43], v4 offset:36864
  v_mfma_f32_16x16x32_bf16 v[140:143], v[92:95], v[96:99], v[140:143]
  ds_read_b128 v[44:47], v4 offset:38912
  v_mfma_f32_16x16x32_bf16 v[156:159], v[92:95], v[100:103], v[156:159]
  v_mfma_f32_16x16x32_bf16 v[152:155], v[88:91], v[100:103], v[152:155]
  ds_read_b64_tr_b16 v[48:49], v6 offset:32768
  v_mfma_f32_16x16x32_bf16 v[148:151], v[84:87], v[100:103], v[148:151]
  ds_read_b64_tr_b16 v[50:51], v6 offset:33792
  v_mfma_f32_16x16x32_bf16 v[144:147], v[80:83], v[100:103], v[144:147]
  ds_read_b64_tr_b16 v[52:53], v7 offset:32768
  v_mfma_f32_16x16x32_bf16 v[160:163], v[80:83], v[104:107], v[160:163]
  ds_read_b64_tr_b16 v[54:55], v7 offset:33792
  v_mfma_f32_16x16x32_bf16 v[164:167], v[84:87], v[104:107], v[164:167]
  v_mfma_f32_16x16x32_bf16 v[168:171], v[88:91], v[104:107], v[168:171]
  ds_read_b64_tr_b16 v[56:57], v8 offset:32768
  v_mfma_f32_16x16x32_bf16 v[172:175], v[92:95], v[104:107], v[172:175]
  ds_read_b64_tr_b16 v[58:59], v8 offset:33792
  v_mfma_f32_16x16x32_bf16 v[188:191], v[92:95], v[108:111], v[188:191]
  ds_read_b64_tr_b16 v[60:61], v9 offset:32768
  v_mfma_f32_16x16x32_bf16 v[184:187], v[88:91], v[108:111], v[184:187]
  ds_read_b64_tr_b16 v[62:63], v9 offset:33792
  v_mfma_f32_16x16x32_bf16 v[180:183], v[84:87], v[108:111], v[180:183]
  v_mfma_f32_16x16x32_bf16 v[176:179], v[80:83], v[108:111], v[176:179]
  ds_read_b64_tr_b16 v[64:65], v10 offset:32768
  v_mfma_f32_16x16x32_bf16 v[192:195], v[80:83], v[112:115], v[192:195]
  ds_read_b64_tr_b16 v[66:67], v10 offset:33792
  v_mfma_f32_16x16x32_bf16 v[196:199], v[84:87], v[112:115], v[196:199]
  ds_read_b64_tr_b16 v[68:69], v11 offset:32768
  v_mfma_f32_16x16x32_bf16 v[200:203], v[88:91], v[112:115], v[200:203]
  ds_read_b64_tr_b16 v[70:71], v11 offset:33792
  v_mfma_f32_16x16x32_bf16 v[204:207], v[92:95], v[112:115], v[204:207]
  v_mfma_f32_16x16x32_bf16 v[220:223], v[92:95], v[116:119], v[220:223]
  ds_read_b64_tr_b16 v[72:73], v12 offset:32768
  v_mfma_f32_16x16x32_bf16 v[216:219], v[88:91], v[116:119], v[216:219]
  ds_read_b64_tr_b16 v[74:75], v12 offset:33792
  v_mfma_f32_16x16x32_bf16 v[212:215], v[84:87], v[116:119], v[212:215]
  ds_read_b64_tr_b16 v[76:77], v13 offset:32768
  v_mfma_f32_16x16x32_bf16 v[208:211], v[80:83], v[116:119], v[208:211]
  ds_read_b64_tr_b16 v[78:79], v13 offset:33792
  v_mfma_f32_16x16x32_bf16 v[224:227], v[80:83], v[120:123], v[224:227]
  v_mfma_f32_16x16x32_bf16 v[228:231], v[84:87], v[120:123], v[228:231]
  v_mfma_f32_16x16x32_bf16 v[232:235], v[88:91], v[120:123], v[232:235]
  v_mfma_f32_16x16x32_bf16 v[236:239], v[92:95], v[120:123], v[236:239]
  v_mfma_f32_16x16x32_bf16 v[252:255], v[92:95], v[124:127], v[252:255]
  v_mfma_f32_16x16x32_bf16 v[248:251], v[88:91], v[124:127], v[248:251]
  v_mfma_f32_16x16x32_bf16 v[244:247], v[84:87], v[124:127], v[244:247]
  v_mfma_f32_16x16x32_bf16 v[240:243], v[80:83], v[124:127], v[240:243]
  s_waitcnt lgkmcnt(0)
  v_mfma_f32_16x16x32_bf16 v[128:131], v[32:35], v[48:51], v[128:131]
  ds_read_b128 v[80:83], v5 offset:32768
  v_mfma_f32_16x16x32_bf16 v[132:135], v[36:39], v[48:51], v[132:135]
  ds_read_b128 v[84:87], v5 offset:34816
  v_mfma_f32_16x16x32_bf16 v[136:139], v[40:43], v[48:51], v[136:139]
  ds_read_b128 v[88:91], v5 offset:36864
  v_mfma_f32_16x16x32_bf16 v[140:143], v[44:47], v[48:51], v[140:143]
  ds_read_b128 v[92:95], v5 offset:38912
  v_mfma_f32_16x16x32_bf16 v[156:159], v[44:47], v[52:55], v[156:159]
  v_mfma_f32_16x16x32_bf16 v[152:155], v[40:43], v[52:55], v[152:155]
  ds_read_b64_tr_b16 v[96:97], v6 offset:40960
  v_mfma_f32_16x16x32_bf16 v[148:151], v[36:39], v[52:55], v[148:151]
  ds_read_b64_tr_b16 v[98:99], v6 offset:41984
  v_mfma_f32_16x16x32_bf16 v[144:147], v[32:35], v[52:55], v[144:147]
  ds_read_b64_tr_b16 v[100:101], v7 offset:40960
  v_mfma_f32_16x16x32_bf16 v[160:163], v[32:35], v[56:59], v[160:163]
  ds_read_b64_tr_b16 v[102:103], v7 offset:41984
  v_mfma_f32_16x16x32_bf16 v[164:167], v[36:39], v[56:59], v[164:167]
  v_mfma_f32_16x16x32_bf16 v[168:171], v[40:43], v[56:59], v[168:171]
  ds_read_b64_tr_b16 v[104:105], v8 offset:40960
  s_add_u32 s62, s64, 512
  v_mfma_f32_16x16x32_bf16 v[172:175], v[44:47], v[56:59], v[172:175]
  ds_read_b64_tr_b16 v[106:107], v8 offset:41984
  buffer_load_dword v31, v2, s[36:39], s62 offen
  v_mfma_f32_16x16x32_bf16 v[188:191], v[44:47], v[60:63], v[188:191]
  ds_read_b64_tr_b16 v[108:109], v9 offset:40960
  s_add_u32 s62, s65, 2097152
  v_mfma_f32_16x16x32_bf16 v[184:187], v[40:43], v[60:63], v[184:187]
  ds_read_b64_tr_b16 v[110:111], v9 offset:41984
  buffer_load_dword v31, v3, s[40:43], s62 offen
  v_mfma_f32_16x16x32_bf16 v[180:183], v[36:39], v[60:63], v[180:183]
  buffer_load_dword v31, v3, s[48:51], s62 offen
  v_mfma_f32_16x16x32_bf16 v[176:179], v[32:35], v[60:63], v[176:179]
  ds_read_b64_tr_b16 v[112:113], v10 offset:40960
  s_mov_b32 s32, s8
  v_mfma_f32_16x16x32_bf16 v[192:195], v[32:35], v[64:67], v[192:195]
  ds_read_b64_tr_b16 v[114:115], v10 offset:41984
  s_mov_b32 s33, s9
  v_mfma_f32_16x16x32_bf16 v[196:199], v[36:39], v[64:67], v[196:199]
  ds_read_b64_tr_b16 v[116:117], v11 offset:40960
  v_mfma_f32_16x16x32_bf16 v[200:203], v[40:43], v[64:67], v[200:203]
  ds_read_b64_tr_b16 v[118:119], v11 offset:41984
  s_mov_b32 s34, 0x400000
  v_mfma_f32_16x16x32_bf16 v[204:207], v[44:47], v[64:67], v[204:207]
  s_mov_b32 s35, 0x20000
  v_mfma_f32_16x16x32_bf16 v[220:223], v[44:47], v[68:71], v[220:223]
  ds_read_b64_tr_b16 v[120:121], v12 offset:40960
  v_lshrrev_b32 v21, 2, v1
  v_mfma_f32_16x16x32_bf16 v[216:219], v[40:43], v[68:71], v[216:219]
  ds_read_b64_tr_b16 v[122:123], v12 offset:41984
  v_lshlrev_b32 v21, 13, v21
  v_mfma_f32_16x16x32_bf16 v[212:215], v[36:39], v[68:71], v[212:215]
  ds_read_b64_tr_b16 v[124:125], v13 offset:40960
  v_and_b32 v20, 2, v1
  v_mfma_f32_16x16x32_bf16 v[208:211], v[32:35], v[68:71], v[208:211]
  ds_read_b64_tr_b16 v[126:127], v13 offset:41984
  v_lshl_add_u32 v20, v20, 6, v21
  v_mfma_f32_16x16x32_bf16 v[224:227], v[32:35], v[72:75], v[224:227]
  v_mfma_f32_16x16x32_bf16 v[228:231], v[36:39], v[72:75], v[228:231]
  s_lshl_b32 s62, s58, 19
  v_mfma_f32_16x16x32_bf16 v[232:235], v[40:43], v[72:75], v[232:235]
  s_lshl_b32 s63, s59, 17
  v_mfma_f32_16x16x32_bf16 v[236:239], v[44:47], v[72:75], v[236:239]
  s_add_u32 s62, s62, s63
  v_mfma_f32_16x16x32_bf16 v[252:255], v[44:47], v[76:79], v[252:255]
  s_lshl_b32 s63, s57, 8
  v_mfma_f32_16x16x32_bf16 v[248:251], v[40:43], v[76:79], v[248:251]
  s_add_u32 s62, s62, s63
  v_mfma_f32_16x16x32_bf16 v[244:247], v[36:39], v[76:79], v[244:247]
  buffer_load_dword v31, v20, s[32:35], s62 offen
  v_mfma_f32_16x16x32_bf16 v[240:243], v[32:35], v[76:79], v[240:243]
  s_waitcnt lgkmcnt(0)
  s_barrier
  v_mfma_f32_16x16x32_bf16 v[128:131], v[80:83], v[96:99], v[128:131]
  ds_read_b128 v[32:35], v4 offset:0
  v_mfma_f32_16x16x32_bf16 v[132:135], v[84:87], v[96:99], v[132:135]
  ds_read_b128 v[36:39], v4 offset:2048
  v_mfma_f32_16x16x32_bf16 v[136:139], v[88:91], v[96:99], v[136:139]
  ds_read_b128 v[40:43], v4 offset:4096
  v_mfma_f32_16x16x32_bf16 v[140:143], v[92:95], v[96:99], v[140:143]
  ds_read_b128 v[44:47], v4 offset:6144
  v_mfma_f32_16x16x32_bf16 v[156:159], v[92:95], v[100:103], v[156:159]
  v_mfma_f32_16x16x32_bf16 v[152:155], v[88:91], v[100:103], v[152:155]
  ds_read_b64_tr_b16 v[48:49], v6 offset:0
  v_mfma_f32_16x16x32_bf16 v[148:151], v[84:87], v[100:103], v[148:151]
  ds_read_b64_tr_b16 v[50:51], v6 offset:1024
  v_mfma_f32_16x16x32_bf16 v[144:147], v[80:83], v[100:103], v[144:147]
  ds_read_b64_tr_b16 v[52:53], v7 offset:0
  v_mfma_f32_16x16x32_bf16 v[160:163], v[80:83], v[104:107], v[160:163]
  ds_read_b64_tr_b16 v[54:55], v7 offset:1024
  v_mfma_f32_16x16x32_bf16 v[164:167], v[84:87], v[104:107], v[164:167]
  v_mfma_f32_16x16x32_bf16 v[168:171], v[88:91], v[104:107], v[168:171]
  ds_read_b64_tr_b16 v[56:57], v8 offset:0
  v_mfma_f32_16x16x32_bf16 v[172:175], v[92:95], v[104:107], v[172:175]
  ds_read_b64_tr_b16 v[58:59], v8 offset:1024
  v_mfma_f32_16x16x32_bf16 v[188:191], v[92:95], v[108:111], v[188:191]
  ds_read_b64_tr_b16 v[60:61], v9 offset:0
  v_mfma_f32_16x16x32_bf16 v[184:187], v[88:91], v[108:111], v[184:187]
  ds_read_b64_tr_b16 v[62:63], v9 offset:1024
  v_mfma_f32_16x16x32_bf16 v[180:183], v[84:87], v[108:111], v[180:183]
  v_mfma_f32_16x16x32_bf16 v[176:179], v[80:83], v[108:111], v[176:179]
  ds_read_b64_tr_b16 v[64:65], v10 offset:0
  v_mfma_f32_16x16x32_bf16 v[192:195], v[80:83], v[112:115], v[192:195]
  ds_read_b64_tr_b16 v[66:67], v10 offset:1024
  v_mfma_f32_16x16x32_bf16 v[196:199], v[84:87], v[112:115], v[196:199]
  ds_read_b64_tr_b16 v[68:69], v11 offset:0
  v_mfma_f32_16x16x32_bf16 v[200:203], v[88:91], v[112:115], v[200:203]
  ds_read_b64_tr_b16 v[70:71], v11 offset:1024
  v_mfma_f32_16x16x32_bf16 v[204:207], v[92:95], v[112:115], v[204:207]
  v_mfma_f32_16x16x32_bf16 v[220:223], v[92:95], v[116:119], v[220:223]
  ds_read_b64_tr_b16 v[72:73], v12 offset:0
  v_mfma_f32_16x16x32_bf16 v[216:219], v[88:91], v[116:119], v[216:219]
  ds_read_b64_tr_b16 v[74:75], v12 offset:1024
  v_mfma_f32_16x16x32_bf16 v[212:215], v[84:87], v[116:119], v[212:215]
  ds_read_b64_tr_b16 v[76:77], v13 offset:0
  v_mfma_f32_16x16x32_bf16 v[208:211], v[80:83], v[116:119], v[208:211]
  ds_read_b64_tr_b16 v[78:79], v13 offset:1024
  v_mfma_f32_16x16x32_bf16 v[224:227], v[80:83], v[120:123], v[224:227]
  v_mfma_f32_16x16x32_bf16 v[228:231], v[84:87], v[120:123], v[228:231]
  v_mfma_f32_16x16x32_bf16 v[232:235], v[88:91], v[120:123], v[232:235]
  v_mfma_f32_16x16x32_bf16 v[236:239], v[92:95], v[120:123], v[236:239]
  v_mfma_f32_16x16x32_bf16 v[252:255], v[92:95], v[124:127], v[252:255]
  v_mfma_f32_16x16x32_bf16 v[248:251], v[88:91], v[124:127], v[248:251]
  v_mfma_f32_16x16x32_bf16 v[244:247], v[84:87], v[124:127], v[244:247]
  v_mfma_f32_16x16x32_bf16 v[240:243], v[80:83], v[124:127], v[240:243]
  s_waitcnt lgkmcnt(0)
  v_mfma_f32_16x16x32_bf16 v[128:131], v[32:35], v[48:51], v[128:131]
  ds_read_b128 v[80:83], v5 offset:0
  v_mfma_f32_16x16x32_bf16 v[132:135], v[36:39], v[48:51], v[132:135]
  ds_read_b128 v[84:87], v5 offset:2048
  v_mfma_f32_16x16x32_bf16 v[136:139], v[40:43], v[48:51], v[136:139]
  ds_read_b128 v[88:91], v5 offset:4096
  v_mfma_f32_16x16x32_bf16 v[140:143], v[44:47], v[48:51], v[140:143]
  ds_read_b128 v[92:95], v5 offset:6144
  v_mfma_f32_16x16x32_bf16 v[156:159], v[44:47], v[52:55], v[156:159]
  v_mfma_f32_16x16x32_bf16 v[152:155], v[40:43], v[52:55], v[152:155]
  ds_read_b64_tr_b16 v[96:97], v6 offset:8192
  v_mfma_f32_16x16x32_bf16 v[148:151], v[36:39], v[52:55], v[148:151]
  ds_read_b64_tr_b16 v[98:99], v6 offset:9216
  v_mfma_f32_16x16x32_bf16 v[144:147], v[32:35], v[52:55], v[144:147]
  ds_read_b64_tr_b16 v[100:101], v7 offset:8192
  v_mfma_f32_16x16x32_bf16 v[160:163], v[32:35], v[56:59], v[160:163]
  ds_read_b64_tr_b16 v[102:103], v7 offset:9216
  v_mfma_f32_16x16x32_bf16 v[164:167], v[36:39], v[56:59], v[164:167]
  v_mfma_f32_16x16x32_bf16 v[168:171], v[40:43], v[56:59], v[168:171]
  ds_read_b64_tr_b16 v[104:105], v8 offset:8192
  s_add_u32 s62, s64, 640
  v_mfma_f32_16x16x32_bf16 v[172:175], v[44:47], v[56:59], v[172:175]
  ds_read_b64_tr_b16 v[106:107], v8 offset:9216
  buffer_load_dword v31, v2, s[36:39], s62 offen
  v_mfma_f32_16x16x32_bf16 v[188:191], v[44:47], v[60:63], v[188:191]
  ds_read_b64_tr_b16 v[108:109], v9 offset:8192
  s_add_u32 s62, s65, 2621440
  v_mfma_f32_16x16x32_bf16 v[184:187], v[40:43], v[60:63], v[184:187]
  ds_read_b64_tr_b16 v[110:111], v9 offset:9216
  buffer_load_dword v31, v3, s[40:43], s62 offen
  v_mfma_f32_16x16x32_bf16 v[180:183], v[36:39], v[60:63], v[180:183]
  buffer_load_dword v31, v3, s[48:51], s62 offen
  v_mfma_f32_16x16x32_bf16 v[176:179], v[32:35], v[60:63], v[176:179]
  ds_read_b64_tr_b16 v[112:113], v10 offset:8192
  s_mov_b32 s32, s18
  v_mfma_f32_16x16x32_bf16 v[192:195], v[32:35], v[64:67], v[192:195]
  ds_read_b64_tr_b16 v[114:115], v10 offset:9216
  s_mov_b32 s33, s19
  v_mfma_f32_16x16x32_bf16 v[196:199], v[36:39], v[64:67], v[196:199]
  ds_read_b64_tr_b16 v[116:117], v11 offset:8192
  s_mov_b32 s34, 0x1c0000
  v_mfma_f32_16x16x32_bf16 v[200:203], v[40:43], v[64:67], v[200:203]
  ds_read_b64_tr_b16 v[118:119], v11 offset:9216
  s_mov_b32 s35, 0x20000
  v_mfma_f32_16x16x32_bf16 v[204:207], v[44:47], v[64:67], v[204:207]
  v_lshrrev_b32 v20, 2, v1
  v_mfma_f32_16x16x32_bf16 v[220:223], v[44:47], v[68:71], v[220:223]
  ds_read_b64_tr_b16 v[120:121], v12 offset:8192
  v_mul_u32_u24 v20, 3584, v20
  v_mfma_f32_16x16x32_bf16 v[216:219], v[40:43], v[68:71], v[216:219]
  ds_read_b64_tr_b16 v[122:123], v12 offset:9216
  s_lshl_b32 s62, s58, 2
  v_mfma_f32_16x16x32_bf16 v[212:215], v[36:39], v[68:71], v[212:215]
  ds_read_b64_tr_b16 v[124:125], v13 offset:8192
  s_add_u32 s62, s62, s59
  v_mfma_f32_16x16x32_bf16 v[208:211], v[32:35], v[68:71], v[208:211]
  ds_read_b64_tr_b16 v[126:127], v13 offset:9216
  s_mul_i32 s62, s62, 57344
  v_mfma_f32_16x16x32_bf16 v[224:227], v[32:35], v[72:75], v[224:227]
  s_lshl_b32 s63, s57, 7
  v_mfma_f32_16x16x32_bf16 v[228:231], v[36:39], v[72:75], v[228:231]
  s_add_u32 s62, s62, s63
  v_mfma_f32_16x16x32_bf16 v[232:235], v[40:43], v[72:75], v[232:235]
  buffer_load_dword v31, v20, s[32:35], s62 offen
  v_mfma_f32_16x16x32_bf16 v[236:239], v[44:47], v[72:75], v[236:239]
  s_mov_b32 s32, s20
  v_mfma_f32_16x16x32_bf16 v[252:255], v[44:47], v[76:79], v[252:255]
  s_mov_b32 s33, s21
  v_mfma_f32_16x16x32_bf16 v[248:251], v[40:43], v[76:79], v[248:251]
  s_mov_b32 s34, 0xe00
  v_mfma_f32_16x16x32_bf16 v[244:247], v[36:39], v[76:79], v[244:247]
  s_mov_b32 s35, 0x20000
  v_mfma_f32_16x16x32_bf16 v[240:243], v[32:35], v[76:79], v[240:243]
  buffer_load_dword v31, off, s[32:35], s63
  s_waitcnt vmcnt(11) lgkmcnt(0)
  s_barrier
  v_mfma_f32_16x16x32_bf16 v[128:131], v[80:83], v[96:99], v[128:131]
  ds_read_b128 v[32:35], v4 offset:32768
  s_mov_b32 s84, s28
  s_mov_b32 s85, s29
  s_mov_b32 s86, 0x80
  s_mov_b32 s87, 0x20000
  s_cmp_eq_u32 s56, 4
  s_cselect_b32 s86, s86, 0
  s_and_b32 s60, s2, 15
  s_lshl_b32 s60, s60, 2
  v_mov_b32 v22, 1
  s_mov_b64 exec, 1
  buffer_atomic_add v22, off, s[84:87], s60 sc1
  s_mov_b64 exec, -1
  v_mfma_f32_16x16x32_bf16 v[132:135], v[84:87], v[96:99], v[132:135]
  ds_read_b128 v[36:39], v4 offset:34816
  v_mfma_f32_16x16x32_bf16 v[136:139], v[88:91], v[96:99], v[136:139]
  ds_read_b128 v[40:43], v4 offset:36864
  v_mfma_f32_16x16x32_bf16 v[140:143], v[92:95], v[96:99], v[140:143]
  ds_read_b128 v[44:47], v4 offset:38912
  v_mfma_f32_16x16x32_bf16 v[156:159], v[92:95], v[100:103], v[156:159]
  v_mfma_f32_16x16x32_bf16 v[152:155], v[88:91], v[100:103], v[152:155]
  ds_read_b64_tr_b16 v[48:49], v6 offset:32768
  v_mfma_f32_16x16x32_bf16 v[148:151], v[84:87], v[100:103], v[148:151]
  ds_read_b64_tr_b16 v[50:51], v6 offset:33792
  v_mfma_f32_16x16x32_bf16 v[144:147], v[80:83], v[100:103], v[144:147]
  ds_read_b64_tr_b16 v[52:53], v7 offset:32768
  v_mfma_f32_16x16x32_bf16 v[160:163], v[80:83], v[104:107], v[160:163]
  ds_read_b64_tr_b16 v[54:55], v7 offset:33792
  v_mfma_f32_16x16x32_bf16 v[164:167], v[84:87], v[104:107], v[164:167]
  v_mfma_f32_16x16x32_bf16 v[168:171], v[88:91], v[104:107], v[168:171]
  ds_read_b64_tr_b16 v[56:57], v8 offset:32768
  v_mfma_f32_16x16x32_bf16 v[172:175], v[92:95], v[104:107], v[172:175]
  ds_read_b64_tr_b16 v[58:59], v8 offset:33792
  v_mfma_f32_16x16x32_bf16 v[188:191], v[92:95], v[108:111], v[188:191]
  ds_read_b64_tr_b16 v[60:61], v9 offset:32768
  v_mfma_f32_16x16x32_bf16 v[184:187], v[88:91], v[108:111], v[184:187]
  ds_read_b64_tr_b16 v[62:63], v9 offset:33792
  v_mfma_f32_16x16x32_bf16 v[180:183], v[84:87], v[108:111], v[180:183]
  v_mfma_f32_16x16x32_bf16 v[176:179], v[80:83], v[108:111], v[176:179]
  ds_read_b64_tr_b16 v[64:65], v10 offset:32768
  v_mfma_f32_16x16x32_bf16 v[192:195], v[80:83], v[112:115], v[192:195]
  ds_read_b64_tr_b16 v[66:67], v10 offset:33792
  v_mfma_f32_16x16x32_bf16 v[196:199], v[84:87], v[112:115], v[196:199]
  ds_read_b64_tr_b16 v[68:69], v11 offset:32768
  v_mfma_f32_16x16x32_bf16 v[200:203], v[88:91], v[112:115], v[200:203]
  ds_read_b64_tr_b16 v[70:71], v11 offset:33792
  v_mfma_f32_16x16x32_bf16 v[204:207], v[92:95], v[112:115], v[204:207]
  v_mfma_f32_16x16x32_bf16 v[220:223], v[92:95], v[116:119], v[220:223]
  ds_read_b64_tr_b16 v[72:73], v12 offset:32768
  v_mfma_f32_16x16x32_bf16 v[216:219], v[88:91], v[116:119], v[216:219]
  ds_read_b64_tr_b16 v[74:75], v12 offset:33792
  v_mfma_f32_16x16x32_bf16 v[212:215], v[84:87], v[116:119], v[212:215]
  ds_read_b64_tr_b16 v[76:77], v13 offset:32768
  v_mfma_f32_16x16x32_bf16 v[208:211], v[80:83], v[116:119], v[208:211]
  ds_read_b64_tr_b16 v[78:79], v13 offset:33792
  v_mfma_f32_16x16x32_bf16 v[224:227], v[80:83], v[120:123], v[224:227]
  v_mfma_f32_16x16x32_bf16 v[228:231], v[84:87], v[120:123], v[228:231]
  v_mfma_f32_16x16x32_bf16 v[232:235], v[88:91], v[120:123], v[232:235]
  v_mfma_f32_16x16x32_bf16 v[236:239], v[92:95], v[120:123], v[236:239]
  v_mfma_f32_16x16x32_bf16 v[252:255], v[92:95], v[124:127], v[252:255]
  v_mfma_f32_16x16x32_bf16 v[248:251], v[88:91], v[124:127], v[248:251]
  v_mfma_f32_16x16x32_bf16 v[244:247], v[84:87], v[124:127], v[244:247]
  v_mfma_f32_16x16x32_bf16 v[240:243], v[80:83], v[124:127], v[240:243]
  s_waitcnt lgkmcnt(0)
  v_mfma_f32_16x16x32_bf16 v[128:131], v[32:35], v[48:51], v[128:131]
  ds_read_b128 v[80:83], v5 offset:32768
  v_mfma_f32_16x16x32_bf16 v[132:135], v[36:39], v[48:51], v[132:135]
  ds_read_b128 v[84:87], v5 offset:34816
  v_mfma_f32_16x16x32_bf16 v[136:139], v[40:43], v[48:51], v[136:139]
  ds_read_b128 v[88:91], v5 offset:36864
  v_mfma_f32_16x16x32_bf16 v[140:143], v[44:47], v[48:51], v[140:143]
  ds_read_b128 v[92:95], v5 offset:38912
  v_mfma_f32_16x16x32_bf16 v[156:159], v[44:47], v[52:55], v[156:159]
  v_mfma_f32_16x16x32_bf16 v[152:155], v[40:43], v[52:55], v[152:155]
  ds_read_b64_tr_b16 v[96:97], v6 offset:40960
  v_mfma_f32_16x16x32_bf16 v[148:151], v[36:39], v[52:55], v[148:151]
  ds_read_b64_tr_b16 v[98:99], v6 offset:41984
  v_mfma_f32_16x16x32_bf16 v[144:147], v[32:35], v[52:55], v[144:147]
  ds_read_b64_tr_b16 v[100:101], v7 offset:40960
  v_mfma_f32_16x16x32_bf16 v[160:163], v[32:35], v[56:59], v[160:163]
  ds_read_b64_tr_b16 v[102:103], v7 offset:41984
  v_mfma_f32_16x16x32_bf16 v[164:167], v[36:39], v[56:59], v[164:167]
  v_mfma_f32_16x16x32_bf16 v[168:171], v[40:43], v[56:59], v[168:171]
  ds_read_b64_tr_b16 v[104:105], v8 offset:40960
  s_add_u32 s62, s64, 768
  v_mfma_f32_16x16x32_bf16 v[172:175], v[44:47], v[56:59], v[172:175]
  ds_read_b64_tr_b16 v[106:107], v8 offset:41984
  v_mfma_f32_16x16x32_bf16 v[188:191], v[44:47], v[60:63], v[188:191]
  ds_read_b64_tr_b16 v[108:109], v9 offset:40960
  v_mfma_f32_16x16x32_bf16 v[184:187], v[40:43], v[60:63], v[184:187]
  ds_read_b64_tr_b16 v[110:111], v9 offset:41984
  v_mfma_f32_16x16x32_bf16 v[180:183], v[36:39], v[60:63], v[180:183]
  buffer_load_dword v31, v2, s[36:39], s62 offen
  v_mfma_f32_16x16x32_bf16 v[176:179], v[32:35], v[60:63], v[176:179]
  ds_read_b64_tr_b16 v[112:113], v10 offset:40960
  v_mfma_f32_16x16x32_bf16 v[192:195], v[32:35], v[64:67], v[192:195]
  ds_read_b64_tr_b16 v[114:115], v10 offset:41984
  v_mfma_f32_16x16x32_bf16 v[196:199], v[36:39], v[64:67], v[196:199]
  ds_read_b64_tr_b16 v[116:117], v11 offset:40960
  v_mfma_f32_16x16x32_bf16 v[200:203], v[40:43], v[64:67], v[200:203]
  ds_read_b64_tr_b16 v[118:119], v11 offset:41984
  s_add_u32 s62, s65, 3145728
  v_mfma_f32_16x16x32_bf16 v[204:207], v[44:47], v[64:67], v[204:207]
  v_mfma_f32_16x16x32_bf16 v[220:223], v[44:47], v[68:71], v[220:223]
  ds_read_b64_tr_b16 v[120:121], v12 offset:40960
  v_mfma_f32_16x16x32_bf16 v[216:219], v[40:43], v[68:71], v[216:219]
  ds_read_b64_tr_b16 v[122:123], v12 offset:41984
  v_mfma_f32_16x16x32_bf16 v[212:215], v[36:39], v[68:71], v[212:215]
  ds_read_b64_tr_b16 v[124:125], v13 offset:40960
  v_mfma_f32_16x16x32_bf16 v[208:211], v[32:35], v[68:71], v[208:211]
  ds_read_b64_tr_b16 v[126:127], v13 offset:41984
  buffer_load_dword v31, v3, s[40:43], s62 offen
  v_mfma_f32_16x16x32_bf16 v[224:227], v[32:35], v[72:75], v[224:227]
  v_mfma_f32_16x16x32_bf16 v[228:231], v[36:39], v[72:75], v[228:231]
  v_mfma_f32_16x16x32_bf16 v[232:235], v[40:43], v[72:75], v[232:235]
  v_mfma_f32_16x16x32_bf16 v[236:239], v[44:47], v[72:75], v[236:239]
  buffer_load_dword v31, v3, s[48:51], s62 offen
  v_mfma_f32_16x16x32_bf16 v[252:255], v[44:47], v[76:79], v[252:255]
  v_mfma_f32_16x16x32_bf16 v[248:251], v[40:43], v[76:79], v[248:251]
  v_mfma_f32_16x16x32_bf16 v[244:247], v[36:39], v[76:79], v[244:247]
  v_mfma_f32_16x16x32_bf16 v[240:243], v[32:35], v[76:79], v[240:243]
  s_waitcnt lgkmcnt(0)
  s_barrier
  v_mfma_f32_16x16x32_bf16 v[128:131], v[80:83], v[96:99], v[128:131]
  ds_read_b128 v[32:35], v4 offset:0
  v_mfma_f32_16x16x32_bf16 v[132:135], v[84:87], v[96:99], v[132:135]
  ds_read_b128 v[36:39], v4 offset:2048
  v_mfma_f32_16x16x32_bf16 v[136:139], v[88:91], v[96:99], v[136:139]
  ds_read_b128 v[40:43], v4 offset:4096
  v_mfma_f32_16x16x32_bf16 v[140:143], v[92:95], v[96:99], v[140:143]
  ds_read_b128 v[44:47], v4 offset:6144
  v_mfma_f32_16x16x32_bf16 v[156:159], v[92:95], v[100:103], v[156:159]
  v_mfma_f32_16x16x32_bf16 v[152:155], v[88:91], v[100:103], v[152:155]
  ds_read_b64_tr_b16 v[48:49], v6 offset:0
  v_mfma_f32_16x16x32_bf16 v[148:151], v[84:87], v[100:103], v[148:151]
  ds_read_b64_tr_b16 v[50:51], v6 offset:1024
  v_mfma_f32_16x16x32_bf16 v[144:147], v[80:83], v[100:103], v[144:147]
  ds_read_b64_tr_b16 v[52:53], v7 offset:0
  v_mfma_f32_16x16x32_bf16 v[160:163], v[80:83], v[104:107], v[160:163]
  ds_read_b64_tr_b16 v[54:55], v7 offset:1024
  v_mfma_f32_16x16x32_bf16 v[164:167], v[84:87], v[104:107], v[164:167]
  v_mfma_f32_16x16x32_bf16 v[168:171], v[88:91], v[104:107], v[168:171]
  ds_read_b64_tr_b16 v[56:57], v8 offset:0
  v_mfma_f32_16x16x32_bf16 v[172:175], v[92:95], v[104:107], v[172:175]
  ds_read_b64_tr_b16 v[58:59], v8 offset:1024
  v_mfma_f32_16x16x32_bf16 v[188:191], v[92:95], v[108:111], v[188:191]
  ds_read_b64_tr_b16 v[60:61], v9 offset:0
  v_mfma_f32_16x16x32_bf16 v[184:187], v[88:91], v[108:111], v[184:187]
  ds_read_b64_tr_b16 v[62:63], v9 offset:1024
  v_mfma_f32_16x16x32_bf16 v[180:183], v[84:87], v[108:111], v[180:183]
  v_mfma_f32_16x16x32_bf16 v[176:179], v[80:83], v[108:111], v[176:179]
  ds_read_b64_tr_b16 v[64:65], v10 offset:0
  v_mfma_f32_16x16x32_bf16 v[192:195], v[80:83], v[112:115], v[192:195]
  ds_read_b64_tr_b16 v[66:67], v10 offset:1024
  v_mfma_f32_16x16x32_bf16 v[196:199], v[84:87], v[112:115], v[196:199]
  ds_read_b64_tr_b16 v[68:69], v11 offset:0
  v_mfma_f32_16x16x32_bf16 v[200:203], v[88:91], v[112:115], v[200:203]
  ds_read_b64_tr_b16 v[70:71], v11 offset:1024
  v_mfma_f32_16x16x32_bf16 v[204:207], v[92:95], v[112:115], v[204:207]
  v_mfma_f32_16x16x32_bf16 v[220:223], v[92:95], v[116:119], v[220:223]
  ds_read_b64_tr_b16 v[72:73], v12 offset:0
  v_mfma_f32_16x16x32_bf16 v[216:219], v[88:91], v[116:119], v[216:219]
  ds_read_b64_tr_b16 v[74:75], v12 offset:1024
  v_mfma_f32_16x16x32_bf16 v[212:215], v[84:87], v[116:119], v[212:215]
  ds_read_b64_tr_b16 v[76:77], v13 offset:0
  v_mfma_f32_16x16x32_bf16 v[208:211], v[80:83], v[116:119], v[208:211]
  ds_read_b64_tr_b16 v[78:79], v13 offset:1024
  v_mfma_f32_16x16x32_bf16 v[224:227], v[80:83], v[120:123], v[224:227]
  v_mfma_f32_16x16x32_bf16 v[228:231], v[84:87], v[120:123], v[228:231]
  v_mfma_f32_16x16x32_bf16 v[232:235], v[88:91], v[120:123], v[232:235]
  v_mfma_f32_16x16x32_bf16 v[236:239], v[92:95], v[120:123], v[236:239]
  v_mfma_f32_16x16x32_bf16 v[252:255], v[92:95], v[124:127], v[252:255]
  v_mfma_f32_16x16x32_bf16 v[248:251], v[88:91], v[124:127], v[248:251]
  v_mfma_f32_16x16x32_bf16 v[244:247], v[84:87], v[124:127], v[244:247]
  v_mfma_f32_16x16x32_bf16 v[240:243], v[80:83], v[124:127], v[240:243]
  s_waitcnt lgkmcnt(0)
  v_mfma_f32_16x16x32_bf16 v[128:131], v[32:35], v[48:51], v[128:131]
  ds_read_b128 v[80:83], v5 offset:0
  v_mfma_f32_16x16x32_bf16 v[132:135], v[36:39], v[48:51], v[132:135]
  ds_read_b128 v[84:87], v5 offset:2048
  v_mfma_f32_16x16x32_bf16 v[136:139], v[40:43], v[48:51], v[136:139]
  ds_read_b128 v[88:91], v5 offset:4096
  v_mfma_f32_16x16x32_bf16 v[140:143], v[44:47], v[48:51], v[140:143]
  ds_read_b128 v[92:95], v5 offset:6144
  v_mfma_f32_16x16x32_bf16 v[156:159], v[44:47], v[52:55], v[156:159]
  v_mfma_f32_16x16x32_bf16 v[152:155], v[40:43], v[52:55], v[152:155]
  ds_read_b64_tr_b16 v[96:97], v6 offset:8192
  v_mfma_f32_16x16x32_bf16 v[148:151], v[36:39], v[52:55], v[148:151]
  ds_read_b64_tr_b16 v[98:99], v6 offset:9216
  v_mfma_f32_16x16x32_bf16 v[144:147], v[32:35], v[52:55], v[144:147]
  ds_read_b64_tr_b16 v[100:101], v7 offset:8192
  v_mfma_f32_16x16x32_bf16 v[160:163], v[32:35], v[56:59], v[160:163]
  ds_read_b64_tr_b16 v[102:103], v7 offset:9216
  v_mfma_f32_16x16x32_bf16 v[164:167], v[36:39], v[56:59], v[164:167]
  v_mfma_f32_16x16x32_bf16 v[168:171], v[40:43], v[56:59], v[168:171]
  ds_read_b64_tr_b16 v[104:105], v8 offset:8192
  s_add_u32 s62, s64, 896
  v_mfma_f32_16x16x32_bf16 v[172:175], v[44:47], v[56:59], v[172:175]
  ds_read_b64_tr_b16 v[106:107], v8 offset:9216
  v_mfma_f32_16x16x32_bf16 v[188:191], v[44:47], v[60:63], v[188:191]
  ds_read_b64_tr_b16 v[108:109], v9 offset:8192
  v_mfma_f32_16x16x32_bf16 v[184:187], v[40:43], v[60:63], v[184:187]
  ds_read_b64_tr_b16 v[110:111], v9 offset:9216
  v_mfma_f32_16x16x32_bf16 v[180:183], v[36:39], v[60:63], v[180:183]
  buffer_load_dword v31, v2, s[36:39], s62 offen
  v_mfma_f32_16x16x32_bf16 v[176:179], v[32:35], v[60:63], v[176:179]
  ds_read_b64_tr_b16 v[112:113], v10 offset:8192
  v_mfma_f32_16x16x32_bf16 v[192:195], v[32:35], v[64:67], v[192:195]
  ds_read_b64_tr_b16 v[114:115], v10 offset:9216
  v_mfma_f32_16x16x32_bf16 v[196:199], v[36:39], v[64:67], v[196:199]
  ds_read_b64_tr_b16 v[116:117], v11 offset:8192
  v_mfma_f32_16x16x32_bf16 v[200:203], v[40:43], v[64:67], v[200:203]
  ds_read_b64_tr_b16 v[118:119], v11 offset:9216
  s_add_u32 s62, s65, 3670016
  v_mfma_f32_16x16x32_bf16 v[204:207], v[44:47], v[64:67], v[204:207]
  v_mfma_f32_16x16x32_bf16 v[220:223], v[44:47], v[68:71], v[220:223]
  ds_read_b64_tr_b16 v[120:121], v12 offset:8192
  v_mfma_f32_16x16x32_bf16 v[216:219], v[40:43], v[68:71], v[216:219]
  ds_read_b64_tr_b16 v[122:123], v12 offset:9216
  v_mfma_f32_16x16x32_bf16 v[212:215], v[36:39], v[68:71], v[212:215]
  ds_read_b64_tr_b16 v[124:125], v13 offset:8192
  v_mfma_f32_16x16x32_bf16 v[208:211], v[32:35], v[68:71], v[208:211]
  ds_read_b64_tr_b16 v[126:127], v13 offset:9216
  buffer_load_dword v31, v3, s[40:43], s62 offen
  v_mfma_f32_16x16x32_bf16 v[224:227], v[32:35], v[72:75], v[224:227]
  v_mfma_f32_16x16x32_bf16 v[228:231], v[36:39], v[72:75], v[228:231]
  v_mfma_f32_16x16x32_bf16 v[232:235], v[40:43], v[72:75], v[232:235]
  v_mfma_f32_16x16x32_bf16 v[236:239], v[44:47], v[72:75], v[236:239]
  buffer_load_dword v31, v3, s[48:51], s62 offen
  v_mfma_f32_16x16x32_bf16 v[252:255], v[44:47], v[76:79], v[252:255]
  v_mfma_f32_16x16x32_bf16 v[248:251], v[40:43], v[76:79], v[248:251]
  v_mfma_f32_16x16x32_bf16 v[244:247], v[36:39], v[76:79], v[244:247]
  v_mfma_f32_16x16x32_bf16 v[240:243], v[32:35], v[76:79], v[240:243]
  s_waitcnt lgkmcnt(0)
  s_barrier
  v_mfma_f32_16x16x32_bf16 v[128:131], v[80:83], v[96:99], v[128:131]
  ds_read_b128 v[32:35], v4 offset:32768
  v_mfma_f32_16x16x32_bf16 v[132:135], v[84:87], v[96:99], v[132:135]
  ds_read_b128 v[36:39], v4 offset:34816
  v_mfma_f32_16x16x32_bf16 v[136:139], v[88:91], v[96:99], v[136:139]
  ds_read_b128 v[40:43], v4 offset:36864
  v_mfma_f32_16x16x32_bf16 v[140:143], v[92:95], v[96:99], v[140:143]
  ds_read_b128 v[44:47], v4 offset:38912
  v_mfma_f32_16x16x32_bf16 v[156:159], v[92:95], v[100:103], v[156:159]
  v_mfma_f32_16x16x32_bf16 v[152:155], v[88:91], v[100:103], v[152:155]
  ds_read_b64_tr_b16 v[48:49], v6 offset:32768
  v_mfma_f32_16x16x32_bf16 v[148:151], v[84:87], v[100:103], v[148:151]
  ds_read_b64_tr_b16 v[50:51], v6 offset:33792
  v_mfma_f32_16x16x32_bf16 v[144:147], v[80:83], v[100:103], v[144:147]
  ds_read_b64_tr_b16 v[52:53], v7 offset:32768
  v_mfma_f32_16x16x32_bf16 v[160:163], v[80:83], v[104:107], v[160:163]
  ds_read_b64_tr_b16 v[54:55], v7 offset:33792
  v_mfma_f32_16x16x32_bf16 v[164:167], v[84:87], v[104:107], v[164:167]
  v_mfma_f32_16x16x32_bf16 v[168:171], v[88:91], v[104:107], v[168:171]
  ds_read_b64_tr_b16 v[56:57], v8 offset:32768
  v_mfma_f32_16x16x32_bf16 v[172:175], v[92:95], v[104:107], v[172:175]
  ds_read_b64_tr_b16 v[58:59], v8 offset:33792
  v_mfma_f32_16x16x32_bf16 v[188:191], v[92:95], v[108:111], v[188:191]
  ds_read_b64_tr_b16 v[60:61], v9 offset:32768
  v_mfma_f32_16x16x32_bf16 v[184:187], v[88:91], v[108:111], v[184:187]
  ds_read_b64_tr_b16 v[62:63], v9 offset:33792
  v_mfma_f32_16x16x32_bf16 v[180:183], v[84:87], v[108:111], v[180:183]
  v_mfma_f32_16x16x32_bf16 v[176:179], v[80:83], v[108:111], v[176:179]
  ds_read_b64_tr_b16 v[64:65], v10 offset:32768
  v_mfma_f32_16x16x32_bf16 v[192:195], v[80:83], v[112:115], v[192:195]
  ds_read_b64_tr_b16 v[66:67], v10 offset:33792
  v_mfma_f32_16x16x32_bf16 v[196:199], v[84:87], v[112:115], v[196:199]
  ds_read_b64_tr_b16 v[68:69], v11 offset:32768
  v_mfma_f32_16x16x32_bf16 v[200:203], v[88:91], v[112:115], v[200:203]
  ds_read_b64_tr_b16 v[70:71], v11 offset:33792
  v_mfma_f32_16x16x32_bf16 v[204:207], v[92:95], v[112:115], v[204:207]
  v_mfma_f32_16x16x32_bf16 v[220:223], v[92:95], v[116:119], v[220:223]
  ds_read_b64_tr_b16 v[72:73], v12 offset:32768
  v_mfma_f32_16x16x32_bf16 v[216:219], v[88:91], v[116:119], v[216:219]
  ds_read_b64_tr_b16 v[74:75], v12 offset:33792
  v_mfma_f32_16x16x32_bf16 v[212:215], v[84:87], v[116:119], v[212:215]
  ds_read_b64_tr_b16 v[76:77], v13 offset:32768
  v_mfma_f32_16x16x32_bf16 v[208:211], v[80:83], v[116:119], v[208:211]
  ds_read_b64_tr_b16 v[78:79], v13 offset:33792
  v_mfma_f32_16x16x32_bf16 v[224:227], v[80:83], v[120:123], v[224:227]
  v_mfma_f32_16x16x32_bf16 v[228:231], v[84:87], v[120:123], v[228:231]
  v_mfma_f32_16x16x32_bf16 v[232:235], v[88:91], v[120:123], v[232:235]
  v_mfma_f32_16x16x32_bf16 v[236:239], v[92:95], v[120:123], v[236:239]
  v_mfma_f32_16x16x32_bf16 v[252:255], v[92:95], v[124:127], v[252:255]
  v_mfma_f32_16x16x32_bf16 v[248:251], v[88:91], v[124:127], v[248:251]
  v_mfma_f32_16x16x32_bf16 v[244:247], v[84:87], v[124:127], v[244:247]
  v_mfma_f32_16x16x32_bf16 v[240:243], v[80:83], v[124:127], v[240:243]
  s_waitcnt lgkmcnt(0)
  v_mfma_f32_16x16x32_bf16 v[128:131], v[32:35], v[48:51], v[128:131]
  ds_read_b128 v[80:83], v5 offset:32768
  v_mfma_f32_16x16x32_bf16 v[132:135], v[36:39], v[48:51], v[132:135]
  ds_read_b128 v[84:87], v5 offset:34816
  v_mfma_f32_16x16x32_bf16 v[136:139], v[40:43], v[48:51], v[136:139]
  ds_read_b128 v[88:91], v5 offset:36864
  v_mfma_f32_16x16x32_bf16 v[140:143], v[44:47], v[48:51], v[140:143]
  ds_read_b128 v[92:95], v5 offset:38912
  v_mfma_f32_16x16x32_bf16 v[156:159], v[44:47], v[52:55], v[156:159]
  v_and_b32 v29, 15, v1
  v_lshlrev_b32 v29, 2, v29
  buffer_load_dword v28, v29, s[84:87], 0 offen sc1
  v_mfma_f32_16x16x32_bf16 v[152:155], v[40:43], v[52:55], v[152:155]
  ds_read_b64_tr_b16 v[96:97], v6 offset:40960
  v_mfma_f32_16x16x32_bf16 v[148:151], v[36:39], v[52:55], v[148:151]
  ds_read_b64_tr_b16 v[98:99], v6 offset:41984
  v_mfma_f32_16x16x32_bf16 v[144:147], v[32:35], v[52:55], v[144:147]
  ds_read_b64_tr_b16 v[100:101], v7 offset:40960
  v_mfma_f32_16x16x32_bf16 v[160:163], v[32:35], v[56:59], v[160:163]
  ds_read_b64_tr_b16 v[102:103], v7 offset:41984
  v_mfma_f32_16x16x32_bf16 v[164:167], v[36:39], v[56:59], v[164:167]
  v_mfma_f32_16x16x32_bf16 v[168:171], v[40:43], v[56:59], v[168:171]
  ds_read_b64_tr_b16 v[104:105], v8 offset:40960
  v_mfma_f32_16x16x32_bf16 v[172:175], v[44:47], v[56:59], v[172:175]
  ds_read_b64_tr_b16 v[106:107], v8 offset:41984
  v_mfma_f32_16x16x32_bf16 v[188:191], v[44:47], v[60:63], v[188:191]
  ds_read_b64_tr_b16 v[108:109], v9 offset:40960
  v_mfma_f32_16x16x32_bf16 v[184:187], v[40:43], v[60:63], v[184:187]
  ds_read_b64_tr_b16 v[110:111], v9 offset:41984
  v_mfma_f32_16x16x32_bf16 v[180:183], v[36:39], v[60:63], v[180:183]
  v_mfma_f32_16x16x32_bf16 v[176:179], v[32:35], v[60:63], v[176:179]
  ds_read_b64_tr_b16 v[112:113], v10 offset:40960
  v_mfma_f32_16x16x32_bf16 v[192:195], v[32:35], v[64:67], v[192:195]
  ds_read_b64_tr_b16 v[114:115], v10 offset:41984
  v_mfma_f32_16x16x32_bf16 v[196:199], v[36:39], v[64:67], v[196:199]
  ds_read_b64_tr_b16 v[116:117], v11 offset:40960
  v_mfma_f32_16x16x32_bf16 v[200:203], v[40:43], v[64:67], v[200:203]
  ds_read_b64_tr_b16 v[118:119], v11 offset:41984
  v_mfma_f32_16x16x32_bf16 v[204:207], v[44:47], v[64:67], v[204:207]
  v_mfma_f32_16x16x32_bf16 v[220:223], v[44:47], v[68:71], v[220:223]
  ds_read_b64_tr_b16 v[120:121], v12 offset:40960
  v_mfma_f32_16x16x32_bf16 v[216:219], v[40:43], v[68:71], v[216:219]
  ds_read_b64_tr_b16 v[122:123], v12 offset:41984
  v_mfma_f32_16x16x32_bf16 v[212:215], v[36:39], v[68:71], v[212:215]
  ds_read_b64_tr_b16 v[124:125], v13 offset:40960
  v_mfma_f32_16x16x32_bf16 v[208:211], v[32:35], v[68:71], v[208:211]
  ds_read_b64_tr_b16 v[126:127], v13 offset:41984
  v_mfma_f32_16x16x32_bf16 v[224:227], v[32:35], v[72:75], v[224:227]
  v_mfma_f32_16x16x32_bf16 v[228:231], v[36:39], v[72:75], v[228:231]
  v_mfma_f32_16x16x32_bf16 v[232:235], v[40:43], v[72:75], v[232:235]
  v_mfma_f32_16x16x32_bf16 v[236:239], v[44:47], v[72:75], v[236:239]
  v_mfma_f32_16x16x32_bf16 v[252:255], v[44:47], v[76:79], v[252:255]
  v_mfma_f32_16x16x32_bf16 v[248:251], v[40:43], v[76:79], v[248:251]
  v_mfma_f32_16x16x32_bf16 v[244:247], v[36:39], v[76:79], v[244:247]
  v_mfma_f32_16x16x32_bf16 v[240:243], v[32:35], v[76:79], v[240:243]
  s_waitcnt lgkmcnt(0)
  s_barrier
  v_mfma_f32_16x16x32_bf16 v[128:131], v[80:83], v[96:99], v[128:131]
  ds_read_b128 v[32:35], v4 offset:0
  v_mfma_f32_16x16x32_bf16 v[132:135], v[84:87], v[96:99], v[132:135]
  ds_read_b128 v[36:39], v4 offset:2048
  v_mfma_f32_16x16x32_bf16 v[136:139], v[88:91], v[96:99], v[136:139]
  ds_read_b128 v[40:43], v4 offset:4096
  v_mfma_f32_16x16x32_bf16 v[140:143], v[92:95], v[96:99], v[140:143]
  ds_read_b128 v[44:47], v4 offset:6144
  v_mfma_f32_16x16x32_bf16 v[156:159], v[92:95], v[100:103], v[156:159]
  v_mfma_f32_16x16x32_bf16 v[152:155], v[88:91], v[100:103], v[152:155]
  ds_read_b64_tr_b16 v[48:49], v6 offset:0
  v_mfma_f32_16x16x32_bf16 v[148:151], v[84:87], v[100:103], v[148:151]
  ds_read_b64_tr_b16 v[50:51], v6 offset:1024
  v_mfma_f32_16x16x32_bf16 v[144:147], v[80:83], v[100:103], v[144:147]
  ds_read_b64_tr_b16 v[52:53], v7 offset:0
  v_mfma_f32_16x16x32_bf16 v[160:163], v[80:83], v[104:107], v[160:163]
  ds_read_b64_tr_b16 v[54:55], v7 offset:1024
  v_mfma_f32_16x16x32_bf16 v[164:167], v[84:87], v[104:107], v[164:167]
  v_mfma_f32_16x16x32_bf16 v[168:171], v[88:91], v[104:107], v[168:171]
  ds_read_b64_tr_b16 v[56:57], v8 offset:0
  v_mfma_f32_16x16x32_bf16 v[172:175], v[92:95], v[104:107], v[172:175]
  ds_read_b64_tr_b16 v[58:59], v8 offset:1024
  v_mfma_f32_16x16x32_bf16 v[188:191], v[92:95], v[108:111], v[188:191]
  ds_read_b64_tr_b16 v[60:61], v9 offset:0
  v_mfma_f32_16x16x32_bf16 v[184:187], v[88:91], v[108:111], v[184:187]
  ds_read_b64_tr_b16 v[62:63], v9 offset:1024
  v_mfma_f32_16x16x32_bf16 v[180:183], v[84:87], v[108:111], v[180:183]
  v_mfma_f32_16x16x32_bf16 v[176:179], v[80:83], v[108:111], v[176:179]
  ds_read_b64_tr_b16 v[64:65], v10 offset:0
  v_mfma_f32_16x16x32_bf16 v[192:195], v[80:83], v[112:115], v[192:195]
  ds_read_b64_tr_b16 v[66:67], v10 offset:1024
  v_mfma_f32_16x16x32_bf16 v[196:199], v[84:87], v[112:115], v[196:199]
  ds_read_b64_tr_b16 v[68:69], v11 offset:0
  v_mfma_f32_16x16x32_bf16 v[200:203], v[88:91], v[112:115], v[200:203]
  ds_read_b64_tr_b16 v[70:71], v11 offset:1024
  v_mfma_f32_16x16x32_bf16 v[204:207], v[92:95], v[112:115], v[204:207]
  v_mfma_f32_16x16x32_bf16 v[220:223], v[92:95], v[116:119], v[220:223]
  ds_read_b64_tr_b16 v[72:73], v12 offset:0
  v_mfma_f32_16x16x32_bf16 v[216:219], v[88:91], v[116:119], v[216:219]
  ds_read_b64_tr_b16 v[74:75], v12 offset:1024
  v_mfma_f32_16x16x32_bf16 v[212:215], v[84:87], v[116:119], v[212:215]
  ds_read_b64_tr_b16 v[76:77], v13 offset:0
  v_mfma_f32_16x16x32_bf16 v[208:211], v[80:83], v[116:119], v[208:211]
  ds_read_b64_tr_b16 v[78:79], v13 offset:1024
  v_mfma_f32_16x16x32_bf16 v[224:227], v[80:83], v[120:123], v[224:227]
  v_mfma_f32_16x16x32_bf16 v[228:231], v[84:87], v[120:123], v[228:231]
  v_mfma_f32_16x16x32_bf16 v[232:235], v[88:91], v[120:123], v[232:235]
  v_mfma_f32_16x16x32_bf16 v[236:239], v[92:95], v[120:123], v[236:239]
  v_mfma_f32_16x16x32_bf16 v[252:255], v[92:95], v[124:127], v[252:255]
  v_mfma_f32_16x16x32_bf16 v[248:251], v[88:91], v[124:127], v[248:251]
  v_mfma_f32_16x16x32_bf16 v[244:247], v[84:87], v[124:127], v[244:247]
  v_mfma_f32_16x16x32_bf16 v[240:243], v[80:83], v[124:127], v[240:243]
  s_waitcnt lgkmcnt(0)
  v_mfma_f32_16x16x32_bf16 v[128:131], v[32:35], v[48:51], v[128:131]
  ds_read_b128 v[80:83], v5 offset:0
  s_mov_b32 s32, s8
  s_mov_b32 s33, s9
  v_mfma_f32_16x16x32_bf16 v[132:135], v[36:39], v[48:51], v[132:135]
  ds_read_b128 v[84:87], v5 offset:2048
  s_mov_b32 s34, 0x400000
  v_mfma_f32_16x16x32_bf16 v[136:139], v[40:43], v[48:51], v[136:139]
  ds_read_b128 v[88:91], v5 offset:4096
  s_mov_b32 s35, 0x20000
  s_mov_b32 s36, s18
  v_mfma_f32_16x16x32_bf16 v[140:143], v[44:47], v[48:51], v[140:143]
  ds_read_b128 v[92:95], v5 offset:6144
  s_mov_b32 s37, s19
  v_mfma_f32_16x16x32_bf16 v[156:159], v[44:47], v[52:55], v[156:159]
  s_mov_b32 s38, 0x1c0000
  v_mfma_f32_16x16x32_bf16 v[152:155], v[40:43], v[52:55], v[152:155]
  ds_read_b64_tr_b16 v[96:97], v6 offset:8192
  s_mov_b32 s39, 0x20000
  s_cmp_lt_u32 s57, 28
  v_mfma_f32_16x16x32_bf16 v[148:151], v[36:39], v[52:55], v[148:151]
  ds_read_b64_tr_b16 v[98:99], v6 offset:9216
  s_cselect_b32 s38, s38, 0
  v_mfma_f32_16x16x32_bf16 v[144:147], v[32:35], v[52:55], v[144:147]
  ds_read_b64_tr_b16 v[100:101], v7 offset:8192
  s_and_b32 s62, s56, 1
  s_lshl_b32 s63, s62, 3
  v_mfma_f32_16x16x32_bf16 v[160:163], v[32:35], v[56:59], v[160:163]
  ds_read_b64_tr_b16 v[102:103], v7 offset:9216
  v_lshrrev_b32 v21, 4, v1
  v_mfma_f32_16x16x32_bf16 v[164:167], v[36:39], v[56:59], v[164:167]
  v_lshlrev_b32 v22, 1, v21
  v_mfma_f32_16x16x32_bf16 v[168:171], v[40:43], v[56:59], v[168:171]
  ds_read_b64_tr_b16 v[104:105], v8 offset:8192
  v_and_b32 v20, 15, v1
  v_xor_b32 v20, v20, v22
  v_mfma_f32_16x16x32_bf16 v[172:175], v[44:47], v[56:59], v[172:175]
  ds_read_b64_tr_b16 v[106:107], v8 offset:9216
  v_xor_b32 v20, s63, v20
  v_mfma_f32_16x16x32_bf16 v[188:191], v[44:47], v[60:63], v[188:191]
  ds_read_b64_tr_b16 v[108:109], v9 offset:8192
  v_lshlrev_b32 v20, 4, v20
  v_lshl_add_u32 v2, v21, 13, v20
  v_mfma_f32_16x16x32_bf16 v[184:187], v[40:43], v[60:63], v[184:187]
  ds_read_b64_tr_b16 v[110:111], v9 offset:9216
  s_lshl_b32 s63, s57, 8
  v_mfma_f32_16x16x32_bf16 v[180:183], v[36:39], v[60:63], v[180:183]
  v_add_u32 v2, s63, v2
  v_mfma_f32_16x16x32_bf16 v[176:179], v[32:35], v[60:63], v[176:179]
  ds_read_b64_tr_b16 v[112:113], v10 offset:8192
  s_lshr_b32 s63, s56, 1
  s_lshl_b32 s63, s63, 2
  v_mfma_f32_16x16x32_bf16 v[192:195], v[32:35], v[64:67], v[192:195]
  ds_read_b64_tr_b16 v[114:115], v10 offset:9216
  s_lshl_b32 s74, s62, 1
  v_mfma_f32_16x16x32_bf16 v[196:199], v[36:39], v[64:67], v[196:199]
  ds_read_b64_tr_b16 v[116:117], v11 offset:8192
  s_add_u32 s63, s63, s74
  v_mfma_f32_16x16x32_bf16 v[200:203], v[40:43], v[64:67], v[200:203]
  ds_read_b64_tr_b16 v[118:119], v11 offset:9216
  s_lshl_b32 s64, s63, 15
  s_add_u32 s65, s64, 32768
  v_mfma_f32_16x16x32_bf16 v[204:207], v[44:47], v[64:67], v[204:207]
  s_lshl_b32 s67, s63, 10
  v_mfma_f32_16x16x32_bf16 v[220:223], v[44:47], v[68:71], v[220:223]
  ds_read_b64_tr_b16 v[120:121], v12 offset:8192
  s_add_u32 s67, s67, 0
  s_lshl_b32 s63, s62, 2
  v_mfma_f32_16x16x32_bf16 v[216:219], v[40:43], v[68:71], v[216:219]
  ds_read_b64_tr_b16 v[122:123], v12 offset:9216
  v_and_b32 v22, 2, v22
  v_mfma_f32_16x16x32_bf16 v[212:215], v[36:39], v[68:71], v[212:215]
  ds_read_b64_tr_b16 v[124:125], v13 offset:8192
  v_and_b32 v20, 7, v1
  v_mfma_f32_16x16x32_bf16 v[208:211], v[32:35], v[68:71], v[208:211]
  ds_read_b64_tr_b16 v[126:127], v13 offset:9216
  v_xor_b32 v20, v20, v22
  v_xor_b32 v20, s63, v20
  v_mfma_f32_16x16x32_bf16 v[224:227], v[32:35], v[72:75], v[224:227]
  v_lshlrev_b32 v20, 4, v20
  v_mfma_f32_16x16x32_bf16 v[228:231], v[36:39], v[72:75], v[228:231]
  v_lshrrev_b32 v21, 3, v1
  v_mul_u32_u24 v21, 3584, v21
  v_mfma_f32_16x16x32_bf16 v[232:235], v[40:43], v[72:75], v[232:235]
  v_add_u32 v3, v21, v20
  v_mfma_f32_16x16x32_bf16 v[236:239], v[44:47], v[72:75], v[236:239]
  s_lshl_b32 s63, s57, 7
  v_mfma_f32_16x16x32_bf16 v[252:255], v[44:47], v[76:79], v[252:255]
  v_add_u32 v3, s63, v3
  s_mul_i32 s66, s56, 28672
  v_mfma_f32_16x16x32_bf16 v[248:251], v[40:43], v[76:79], v[248:251]
  s_lshl_b32 s68, s56, 10
  v_mfma_f32_16x16x32_bf16 v[244:247], v[36:39], v[76:79], v[244:247]
  s_add_u32 s68, s68, 131072
  v_mfma_f32_16x16x32_bf16 v[240:243], v[32:35], v[76:79], v[240:243]
  s_waitcnt vmcnt(0)
  s_cmp_lg_u32 s56, 4
  s_cbranch_scc1 LF_noinitchk
  v_cmp_gt_u32 vcc, 16, v28
  s_nop 0
  s_cbranch_vccz L_poll1_ok
  s_mov_b32 s3, 0x10000
L_poll1:
  s_sleep 2
  buffer_load_dword v28, v29, s[84:87], 0 offen sc1
  s_waitcnt vmcnt(0)
  v_cmp_gt_u32 vcc, 16, v28
  s_sub_u32 s3, s3, 1
  s_cbranch_scc1 L_poll1_ok
  s_cbranch_vccnz L_poll1
L_poll1_ok:
LF_noinitchk:
  s_waitcnt lgkmcnt(0)
  s_barrier
  v_mfma_f32_16x16x32_bf16 v[128:131], v[80:83], v[96:99], v[128:131]
  ds_read_b128 v[32:35], v4 offset:32768
  s_add_u32 m0, s67, 0
  v_mfma_f32_16x16x32_bf16 v[132:135], v[84:87], v[96:99], v[132:135]
  ds_read_b128 v[36:39], v4 offset:34816
  v_mfma_f32_16x16x32_bf16 v[136:139], v[88:91], v[96:99], v[136:139]
  ds_read_b128 v[40:43], v4 offset:36864
  buffer_load_dwordx4 v2, s[32:35], s64 offen lds
  v_mfma_f32_16x16x32_bf16 v[140:143], v[92:95], v[96:99], v[140:143]
  ds_read_b128 v[44:47], v4 offset:38912
  v_mfma_f32_16x16x32_bf16 v[156:159], v[92:95], v[100:103], v[156:159]
  s_add_u32 m0, s67, 1024
  v_mfma_f32_16x16x32_bf16 v[152:155], v[88:91], v[100:103], v[152:155]
  ds_read_b64_tr_b16 v[48:49], v6 offset:32768
  v_mfma_f32_16x16x32_bf16 v[148:151], v[84:87], v[100:103], v[148:151]
  ds_read_b64_tr_b16 v[50:51], v6 offset:33792
  buffer_load_dwordx4 v2, s[32:35], s65 offen lds
  v_mfma_f32_16x16x32_bf16 v[144:147], v[80:83], v[100:103], v[144:147]
  ds_read_b64_tr_b16 v[52:53], v7 offset:32768
  v_mfma_f32_16x16x32_bf16 v[160:163], v[80:83], v[104:107], v[160:163]
  ds_read_b64_tr_b16 v[54:55], v7 offset:33792
  s_add_u32 m0, s68, 0
  v_mfma_f32_16x16x32_bf16 v[164:167], v[84:87], v[104:107], v[164:167]
  v_mfma_f32_16x16x32_bf16 v[168:171], v[88:91], v[104:107], v[168:171]
  ds_read_b64_tr_b16 v[56:57], v8 offset:32768
  buffer_load_dwordx4 v3, s[36:39], s66 offen lds
  v_mfma_f32_16x16x32_bf16 v[172:175], v[92:95], v[104:107], v[172:175]
  ds_read_b64_tr_b16 v[58:59], v8 offset:33792
  v_mfma_f32_16x16x32_bf16 v[188:191], v[92:95], v[108:111], v[188:191]
  ds_read_b64_tr_b16 v[60:61], v9 offset:32768
  v_add_u32 v2, 0x80000, v2
  v_mfma_f32_16x16x32_bf16 v[184:187], v[88:91], v[108:111], v[184:187]
  ds_read_b64_tr_b16 v[62:63], v9 offset:33792
  v_mfma_f32_16x16x32_bf16 v[180:183], v[84:87], v[108:111], v[180:183]
  v_add_u32 v3, 229376, v3
  v_mfma_f32_16x16x32_bf16 v[176:179], v[80:83], v[108:111], v[176:179]
  ds_read_b64_tr_b16 v[64:65], v10 offset:32768
  v_mfma_f32_16x16x32_bf16 v[192:195], v[80:83], v[112:115], v[192:195]
  ds_read_b64_tr_b16 v[66:67], v10 offset:33792
  s_add_u32 m0, s67, 16384
  v_mfma_f32_16x16x32_bf16 v[196:199], v[84:87], v[112:115], v[196:199]
  ds_read_b64_tr_b16 v[68:69], v11 offset:32768
  v_mfma_f32_16x16x32_bf16 v[200:203], v[88:91], v[112:115], v[200:203]
  ds_read_b64_tr_b16 v[70:71], v11 offset:33792
  buffer_load_dwordx4 v2, s[32:35], s64 offen lds
  v_mfma_f32_16x16x32_bf16 v[204:207], v[92:95], v[112:115], v[204:207]
  v_mfma_f32_16x16x32_bf16 v[220:223], v[92:95], v[116:119], v[220:223]
  ds_read_b64_tr_b16 v[72:73], v12 offset:32768
  s_add_u32 m0, s67, 17408
  v_mfma_f32_16x16x32_bf16 v[216:219], v[88:91], v[116:119], v[216:219]
  ds_read_b64_tr_b16 v[74:75], v12 offset:33792
  v_mfma_f32_16x16x32_bf16 v[212:215], v[84:87], v[116:119], v[212:215]
  ds_read_b64_tr_b16 v[76:77], v13 offset:32768
  buffer_load_dwordx4 v2, s[32:35], s65 offen lds
  v_mfma_f32_16x16x32_bf16 v[208:211], v[80:83], v[116:119], v[208:211]
  ds_read_b64_tr_b16 v[78:79], v13 offset:33792
  v_mfma_f32_16x16x32_bf16 v[224:227], v[80:83], v[120:123], v[224:227]
  s_add_u32 m0, s68, 8192
  v_mfma_f32_16x16x32_bf16 v[228:231], v[84:87], v[120:123], v[228:231]
  v_mfma_f32_16x16x32_bf16 v[232:235], v[88:91], v[120:123], v[232:235]
  buffer_load_dwordx4 v3, s[36:39], s66 offen lds
  v_mfma_f32_16x16x32_bf16 v[236:239], v[92:95], v[120:123], v[236:239]
  v_mfma_f32_16x16x32_bf16 v[252:255], v[92:95], v[124:127], v[252:255]
  v_add_u32 v2, 0x80000, v2
  v_mfma_f32_16x16x32_bf16 v[248:251], v[88:91], v[124:127], v[248:251]
  v_mfma_f32_16x16x32_bf16 v[244:247], v[84:87], v[124:127], v[244:247]
  v_add_u32 v3, 229376, v3
  v_mfma_f32_16x16x32_bf16 v[240:243], v[80:83], v[124:127], v[240:243]
  s_waitcnt lgkmcnt(0)
  v_mfma_f32_16x16x32_bf16 v[128:131], v[32:35], v[48:51], v[128:131]
  ds_read_b128 v[80:83], v5 offset:32768
  v_mfma_f32_16x16x32_bf16 v[132:135], v[36:39], v[48:51], v[132:135]
  ds_read_b128 v[84:87], v5 offset:34816
  v_mfma_f32_16x16x32_bf16 v[136:139], v[40:43], v[48:51], v[136:139]
  ds_read_b128 v[88:91], v5 offset:36864
  v_mfma_f32_16x16x32_bf16 v[140:143], v[44:47], v[48:51], v[140:143]
  ds_read_b128 v[92:95], v5 offset:38912
  v_mfma_f32_16x16x32_bf16 v[156:159], v[44:47], v[52:55], v[156:159]
  v_mfma_f32_16x16x32_bf16 v[152:155], v[40:43], v[52:55], v[152:155]
  ds_read_b64_tr_b16 v[96:97], v6 offset:40960
  v_mfma_f32_16x16x32_bf16 v[148:151], v[36:39], v[52:55], v[148:151]
  ds_read_b64_tr_b16 v[98:99], v6 offset:41984
  v_mfma_f32_16x16x32_bf16 v[144:147], v[32:35], v[52:55], v[144:147]
  ds_read_b64_tr_b16 v[100:101], v7 offset:40960
  v_mfma_f32_16x16x32_bf16 v[160:163], v[32:35], v[56:59], v[160:163]
  ds_read_b64_tr_b16 v[102:103], v7 offset:41984
  v_mfma_f32_16x16x32_bf16 v[164:167], v[36:39], v[56:59], v[164:167]
  v_mfma_f32_16x16x32_bf16 v[168:171], v[40:43], v[56:59], v[168:171]
  ds_read_b64_tr_b16 v[104:105], v8 offset:40960
  v_mfma_f32_16x16x32_bf16 v[172:175], v[44:47], v[56:59], v[172:175]
  ds_read_b64_tr_b16 v[106:107], v8 offset:41984
  v_mfma_f32_16x16x32_bf16 v[188:191], v[44:47], v[60:63], v[188:191]
  ds_read_b64_tr_b16 v[108:109], v9 offset:40960
  v_mfma_f32_16x16x32_bf16 v[184:187], v[40:43], v[60:63], v[184:187]
  ds_read_b64_tr_b16 v[110:111], v9 offset:41984
  v_mfma_f32_16x16x32_bf16 v[180:183], v[36:39], v[60:63], v[180:183]
  v_mfma_f32_16x16x32_bf16 v[176:179], v[32:35], v[60:63], v[176:179]
  ds_read_b64_tr_b16 v[112:113], v10 offset:40960
  v_mfma_f32_16x16x32_bf16 v[192:195], v[32:35], v[64:67], v[192:195]
  ds_read_b64_tr_b16 v[114:115], v10 offset:41984
  v_mfma_f32_16x16x32_bf16 v[196:199], v[36:39], v[64:67], v[196:199]
  ds_read_b64_tr_b16 v[116:117], v11 offset:40960
  v_mfma_f32_16x16x32_bf16 v[200:203], v[40:43], v[64:67], v[200:203]
  ds_read_b64_tr_b16 v[118:119], v11 offset:41984
  v_mfma_f32_16x16x32_bf16 v[204:207], v[44:47], v[64:67], v[204:207]
  v_mfma_f32_16x16x32_bf16 v[220:223], v[44:47], v[68:71], v[220:223]
  ds_read_b64_tr_b16 v[120:121], v12 offset:40960
  v_mfma_f32_16x16x32_bf16 v[216:219], v[40:43], v[68:71], v[216:219]
  ds_read_b64_tr_b16 v[122:123], v12 offset:41984
  v_mfma_f32_16x16x32_bf16 v[212:215], v[36:39], v[68:71], v[212:215]
  ds_read_b64_tr_b16 v[124:125], v13 offset:40960
  v_mfma_f32_16x16x32_bf16 v[208:211], v[32:35], v[68:71], v[208:211]
  ds_read_b64_tr_b16 v[126:127], v13 offset:41984
  v_mfma_f32_16x16x32_bf16 v[224:227], v[32:35], v[72:75], v[224:227]
  v_mfma_f32_16x16x32_bf16 v[228:231], v[36:39], v[72:75], v[228:231]
  v_mfma_f32_16x16x32_bf16 v[232:235], v[40:43], v[72:75], v[232:235]
  v_mfma_f32_16x16x32_bf16 v[236:239], v[44:47], v[72:75], v[236:239]
  v_mfma_f32_16x16x32_bf16 v[252:255], v[44:47], v[76:79], v[252:255]
  v_mfma_f32_16x16x32_bf16 v[248:251], v[40:43], v[76:79], v[248:251]
  v_mfma_f32_16x16x32_bf16 v[244:247], v[36:39], v[76:79], v[244:247]
  v_mfma_f32_16x16x32_bf16 v[240:243], v[32:35], v[76:79], v[240:243]
  s_waitcnt vmcnt(3) lgkmcnt(0)
  s_barrier
  v_mfma_f32_16x16x32_bf16 v[128:131], v[80:83], v[96:99], v[128:131]
  s_lshl_b32 s63, s76, 10
  v_and_b32 v30, 8, v1
  v_lshlrev_b32 v30, 10, v30
  v_lshrrev_b32 v12, 4, v1
  v_lshl_add_u32 v30, v12, 7, v30
  v_mfma_f32_16x16x32_bf16 v[132:135], v[84:87], v[96:99], v[132:135]
  v_and_b32 v12, 7, v1
  v_lshl_add_u32 v30, v12, 4, v30
  v_add_u32 v12, s63, v30
  s_mov_b32 s69, 16384
  v_and_b32 v72, 15, v1
  v_lshrrev_b32 v73, 4, v1
  v_mfma_f32_16x16x32_bf16 v[136:139], v[88:91], v[96:99], v[136:139]
  buffer_load_dwordx4 v[32:35], v12, s[44:47], 0 offen offset:0 sc1
  v_lshrrev_b32 v74, 2, v72
  v_mfma_f32_16x16x32_bf16 v[140:143], v[92:95], v[96:99], v[140:143]
  v_and_b32 v75, 1, v73
  v_lshl_add_u32 v76, v75, 2, v74
  v_mfma_f32_16x16x32_bf16 v[156:159], v[92:95], v[100:103], v[156:159]
  v_lshrrev_b32 v77, 1, v74
  v_mfma_f32_16x16x32_bf16 v[152:155], v[88:91], v[100:103], v[152:155]
  buffer_load_dwordx4 v[36:39], v12, s[44:47], s69 offen offset:0 sc1
  v_lshl_add_u32 v77, v75, 1, v77
  v_lshl_add_u32 v74, v73, 3, v74
  v_mfma_f32_16x16x32_bf16 v[148:151], v[84:87], v[100:103], v[148:151]
  v_and_b32 v78, 3, v1
  v_mfma_f32_16x16x32_bf16 v[144:147], v[80:83], v[100:103], v[144:147]
  v_lshlrev_b32 v78, 3, v78
  v_lshl_add_u32 v79, v74, 8, v78
  v_mfma_f32_16x16x32_bf16 v[160:163], v[80:83], v[104:107], v[160:163]
  buffer_load_dwordx4 v[40:43], v12, s[44:47], 0 offen offset:512 sc1
  v_lshl_add_u32 v13, v74, 7, v78
  v_mfma_f32_16x16x32_bf16 v[164:167], v[84:87], v[104:107], v[164:167]
  v_add_u32 v13, 131072, v13
  v_xor_b32 v72, 0, v76
  v_mfma_f32_16x16x32_bf16 v[168:171], v[88:91], v[104:107], v[168:171]
  v_lshl_add_u32 v4, v72, 5, v79
  v_mfma_f32_16x16x32_bf16 v[172:175], v[92:95], v[104:107], v[172:175]
  buffer_load_dwordx4 v[44:47], v12, s[44:47], s69 offen offset:512 sc1
  v_add_u32 v20, 0x10000, v4
  v_mfma_f32_16x16x32_bf16 v[188:191], v[92:95], v[108:111], v[188:191]
  v_xor_b32 v72, 1, v76
  v_lshl_add_u32 v5, v72, 5, v79
  v_mfma_f32_16x16x32_bf16 v[184:187], v[88:91], v[108:111], v[184:187]
  v_add_u32 v21, 0x10000, v5
  v_mfma_f32_16x16x32_bf16 v[180:183], v[84:87], v[108:111], v[180:183]
  v_add_u32 v12, 1024, v12
  v_xor_b32 v72, 2, v76
  v_lshl_add_u32 v6, v72, 5, v79
  v_mfma_f32_16x16x32_bf16 v[176:179], v[80:83], v[108:111], v[176:179]
  v_add_u32 v22, 0x10000, v6
  v_mfma_f32_16x16x32_bf16 v[192:195], v[80:83], v[112:115], v[192:195]
  v_xor_b32 v72, 3, v76
  v_lshl_add_u32 v7, v72, 5, v79
  v_mfma_f32_16x16x32_bf16 v[196:199], v[84:87], v[112:115], v[196:199]
  buffer_load_dwordx4 v[48:51], v12, s[44:47], 0 offen offset:0 sc1
  v_add_u32 v23, 0x10000, v7
  v_mfma_f32_16x16x32_bf16 v[200:203], v[88:91], v[112:115], v[200:203]
  v_xor_b32 v72, 4, v76
  v_lshl_add_u32 v8, v72, 5, v79
  v_mfma_f32_16x16x32_bf16 v[204:207], v[92:95], v[112:115], v[204:207]
  v_add_u32 v24, 0x10000, v8
  v_mfma_f32_16x16x32_bf16 v[220:223], v[92:95], v[116:119], v[220:223]
  buffer_load_dwordx4 v[52:55], v12, s[44:47], s69 offen offset:0 sc1
  v_xor_b32 v72, 5, v76
  v_lshl_add_u32 v9, v72, 5, v79
  v_mfma_f32_16x16x32_bf16 v[216:219], v[88:91], v[116:119], v[216:219]
  v_add_u32 v25, 0x10000, v9
  v_mfma_f32_16x16x32_bf16 v[212:215], v[84:87], v[116:119], v[212:215]
  v_xor_b32 v72, 6, v76
  v_mfma_f32_16x16x32_bf16 v[208:211], v[80:83], v[116:119], v[208:211]
  s_mov_b32 s40, s20
  s_mov_b32 s41, s21
  v_lshl_add_u32 v10, v72, 5, v79
  v_add_u32 v26, 0x10000, v10
  v_mfma_f32_16x16x32_bf16 v[224:227], v[80:83], v[120:123], v[224:227]
  s_mov_b32 s42, 0xe00
  v_xor_b32 v72, 7, v76
  v_mfma_f32_16x16x32_bf16 v[228:231], v[84:87], v[120:123], v[228:231]
  s_mov_b32 s43, 0x20000
  v_lshl_add_u32 v11, v72, 5, v79
  v_add_u32 v27, 0x10000, v11
  v_mfma_f32_16x16x32_bf16 v[232:235], v[88:91], v[120:123], v[232:235]
  v_lshrrev_b32 v30, 4, v1
  v_xor_b32 v72, 0, v77
  v_mfma_f32_16x16x32_bf16 v[236:239], v[92:95], v[120:123], v[236:239]
  v_lshlrev_b32 v30, 3, v30
  s_lshl_b32 s63, s57, 7
  v_lshl_add_u32 v16, v72, 5, v13
  v_xor_b32 v72, 1, v77
  v_mfma_f32_16x16x32_bf16 v[252:255], v[92:95], v[124:127], v[252:255]
  buffer_load_dwordx2 v[64:65], v30, s[40:43], s63 offen offset:0
  v_lshl_add_u32 v17, v72, 5, v13
  v_mfma_f32_16x16x32_bf16 v[248:251], v[88:91], v[124:127], v[248:251]
  buffer_load_dwordx2 v[66:67], v30, s[40:43], s63 offen offset:32
  v_xor_b32 v72, 2, v77
  v_lshl_add_u32 v18, v72, 5, v13
  v_mfma_f32_16x16x32_bf16 v[244:247], v[84:87], v[124:127], v[244:247]
  buffer_load_dwordx2 v[68:69], v30, s[40:43], s63 offen offset:64
  v_xor_b32 v72, 3, v77
  v_mfma_f32_16x16x32_bf16 v[240:243], v[80:83], v[124:127], v[240:243]
  buffer_load_dwordx2 v[70:71], v30, s[40:43], s63 offen offset:96
  v_lshl_add_u32 v19, v72, 5, v13
  s_lshl_b32 s60, s57, 20
  s_lshl_b32 s61, s58, 2
  s_add_u32 s61, s61, s59
  s_lshl_b32 s61, s61, 15
  s_add_u32 s60, s60, s61
  s_add_u32 s80, s60, 2113536
  s_add_u32 s81, s80, 4096
  s_add_u32 s82, s80, 8192
  s_add_u32 s83, s80, 12288
  v_cvt_pk_bf16_f32 v80, v128, v129
  v_cvt_pk_bf16_f32 v81, v130, v131
  v_cvt_pk_bf16_f32 v82, v132, v133
  v_cvt_pk_bf16_f32 v83, v134, v135
  buffer_store_dwordx4 v[80:83], v14, s[44:47], s80 offen sc1
  v_cvt_pk_bf16_f32 v84, v144, v145
  v_cvt_pk_bf16_f32 v85, v146, v147
  v_cvt_pk_bf16_f32 v86, v148, v149
  v_cvt_pk_bf16_f32 v87, v150, v151
  buffer_store_dwordx4 v[84:87], v14, s[44:47], s81 offen sc1
  v_cvt_pk_bf16_f32 v88, v136, v137
  v_cvt_pk_bf16_f32 v89, v138, v139
  v_cvt_pk_bf16_f32 v90, v140, v141
  v_cvt_pk_bf16_f32 v91, v142, v143
  buffer_store_dwordx4 v[88:91], v14, s[44:47], s82 offen sc1
  v_cvt_pk_bf16_f32 v92, v152, v153
  v_cvt_pk_bf16_f32 v93, v154, v155
  v_cvt_pk_bf16_f32 v94, v156, v157
  v_cvt_pk_bf16_f32 v95, v158, v159
  buffer_store_dwordx4 v[92:95], v14, s[44:47], s83 offen sc1
  v_cvt_pk_bf16_f32 v112, v160, v161
  v_cvt_pk_bf16_f32 v113, v162, v163
  v_cvt_pk_bf16_f32 v114, v164, v165
  v_cvt_pk_bf16_f32 v115, v166, v167
  v_cvt_pk_bf16_f32 v116, v176, v177
  v_cvt_pk_bf16_f32 v117, v178, v179
  v_cvt_pk_bf16_f32 v118, v180, v181
  v_cvt_pk_bf16_f32 v119, v182, v183
  v_cvt_pk_bf16_f32 v120, v168, v169
  v_cvt_pk_bf16_f32 v121, v170, v171
  v_cvt_pk_bf16_f32 v122, v172, v173
  v_cvt_pk_bf16_f32 v123, v174, v175
  v_cvt_pk_bf16_f32 v124, v184, v185
  v_cvt_pk_bf16_f32 v125, v186, v187
  v_cvt_pk_bf16_f32 v126, v188, v189
  v_cvt_pk_bf16_f32 v127, v190, v191
  v_cvt_pk_bf16_f32 v128, v192, v193
  v_cvt_pk_bf16_f32 v129, v194, v195
  v_cvt_pk_bf16_f32 v130, v196, v197
  v_cvt_pk_bf16_f32 v131, v198, v199
  v_cvt_pk_bf16_f32 v132, v208, v209
  v_cvt_pk_bf16_f32 v133, v210, v211
  v_cvt_pk_bf16_f32 v134, v212, v213
  v_cvt_pk_bf16_f32 v135, v214, v215
  v_cvt_pk_bf16_f32 v136, v200, v201
  v_cvt_pk_bf16_f32 v137, v202, v203
  v_cvt_pk_bf16_f32 v138, v204, v205
  v_cvt_pk_bf16_f32 v139, v206, v207
  v_cvt_pk_bf16_f32 v140, v216, v217
  v_cvt_pk_bf16_f32 v141, v218, v219
  v_cvt_pk_bf16_f32 v142, v220, v221
  v_cvt_pk_bf16_f32 v143, v222, v223
  v_cvt_pk_bf16_f32 v144, v224, v225
  v_cvt_pk_bf16_f32 v145, v226, v227
  v_cvt_pk_bf16_f32 v146, v228, v229
  v_cvt_pk_bf16_f32 v147, v230, v231
  v_cvt_pk_bf16_f32 v148, v240, v241
  v_cvt_pk_bf16_f32 v149, v242, v243
  v_cvt_pk_bf16_f32 v150, v244, v245
  v_cvt_pk_bf16_f32 v151, v246, v247
  v_cvt_pk_bf16_f32 v152, v232, v233
  v_cvt_pk_bf16_f32 v153, v234, v235
  v_cvt_pk_bf16_f32 v154, v236, v237
  v_cvt_pk_bf16_f32 v155, v238, v239
  v_cvt_pk_bf16_f32 v156, v248, v249
  v_cvt_pk_bf16_f32 v157, v250, v251
  v_cvt_pk_bf16_f32 v158, v252, v253
  v_cvt_pk_bf16_f32 v159, v254, v255
  s_branch LF1_done
LF1_K:
  s_sub_u32 s62, 15, s58
  s_cmp_lt_u32 s56, 4
  s_cselect_b32 s62, s58, s62
  s_lshl_b32 s62, s62, 2
  s_add_u32 s62, s62, s59
  s_lshl_b32 s76, s62, 5
  v_and_b32 v20, 15, v1
  v_lshrrev_b32 v21, 4, v1
  v_lshrrev_b32 v22, 1, v20
  v_xor_b32 v22, v22, v21
  v_lshlrev_b32 v22, 4, v22
  v_lshl_add_u32 v22, v20, 7, v22
  s_lshl_b32 s63, s59, 13
  v_add_u32 v4, s63, v22
  v_xor_b32 v5, 64, v4
  v_lshrrev_b32 v22, 2, v20
  v_and_b32 v23, 1, v21
  v_lshl_add_u32 v23, v23, 2, v22
  v_lshl_add_u32 v22, v21, 3, v22
  v_lshlrev_b32 v22, 8, v22
  v_and_b32 v24, 3, v1
  v_lshl_add_u32 v22, v24, 3, v22
  s_lshr_b32 s74, s56, 2
  s_lshl_b32 s74, s74, 14
  s_add_u32 s74, s74, 65536
  v_add_u32 v22, s74, v22
  v_xor_b32 v24, 0, v23
  v_lshl_add_u32 v6, v24, 5, v22
  v_xor_b32 v24, 1, v23
  v_lshl_add_u32 v7, v24, 5, v22
  v_xor_b32 v24, 2, v23
  v_lshl_add_u32 v8, v24, 5, v22
  v_xor_b32 v24, 3, v23
  v_lshl_add_u32 v9, v24, 5, v22
  v_xor_b32 v24, 4, v23
  v_lshl_add_u32 v10, v24, 5, v22
  v_xor_b32 v24, 5, v23
  v_lshl_add_u32 v11, v24, 5, v22
  v_xor_b32 v24, 6, v23
  v_lshl_add_u32 v12, v24, 5, v22
  v_xor_b32 v24, 7, v23
  v_lshl_add_u32 v13, v24, 5, v22
  s_mov_b32 s44, s30
  s_mov_b32 s45, s31
  s_mov_b32 s46, 0x2900000
  s_mov_b32 s47, 0x20000
  s_add_u32 s88, s30, 0x5900000
  s_addc_u32 s89, s31, 0
  s_mov_b32 s90, 0x40000
  s_mov_b32 s91, 0x20000
  s_waitcnt vmcnt(0)
  s_barrier
  ds_read_b128 v[32:35], v4 offset:0
  ds_read_b128 v[36:39], v4 offset:2048
  ds_read_b128 v[40:43], v4 offset:4096
  ds_read_b128 v[44:47], v4 offset:6144
  ds_read_b64_tr_b16 v[48:49], v6 offset:0
  ds_read_b64_tr_b16 v[50:51], v6 offset:1024
  ds_read_b64_tr_b16 v[52:53], v7 offset:0
  ds_read_b64_tr_b16 v[54:55], v7 offset:1024
  ds_read_b64_tr_b16 v[56:57], v8 offset:0
  ds_read_b64_tr_b16 v[58:59], v8 offset:1024
  ds_read_b64_tr_b16 v[60:61], v9 offset:0
  ds_read_b64_tr_b16 v[62:63], v9 offset:1024
  ds_read_b64_tr_b16 v[64:65], v10 offset:0
  ds_read_b64_tr_b16 v[66:67], v10 offset:1024
  ds_read_b64_tr_b16 v[68:69], v11 offset:0
  ds_read_b64_tr_b16 v[70:71], v11 offset:1024
  ds_read_b64_tr_b16 v[72:73], v12 offset:0
  ds_read_b64_tr_b16 v[74:75], v12 offset:1024
  ds_read_b64_tr_b16 v[76:77], v13 offset:0
  ds_read_b64_tr_b16 v[78:79], v13 offset:1024
  s_waitcnt lgkmcnt(0)
  v_mfma_f32_16x16x32_bf16 v[128:131], v[48:51], v[32:35], 0
  ds_read_b128 v[80:83], v5 offset:0
  s_lshr_b32 m0, s64, 3
  s_add_u32 m0, m0, 32768
  v_mfma_f32_16x16x32_bf16 v[132:135], v[48:51], v[36:39], 0
  ds_read_b128 v[84:87], v5 offset:2048
  buffer_load_dwordx4 v2, s[36:39], s64 offen lds
  s_lshr_b32 m0, s72, 5
  s_add_u32 m0, m0, s81
  v_mfma_f32_16x16x32_bf16 v[136:139], v[48:51], v[40:43], 0
  ds_read_b128 v[88:91], v5 offset:4096
  buffer_load_dwordx4 v3, s[40:43], s72 offen lds
  s_lshr_b32 m0, s65, 3
  s_add_u32 m0, m0, 32768
  s_lshl_b32 s60, s56, 10
  v_mfma_f32_16x16x32_bf16 v[140:143], v[48:51], v[44:47], 0
  ds_read_b128 v[92:95], v5 offset:6144
  buffer_load_dwordx4 v2, s[36:39], s65 offen lds
  s_lshr_b32 m0, s73, 5
  s_add_u32 m0, m0, s81
  s_add_u32 s60, s60, 131072
  v_mfma_f32_16x16x32_bf16 v[156:159], v[52:55], v[44:47], 0
  buffer_load_dwordx4 v3, s[40:43], s73 offen lds
  s_lshr_b32 m0, s66, 3
  s_add_u32 m0, m0, 32768
  v_add_u32 v20, s60, v14
  v_mfma_f32_16x16x32_bf16 v[152:155], v[52:55], v[40:43], 0
  ds_read_b64_tr_b16 v[96:97], v6 offset:8192
  buffer_load_dwordx4 v2, s[36:39], s66 offen lds
  s_lshr_b32 m0, s78, 5
  s_add_u32 m0, m0, s81
  ds_read_b128 v[16:19], v20
  v_mfma_f32_16x16x32_bf16 v[148:151], v[52:55], v[36:39], 0
  ds_read_b64_tr_b16 v[98:99], v6 offset:9216
  buffer_load_dwordx4 v3, s[40:43], s78 offen lds
  s_lshr_b32 m0, s67, 3
  s_add_u32 m0, m0, 32768
  s_lshl_b32 s61, s2, 3
  v_mfma_f32_16x16x32_bf16 v[144:147], v[52:55], v[32:35], 0
  ds_read_b64_tr_b16 v[100:101], v7 offset:8192
  buffer_load_dwordx4 v2, s[36:39], s67 offen lds
  s_lshr_b32 m0, s79, 5
  s_add_u32 m0, m0, s81
  s_add_u32 s61, s61, s56
  v_mfma_f32_16x16x32_bf16 v[160:163], v[56:59], v[32:35], 0
  ds_read_b64_tr_b16 v[102:103], v7 offset:9216
  buffer_load_dwordx4 v3, s[40:43], s79 offen lds
  s_lshr_b32 m0, s68, 3
  s_add_u32 m0, m0, 32768
  s_lshl_b32 s61, s61, 10
  v_mfma_f32_16x16x32_bf16 v[164:167], v[56:59], v[36:39], 0
  buffer_load_dwordx4 v2, s[36:39], s68 offen lds
  s_lshr_b32 m0, s72, 5
  s_add_u32 m0, m0, s80
  v_mfma_f32_16x16x32_bf16 v[168:171], v[56:59], v[40:43], 0
  ds_read_b64_tr_b16 v[104:105], v8 offset:8192
  buffer_load_dwordx4 v3, s[48:51], s72 offen lds
  s_lshr_b32 m0, s69, 3
  s_add_u32 m0, m0, 32768
  v_mfma_f32_16x16x32_bf16 v[172:175], v[56:59], v[44:47], 0
  ds_read_b64_tr_b16 v[106:107], v8 offset:9216
  buffer_load_dwordx4 v2, s[36:39], s69 offen lds
  s_lshr_b32 m0, s73, 5
  s_add_u32 m0, m0, s80
  v_mfma_f32_16x16x32_bf16 v[188:191], v[60:63], v[44:47], 0
  ds_read_b64_tr_b16 v[108:109], v9 offset:8192
  buffer_load_dwordx4 v3, s[48:51], s73 offen lds
  s_lshr_b32 m0, s70, 3
  s_add_u32 m0, m0, 32768
  v_mfma_f32_16x16x32_bf16 v[184:187], v[60:63], v[40:43], 0
  ds_read_b64_tr_b16 v[110:111], v9 offset:9216
  buffer_load_dwordx4 v2, s[36:39], s70 offen lds
  s_lshr_b32 m0, s78, 5
  s_add_u32 m0, m0, s80
  v_mfma_f32_16x16x32_bf16 v[180:183], v[60:63], v[36:39], 0
  buffer_load_dwordx4 v3, s[48:51], s78 offen lds
  s_lshr_b32 m0, s71, 3
  s_add_u32 m0, m0, 32768
  s_waitcnt lgkmcnt(7)
  buffer_store_dwordx4 v[16:19], v14, s[44:47], s61 offen sc1
  v_mfma_f32_16x16x32_bf16 v[176:179], v[60:63], v[32:35], 0
  ds_read_b64_tr_b16 v[112:113], v10 offset:8192
  buffer_load_dwordx4 v2, s[36:39], s71 offen lds
  s_lshr_b32 m0, s79, 5
  s_add_u32 m0, m0, s80
  v_mfma_f32_16x16x32_bf16 v[192:195], v[64:67], v[32:35], 0
  ds_read_b64_tr_b16 v[114:115], v10 offset:9216
  buffer_load_dwordx4 v3, s[48:51], s79 offen lds
  v_mfma_f32_16x16x32_bf16 v[196:199], v[64:67], v[36:39], 0
  ds_read_b64_tr_b16 v[116:117], v11 offset:8192
  v_mfma_f32_16x16x32_bf16 v[200:203], v[64:67], v[40:43], 0
  ds_read_b64_tr_b16 v[118:119], v11 offset:9216
  v_add_u32 v2, 128, v2
  s_xor_b32 s81, s81, 32768
  v_mfma_f32_16x16x32_bf16 v[204:207], v[64:67], v[44:47], 0
  v_add_u32 v3, 0x80000, v3
  s_xor_b32 s80, s80, 32768
  v_mfma_f32_16x16x32_bf16 v[220:223], v[68:71], v[44:47], 0
  ds_read_b64_tr_b16 v[120:121], v12 offset:8192
  v_mfma_f32_16x16x32_bf16 v[216:219], v[68:71], v[40:43], 0
  ds_read_b64_tr_b16 v[122:123], v12 offset:9216
  v_mfma_f32_16x16x32_bf16 v[212:215], v[68:71], v[36:39], 0
  ds_read_b64_tr_b16 v[124:125], v13 offset:8192
  v_mfma_f32_16x16x32_bf16 v[208:211], v[68:71], v[32:35], 0
  ds_read_b64_tr_b16 v[126:127], v13 offset:9216
  v_mfma_f32_16x16x32_bf16 v[224:227], v[72:75], v[32:35], 0
  v_mfma_f32_16x16x32_bf16 v[228:231], v[72:75], v[36:39], 0
  v_mfma_f32_16x16x32_bf16 v[232:235], v[72:75], v[40:43], 0
  v_mfma_f32_16x16x32_bf16 v[236:239], v[72:75], v[44:47], 0
  v_mfma_f32_16x16x32_bf16 v[252:255], v[76:79], v[44:47], 0
  v_mfma_f32_16x16x32_bf16 v[248:251], v[76:79], v[40:43], 0
  v_mfma_f32_16x16x32_bf16 v[244:247], v[76:79], v[36:39], 0
  v_mfma_f32_16x16x32_bf16 v[240:243], v[76:79], v[32:35], 0
  s_waitcnt vmcnt(0) lgkmcnt(0)
  s_barrier
  v_mfma_f32_16x16x32_bf16 v[128:131], v[96:99], v[80:83], v[128:131]
  ds_read_b128 v[32:35], v4 offset:32768
  s_lshr_b32 m0, s64, 3
  v_mfma_f32_16x16x32_bf16 v[132:135], v[96:99], v[84:87], v[132:135]
  ds_read_b128 v[36:39], v4 offset:34816
  buffer_load_dwordx4 v2, s[36:39], s64 offen lds
  v_mfma_f32_16x16x32_bf16 v[136:139], v[96:99], v[88:91], v[136:139]
  ds_read_b128 v[40:43], v4 offset:36864
  s_lshr_b32 m0, s72, 5
  s_add_u32 m0, m0, s81
  v_mfma_f32_16x16x32_bf16 v[140:143], v[96:99], v[92:95], v[140:143]
  ds_read_b128 v[44:47], v4 offset:38912
  buffer_load_dwordx4 v3, s[40:43], s72 offen lds
  v_mfma_f32_16x16x32_bf16 v[156:159], v[100:103], v[92:95], v[156:159]
  v_mfma_f32_16x16x32_bf16 v[152:155], v[100:103], v[88:91], v[152:155]
  ds_read_b64_tr_b16 v[48:49], v6 offset:32768
  s_lshr_b32 m0, s65, 3
  v_mfma_f32_16x16x32_bf16 v[148:151], v[100:103], v[84:87], v[148:151]
  ds_read_b64_tr_b16 v[50:51], v6 offset:33792
  buffer_load_dwordx4 v2, s[36:39], s65 offen lds
  v_mfma_f32_16x16x32_bf16 v[144:147], v[100:103], v[80:83], v[144:147]
  ds_read_b64_tr_b16 v[52:53], v7 offset:32768
  v_mfma_f32_16x16x32_bf16 v[160:163], v[104:107], v[80:83], v[160:163]
  ds_read_b64_tr_b16 v[54:55], v7 offset:33792
  s_lshr_b32 m0, s73, 5
  s_add_u32 m0, m0, s81
  v_mfma_f32_16x16x32_bf16 v[164:167], v[104:107], v[84:87], v[164:167]
  buffer_load_dwordx4 v3, s[40:43], s73 offen lds
  v_mfma_f32_16x16x32_bf16 v[168:171], v[104:107], v[88:91], v[168:171]
  ds_read_b64_tr_b16 v[56:57], v8 offset:32768
  v_mfma_f32_16x16x32_bf16 v[172:175], v[104:107], v[92:95], v[172:175]
  ds_read_b64_tr_b16 v[58:59], v8 offset:33792
  s_lshr_b32 m0, s66, 3
  v_mfma_f32_16x16x32_bf16 v[188:191], v[108:111], v[92:95], v[188:191]
  ds_read_b64_tr_b16 v[60:61], v9 offset:32768
  buffer_load_dwordx4 v2, s[36:39], s66 offen lds
  v_mfma_f32_16x16x32_bf16 v[184:187], v[108:111], v[88:91], v[184:187]
  ds_read_b64_tr_b16 v[62:63], v9 offset:33792
  v_mfma_f32_16x16x32_bf16 v[180:183], v[108:111], v[84:87], v[180:183]
  s_lshr_b32 m0, s78, 5
  s_add_u32 m0, m0, s81
  v_mfma_f32_16x16x32_bf16 v[176:179], v[108:111], v[80:83], v[176:179]
  ds_read_b64_tr_b16 v[64:65], v10 offset:32768
  buffer_load_dwordx4 v3, s[40:43], s78 offen lds
  v_mfma_f32_16x16x32_bf16 v[192:195], v[112:115], v[80:83], v[192:195]
  ds_read_b64_tr_b16 v[66:67], v10 offset:33792
  v_mfma_f32_16x16x32_bf16 v[196:199], v[112:115], v[84:87], v[196:199]
  ds_read_b64_tr_b16 v[68:69], v11 offset:32768
  s_lshr_b32 m0, s67, 3
  v_mfma_f32_16x16x32_bf16 v[200:203], v[112:115], v[88:91], v[200:203]
  ds_read_b64_tr_b16 v[70:71], v11 offset:33792
  buffer_load_dwordx4 v2, s[36:39], s67 offen lds
  v_mfma_f32_16x16x32_bf16 v[204:207], v[112:115], v[92:95], v[204:207]
  v_mfma_f32_16x16x32_bf16 v[220:223], v[116:119], v[92:95], v[220:223]
  ds_read_b64_tr_b16 v[72:73], v12 offset:32768
  s_lshr_b32 m0, s79, 5
  s_add_u32 m0, m0, s81
  v_mfma_f32_16x16x32_bf16 v[216:219], v[116:119], v[88:91], v[216:219]
  ds_read_b64_tr_b16 v[74:75], v12 offset:33792
  buffer_load_dwordx4 v3, s[40:43], s79 offen lds
  v_mfma_f32_16x16x32_bf16 v[212:215], v[116:119], v[84:87], v[212:215]
  ds_read_b64_tr_b16 v[76:77], v13 offset:32768
  v_mfma_f32_16x16x32_bf16 v[208:211], v[116:119], v[80:83], v[208:211]
  ds_read_b64_tr_b16 v[78:79], v13 offset:33792
  s_lshr_b32 m0, s68, 3
  v_mfma_f32_16x16x32_bf16 v[224:227], v[120:123], v[80:83], v[224:227]
  buffer_load_dwordx4 v2, s[36:39], s68 offen lds
  v_mfma_f32_16x16x32_bf16 v[228:231], v[120:123], v[84:87], v[228:231]
  v_mfma_f32_16x16x32_bf16 v[232:235], v[120:123], v[88:91], v[232:235]
  s_lshr_b32 m0, s72, 5
  s_add_u32 m0, m0, s80
  v_mfma_f32_16x16x32_bf16 v[236:239], v[120:123], v[92:95], v[236:239]
  buffer_load_dwordx4 v3, s[48:51], s72 offen lds
  v_mfma_f32_16x16x32_bf16 v[252:255], v[124:127], v[92:95], v[252:255]
  v_mfma_f32_16x16x32_bf16 v[248:251], v[124:127], v[88:91], v[248:251]
  s_lshr_b32 m0, s69, 3
  v_mfma_f32_16x16x32_bf16 v[244:247], v[124:127], v[84:87], v[244:247]
  buffer_load_dwordx4 v2, s[36:39], s69 offen lds
  v_mfma_f32_16x16x32_bf16 v[240:243], v[124:127], v[80:83], v[240:243]
  s_waitcnt lgkmcnt(0)
  v_mfma_f32_16x16x32_bf16 v[128:131], v[48:51], v[32:35], v[128:131]
  ds_read_b128 v[80:83], v5 offset:32768
  s_lshr_b32 m0, s73, 5
  s_add_u32 m0, m0, s80
  v_mfma_f32_16x16x32_bf16 v[132:135], v[48:51], v[36:39], v[132:135]
  ds_read_b128 v[84:87], v5 offset:34816
  buffer_load_dwordx4 v3, s[48:51], s73 offen lds
  v_mfma_f32_16x16x32_bf16 v[136:139], v[48:51], v[40:43], v[136:139]
  ds_read_b128 v[88:91], v5 offset:36864
  v_mfma_f32_16x16x32_bf16 v[140:143], v[48:51], v[44:47], v[140:143]
  ds_read_b128 v[92:95], v5 offset:38912
  s_lshr_b32 m0, s70, 3
  v_mfma_f32_16x16x32_bf16 v[156:159], v[52:55], v[44:47], v[156:159]
  buffer_load_dwordx4 v2, s[36:39], s70 offen lds
  v_mfma_f32_16x16x32_bf16 v[152:155], v[52:55], v[40:43], v[152:155]
  ds_read_b64_tr_b16 v[96:97], v6 offset:40960
  v_mfma_f32_16x16x32_bf16 v[148:151], v[52:55], v[36:39], v[148:151]
  ds_read_b64_tr_b16 v[98:99], v6 offset:41984
  s_lshr_b32 m0, s78, 5
  s_add_u32 m0, m0, s80
  v_mfma_f32_16x16x32_bf16 v[144:147], v[52:55], v[32:35], v[144:147]
  ds_read_b64_tr_b16 v[100:101], v7 offset:40960
  buffer_load_dwordx4 v3, s[48:51], s78 offen lds
  v_mfma_f32_16x16x32_bf16 v[160:163], v[56:59], v[32:35], v[160:163]
  ds_read_b64_tr_b16 v[102:103], v7 offset:41984
  v_mfma_f32_16x16x32_bf16 v[164:167], v[56:59], v[36:39], v[164:167]
  s_lshr_b32 m0, s71, 3
  v_mfma_f32_16x16x32_bf16 v[168:171], v[56:59], v[40:43], v[168:171]
  ds_read_b64_tr_b16 v[104:105], v8 offset:40960
  buffer_load_dwordx4 v2, s[36:39], s71 offen lds
  v_mfma_f32_16x16x32_bf16 v[172:175], v[56:59], v[44:47], v[172:175]
  ds_read_b64_tr_b16 v[106:107], v8 offset:41984
  v_mfma_f32_16x16x32_bf16 v[188:191], v[60:63], v[44:47], v[188:191]
  ds_read_b64_tr_b16 v[108:109], v9 offset:40960
  s_lshr_b32 m0, s79, 5
  s_add_u32 m0, m0, s80
  v_mfma_f32_16x16x32_bf16 v[184:187], v[60:63], v[40:43], v[184:187]
  ds_read_b64_tr_b16 v[110:111], v9 offset:41984
  buffer_load_dwordx4 v3, s[48:51], s79 offen lds
  v_mfma_f32_16x16x32_bf16 v[180:183], v[60:63], v[36:39], v[180:183]
  v_mfma_f32_16x16x32_bf16 v[176:179], v[60:63], v[32:35], v[176:179]
  ds_read_b64_tr_b16 v[112:113], v10 offset:40960
  v_mfma_f32_16x16x32_bf16 v[192:195], v[64:67], v[32:35], v[192:195]
  ds_read_b64_tr_b16 v[114:115], v10 offset:41984
  v_add_u32 v2, 128, v2
  s_xor_b32 s81, s81, 32768
  v_mfma_f32_16x16x32_bf16 v[196:199], v[64:67], v[36:39], v[196:199]
  ds_read_b64_tr_b16 v[116:117], v11 offset:40960
  v_add_u32 v3, 0x80000, v3
  s_xor_b32 s80, s80, 32768
  v_mfma_f32_16x16x32_bf16 v[200:203], v[64:67], v[40:43], v[200:203]
  ds_read_b64_tr_b16 v[118:119], v11 offset:41984
  v_mfma_f32_16x16x32_bf16 v[204:207], v[64:67], v[44:47], v[204:207]
  v_mfma_f32_16x16x32_bf16 v[220:223], v[68:71], v[44:47], v[220:223]
  ds_read_b64_tr_b16 v[120:121], v12 offset:40960
  v_mfma_f32_16x16x32_bf16 v[216:219], v[68:71], v[40:43], v[216:219]
  ds_read_b64_tr_b16 v[122:123], v12 offset:41984
  v_mfma_f32_16x16x32_bf16 v[212:215], v[68:71], v[36:39], v[212:215]
  ds_read_b64_tr_b16 v[124:125], v13 offset:40960
  v_mfma_f32_16x16x32_bf16 v[208:211], v[68:71], v[32:35], v[208:211]
  ds_read_b64_tr_b16 v[126:127], v13 offset:41984
  v_mfma_f32_16x16x32_bf16 v[224:227], v[72:75], v[32:35], v[224:227]
  v_mfma_f32_16x16x32_bf16 v[228:231], v[72:75], v[36:39], v[228:231]
  v_mfma_f32_16x16x32_bf16 v[232:235], v[72:75], v[40:43], v[232:235]
  v_mfma_f32_16x16x32_bf16 v[236:239], v[72:75], v[44:47], v[236:239]
  v_mfma_f32_16x16x32_bf16 v[252:255], v[76:79], v[44:47], v[252:255]
  v_mfma_f32_16x16x32_bf16 v[248:251], v[76:79], v[40:43], v[248:251]
  v_mfma_f32_16x16x32_bf16 v[244:247], v[76:79], v[36:39], v[244:247]
  v_mfma_f32_16x16x32_bf16 v[240:243], v[76:79], v[32:35], v[240:243]
  s_waitcnt vmcnt(0) lgkmcnt(0)
  s_barrier
  v_mfma_f32_16x16x32_bf16 v[128:131], v[96:99], v[80:83], v[128:131]
  ds_read_b128 v[32:35], v4 offset:0
  s_lshr_b32 m0, s64, 3
  s_add_u32 m0, m0, 32768
  v_mfma_f32_16x16x32_bf16 v[132:135], v[96:99], v[84:87], v[132:135]
  ds_read_b128 v[36:39], v4 offset:2048
  buffer_load_dwordx4 v2, s[36:39], s64 offen lds
  v_mfma_f32_16x16x32_bf16 v[136:139], v[96:99], v[88:91], v[136:139]
  ds_read_b128 v[40:43], v4 offset:4096
  s_lshr_b32 m0, s72, 5
  s_add_u32 m0, m0, s81
  v_mfma_f32_16x16x32_bf16 v[140:143], v[96:99], v[92:95], v[140:143]
  ds_read_b128 v[44:47], v4 offset:6144
  buffer_load_dwordx4 v3, s[40:43], s72 offen lds
  v_mfma_f32_16x16x32_bf16 v[156:159], v[100:103], v[92:95], v[156:159]
  v_mfma_f32_16x16x32_bf16 v[152:155], v[100:103], v[88:91], v[152:155]
  ds_read_b64_tr_b16 v[48:49], v6 offset:0
  s_lshr_b32 m0, s65, 3
  s_add_u32 m0, m0, 32768
  v_mfma_f32_16x16x32_bf16 v[148:151], v[100:103], v[84:87], v[148:151]
  ds_read_b64_tr_b16 v[50:51], v6 offset:1024
  buffer_load_dwordx4 v2, s[36:39], s65 offen lds
  v_mfma_f32_16x16x32_bf16 v[144:147], v[100:103], v[80:83], v[144:147]
  ds_read_b64_tr_b16 v[52:53], v7 offset:0
  v_mfma_f32_16x16x32_bf16 v[160:163], v[104:107], v[80:83], v[160:163]
  ds_read_b64_tr_b16 v[54:55], v7 offset:1024
  s_lshr_b32 m0, s73, 5
  s_add_u32 m0, m0, s81
  v_mfma_f32_16x16x32_bf16 v[164:167], v[104:107], v[84:87], v[164:167]
  buffer_load_dwordx4 v3, s[40:43], s73 offen lds
  v_mfma_f32_16x16x32_bf16 v[168:171], v[104:107], v[88:91], v[168:171]
  ds_read_b64_tr_b16 v[56:57], v8 offset:0
  v_mfma_f32_16x16x32_bf16 v[172:175], v[104:107], v[92:95], v[172:175]
  ds_read_b64_tr_b16 v[58:59], v8 offset:1024
  s_lshr_b32 m0, s66, 3
  s_add_u32 m0, m0, 32768
  v_mfma_f32_16x16x32_bf16 v[188:191], v[108:111], v[92:95], v[188:191]
  ds_read_b64_tr_b16 v[60:61], v9 offset:0
  buffer_load_dwordx4 v2, s[36:39], s66 offen lds
  v_mfma_f32_16x16x32_bf16 v[184:187], v[108:111], v[88:91], v[184:187]
  ds_read_b64_tr_b16 v[62:63], v9 offset:1024
  v_mfma_f32_16x16x32_bf16 v[180:183], v[108:111], v[84:87], v[180:183]
  s_lshr_b32 m0, s78, 5
  s_add_u32 m0, m0, s81
  v_mfma_f32_16x16x32_bf16 v[176:179], v[108:111], v[80:83], v[176:179]
  ds_read_b64_tr_b16 v[64:65], v10 offset:0
  buffer_load_dwordx4 v3, s[40:43], s78 offen lds
  v_mfma_f32_16x16x32_bf16 v[192:195], v[112:115], v[80:83], v[192:195]
  ds_read_b64_tr_b16 v[66:67], v10 offset:1024
  v_mfma_f32_16x16x32_bf16 v[196:199], v[112:115], v[84:87], v[196:199]
  ds_read_b64_tr_b16 v[68:69], v11 offset:0
  s_lshr_b32 m0, s67, 3
  s_add_u32 m0, m0, 32768
  v_mfma_f32_16x16x32_bf16 v[200:203], v[112:115], v[88:91], v[200:203]
  ds_read_b64_tr_b16 v[70:71], v11 offset:1024
  buffer_load_dwordx4 v2, s[36:39], s67 offen lds
  v_mfma_f32_16x16x32_bf16 v[204:207], v[112:115], v[92:95], v[204:207]
  v_mfma_f32_16x16x32_bf16 v[220:223], v[116:119], v[92:95], v[220:223]
  ds_read_b64_tr_b16 v[72:73], v12 offset:0
  s_lshr_b32 m0, s79, 5
  s_add_u32 m0, m0, s81
  v_mfma_f32_16x16x32_bf16 v[216:219], v[116:119], v[88:91], v[216:219]
  ds_read_b64_tr_b16 v[74:75], v12 offset:1024
  buffer_load_dwordx4 v3, s[40:43], s79 offen lds
  v_mfma_f32_16x16x32_bf16 v[212:215], v[116:119], v[84:87], v[212:215]
  ds_read_b64_tr_b16 v[76:77], v13 offset:0
  v_mfma_f32_16x16x32_bf16 v[208:211], v[116:119], v[80:83], v[208:211]
  ds_read_b64_tr_b16 v[78:79], v13 offset:1024
  s_lshr_b32 m0, s68, 3
  s_add_u32 m0, m0, 32768
  v_mfma_f32_16x16x32_bf16 v[224:227], v[120:123], v[80:83], v[224:227]
  buffer_load_dwordx4 v2, s[36:39], s68 offen lds
  v_mfma_f32_16x16x32_bf16 v[228:231], v[120:123], v[84:87], v[228:231]
  v_mfma_f32_16x16x32_bf16 v[232:235], v[120:123], v[88:91], v[232:235]
  s_lshr_b32 m0, s72, 5
  s_add_u32 m0, m0, s80
  v_mfma_f32_16x16x32_bf16 v[236:239], v[120:123], v[92:95], v[236:239]
  buffer_load_dwordx4 v3, s[48:51], s72 offen lds
  v_mfma_f32_16x16x32_bf16 v[252:255], v[124:127], v[92:95], v[252:255]
  v_mfma_f32_16x16x32_bf16 v[248:251], v[124:127], v[88:91], v[248:251]
  s_lshr_b32 m0, s69, 3
  s_add_u32 m0, m0, 32768
  v_mfma_f32_16x16x32_bf16 v[244:247], v[124:127], v[84:87], v[244:247]
  buffer_load_dwordx4 v2, s[36:39], s69 offen lds
  v_mfma_f32_16x16x32_bf16 v[240:243], v[124:127], v[80:83], v[240:243]
  s_waitcnt lgkmcnt(0)
  v_mfma_f32_16x16x32_bf16 v[128:131], v[48:51], v[32:35], v[128:131]
  ds_read_b128 v[80:83], v5 offset:0
  s_lshr_b32 m0, s73, 5
  s_add_u32 m0, m0, s80
  v_mfma_f32_16x16x32_bf16 v[132:135], v[48:51], v[36:39], v[132:135]
  ds_read_b128 v[84:87], v5 offset:2048
  buffer_load_dwordx4 v3, s[48:51], s73 offen lds
  v_mfma_f32_16x16x32_bf16 v[136:139], v[48:51], v[40:43], v[136:139]
  ds_read_b128 v[88:91], v5 offset:4096
  v_mfma_f32_16x16x32_bf16 v[140:143], v[48:51], v[44:47], v[140:143]
  ds_read_b128 v[92:95], v5 offset:6144
  s_lshr_b32 m0, s70, 3
  s_add_u32 m0, m0, 32768
  v_mfma_f32_16x16x32_bf16 v[156:159], v[52:55], v[44:47], v[156:159]
  buffer_load_dwordx4 v2, s[36:39], s70 offen lds
  v_mfma_f32_16x16x32_bf16 v[152:155], v[52:55], v[40:43], v[152:155]
  ds_read_b64_tr_b16 v[96:97], v6 offset:8192
  v_mfma_f32_16x16x32_bf16 v[148:151], v[52:55], v[36:39], v[148:151]
  ds_read_b64_tr_b16 v[98:99], v6 offset:9216
  s_lshr_b32 m0, s78, 5
  s_add_u32 m0, m0, s80
  v_mfma_f32_16x16x32_bf16 v[144:147], v[52:55], v[32:35], v[144:147]
  ds_read_b64_tr_b16 v[100:101], v7 offset:8192
  buffer_load_dwordx4 v3, s[48:51], s78 offen lds
  v_mfma_f32_16x16x32_bf16 v[160:163], v[56:59], v[32:35], v[160:163]
  ds_read_b64_tr_b16 v[102:103], v7 offset:9216
  v_mfma_f32_16x16x32_bf16 v[164:167], v[56:59], v[36:39], v[164:167]
  s_lshr_b32 m0, s71, 3
  s_add_u32 m0, m0, 32768
  v_mfma_f32_16x16x32_bf16 v[168:171], v[56:59], v[40:43], v[168:171]
  ds_read_b64_tr_b16 v[104:105], v8 offset:8192
  buffer_load_dwordx4 v2, s[36:39], s71 offen lds
  v_mfma_f32_16x16x32_bf16 v[172:175], v[56:59], v[44:47], v[172:175]
  ds_read_b64_tr_b16 v[106:107], v8 offset:9216
  v_mfma_f32_16x16x32_bf16 v[188:191], v[60:63], v[44:47], v[188:191]
  ds_read_b64_tr_b16 v[108:109], v9 offset:8192
  s_lshr_b32 m0, s79, 5
  s_add_u32 m0, m0, s80
  v_mfma_f32_16x16x32_bf16 v[184:187], v[60:63], v[40:43], v[184:187]
  ds_read_b64_tr_b16 v[110:111], v9 offset:9216
  buffer_load_dwordx4 v3, s[48:51], s79 offen lds
  v_mfma_f32_16x16x32_bf16 v[180:183], v[60:63], v[36:39], v[180:183]
  v_mfma_f32_16x16x32_bf16 v[176:179], v[60:63], v[32:35], v[176:179]
  ds_read_b64_tr_b16 v[112:113], v10 offset:8192
  v_mfma_f32_16x16x32_bf16 v[192:195], v[64:67], v[32:35], v[192:195]
  ds_read_b64_tr_b16 v[114:115], v10 offset:9216
  v_add_u32 v2, 128, v2
  s_xor_b32 s81, s81, 32768
  v_mfma_f32_16x16x32_bf16 v[196:199], v[64:67], v[36:39], v[196:199]
  ds_read_b64_tr_b16 v[116:117], v11 offset:8192
  v_add_u32 v3, 0x80000, v3
  s_xor_b32 s80, s80, 32768
  v_mfma_f32_16x16x32_bf16 v[200:203], v[64:67], v[40:43], v[200:203]
  ds_read_b64_tr_b16 v[118:119], v11 offset:9216
  v_mfma_f32_16x16x32_bf16 v[204:207], v[64:67], v[44:47], v[204:207]
  v_mfma_f32_16x16x32_bf16 v[220:223], v[68:71], v[44:47], v[220:223]
  ds_read_b64_tr_b16 v[120:121], v12 offset:8192
  v_mfma_f32_16x16x32_bf16 v[216:219], v[68:71], v[40:43], v[216:219]
  ds_read_b64_tr_b16 v[122:123], v12 offset:9216
  v_mfma_f32_16x16x32_bf16 v[212:215], v[68:71], v[36:39], v[212:215]
  ds_read_b64_tr_b16 v[124:125], v13 offset:8192
  v_mfma_f32_16x16x32_bf16 v[208:211], v[68:71], v[32:35], v[208:211]
  ds_read_b64_tr_b16 v[126:127], v13 offset:9216
  v_mfma_f32_16x16x32_bf16 v[224:227], v[72:75], v[32:35], v[224:227]
  v_mfma_f32_16x16x32_bf16 v[228:231], v[72:75], v[36:39], v[228:231]
  v_mfma_f32_16x16x32_bf16 v[232:235], v[72:75], v[40:43], v[232:235]
  v_mfma_f32_16x16x32_bf16 v[236:239], v[72:75], v[44:47], v[236:239]
  v_mfma_f32_16x16x32_bf16 v[252:255], v[76:79], v[44:47], v[252:255]
  v_mfma_f32_16x16x32_bf16 v[248:251], v[76:79], v[40:43], v[248:251]
  v_mfma_f32_16x16x32_bf16 v[244:247], v[76:79], v[36:39], v[244:247]
  v_mfma_f32_16x16x32_bf16 v[240:243], v[76:79], v[32:35], v[240:243]
  s_waitcnt vmcnt(0) lgkmcnt(0)
  s_barrier
  v_mfma_f32_16x16x32_bf16 v[128:131], v[96:99], v[80:83], v[128:131]
  ds_read_b128 v[32:35], v4 offset:32768
  s_lshr_b32 m0, s64, 3
  v_mfma_f32_16x16x32_bf16 v[132:135], v[96:99], v[84:87], v[132:135]
  ds_read_b128 v[36:39], v4 offset:34816
  buffer_load_dwordx4 v2, s[36:39], s64 offen lds
  v_mfma_f32_16x16x32_bf16 v[136:139], v[96:99], v[88:91], v[136:139]
  ds_read_b128 v[40:43], v4 offset:36864
  s_lshr_b32 m0, s72, 5
  s_add_u32 m0, m0, s81
  v_mfma_f32_16x16x32_bf16 v[140:143], v[96:99], v[92:95], v[140:143]
  ds_read_b128 v[44:47], v4 offset:38912
  buffer_load_dwordx4 v3, s[40:43], s72 offen lds
  v_mfma_f32_16x16x32_bf16 v[156:159], v[100:103], v[92:95], v[156:159]
  v_mfma_f32_16x16x32_bf16 v[152:155], v[100:103], v[88:91], v[152:155]
  ds_read_b64_tr_b16 v[48:49], v6 offset:32768
  s_lshr_b32 m0, s65, 3
  v_mfma_f32_16x16x32_bf16 v[148:151], v[100:103], v[84:87], v[148:151]
  ds_read_b64_tr_b16 v[50:51], v6 offset:33792
  buffer_load_dwordx4 v2, s[36:39], s65 offen lds
  v_mfma_f32_16x16x32_bf16 v[144:147], v[100:103], v[80:83], v[144:147]
  ds_read_b64_tr_b16 v[52:53], v7 offset:32768
  v_mfma_f32_16x16x32_bf16 v[160:163], v[104:107], v[80:83], v[160:163]
  ds_read_b64_tr_b16 v[54:55], v7 offset:33792
  s_lshr_b32 m0, s73, 5
  s_add_u32 m0, m0, s81
  v_mfma_f32_16x16x32_bf16 v[164:167], v[104:107], v[84:87], v[164:167]
  buffer_load_dwordx4 v3, s[40:43], s73 offen lds
  v_mfma_f32_16x16x32_bf16 v[168:171], v[104:107], v[88:91], v[168:171]
  ds_read_b64_tr_b16 v[56:57], v8 offset:32768
  v_mfma_f32_16x16x32_bf16 v[172:175], v[104:107], v[92:95], v[172:175]
  ds_read_b64_tr_b16 v[58:59], v8 offset:33792
  s_lshr_b32 m0, s66, 3
  v_mfma_f32_16x16x32_bf16 v[188:191], v[108:111], v[92:95], v[188:191]
  ds_read_b64_tr_b16 v[60:61], v9 offset:32768
  buffer_load_dwordx4 v2, s[36:39], s66 offen lds
  v_mfma_f32_16x16x32_bf16 v[184:187], v[108:111], v[88:91], v[184:187]
  ds_read_b64_tr_b16 v[62:63], v9 offset:33792
  v_mfma_f32_16x16x32_bf16 v[180:183], v[108:111], v[84:87], v[180:183]
  s_lshr_b32 m0, s78, 5
  s_add_u32 m0, m0, s81
  v_mfma_f32_16x16x32_bf16 v[176:179], v[108:111], v[80:83], v[176:179]
  ds_read_b64_tr_b16 v[64:65], v10 offset:32768
  buffer_load_dwordx4 v3, s[40:43], s78 offen lds
  v_mfma_f32_16x16x32_bf16 v[192:195], v[112:115], v[80:83], v[192:195]
  ds_read_b64_tr_b16 v[66:67], v10 offset:33792
  v_mfma_f32_16x16x32_bf16 v[196:199], v[112:115], v[84:87], v[196:199]
  ds_read_b64_tr_b16 v[68:69], v11 offset:32768
  s_lshr_b32 m0, s67, 3
  v_mfma_f32_16x16x32_bf16 v[200:203], v[112:115], v[88:91], v[200:203]
  ds_read_b64_tr_b16 v[70:71], v11 offset:33792
  buffer_load_dwordx4 v2, s[36:39], s67 offen lds
  v_mfma_f32_16x16x32_bf16 v[204:207], v[112:115], v[92:95], v[204:207]
  v_mfma_f32_16x16x32_bf16 v[220:223], v[116:119], v[92:95], v[220:223]
  ds_read_b64_tr_b16 v[72:73], v12 offset:32768
  s_lshr_b32 m0, s79, 5
  s_add_u32 m0, m0, s81
  v_mfma_f32_16x16x32_bf16 v[216:219], v[116:119], v[88:91], v[216:219]
  ds_read_b64_tr_b16 v[74:75], v12 offset:33792
  buffer_load_dwordx4 v3, s[40:43], s79 offen lds
  v_mfma_f32_16x16x32_bf16 v[212:215], v[116:119], v[84:87], v[212:215]
  ds_read_b64_tr_b16 v[76:77], v13 offset:32768
  v_mfma_f32_16x16x32_bf16 v[208:211], v[116:119], v[80:83], v[208:211]
  ds_read_b64_tr_b16 v[78:79], v13 offset:33792
  s_lshr_b32 m0, s68, 3
  v_mfma_f32_16x16x32_bf16 v[224:227], v[120:123], v[80:83], v[224:227]
  buffer_load_dwordx4 v2, s[36:39], s68 offen lds
  v_mfma_f32_16x16x32_bf16 v[228:231], v[120:123], v[84:87], v[228:231]
  v_mfma_f32_16x16x32_bf16 v[232:235], v[120:123], v[88:91], v[232:235]
  s_lshr_b32 m0, s72, 5
  s_add_u32 m0, m0, s80
  v_mfma_f32_16x16x32_bf16 v[236:239], v[120:123], v[92:95], v[236:239]
  buffer_load_dwordx4 v3, s[48:51], s72 offen lds
  v_mfma_f32_16x16x32_bf16 v[252:255], v[124:127], v[92:95], v[252:255]
  v_mfma_f32_16x16x32_bf16 v[248:251], v[124:127], v[88:91], v[248:251]
  s_lshr_b32 m0, s69, 3
  v_mfma_f32_16x16x32_bf16 v[244:247], v[124:127], v[84:87], v[244:247]
  buffer_load_dwordx4 v2, s[36:39], s69 offen lds
  v_mfma_f32_16x16x32_bf16 v[240:243], v[124:127], v[80:83], v[240:243]
  s_waitcnt lgkmcnt(0)
  v_mfma_f32_16x16x32_bf16 v[128:131], v[48:51], v[32:35], v[128:131]
  ds_read_b128 v[80:83], v5 offset:32768
  s_lshr_b32 m0, s73, 5
  s_add_u32 m0, m0, s80
  v_mfma_f32_16x16x32_bf16 v[132:135], v[48:51], v[36:39], v[132:135]
  ds_read_b128 v[84:87], v5 offset:34816
  buffer_load_dwordx4 v3, s[48:51], s73 offen lds
  v_mfma_f32_16x16x32_bf16 v[136:139], v[48:51], v[40:43], v[136:139]
  ds_read_b128 v[88:91], v5 offset:36864
  v_mfma_f32_16x16x32_bf16 v[140:143], v[48:51], v[44:47], v[140:143]
  ds_read_b128 v[92:95], v5 offset:38912
  s_lshr_b32 m0, s70, 3
  v_mfma_f32_16x16x32_bf16 v[156:159], v[52:55], v[44:47], v[156:159]
  buffer_load_dwordx4 v2, s[36:39], s70 offen lds
  v_mfma_f32_16x16x32_bf16 v[152:155], v[52:55], v[40:43], v[152:155]
  ds_read_b64_tr_b16 v[96:97], v6 offset:40960
  v_mfma_f32_16x16x32_bf16 v[148:151], v[52:55], v[36:39], v[148:151]
  ds_read_b64_tr_b16 v[98:99], v6 offset:41984
  s_lshr_b32 m0, s78, 5
  s_add_u32 m0, m0, s80
  v_mfma_f32_16x16x32_bf16 v[144:147], v[52:55], v[32:35], v[144:147]
  ds_read_b64_tr_b16 v[100:101], v7 offset:40960
  buffer_load_dwordx4 v3, s[48:51], s78 offen lds
  v_mfma_f32_16x16x32_bf16 v[160:163], v[56:59], v[32:35], v[160:163]
  ds_read_b64_tr_b16 v[102:103], v7 offset:41984
  v_mfma_f32_16x16x32_bf16 v[164:167], v[56:59], v[36:39], v[164:167]
  s_lshr_b32 m0, s71, 3
  v_mfma_f32_16x16x32_bf16 v[168:171], v[56:59], v[40:43], v[168:171]
  ds_read_b64_tr_b16 v[104:105], v8 offset:40960
  buffer_load_dwordx4 v2, s[36:39], s71 offen lds
  v_mfma_f32_16x16x32_bf16 v[172:175], v[56:59], v[44:47], v[172:175]
  ds_read_b64_tr_b16 v[106:107], v8 offset:41984
  v_mfma_f32_16x16x32_bf16 v[188:191], v[60:63], v[44:47], v[188:191]
  ds_read_b64_tr_b16 v[108:109], v9 offset:40960
  s_lshr_b32 m0, s79, 5
  s_add_u32 m0, m0, s80
  v_mfma_f32_16x16x32_bf16 v[184:187], v[60:63], v[40:43], v[184:187]
  ds_read_b64_tr_b16 v[110:111], v9 offset:41984
  buffer_load_dwordx4 v3, s[48:51], s79 offen lds
  v_mfma_f32_16x16x32_bf16 v[180:183], v[60:63], v[36:39], v[180:183]
  v_mfma_f32_16x16x32_bf16 v[176:179], v[60:63], v[32:35], v[176:179]
  ds_read_b64_tr_b16 v[112:113], v10 offset:40960
  v_mfma_f32_16x16x32_bf16 v[192:195], v[64:67], v[32:35], v[192:195]
  ds_read_b64_tr_b16 v[114:115], v10 offset:41984
  v_add_u32 v2, 128, v2
  s_xor_b32 s81, s81, 32768
  v_mfma_f32_16x16x32_bf16 v[196:199], v[64:67], v[36:39], v[196:199]
  ds_read_b64_tr_b16 v[116:117], v11 offset:40960
  v_add_u32 v3, 0x80000, v3
  s_xor_b32 s80, s80, 32768
  v_mfma_f32_16x16x32_bf16 v[200:203], v[64:67], v[40:43], v[200:203]
  ds_read_b64_tr_b16 v[118:119], v11 offset:41984
  v_mfma_f32_16x16x32_bf16 v[204:207], v[64:67], v[44:47], v[204:207]
  v_mfma_f32_16x16x32_bf16 v[220:223], v[68:71], v[44:47], v[220:223]
  ds_read_b64_tr_b16 v[120:121], v12 offset:40960
  v_mfma_f32_16x16x32_bf16 v[216:219], v[68:71], v[40:43], v[216:219]
  ds_read_b64_tr_b16 v[122:123], v12 offset:41984
  v_mfma_f32_16x16x32_bf16 v[212:215], v[68:71], v[36:39], v[212:215]
  ds_read_b64_tr_b16 v[124:125], v13 offset:40960
  v_mfma_f32_16x16x32_bf16 v[208:211], v[68:71], v[32:35], v[208:211]
  ds_read_b64_tr_b16 v[126:127], v13 offset:41984
  v_mfma_f32_16x16x32_bf16 v[224:227], v[72:75], v[32:35], v[224:227]
  v_mfma_f32_16x16x32_bf16 v[228:231], v[72:75], v[36:39], v[228:231]
  v_mfma_f32_16x16x32_bf16 v[232:235], v[72:75], v[40:43], v[232:235]
  v_mfma_f32_16x16x32_bf16 v[236:239], v[72:75], v[44:47], v[236:239]
  v_mfma_f32_16x16x32_bf16 v[252:255], v[76:79], v[44:47], v[252:255]
  v_mfma_f32_16x16x32_bf16 v[248:251], v[76:79], v[40:43], v[248:251]
  v_mfma_f32_16x16x32_bf16 v[244:247], v[76:79], v[36:39], v[244:247]
  v_mfma_f32_16x16x32_bf16 v[240:243], v[76:79], v[32:35], v[240:243]
  s_waitcnt vmcnt(0) lgkmcnt(0)
  s_barrier
  v_mfma_f32_16x16x32_bf16 v[128:131], v[96:99], v[80:83], v[128:131]
  ds_read_b128 v[32:35], v4 offset:0
  s_lshr_b32 m0, s64, 3
  s_add_u32 m0, m0, 32768
  v_mfma_f32_16x16x32_bf16 v[132:135], v[96:99], v[84:87], v[132:135]
  ds_read_b128 v[36:39], v4 offset:2048
  buffer_load_dwordx4 v2, s[36:39], s64 offen lds
  v_mfma_f32_16x16x32_bf16 v[136:139], v[96:99], v[88:91], v[136:139]
  ds_read_b128 v[40:43], v4 offset:4096
  s_lshr_b32 m0, s72, 5
  s_add_u32 m0, m0, s81
  v_mfma_f32_16x16x32_bf16 v[140:143], v[96:99], v[92:95], v[140:143]
  ds_read_b128 v[44:47], v4 offset:6144
  buffer_load_dwordx4 v3, s[40:43], s72 offen lds
  v_mfma_f32_16x16x32_bf16 v[156:159], v[100:103], v[92:95], v[156:159]
  v_mfma_f32_16x16x32_bf16 v[152:155], v[100:103], v[88:91], v[152:155]
  ds_read_b64_tr_b16 v[48:49], v6 offset:0
  s_lshr_b32 m0, s65, 3
  s_add_u32 m0, m0, 32768
  v_mfma_f32_16x16x32_bf16 v[148:151], v[100:103], v[84:87], v[148:151]
  ds_read_b64_tr_b16 v[50:51], v6 offset:1024
  buffer_load_dwordx4 v2, s[36:39], s65 offen lds
  v_mfma_f32_16x16x32_bf16 v[144:147], v[100:103], v[80:83], v[144:147]
  ds_read_b64_tr_b16 v[52:53], v7 offset:0
  v_mfma_f32_16x16x32_bf16 v[160:163], v[104:107], v[80:83], v[160:163]
  ds_read_b64_tr_b16 v[54:55], v7 offset:1024
  s_lshr_b32 m0, s73, 5
  s_add_u32 m0, m0, s81
  v_mfma_f32_16x16x32_bf16 v[164:167], v[104:107], v[84:87], v[164:167]
  buffer_load_dwordx4 v3, s[40:43], s73 offen lds
  v_mfma_f32_16x16x32_bf16 v[168:171], v[104:107], v[88:91], v[168:171]
  ds_read_b64_tr_b16 v[56:57], v8 offset:0
  v_mfma_f32_16x16x32_bf16 v[172:175], v[104:107], v[92:95], v[172:175]
  ds_read_b64_tr_b16 v[58:59], v8 offset:1024
  s_lshr_b32 m0, s66, 3
  s_add_u32 m0, m0, 32768
  v_mfma_f32_16x16x32_bf16 v[188:191], v[108:111], v[92:95], v[188:191]
  ds_read_b64_tr_b16 v[60:61], v9 offset:0
  buffer_load_dwordx4 v2, s[36:39], s66 offen lds
  v_mfma_f32_16x16x32_bf16 v[184:187], v[108:111], v[88:91], v[184:187]
  ds_read_b64_tr_b16 v[62:63], v9 offset:1024
  v_mfma_f32_16x16x32_bf16 v[180:183], v[108:111], v[84:87], v[180:183]
  s_lshr_b32 m0, s78, 5
  s_add_u32 m0, m0, s81
  v_mfma_f32_16x16x32_bf16 v[176:179], v[108:111], v[80:83], v[176:179]
  ds_read_b64_tr_b16 v[64:65], v10 offset:0
  buffer_load_dwordx4 v3, s[40:43], s78 offen lds
  v_mfma_f32_16x16x32_bf16 v[192:195], v[112:115], v[80:83], v[192:195]
  ds_read_b64_tr_b16 v[66:67], v10 offset:1024
  v_mfma_f32_16x16x32_bf16 v[196:199], v[112:115], v[84:87], v[196:199]
  ds_read_b64_tr_b16 v[68:69], v11 offset:0
  s_lshr_b32 m0, s67, 3
  s_add_u32 m0, m0, 32768
  v_mfma_f32_16x16x32_bf16 v[200:203], v[112:115], v[88:91], v[200:203]
  ds_read_b64_tr_b16 v[70:71], v11 offset:1024
  buffer_load_dwordx4 v2, s[36:39], s67 offen lds
  v_mfma_f32_16x16x32_bf16 v[204:207], v[112:115], v[92:95], v[204:207]
  v_mfma_f32_16x16x32_bf16 v[220:223], v[116:119], v[92:95], v[220:223]
  ds_read_b64_tr_b16 v[72:73], v12 offset:0
  s_lshr_b32 m0, s79, 5
  s_add_u32 m0, m0, s81
  v_mfma_f32_16x16x32_bf16 v[216:219], v[116:119], v[88:91], v[216:219]
  ds_read_b64_tr_b16 v[74:75], v12 offset:1024
  buffer_load_dwordx4 v3, s[40:43], s79 offen lds
  v_mfma_f32_16x16x32_bf16 v[212:215], v[116:119], v[84:87], v[212:215]
  ds_read_b64_tr_b16 v[76:77], v13 offset:0
  v_mfma_f32_16x16x32_bf16 v[208:211], v[116:119], v[80:83], v[208:211]
  ds_read_b64_tr_b16 v[78:79], v13 offset:1024
  s_lshr_b32 m0, s68, 3
  s_add_u32 m0, m0, 32768
  v_mfma_f32_16x16x32_bf16 v[224:227], v[120:123], v[80:83], v[224:227]
  buffer_load_dwordx4 v2, s[36:39], s68 offen lds
  v_mfma_f32_16x16x32_bf16 v[228:231], v[120:123], v[84:87], v[228:231]
  v_mfma_f32_16x16x32_bf16 v[232:235], v[120:123], v[88:91], v[232:235]
  s_lshr_b32 m0, s72, 5
  s_add_u32 m0, m0, s80
  v_mfma_f32_16x16x32_bf16 v[236:239], v[120:123], v[92:95], v[236:239]
  buffer_load_dwordx4 v3, s[48:51], s72 offen lds
  v_mfma_f32_16x16x32_bf16 v[252:255], v[124:127], v[92:95], v[252:255]
  v_mfma_f32_16x16x32_bf16 v[248:251], v[124:127], v[88:91], v[248:251]
  s_lshr_b32 m0, s69, 3
  s_add_u32 m0, m0, 32768
  v_mfma_f32_16x16x32_bf16 v[244:247], v[124:127], v[84:87], v[244:247]
  buffer_load_dwordx4 v2, s[36:39], s69 offen lds
  v_mfma_f32_16x16x32_bf16 v[240:243], v[124:127], v[80:83], v[240:243]
  s_waitcnt lgkmcnt(0)
  v_mfma_f32_16x16x32_bf16 v[128:131], v[48:51], v[32:35], v[128:131]
  ds_read_b128 v[80:83], v5 offset:0
  s_lshr_b32 m0, s73, 5
  s_add_u32 m0, m0, s80
  v_mfma_f32_16x16x32_bf16 v[132:135], v[48:51], v[36:39], v[132:135]
  ds_read_b128 v[84:87], v5 offset:2048
  buffer_load_dwordx4 v3, s[48:51], s73 offen lds
  v_mfma_f32_16x16x32_bf16 v[136:139], v[48:51], v[40:43], v[136:139]
  ds_read_b128 v[88:91], v5 offset:4096
  v_mfma_f32_16x16x32_bf16 v[140:143], v[48:51], v[44:47], v[140:143]
  ds_read_b128 v[92:95], v5 offset:6144
  s_lshr_b32 m0, s70, 3
  s_add_u32 m0, m0, 32768
  v_mfma_f32_16x16x32_bf16 v[156:159], v[52:55], v[44:47], v[156:159]
  buffer_load_dwordx4 v2, s[36:39], s70 offen lds
  v_mfma_f32_16x16x32_bf16 v[152:155], v[52:55], v[40:43], v[152:155]
  ds_read_b64_tr_b16 v[96:97], v6 offset:8192
  v_mfma_f32_16x16x32_bf16 v[148:151], v[52:55], v[36:39], v[148:151]
  ds_read_b64_tr_b16 v[98:99], v6 offset:9216
  s_lshr_b32 m0, s78, 5
  s_add_u32 m0, m0, s80
  v_mfma_f32_16x16x32_bf16 v[144:147], v[52:55], v[32:35], v[144:147]
  ds_read_b64_tr_b16 v[100:101], v7 offset:8192
  buffer_load_dwordx4 v3, s[48:51], s78 offen lds
  v_mfma_f32_16x16x32_bf16 v[160:163], v[56:59], v[32:35], v[160:163]
  ds_read_b64_tr_b16 v[102:103], v7 offset:9216
  v_mfma_f32_16x16x32_bf16 v[164:167], v[56:59], v[36:39], v[164:167]
  s_lshr_b32 m0, s71, 3
  s_add_u32 m0, m0, 32768
  v_mfma_f32_16x16x32_bf16 v[168:171], v[56:59], v[40:43], v[168:171]
  ds_read_b64_tr_b16 v[104:105], v8 offset:8192
  buffer_load_dwordx4 v2, s[36:39], s71 offen lds
  v_mfma_f32_16x16x32_bf16 v[172:175], v[56:59], v[44:47], v[172:175]
  ds_read_b64_tr_b16 v[106:107], v8 offset:9216
  v_mfma_f32_16x16x32_bf16 v[188:191], v[60:63], v[44:47], v[188:191]
  ds_read_b64_tr_b16 v[108:109], v9 offset:8192
  s_lshr_b32 m0, s79, 5
  s_add_u32 m0, m0, s80
  v_mfma_f32_16x16x32_bf16 v[184:187], v[60:63], v[40:43], v[184:187]
  ds_read_b64_tr_b16 v[110:111], v9 offset:9216
  buffer_load_dwordx4 v3, s[48:51], s79 offen lds
  v_mfma_f32_16x16x32_bf16 v[180:183], v[60:63], v[36:39], v[180:183]
  v_mfma_f32_16x16x32_bf16 v[176:179], v[60:63], v[32:35], v[176:179]
  ds_read_b64_tr_b16 v[112:113], v10 offset:8192
  v_mfma_f32_16x16x32_bf16 v[192:195], v[64:67], v[32:35], v[192:195]
  ds_read_b64_tr_b16 v[114:115], v10 offset:9216
  v_add_u32 v2, 128, v2
  s_xor_b32 s81, s81, 32768
  v_mfma_f32_16x16x32_bf16 v[196:199], v[64:67], v[36:39], v[196:199]
  ds_read_b64_tr_b16 v[116:117], v11 offset:8192
  v_add_u32 v3, 0x80000, v3
  s_xor_b32 s80, s80, 32768
  v_mfma_f32_16x16x32_bf16 v[200:203], v[64:67], v[40:43], v[200:203]
  ds_read_b64_tr_b16 v[118:119], v11 offset:9216
  v_mfma_f32_16x16x32_bf16 v[204:207], v[64:67], v[44:47], v[204:207]
  v_mfma_f32_16x16x32_bf16 v[220:223], v[68:71], v[44:47], v[220:223]
  ds_read_b64_tr_b16 v[120:121], v12 offset:8192
  v_mfma_f32_16x16x32_bf16 v[216:219], v[68:71], v[40:43], v[216:219]
  ds_read_b64_tr_b16 v[122:123], v12 offset:9216
  v_mfma_f32_16x16x32_bf16 v[212:215], v[68:71], v[36:39], v[212:215]
  ds_read_b64_tr_b16 v[124:125], v13 offset:8192
  v_mfma_f32_16x16x32_bf16 v[208:211], v[68:71], v[32:35], v[208:211]
  ds_read_b64_tr_b16 v[126:127], v13 offset:9216
  v_mfma_f32_16x16x32_bf16 v[224:227], v[72:75], v[32:35], v[224:227]
  v_mfma_f32_16x16x32_bf16 v[228:231], v[72:75], v[36:39], v[228:231]
  v_mfma_f32_16x16x32_bf16 v[232:235], v[72:75], v[40:43], v[232:235]
  v_mfma_f32_16x16x32_bf16 v[236:239], v[72:75], v[44:47], v[236:239]
  v_mfma_f32_16x16x32_bf16 v[252:255], v[76:79], v[44:47], v[252:255]
  v_mfma_f32_16x16x32_bf16 v[248:251], v[76:79], v[40:43], v[248:251]
  v_mfma_f32_16x16x32_bf16 v[244:247], v[76:79], v[36:39], v[244:247]
  v_mfma_f32_16x16x32_bf16 v[240:243], v[76:79], v[32:35], v[240:243]
  s_waitcnt vmcnt(0) lgkmcnt(0)
  s_barrier
  v_mfma_f32_16x16x32_bf16 v[128:131], v[96:99], v[80:83], v[128:131]
  ds_read_b128 v[32:35], v4 offset:32768
  s_lshr_b32 m0, s64, 3
  v_mfma_f32_16x16x32_bf16 v[132:135], v[96:99], v[84:87], v[132:135]
  ds_read_b128 v[36:39], v4 offset:34816
  buffer_load_dwordx4 v2, s[36:39], s64 offen lds
  v_mfma_f32_16x16x32_bf16 v[136:139], v[96:99], v[88:91], v[136:139]
  ds_read_b128 v[40:43], v4 offset:36864
  s_lshr_b32 m0, s72, 5
  s_add_u32 m0, m0, s81
  v_mfma_f32_16x16x32_bf16 v[140:143], v[96:99], v[92:95], v[140:143]
  ds_read_b128 v[44:47], v4 offset:38912
  buffer_load_dwordx4 v3, s[40:43], s72 offen lds
  v_mfma_f32_16x16x32_bf16 v[156:159], v[100:103], v[92:95], v[156:159]
  v_mfma_f32_16x16x32_bf16 v[152:155], v[100:103], v[88:91], v[152:155]
  ds_read_b64_tr_b16 v[48:49], v6 offset:32768
  s_lshr_b32 m0, s65, 3
  v_mfma_f32_16x16x32_bf16 v[148:151], v[100:103], v[84:87], v[148:151]
  ds_read_b64_tr_b16 v[50:51], v6 offset:33792
  buffer_load_dwordx4 v2, s[36:39], s65 offen lds
  v_mfma_f32_16x16x32_bf16 v[144:147], v[100:103], v[80:83], v[144:147]
  ds_read_b64_tr_b16 v[52:53], v7 offset:32768
  v_mfma_f32_16x16x32_bf16 v[160:163], v[104:107], v[80:83], v[160:163]
  ds_read_b64_tr_b16 v[54:55], v7 offset:33792
  s_lshr_b32 m0, s73, 5
  s_add_u32 m0, m0, s81
  v_mfma_f32_16x16x32_bf16 v[164:167], v[104:107], v[84:87], v[164:167]
  buffer_load_dwordx4 v3, s[40:43], s73 offen lds
  v_mfma_f32_16x16x32_bf16 v[168:171], v[104:107], v[88:91], v[168:171]
  ds_read_b64_tr_b16 v[56:57], v8 offset:32768
  v_mfma_f32_16x16x32_bf16 v[172:175], v[104:107], v[92:95], v[172:175]
  ds_read_b64_tr_b16 v[58:59], v8 offset:33792
  s_lshr_b32 m0, s66, 3
  v_mfma_f32_16x16x32_bf16 v[188:191], v[108:111], v[92:95], v[188:191]
  ds_read_b64_tr_b16 v[60:61], v9 offset:32768
  buffer_load_dwordx4 v2, s[36:39], s66 offen lds
  v_mfma_f32_16x16x32_bf16 v[184:187], v[108:111], v[88:91], v[184:187]
  ds_read_b64_tr_b16 v[62:63], v9 offset:33792
  v_mfma_f32_16x16x32_bf16 v[180:183], v[108:111], v[84:87], v[180:183]
  s_lshr_b32 m0, s78, 5
  s_add_u32 m0, m0, s81
  v_mfma_f32_16x16x32_bf16 v[176:179], v[108:111], v[80:83], v[176:179]
  ds_read_b64_tr_b16 v[64:65], v10 offset:32768
  buffer_load_dwordx4 v3, s[40:43], s78 offen lds
  v_mfma_f32_16x16x32_bf16 v[192:195], v[112:115], v[80:83], v[192:195]
  ds_read_b64_tr_b16 v[66:67], v10 offset:33792
  v_mfma_f32_16x16x32_bf16 v[196:199], v[112:115], v[84:87], v[196:199]
  ds_read_b64_tr_b16 v[68:69], v11 offset:32768
  s_lshr_b32 m0, s67, 3
  v_mfma_f32_16x16x32_bf16 v[200:203], v[112:115], v[88:91], v[200:203]
  ds_read_b64_tr_b16 v[70:71], v11 offset:33792
  buffer_load_dwordx4 v2, s[36:39], s67 offen lds
  v_mfma_f32_16x16x32_bf16 v[204:207], v[112:115], v[92:95], v[204:207]
  v_mfma_f32_16x16x32_bf16 v[220:223], v[116:119], v[92:95], v[220:223]
  ds_read_b64_tr_b16 v[72:73], v12 offset:32768
  s_lshr_b32 m0, s79, 5
  s_add_u32 m0, m0, s81
  v_mfma_f32_16x16x32_bf16 v[216:219], v[116:119], v[88:91], v[216:219]
  ds_read_b64_tr_b16 v[74:75], v12 offset:33792
  buffer_load_dwordx4 v3, s[40:43], s79 offen lds
  v_mfma_f32_16x16x32_bf16 v[212:215], v[116:119], v[84:87], v[212:215]
  ds_read_b64_tr_b16 v[76:77], v13 offset:32768
  v_mfma_f32_16x16x32_bf16 v[208:211], v[116:119], v[80:83], v[208:211]
  ds_read_b64_tr_b16 v[78:79], v13 offset:33792
  s_lshr_b32 m0, s68, 3
  v_mfma_f32_16x16x32_bf16 v[224:227], v[120:123], v[80:83], v[224:227]
  buffer_load_dwordx4 v2, s[36:39], s68 offen lds
  v_mfma_f32_16x16x32_bf16 v[228:231], v[120:123], v[84:87], v[228:231]
  v_mfma_f32_16x16x32_bf16 v[232:235], v[120:123], v[88:91], v[232:235]
  s_lshr_b32 m0, s72, 5
  s_add_u32 m0, m0, s80
  v_mfma_f32_16x16x32_bf16 v[236:239], v[120:123], v[92:95], v[236:239]
  buffer_load_dwordx4 v3, s[48:51], s72 offen lds
  v_mfma_f32_16x16x32_bf16 v[252:255], v[124:127], v[92:95], v[252:255]
  v_mfma_f32_16x16x32_bf16 v[248:251], v[124:127], v[88:91], v[248:251]
  s_lshr_b32 m0, s69, 3
  v_mfma_f32_16x16x32_bf16 v[244:247], v[124:127], v[84:87], v[244:247]
  buffer_load_dwordx4 v2, s[36:39], s69 offen lds
  v_mfma_f32_16x16x32_bf16 v[240:243], v[124:127], v[80:83], v[240:243]
  s_waitcnt lgkmcnt(0)
  v_mfma_f32_16x16x32_bf16 v[128:131], v[48:51], v[32:35], v[128:131]
  ds_read_b128 v[80:83], v5 offset:32768
  s_lshr_b32 m0, s73, 5
  s_add_u32 m0, m0, s80
  v_mfma_f32_16x16x32_bf16 v[132:135], v[48:51], v[36:39], v[132:135]
  ds_read_b128 v[84:87], v5 offset:34816
  buffer_load_dwordx4 v3, s[48:51], s73 offen lds
  v_mfma_f32_16x16x32_bf16 v[136:139], v[48:51], v[40:43], v[136:139]
  ds_read_b128 v[88:91], v5 offset:36864
  v_mfma_f32_16x16x32_bf16 v[140:143], v[48:51], v[44:47], v[140:143]
  ds_read_b128 v[92:95], v5 offset:38912
  s_lshr_b32 m0, s70, 3
  v_mfma_f32_16x16x32_bf16 v[156:159], v[52:55], v[44:47], v[156:159]
  buffer_load_dwordx4 v2, s[36:39], s70 offen lds
  v_mfma_f32_16x16x32_bf16 v[152:155], v[52:55], v[40:43], v[152:155]
  ds_read_b64_tr_b16 v[96:97], v6 offset:40960
  v_mfma_f32_16x16x32_bf16 v[148:151], v[52:55], v[36:39], v[148:151]
  ds_read_b64_tr_b16 v[98:99], v6 offset:41984
  s_lshr_b32 m0, s78, 5
  s_add_u32 m0, m0, s80
  v_mfma_f32_16x16x32_bf16 v[144:147], v[52:55], v[32:35], v[144:147]
  ds_read_b64_tr_b16 v[100:101], v7 offset:40960
  buffer_load_dwordx4 v3, s[48:51], s78 offen lds
  v_mfma_f32_16x16x32_bf16 v[160:163], v[56:59], v[32:35], v[160:163]
  ds_read_b64_tr_b16 v[102:103], v7 offset:41984
  v_mfma_f32_16x16x32_bf16 v[164:167], v[56:59], v[36:39], v[164:167]
  s_lshr_b32 m0, s71, 3
  v_mfma_f32_16x16x32_bf16 v[168:171], v[56:59], v[40:43], v[168:171]
  ds_read_b64_tr_b16 v[104:105], v8 offset:40960
  buffer_load_dwordx4 v2, s[36:39], s71 offen lds
  v_mfma_f32_16x16x32_bf16 v[172:175], v[56:59], v[44:47], v[172:175]
  ds_read_b64_tr_b16 v[106:107], v8 offset:41984
  v_mfma_f32_16x16x32_bf16 v[188:191], v[60:63], v[44:47], v[188:191]
  ds_read_b64_tr_b16 v[108:109], v9 offset:40960
  s_lshr_b32 m0, s79, 5
  s_add_u32 m0, m0, s80
  v_mfma_f32_16x16x32_bf16 v[184:187], v[60:63], v[40:43], v[184:187]
  ds_read_b64_tr_b16 v[110:111], v9 offset:41984
  buffer_load_dwordx4 v3, s[48:51], s79 offen lds
  v_mfma_f32_16x16x32_bf16 v[180:183], v[60:63], v[36:39], v[180:183]
  v_mfma_f32_16x16x32_bf16 v[176:179], v[60:63], v[32:35], v[176:179]
  ds_read_b64_tr_b16 v[112:113], v10 offset:40960
  v_mfma_f32_16x16x32_bf16 v[192:195], v[64:67], v[32:35], v[192:195]
  ds_read_b64_tr_b16 v[114:115], v10 offset:41984
  v_add_u32 v2, 128, v2
  s_xor_b32 s81, s81, 32768
  v_mfma_f32_16x16x32_bf16 v[196:199], v[64:67], v[36:39], v[196:199]
  ds_read_b64_tr_b16 v[116:117], v11 offset:40960
  v_add_u32 v3, 0x80000, v3
  s_xor_b32 s80, s80, 32768
  v_mfma_f32_16x16x32_bf16 v[200:203], v[64:67], v[40:43], v[200:203]
  ds_read_b64_tr_b16 v[118:119], v11 offset:41984
  v_mfma_f32_16x16x32_bf16 v[204:207], v[64:67], v[44:47], v[204:207]
  v_mfma_f32_16x16x32_bf16 v[220:223], v[68:71], v[44:47], v[220:223]
  ds_read_b64_tr_b16 v[120:121], v12 offset:40960
  v_mfma_f32_16x16x32_bf16 v[216:219], v[68:71], v[40:43], v[216:219]
  ds_read_b64_tr_b16 v[122:123], v12 offset:41984
  v_mfma_f32_16x16x32_bf16 v[212:215], v[68:71], v[36:39], v[212:215]
  ds_read_b64_tr_b16 v[124:125], v13 offset:40960
  v_mfma_f32_16x16x32_bf16 v[208:211], v[68:71], v[32:35], v[208:211]
  ds_read_b64_tr_b16 v[126:127], v13 offset:41984
  v_mfma_f32_16x16x32_bf16 v[224:227], v[72:75], v[32:35], v[224:227]
  v_mfma_f32_16x16x32_bf16 v[228:231], v[72:75], v[36:39], v[228:231]
  v_mfma_f32_16x16x32_bf16 v[232:235], v[72:75], v[40:43], v[232:235]
  v_mfma_f32_16x16x32_bf16 v[236:239], v[72:75], v[44:47], v[236:239]
  v_mfma_f32_16x16x32_bf16 v[252:255], v[76:79], v[44:47], v[252:255]
  v_mfma_f32_16x16x32_bf16 v[248:251], v[76:79], v[40:43], v[248:251]
  v_mfma_f32_16x16x32_bf16 v[244:247], v[76:79], v[36:39], v[244:247]
  v_mfma_f32_16x16x32_bf16 v[240:243], v[76:79], v[32:35], v[240:243]
  s_waitcnt vmcnt(0) lgkmcnt(0)
  s_barrier
  v_mfma_f32_16x16x32_bf16 v[128:131], v[96:99], v[80:83], v[128:131]
  ds_read_b128 v[32:35], v4 offset:0
  s_lshr_b32 m0, s64, 3
  s_add_u32 m0, m0, 32768
  v_mfma_f32_16x16x32_bf16 v[132:135], v[96:99], v[84:87], v[132:135]
  ds_read_b128 v[36:39], v4 offset:2048
  buffer_load_dwordx4 v2, s[36:39], s64 offen lds
  v_mfma_f32_16x16x32_bf16 v[136:139], v[96:99], v[88:91], v[136:139]
  ds_read_b128 v[40:43], v4 offset:4096
  s_lshr_b32 m0, s72, 5
  s_add_u32 m0, m0, s81
  v_mfma_f32_16x16x32_bf16 v[140:143], v[96:99], v[92:95], v[140:143]
  ds_read_b128 v[44:47], v4 offset:6144
  buffer_load_dwordx4 v3, s[40:43], s72 offen lds
  v_mfma_f32_16x16x32_bf16 v[156:159], v[100:103], v[92:95], v[156:159]
  v_mfma_f32_16x16x32_bf16 v[152:155], v[100:103], v[88:91], v[152:155]
  ds_read_b64_tr_b16 v[48:49], v6 offset:0
  s_lshr_b32 m0, s65, 3
  s_add_u32 m0, m0, 32768
  v_mfma_f32_16x16x32_bf16 v[148:151], v[100:103], v[84:87], v[148:151]
  ds_read_b64_tr_b16 v[50:51], v6 offset:1024
  buffer_load_dwordx4 v2, s[36:39], s65 offen lds
  v_mfma_f32_16x16x32_bf16 v[144:147], v[100:103], v[80:83], v[144:147]
  ds_read_b64_tr_b16 v[52:53], v7 offset:0
  v_mfma_f32_16x16x32_bf16 v[160:163], v[104:107], v[80:83], v[160:163]
  ds_read_b64_tr_b16 v[54:55], v7 offset:1024
  s_lshr_b32 m0, s73, 5
  s_add_u32 m0, m0, s81
  v_mfma_f32_16x16x32_bf16 v[164:167], v[104:107], v[84:87], v[164:167]
  buffer_load_dwordx4 v3, s[40:43], s73 offen lds
  v_mfma_f32_16x16x32_bf16 v[168:171], v[104:107], v[88:91], v[168:171]
  ds_read_b64_tr_b16 v[56:57], v8 offset:0
  v_mfma_f32_16x16x32_bf16 v[172:175], v[104:107], v[92:95], v[172:175]
  ds_read_b64_tr_b16 v[58:59], v8 offset:1024
  s_lshr_b32 m0, s66, 3
  s_add_u32 m0, m0, 32768
  v_mfma_f32_16x16x32_bf16 v[188:191], v[108:111], v[92:95], v[188:191]
  ds_read_b64_tr_b16 v[60:61], v9 offset:0
  buffer_load_dwordx4 v2, s[36:39], s66 offen lds
  v_mfma_f32_16x16x32_bf16 v[184:187], v[108:111], v[88:91], v[184:187]
  ds_read_b64_tr_b16 v[62:63], v9 offset:1024
  v_mfma_f32_16x16x32_bf16 v[180:183], v[108:111], v[84:87], v[180:183]
  s_lshr_b32 m0, s78, 5
  s_add_u32 m0, m0, s81
  v_mfma_f32_16x16x32_bf16 v[176:179], v[108:111], v[80:83], v[176:179]
  ds_read_b64_tr_b16 v[64:65], v10 offset:0
  buffer_load_dwordx4 v3, s[40:43], s78 offen lds
  v_mfma_f32_16x16x32_bf16 v[192:195], v[112:115], v[80:83], v[192:195]
  ds_read_b64_tr_b16 v[66:67], v10 offset:1024
  v_mfma_f32_16x16x32_bf16 v[196:199], v[112:115], v[84:87], v[196:199]
  ds_read_b64_tr_b16 v[68:69], v11 offset:0
  s_lshr_b32 m0, s67, 3
  s_add_u32 m0, m0, 32768
  v_mfma_f32_16x16x32_bf16 v[200:203], v[112:115], v[88:91], v[200:203]
  ds_read_b64_tr_b16 v[70:71], v11 offset:1024
  buffer_load_dwordx4 v2, s[36:39], s67 offen lds
  v_mfma_f32_16x16x32_bf16 v[204:207], v[112:115], v[92:95], v[204:207]
  v_mfma_f32_16x16x32_bf16 v[220:223], v[116:119], v[92:95], v[220:223]
  ds_read_b64_tr_b16 v[72:73], v12 offset:0
  s_lshr_b32 m0, s79, 5
  s_add_u32 m0, m0, s81
  v_mfma_f32_16x16x32_bf16 v[216:219], v[116:119], v[88:91], v[216:219]
  ds_read_b64_tr_b16 v[74:75], v12 offset:1024
  buffer_load_dwordx4 v3, s[40:43], s79 offen lds
  v_mfma_f32_16x16x32_bf16 v[212:215], v[116:119], v[84:87], v[212:215]
  ds_read_b64_tr_b16 v[76:77], v13 offset:0
  v_mfma_f32_16x16x32_bf16 v[208:211], v[116:119], v[80:83], v[208:211]
  ds_read_b64_tr_b16 v[78:79], v13 offset:1024
  s_lshr_b32 m0, s68, 3
  s_add_u32 m0, m0, 32768
  v_mfma_f32_16x16x32_bf16 v[224:227], v[120:123], v[80:83], v[224:227]
  buffer_load_dwordx4 v2, s[36:39], s68 offen lds
  v_mfma_f32_16x16x32_bf16 v[228:231], v[120:123], v[84:87], v[228:231]
  v_mfma_f32_16x16x32_bf16 v[232:235], v[120:123], v[88:91], v[232:235]
  s_lshr_b32 m0, s72, 5
  s_add_u32 m0, m0, s80
  v_mfma_f32_16x16x32_bf16 v[236:239], v[120:123], v[92:95], v[236:239]
  buffer_load_dwordx4 v3, s[48:51], s72 offen lds
  v_mfma_f32_16x16x32_bf16 v[252:255], v[124:127], v[92:95], v[252:255]
  v_mfma_f32_16x16x32_bf16 v[248:251], v[124:127], v[88:91], v[248:251]
  s_lshr_b32 m0, s69, 3
  s_add_u32 m0, m0, 32768
  v_mfma_f32_16x16x32_bf16 v[244:247], v[124:127], v[84:87], v[244:247]
  buffer_load_dwordx4 v2, s[36:39], s69 offen lds
  v_mfma_f32_16x16x32_bf16 v[240:243], v[124:127], v[80:83], v[240:243]
  s_waitcnt lgkmcnt(0)
  v_mfma_f32_16x16x32_bf16 v[128:131], v[48:51], v[32:35], v[128:131]
  ds_read_b128 v[80:83], v5 offset:0
  s_lshr_b32 m0, s73, 5
  s_add_u32 m0, m0, s80
  v_mfma_f32_16x16x32_bf16 v[132:135], v[48:51], v[36:39], v[132:135]
  ds_read_b128 v[84:87], v5 offset:2048
  buffer_load_dwordx4 v3, s[48:51], s73 offen lds
  v_mfma_f32_16x16x32_bf16 v[136:139], v[48:51], v[40:43], v[136:139]
  ds_read_b128 v[88:91], v5 offset:4096
  v_mfma_f32_16x16x32_bf16 v[140:143], v[48:51], v[44:47], v[140:143]
  ds_read_b128 v[92:95], v5 offset:6144
  s_lshr_b32 m0, s70, 3
  s_add_u32 m0, m0, 32768
  v_mfma_f32_16x16x32_bf16 v[156:159], v[52:55], v[44:47], v[156:159]
  buffer_load_dwordx4 v2, s[36:39], s70 offen lds
  v_mfma_f32_16x16x32_bf16 v[152:155], v[52:55], v[40:43], v[152:155]
  ds_read_b64_tr_b16 v[96:97], v6 offset:8192
  v_mfma_f32_16x16x32_bf16 v[148:151], v[52:55], v[36:39], v[148:151]
  ds_read_b64_tr_b16 v[98:99], v6 offset:9216
  s_lshr_b32 m0, s78, 5
  s_add_u32 m0, m0, s80
  v_mfma_f32_16x16x32_bf16 v[144:147], v[52:55], v[32:35], v[144:147]
  ds_read_b64_tr_b16 v[100:101], v7 offset:8192
  buffer_load_dwordx4 v3, s[48:51], s78 offen lds
  v_mfma_f32_16x16x32_bf16 v[160:163], v[56:59], v[32:35], v[160:163]
  ds_read_b64_tr_b16 v[102:103], v7 offset:9216
  v_mfma_f32_16x16x32_bf16 v[164:167], v[56:59], v[36:39], v[164:167]
  s_lshr_b32 m0, s71, 3
  s_add_u32 m0, m0, 32768
  v_mfma_f32_16x16x32_bf16 v[168:171], v[56:59], v[40:43], v[168:171]
  ds_read_b64_tr_b16 v[104:105], v8 offset:8192
  buffer_load_dwordx4 v2, s[36:39], s71 offen lds
  v_mfma_f32_16x16x32_bf16 v[172:175], v[56:59], v[44:47], v[172:175]
  ds_read_b64_tr_b16 v[106:107], v8 offset:9216
  v_mfma_f32_16x16x32_bf16 v[188:191], v[60:63], v[44:47], v[188:191]
  ds_read_b64_tr_b16 v[108:109], v9 offset:8192
  s_lshr_b32 m0, s79, 5
  s_add_u32 m0, m0, s80
  v_mfma_f32_16x16x32_bf16 v[184:187], v[60:63], v[40:43], v[184:187]
  ds_read_b64_tr_b16 v[110:111], v9 offset:9216
  buffer_load_dwordx4 v3, s[48:51], s79 offen lds
  v_mfma_f32_16x16x32_bf16 v[180:183], v[60:63], v[36:39], v[180:183]
  v_mfma_f32_16x16x32_bf16 v[176:179], v[60:63], v[32:35], v[176:179]
  ds_read_b64_tr_b16 v[112:113], v10 offset:8192
  v_mfma_f32_16x16x32_bf16 v[192:195], v[64:67], v[32:35], v[192:195]
  ds_read_b64_tr_b16 v[114:115], v10 offset:9216
  v_add_u32 v2, 128, v2
  s_xor_b32 s81, s81, 32768
  v_mfma_f32_16x16x32_bf16 v[196:199], v[64:67], v[36:39], v[196:199]
  ds_read_b64_tr_b16 v[116:117], v11 offset:8192
  v_add_u32 v3, 0x80000, v3
  s_xor_b32 s80, s80, 32768
  v_mfma_f32_16x16x32_bf16 v[200:203], v[64:67], v[40:43], v[200:203]
  ds_read_b64_tr_b16 v[118:119], v11 offset:9216
  s_mov_b32 s32, s8
  s_mov_b32 s33, s9
  s_mov_b32 s34, 0x400000
  s_mov_b32 s35, 0x20000
  v_mfma_f32_16x16x32_bf16 v[204:207], v[64:67], v[44:47], v[204:207]
  s_mov_b32 s36, s18
  s_mov_b32 s37, s19
  s_mov_b32 s38, 0x1c0000
  v_mfma_f32_16x16x32_bf16 v[220:223], v[68:71], v[44:47], v[220:223]
  ds_read_b64_tr_b16 v[120:121], v12 offset:8192
  s_mov_b32 s39, 0x20000
  s_cmp_lt_u32 s57, 28
  s_cselect_b32 s38, s38, 0
  v_mfma_f32_16x16x32_bf16 v[216:219], v[68:71], v[40:43], v[216:219]
  ds_read_b64_tr_b16 v[122:123], v12 offset:9216
  s_and_b32 s62, s56, 1
  s_lshl_b32 s63, s62, 3
  v_lshrrev_b32 v21, 4, v1
  v_lshlrev_b32 v22, 1, v21
  v_mfma_f32_16x16x32_bf16 v[212:215], v[68:71], v[36:39], v[212:215]
  ds_read_b64_tr_b16 v[124:125], v13 offset:8192
  v_and_b32 v20, 15, v1
  v_xor_b32 v20, v20, v22
  v_xor_b32 v20, s63, v20
  v_mfma_f32_16x16x32_bf16 v[208:211], v[68:71], v[32:35], v[208:211]
  ds_read_b64_tr_b16 v[126:127], v13 offset:9216
  v_lshlrev_b32 v20, 4, v20
  v_lshl_add_u32 v2, v21, 13, v20
  s_lshl_b32 s63, s57, 8
  v_mfma_f32_16x16x32_bf16 v[224:227], v[72:75], v[32:35], v[224:227]
  v_add_u32 v2, s63, v2
  s_lshr_b32 s63, s56, 1
  s_lshl_b32 s63, s63, 2
  s_lshl_b32 s74, s62, 1
  v_mfma_f32_16x16x32_bf16 v[228:231], v[72:75], v[36:39], v[228:231]
  s_add_u32 s63, s63, s74
  s_lshl_b32 s64, s63, 15
  s_add_u32 s65, s64, 32768
  v_mfma_f32_16x16x32_bf16 v[232:235], v[72:75], v[40:43], v[232:235]
  s_lshl_b32 s67, s63, 10
  s_add_u32 s67, s67, 0
  s_lshl_b32 s63, s62, 2
  v_mfma_f32_16x16x32_bf16 v[236:239], v[72:75], v[44:47], v[236:239]
  v_and_b32 v22, 2, v22
  v_and_b32 v20, 7, v1
  v_xor_b32 v20, v20, v22
  v_xor_b32 v20, s63, v20
  v_mfma_f32_16x16x32_bf16 v[252:255], v[76:79], v[44:47], v[252:255]
  v_lshlrev_b32 v20, 4, v20
  v_lshrrev_b32 v21, 3, v1
  v_mul_u32_u24 v21, 3584, v21
  v_mfma_f32_16x16x32_bf16 v[248:251], v[76:79], v[40:43], v[248:251]
  v_add_u32 v3, v21, v20
  s_lshl_b32 s63, s57, 7
  v_add_u32 v3, s63, v3
  v_mfma_f32_16x16x32_bf16 v[244:247], v[76:79], v[36:39], v[244:247]
  s_mul_i32 s66, s56, 28672
  s_lshl_b32 s68, s56, 10
  s_add_u32 s68, s68, 131072
  v_mfma_f32_16x16x32_bf16 v[240:243], v[76:79], v[32:35], v[240:243]
  s_waitcnt vmcnt(0) lgkmcnt(0)
  s_barrier
  v_mfma_f32_16x16x32_bf16 v[128:131], v[96:99], v[80:83], v[128:131]
  ds_read_b128 v[32:35], v4 offset:32768
  s_add_u32 m0, s67, 0
  v_mfma_f32_16x16x32_bf16 v[132:135], v[96:99], v[84:87], v[132:135]
  ds_read_b128 v[36:39], v4 offset:34816
  v_mfma_f32_16x16x32_bf16 v[136:139], v[96:99], v[88:91], v[136:139]
  ds_read_b128 v[40:43], v4 offset:36864
  buffer_load_dwordx4 v2, s[32:35], s64 offen lds
  v_mfma_f32_16x16x32_bf16 v[140:143], v[96:99], v[92:95], v[140:143]
  ds_read_b128 v[44:47], v4 offset:38912
  v_mfma_f32_16x16x32_bf16 v[156:159], v[100:103], v[92:95], v[156:159]
  s_add_u32 m0, s67, 1024
  v_mfma_f32_16x16x32_bf16 v[152:155], v[100:103], v[88:91], v[152:155]
  ds_read_b64_tr_b16 v[48:49], v6 offset:32768
  v_mfma_f32_16x16x32_bf16 v[148:151], v[100:103], v[84:87], v[148:151]
  ds_read_b64_tr_b16 v[50:51], v6 offset:33792
  buffer_load_dwordx4 v2, s[32:35], s65 offen lds
  v_mfma_f32_16x16x32_bf16 v[144:147], v[100:103], v[80:83], v[144:147]
  ds_read_b64_tr_b16 v[52:53], v7 offset:32768
  v_mfma_f32_16x16x32_bf16 v[160:163], v[104:107], v[80:83], v[160:163]
  ds_read_b64_tr_b16 v[54:55], v7 offset:33792
  s_add_u32 m0, s68, 0
  v_mfma_f32_16x16x32_bf16 v[164:167], v[104:107], v[84:87], v[164:167]
  v_mfma_f32_16x16x32_bf16 v[168:171], v[104:107], v[88:91], v[168:171]
  ds_read_b64_tr_b16 v[56:57], v8 offset:32768
  buffer_load_dwordx4 v3, s[36:39], s66 offen lds
  v_mfma_f32_16x16x32_bf16 v[172:175], v[104:107], v[92:95], v[172:175]
  ds_read_b64_tr_b16 v[58:59], v8 offset:33792
  v_mfma_f32_16x16x32_bf16 v[188:191], v[108:111], v[92:95], v[188:191]
  ds_read_b64_tr_b16 v[60:61], v9 offset:32768
  v_add_u32 v2, 0x80000, v2
  v_mfma_f32_16x16x32_bf16 v[184:187], v[108:111], v[88:91], v[184:187]
  ds_read_b64_tr_b16 v[62:63], v9 offset:33792
  v_mfma_f32_16x16x32_bf16 v[180:183], v[108:111], v[84:87], v[180:183]
  v_add_u32 v3, 229376, v3
  v_mfma_f32_16x16x32_bf16 v[176:179], v[108:111], v[80:83], v[176:179]
  ds_read_b64_tr_b16 v[64:65], v10 offset:32768
  v_mfma_f32_16x16x32_bf16 v[192:195], v[112:115], v[80:83], v[192:195]
  ds_read_b64_tr_b16 v[66:67], v10 offset:33792
  s_add_u32 m0, s67, 16384
  v_mfma_f32_16x16x32_bf16 v[196:199], v[112:115], v[84:87], v[196:199]
  ds_read_b64_tr_b16 v[68:69], v11 offset:32768
  v_mfma_f32_16x16x32_bf16 v[200:203], v[112:115], v[88:91], v[200:203]
  ds_read_b64_tr_b16 v[70:71], v11 offset:33792
  buffer_load_dwordx4 v2, s[32:35], s64 offen lds
  v_mfma_f32_16x16x32_bf16 v[204:207], v[112:115], v[92:95], v[204:207]
  v_mfma_f32_16x16x32_bf16 v[220:223], v[116:119], v[92:95], v[220:223]
  ds_read_b64_tr_b16 v[72:73], v12 offset:32768
  s_add_u32 m0, s67, 17408
  v_mfma_f32_16x16x32_bf16 v[216:219], v[116:119], v[88:91], v[216:219]
  ds_read_b64_tr_b16 v[74:75], v12 offset:33792
  v_mfma_f32_16x16x32_bf16 v[212:215], v[116:119], v[84:87], v[212:215]
  ds_read_b64_tr_b16 v[76:77], v13 offset:32768
  buffer_load_dwordx4 v2, s[32:35], s65 offen lds
  v_mfma_f32_16x16x32_bf16 v[208:211], v[116:119], v[80:83], v[208:211]
  ds_read_b64_tr_b16 v[78:79], v13 offset:33792
  v_mfma_f32_16x16x32_bf16 v[224:227], v[120:123], v[80:83], v[224:227]
  s_add_u32 m0, s68, 8192
  v_mfma_f32_16x16x32_bf16 v[228:231], v[120:123], v[84:87], v[228:231]
  v_mfma_f32_16x16x32_bf16 v[232:235], v[120:123], v[88:91], v[232:235]
  buffer_load_dwordx4 v3, s[36:39], s66 offen lds
  v_mfma_f32_16x16x32_bf16 v[236:239], v[120:123], v[92:95], v[236:239]
  v_mfma_f32_16x16x32_bf16 v[252:255], v[124:127], v[92:95], v[252:255]
  v_add_u32 v2, 0x80000, v2
  v_mfma_f32_16x16x32_bf16 v[248:251], v[124:127], v[88:91], v[248:251]
  v_mfma_f32_16x16x32_bf16 v[244:247], v[124:127], v[84:87], v[244:247]
  v_add_u32 v3, 229376, v3
  v_mfma_f32_16x16x32_bf16 v[240:243], v[124:127], v[80:83], v[240:243]
  s_waitcnt lgkmcnt(0)
  v_mfma_f32_16x16x32_bf16 v[128:131], v[48:51], v[32:35], v[128:131]
  ds_read_b128 v[80:83], v5 offset:32768
  v_mfma_f32_16x16x32_bf16 v[132:135], v[48:51], v[36:39], v[132:135]
  ds_read_b128 v[84:87], v5 offset:34816
  v_mfma_f32_16x16x32_bf16 v[136:139], v[48:51], v[40:43], v[136:139]
  ds_read_b128 v[88:91], v5 offset:36864
  v_mfma_f32_16x16x32_bf16 v[140:143], v[48:51], v[44:47], v[140:143]
  ds_read_b128 v[92:95], v5 offset:38912
  v_mfma_f32_16x16x32_bf16 v[156:159], v[52:55], v[44:47], v[156:159]
  v_mfma_f32_16x16x32_bf16 v[152:155], v[52:55], v[40:43], v[152:155]
  ds_read_b64_tr_b16 v[96:97], v6 offset:40960
  v_mfma_f32_16x16x32_bf16 v[148:151], v[52:55], v[36:39], v[148:151]
  ds_read_b64_tr_b16 v[98:99], v6 offset:41984
  v_mfma_f32_16x16x32_bf16 v[144:147], v[52:55], v[32:35], v[144:147]
  ds_read_b64_tr_b16 v[100:101], v7 offset:40960
  v_mfma_f32_16x16x32_bf16 v[160:163], v[56:59], v[32:35], v[160:163]
  ds_read_b64_tr_b16 v[102:103], v7 offset:41984
  v_mfma_f32_16x16x32_bf16 v[164:167], v[56:59], v[36:39], v[164:167]
  v_mfma_f32_16x16x32_bf16 v[168:171], v[56:59], v[40:43], v[168:171]
  ds_read_b64_tr_b16 v[104:105], v8 offset:40960
  v_mfma_f32_16x16x32_bf16 v[172:175], v[56:59], v[44:47], v[172:175]
  ds_read_b64_tr_b16 v[106:107], v8 offset:41984
  v_mfma_f32_16x16x32_bf16 v[188:191], v[60:63], v[44:47], v[188:191]
  ds_read_b64_tr_b16 v[108:109], v9 offset:40960
  v_mfma_f32_16x16x32_bf16 v[184:187], v[60:63], v[40:43], v[184:187]
  ds_read_b64_tr_b16 v[110:111], v9 offset:41984
  v_mfma_f32_16x16x32_bf16 v[180:183], v[60:63], v[36:39], v[180:183]
  v_mfma_f32_16x16x32_bf16 v[176:179], v[60:63], v[32:35], v[176:179]
  ds_read_b64_tr_b16 v[112:113], v10 offset:40960
  v_mfma_f32_16x16x32_bf16 v[192:195], v[64:67], v[32:35], v[192:195]
  ds_read_b64_tr_b16 v[114:115], v10 offset:41984
  v_mfma_f32_16x16x32_bf16 v[196:199], v[64:67], v[36:39], v[196:199]
  ds_read_b64_tr_b16 v[116:117], v11 offset:40960
  v_mfma_f32_16x16x32_bf16 v[200:203], v[64:67], v[40:43], v[200:203]
  ds_read_b64_tr_b16 v[118:119], v11 offset:41984
  v_mfma_f32_16x16x32_bf16 v[204:207], v[64:67], v[44:47], v[204:207]
  v_mfma_f32_16x16x32_bf16 v[220:223], v[68:71], v[44:47], v[220:223]
  ds_read_b64_tr_b16 v[120:121], v12 offset:40960
  v_mfma_f32_16x16x32_bf16 v[216:219], v[68:71], v[40:43], v[216:219]
  ds_read_b64_tr_b16 v[122:123], v12 offset:41984
  v_mfma_f32_16x16x32_bf16 v[212:215], v[68:71], v[36:39], v[212:215]
  ds_read_b64_tr_b16 v[124:125], v13 offset:40960
  v_mfma_f32_16x16x32_bf16 v[208:211], v[68:71], v[32:35], v[208:211]
  ds_read_b64_tr_b16 v[126:127], v13 offset:41984
  v_mfma_f32_16x16x32_bf16 v[224:227], v[72:75], v[32:35], v[224:227]
  v_mfma_f32_16x16x32_bf16 v[228:231], v[72:75], v[36:39], v[228:231]
  v_mfma_f32_16x16x32_bf16 v[232:235], v[72:75], v[40:43], v[232:235]
  v_mfma_f32_16x16x32_bf16 v[236:239], v[72:75], v[44:47], v[236:239]
  v_mfma_f32_16x16x32_bf16 v[252:255], v[76:79], v[44:47], v[252:255]
  v_mfma_f32_16x16x32_bf16 v[248:251], v[76:79], v[40:43], v[248:251]
  v_mfma_f32_16x16x32_bf16 v[244:247], v[76:79], v[36:39], v[244:247]
  v_mfma_f32_16x16x32_bf16 v[240:243], v[76:79], v[32:35], v[240:243]
  s_waitcnt vmcnt(3) lgkmcnt(0)
  s_barrier
  v_mfma_f32_16x16x32_bf16 v[128:131], v[96:99], v[80:83], v[128:131]
  s_lshl_b32 s63, s76, 10
  v_and_b32 v30, 8, v1
  v_lshlrev_b32 v30, 10, v30
  v_lshrrev_b32 v12, 4, v1
  v_lshl_add_u32 v30, v12, 7, v30
  v_mfma_f32_16x16x32_bf16 v[132:135], v[96:99], v[84:87], v[132:135]
  v_and_b32 v12, 7, v1
  v_lshl_add_u32 v30, v12, 4, v30
  v_add_u32 v12, s63, v30
  s_mov_b32 s69, 16384
  v_and_b32 v72, 15, v1
  v_lshrrev_b32 v73, 4, v1
  v_mfma_f32_16x16x32_bf16 v[136:139], v[96:99], v[88:91], v[136:139]
  buffer_load_dwordx4 v[32:35], v12, s[44:47], 0 offen offset:0 sc1
  v_lshrrev_b32 v74, 2, v72
  v_mfma_f32_16x16x32_bf16 v[140:143], v[96:99], v[92:95], v[140:143]
  v_and_b32 v75, 1, v73
  v_lshl_add_u32 v76, v75, 2, v74
  v_mfma_f32_16x16x32_bf16 v[156:159], v[100:103], v[92:95], v[156:159]
  v_lshrrev_b32 v77, 1, v74
  v_mfma_f32_16x16x32_bf16 v[152:155], v[100:103], v[88:91], v[152:155]
  buffer_load_dwordx4 v[36:39], v12, s[44:47], s69 offen offset:0 sc1
  v_lshl_add_u32 v77, v75, 1, v77
  v_lshl_add_u32 v74, v73, 3, v74
  v_mfma_f32_16x16x32_bf16 v[148:151], v[100:103], v[84:87], v[148:151]
  v_and_b32 v78, 3, v1
  v_mfma_f32_16x16x32_bf16 v[144:147], v[100:103], v[80:83], v[144:147]
  v_lshlrev_b32 v78, 3, v78
  v_lshl_add_u32 v79, v74, 8, v78
  v_mfma_f32_16x16x32_bf16 v[160:163], v[104:107], v[80:83], v[160:163]
  buffer_load_dwordx4 v[40:43], v12, s[44:47], 0 offen offset:512 sc1
  v_lshl_add_u32 v13, v74, 7, v78
  v_mfma_f32_16x16x32_bf16 v[164:167], v[104:107], v[84:87], v[164:167]
  v_add_u32 v13, 131072, v13
  v_xor_b32 v72, 0, v76
  v_mfma_f32_16x16x32_bf16 v[168:171], v[104:107], v[88:91], v[168:171]
  v_lshl_add_u32 v4, v72, 5, v79
  v_mfma_f32_16x16x32_bf16 v[172:175], v[104:107], v[92:95], v[172:175]
  buffer_load_dwordx4 v[44:47], v12, s[44:47], s69 offen offset:512 sc1
  v_add_u32 v20, 0x10000, v4
  v_mfma_f32_16x16x32_bf16 v[188:191], v[108:111], v[92:95], v[188:191]
  v_xor_b32 v72, 1, v76
  v_lshl_add_u32 v5, v72, 5, v79
  v_mfma_f32_16x16x32_bf16 v[184:187], v[108:111], v[88:91], v[184:187]
  v_add_u32 v21, 0x10000, v5
  v_mfma_f32_16x16x32_bf16 v[180:183], v[108:111], v[84:87], v[180:183]
  v_add_u32 v12, 1024, v12
  v_xor_b32 v72, 2, v76
  v_lshl_add_u32 v6, v72, 5, v79
  v_mfma_f32_16x16x32_bf16 v[176:179], v[108:111], v[80:83], v[176:179]
  v_add_u32 v22, 0x10000, v6
  v_mfma_f32_16x16x32_bf16 v[192:195], v[112:115], v[80:83], v[192:195]
  v_xor_b32 v72, 3, v76
  v_lshl_add_u32 v7, v72, 5, v79
  v_mfma_f32_16x16x32_bf16 v[196:199], v[112:115], v[84:87], v[196:199]
  buffer_load_dwordx4 v[48:51], v12, s[44:47], 0 offen offset:0 sc1
  v_add_u32 v23, 0x10000, v7
  v_mfma_f32_16x16x32_bf16 v[200:203], v[112:115], v[88:91], v[200:203]
  v_xor_b32 v72, 4, v76
  v_lshl_add_u32 v8, v72, 5, v79
  v_mfma_f32_16x16x32_bf16 v[204:207], v[112:115], v[92:95], v[204:207]
  v_add_u32 v24, 0x10000, v8
  v_mfma_f32_16x16x32_bf16 v[220:223], v[116:119], v[92:95], v[220:223]
  buffer_load_dwordx4 v[52:55], v12, s[44:47], s69 offen offset:0 sc1
  v_xor_b32 v72, 5, v76
  v_lshl_add_u32 v9, v72, 5, v79
  v_mfma_f32_16x16x32_bf16 v[216:219], v[116:119], v[88:91], v[216:219]
  v_add_u32 v25, 0x10000, v9
  v_mfma_f32_16x16x32_bf16 v[212:215], v[116:119], v[84:87], v[212:215]
  v_xor_b32 v72, 6, v76
  v_mfma_f32_16x16x32_bf16 v[208:211], v[116:119], v[80:83], v[208:211]
  s_mov_b32 s40, s20
  s_mov_b32 s41, s21
  v_lshl_add_u32 v10, v72, 5, v79
  v_add_u32 v26, 0x10000, v10
  v_mfma_f32_16x16x32_bf16 v[224:227], v[120:123], v[80:83], v[224:227]
  s_mov_b32 s42, 0xe00
  v_xor_b32 v72, 7, v76
  v_mfma_f32_16x16x32_bf16 v[228:231], v[120:123], v[84:87], v[228:231]
  s_mov_b32 s43, 0x20000
  v_lshl_add_u32 v11, v72, 5, v79
  v_add_u32 v27, 0x10000, v11
  v_mfma_f32_16x16x32_bf16 v[232:235], v[120:123], v[88:91], v[232:235]
  v_lshrrev_b32 v30, 4, v1
  v_xor_b32 v72, 0, v77
  v_mfma_f32_16x16x32_bf16 v[236:239], v[120:123], v[92:95], v[236:239]
  v_lshlrev_b32 v30, 3, v30
  s_lshl_b32 s63, s57, 7
  v_lshl_add_u32 v16, v72, 5, v13
  v_xor_b32 v72, 1, v77
  v_mfma_f32_16x16x32_bf16 v[252:255], v[124:127], v[92:95], v[252:255]
  buffer_load_dwordx2 v[64:65], v30, s[40:43], s63 offen offset:0
  v_lshl_add_u32 v17, v72, 5, v13
  v_mfma_f32_16x16x32_bf16 v[248:251], v[124:127], v[88:91], v[248:251]
  buffer_load_dwordx2 v[66:67], v30, s[40:43], s63 offen offset:32
  v_xor_b32 v72, 2, v77
  v_lshl_add_u32 v18, v72, 5, v13
  v_mfma_f32_16x16x32_bf16 v[244:247], v[124:127], v[84:87], v[244:247]
  buffer_load_dwordx2 v[68:69], v30, s[40:43], s63 offen offset:64
  v_xor_b32 v72, 3, v77
  v_mfma_f32_16x16x32_bf16 v[240:243], v[124:127], v[80:83], v[240:243]
  buffer_load_dwordx2 v[70:71], v30, s[40:43], s63 offen offset:96
  v_lshl_add_u32 v19, v72, 5, v13
  s_lshl_b32 s60, s57, 20
  s_lshl_b32 s61, s58, 2
  s_add_u32 s61, s61, s59
  s_lshl_b32 s61, s61, 15
  s_add_u32 s60, s60, s61
  s_add_u32 s80, s60, 2097152
  s_add_u32 s81, s80, 4096
  s_add_u32 s82, s80, 8192
  s_add_u32 s83, s80, 12288
  v_cvt_pk_bf16_f32 v80, v128, v129
  v_cvt_pk_bf16_f32 v81, v130, v131
  v_cvt_pk_bf16_f32 v82, v144, v145
  v_cvt_pk_bf16_f32 v83, v146, v147
  buffer_store_dwordx4 v[80:83], v14, s[44:47], s80 offen sc1
  v_cvt_pk_bf16_f32 v84, v132, v133
  v_cvt_pk_bf16_f32 v85, v134, v135
  v_cvt_pk_bf16_f32 v86, v148, v149
  v_cvt_pk_bf16_f32 v87, v150, v151
  buffer_store_dwordx4 v[84:87], v14, s[44:47], s81 offen sc1
  v_cvt_pk_bf16_f32 v88, v136, v137
  v_cvt_pk_bf16_f32 v89, v138, v139
  v_cvt_pk_bf16_f32 v90, v152, v153
  v_cvt_pk_bf16_f32 v91, v154, v155
  buffer_store_dwordx4 v[88:91], v14, s[44:47], s82 offen sc1
  v_cvt_pk_bf16_f32 v92, v140, v141
  v_cvt_pk_bf16_f32 v93, v142, v143
  v_cvt_pk_bf16_f32 v94, v156, v157
  v_cvt_pk_bf16_f32 v95, v158, v159
  buffer_store_dwordx4 v[92:95], v14, s[44:47], s83 offen sc1
  v_cvt_pk_bf16_f32 v112, v160, v161
  v_cvt_pk_bf16_f32 v113, v162, v163
  v_cvt_pk_bf16_f32 v114, v176, v177
  v_cvt_pk_bf16_f32 v115, v178, v179
  v_cvt_pk_bf16_f32 v116, v164, v165
  v_cvt_pk_bf16_f32 v117, v166, v167
  v_cvt_pk_bf16_f32 v118, v180, v181
  v_cvt_pk_bf16_f32 v119, v182, v183
  v_cvt_pk_bf16_f32 v120, v168, v169
  v_cvt_pk_bf16_f32 v121, v170, v171
  v_cvt_pk_bf16_f32 v122, v184, v185
  v_cvt_pk_bf16_f32 v123, v186, v187
  v_cvt_pk_bf16_f32 v124, v172, v173
  v_cvt_pk_bf16_f32 v125, v174, v175
  v_cvt_pk_bf16_f32 v126, v188, v189
  v_cvt_pk_bf16_f32 v127, v190, v191
  v_cvt_pk_bf16_f32 v128, v192, v193
  v_cvt_pk_bf16_f32 v129, v194, v195
  v_cvt_pk_bf16_f32 v130, v208, v209
  v_cvt_pk_bf16_f32 v131, v210, v211
  v_cvt_pk_bf16_f32 v132, v196, v197
  v_cvt_pk_bf16_f32 v133, v198, v199
  v_cvt_pk_bf16_f32 v134, v212, v213
  v_cvt_pk_bf16_f32 v135, v214, v215
  v_cvt_pk_bf16_f32 v136, v200, v201
  v_cvt_pk_bf16_f32 v137, v202, v203
  v_cvt_pk_bf16_f32 v138, v216, v217
  v_cvt_pk_bf16_f32 v139, v218, v219
  v_cvt_pk_bf16_f32 v140, v204, v205
  v_cvt_pk_bf16_f32 v141, v206, v207
  v_cvt_pk_bf16_f32 v142, v220, v221
  v_cvt_pk_bf16_f32 v143, v222, v223
  v_cvt_pk_bf16_f32 v144, v224, v225
  v_cvt_pk_bf16_f32 v145, v226, v227
  v_cvt_pk_bf16_f32 v146, v240, v241
  v_cvt_pk_bf16_f32 v147, v242, v243
  v_cvt_pk_bf16_f32 v148, v228, v229
  v_cvt_pk_bf16_f32 v149, v230, v231
  v_cvt_pk_bf16_f32 v150, v244, v245
  v_cvt_pk_bf16_f32 v151, v246, v247
  v_cvt_pk_bf16_f32 v152, v232, v233
  v_cvt_pk_bf16_f32 v153, v234, v235
  v_cvt_pk_bf16_f32 v154, v248, v249
  v_cvt_pk_bf16_f32 v155, v250, v251
  v_cvt_pk_bf16_f32 v156, v236, v237
  v_cvt_pk_bf16_f32 v157, v238, v239
  v_cvt_pk_bf16_f32 v158, v252, v253
  v_cvt_pk_bf16_f32 v159, v254, v255
LF1_done:
  s_waitcnt vmcnt(7)
  v_lshlrev_b32 v224, 16, v64
  v_and_b32 v225, 0xffff0000, v64
  v_lshlrev_b32 v226, 16, v65
  v_and_b32 v227, 0xffff0000, v65
  v_lshlrev_b32 v228, 16, v64
  v_and_b32 v229, 0xffff0000, v64
  v_lshlrev_b32 v230, 16, v65
  v_and_b32 v231, 0xffff0000, v65
  s_waitcnt vmcnt(6)
  v_lshlrev_b32 v232, 16, v66
  v_and_b32 v233, 0xffff0000, v66
  v_lshlrev_b32 v234, 16, v67
  v_and_b32 v235, 0xffff0000, v67
  v_lshlrev_b32 v236, 16, v66
  v_and_b32 v237, 0xffff0000, v66
  v_lshlrev_b32 v238, 16, v67
  v_and_b32 v239, 0xffff0000, v67
  s_waitcnt vmcnt(5)
  v_lshlrev_b32 v240, 16, v68
  v_and_b32 v241, 0xffff0000, v68
  v_lshlrev_b32 v242, 16, v69
  v_and_b32 v243, 0xffff0000, v69
  v_lshlrev_b32 v244, 16, v68
  v_and_b32 v245, 0xffff0000, v68
  v_lshlrev_b32 v246, 16, v69
  v_and_b32 v247, 0xffff0000, v69
  s_waitcnt vmcnt(4)
  v_lshlrev_b32 v248, 16, v70
  v_and_b32 v249, 0xffff0000, v70
  v_lshlrev_b32 v250, 16, v71
  v_and_b32 v251, 0xffff0000, v71
  v_lshlrev_b32 v252, 16, v70
  v_and_b32 v253, 0xffff0000, v70
  v_lshlrev_b32 v254, 16, v71
  v_and_b32 v255, 0xffff0000, v71
  s_cmp_ge_u32 s58, 2
  s_cbranch_scc1 LF2_late
  ds_read_b64_tr_b16 v[64:65], v4 offset:0
  ds_read_b64_tr_b16 v[66:67], v4 offset:1024
  ds_read_b64_tr_b16 v[68:69], v5 offset:0
  ds_read_b64_tr_b16 v[70:71], v5 offset:1024
  ds_read_b64_tr_b16 v[72:73], v6 offset:0
  ds_read_b64_tr_b16 v[74:75], v6 offset:1024
  ds_read_b64_tr_b16 v[76:77], v7 offset:0
  ds_read_b64_tr_b16 v[78:79], v7 offset:1024
  ds_read_b64_tr_b16 v[80:81], v8 offset:0
  ds_read_b64_tr_b16 v[82:83], v8 offset:1024
  ds_read_b64_tr_b16 v[84:85], v9 offset:0
  ds_read_b64_tr_b16 v[86:87], v9 offset:1024
  ds_read_b64_tr_b16 v[88:89], v10 offset:0
  ds_read_b64_tr_b16 v[90:91], v10 offset:1024
  ds_read_b64_tr_b16 v[92:93], v11 offset:0
  ds_read_b64_tr_b16 v[94:95], v11 offset:1024
  ds_read_b64_tr_b16 v[96:97], v16 offset:0
  ds_read_b64_tr_b16 v[98:99], v16 offset:512
  ds_read_b64_tr_b16 v[100:101], v17 offset:0
  ds_read_b64_tr_b16 v[102:103], v17 offset:512
  ds_read_b64_tr_b16 v[104:105], v18 offset:0
  ds_read_b64_tr_b16 v[106:107], v18 offset:512
  ds_read_b64_tr_b16 v[108:109], v19 offset:0
  ds_read_b64_tr_b16 v[110:111], v19 offset:512
  s_waitcnt lgkmcnt(12)
  v_mfma_f32_16x16x32_bf16 v[160:163], v[64:67], v[32:35], 0
  v_mfma_f32_16x16x32_bf16 v[164:167], v[64:67], v[36:39], 0
  ds_read_b64_tr_b16 v[64:65], v4 offset:8192
  buffer_load_dwordx4 v[56:59], v12, s[44:47], 0 offen offset:512 sc1
  v_mfma_f32_16x16x32_bf16 v[172:175], v[68:71], v[36:39], 0
  ds_read_b64_tr_b16 v[66:67], v4 offset:9216
  v_mfma_f32_16x16x32_bf16 v[168:171], v[68:71], v[32:35], 0
  ds_read_b64_tr_b16 v[68:69], v5 offset:8192
  v_mfma_f32_16x16x32_bf16 v[176:179], v[72:75], v[32:35], 0
  ds_read_b64_tr_b16 v[70:71], v5 offset:9216
  buffer_load_dwordx4 v[60:63], v12, s[44:47], s69 offen offset:512 sc1
  v_mfma_f32_16x16x32_bf16 v[180:183], v[72:75], v[36:39], 0
  ds_read_b64_tr_b16 v[72:73], v6 offset:8192
  v_mfma_f32_16x16x32_bf16 v[188:191], v[76:79], v[36:39], 0
  ds_read_b64_tr_b16 v[74:75], v6 offset:9216
  v_mfma_f32_16x16x32_bf16 v[184:187], v[76:79], v[32:35], 0
  ds_read_b64_tr_b16 v[76:77], v7 offset:8192
  v_mfma_f32_16x16x32_bf16 v[192:195], v[80:83], v[32:35], 0
  ds_read_b64_tr_b16 v[78:79], v7 offset:9216
  v_add_u32 v12, 1024, v12
  v_mfma_f32_16x16x32_bf16 v[196:199], v[80:83], v[36:39], 0
  ds_read_b64_tr_b16 v[80:81], v8 offset:8192
  v_mfma_f32_16x16x32_bf16 v[204:207], v[84:87], v[36:39], 0
  ds_read_b64_tr_b16 v[82:83], v8 offset:9216
  v_mfma_f32_16x16x32_bf16 v[200:203], v[84:87], v[32:35], 0
  ds_read_b64_tr_b16 v[84:85], v9 offset:8192
  s_waitcnt lgkmcnt(11)
  v_mfma_f32_16x16x32_bf16 v[208:211], v[88:91], v[32:35], 0
  ds_read_b64_tr_b16 v[86:87], v9 offset:9216
  buffer_store_dwordx4 v[112:115], v14, s[44:47], s80 offen offset:1024 sc1
  v_mfma_f32_16x16x32_bf16 v[212:215], v[88:91], v[36:39], 0
  ds_read_b64_tr_b16 v[88:89], v10 offset:8192
  v_mfma_f32_16x16x32_bf16 v[220:223], v[92:95], v[36:39], 0
  ds_read_b64_tr_b16 v[90:91], v10 offset:9216
  v_mfma_f32_16x16x32_bf16 v[216:219], v[92:95], v[32:35], 0
  ds_read_b64_tr_b16 v[92:93], v11 offset:8192
  buffer_store_dwordx4 v[116:119], v14, s[44:47], s81 offen offset:1024 sc1
  v_mfma_f32_16x16x32_bf16 v[224:227], v[96:99], v[32:35], v[224:227]
  ds_read_b64_tr_b16 v[94:95], v11 offset:9216
  v_mfma_f32_16x16x32_bf16 v[228:231], v[96:99], v[36:39], v[228:231]
  ds_read_b64_tr_b16 v[96:97], v16 offset:4096
  v_mfma_f32_16x16x32_bf16 v[236:239], v[100:103], v[36:39], v[236:239]
  ds_read_b64_tr_b16 v[98:99], v16 offset:4608
  v_mfma_f32_16x16x32_bf16 v[232:235], v[100:103], v[32:35], v[232:235]
  ds_read_b64_tr_b16 v[100:101], v17 offset:4096
  buffer_store_dwordx4 v[120:123], v14, s[44:47], s82 offen offset:1024 sc1
  v_mfma_f32_16x16x32_bf16 v[240:243], v[104:107], v[32:35], v[240:243]
  ds_read_b64_tr_b16 v[102:103], v17 offset:4608
  v_mfma_f32_16x16x32_bf16 v[244:247], v[104:107], v[36:39], v[244:247]
  ds_read_b64_tr_b16 v[104:105], v18 offset:4096
  v_mfma_f32_16x16x32_bf16 v[252:255], v[108:111], v[36:39], v[252:255]
  ds_read_b64_tr_b16 v[106:107], v18 offset:4608
  v_mfma_f32_16x16x32_bf16 v[248:251], v[108:111], v[32:35], v[248:251]
  ds_read_b64_tr_b16 v[108:109], v19 offset:4096
  ds_read_b64_tr_b16 v[110:111], v19 offset:4608
  s_barrier
  s_waitcnt lgkmcnt(12)
  v_mfma_f32_16x16x32_bf16 v[160:163], v[64:67], v[40:43], v[160:163]
  v_mfma_f32_16x16x32_bf16 v[164:167], v[64:67], v[44:47], v[164:167]
  ds_read_b64_tr_b16 v[64:65], v4 offset:16384
  s_add_u32 m0, s67, 65536
  v_mfma_f32_16x16x32_bf16 v[172:175], v[68:71], v[44:47], v[172:175]
  ds_read_b64_tr_b16 v[66:67], v4 offset:17408
  buffer_load_dwordx4 v2, s[32:35], s64 offen lds
  v_mfma_f32_16x16x32_bf16 v[168:171], v[68:71], v[40:43], v[168:171]
  ds_read_b64_tr_b16 v[68:69], v5 offset:16384
  s_add_u32 m0, s67, 66560
  v_mfma_f32_16x16x32_bf16 v[176:179], v[72:75], v[40:43], v[176:179]
  ds_read_b64_tr_b16 v[70:71], v5 offset:17408
  buffer_load_dwordx4 v2, s[32:35], s65 offen lds
  v_mfma_f32_16x16x32_bf16 v[180:183], v[72:75], v[44:47], v[180:183]
  ds_read_b64_tr_b16 v[72:73], v6 offset:16384
  s_add_u32 m0, s68, 16384
  v_mfma_f32_16x16x32_bf16 v[188:191], v[76:79], v[44:47], v[188:191]
  ds_read_b64_tr_b16 v[74:75], v6 offset:17408
  v_mfma_f32_16x16x32_bf16 v[184:187], v[76:79], v[40:43], v[184:187]
  ds_read_b64_tr_b16 v[76:77], v7 offset:16384
  buffer_load_dwordx4 v3, s[36:39], s66 offen lds
  v_mfma_f32_16x16x32_bf16 v[192:195], v[80:83], v[40:43], v[192:195]
  ds_read_b64_tr_b16 v[78:79], v7 offset:17408
  v_add_u32 v2, 0x80000, v2
  v_mfma_f32_16x16x32_bf16 v[196:199], v[80:83], v[44:47], v[196:199]
  ds_read_b64_tr_b16 v[80:81], v8 offset:16384
  v_add_u32 v3, 229376, v3
  v_mfma_f32_16x16x32_bf16 v[204:207], v[84:87], v[44:47], v[204:207]
  ds_read_b64_tr_b16 v[82:83], v8 offset:17408
  s_add_u32 m0, s67, 81920
  v_mfma_f32_16x16x32_bf16 v[200:203], v[84:87], v[40:43], v[200:203]
  ds_read_b64_tr_b16 v[84:85], v9 offset:16384
  s_waitcnt lgkmcnt(11)
  v_mfma_f32_16x16x32_bf16 v[208:211], v[88:91], v[40:43], v[208:211]
  ds_read_b64_tr_b16 v[86:87], v9 offset:17408
  buffer_load_dwordx4 v2, s[32:35], s64 offen lds
  v_mfma_f32_16x16x32_bf16 v[212:215], v[88:91], v[44:47], v[212:215]
  ds_read_b64_tr_b16 v[88:89], v10 offset:16384
  s_add_u32 m0, s67, 82944
  v_mfma_f32_16x16x32_bf16 v[220:223], v[92:95], v[44:47], v[220:223]
  ds_read_b64_tr_b16 v[90:91], v10 offset:17408
  buffer_load_dwordx4 v2, s[32:35], s65 offen lds
  v_mfma_f32_16x16x32_bf16 v[216:219], v[92:95], v[40:43], v[216:219]
  ds_read_b64_tr_b16 v[92:93], v11 offset:16384
  s_add_u32 m0, s68, 24576
  v_mfma_f32_16x16x32_bf16 v[224:227], v[96:99], v[40:43], v[224:227]
  ds_read_b64_tr_b16 v[94:95], v11 offset:17408
  buffer_load_dwordx4 v3, s[36:39], s66 offen lds
  v_mfma_f32_16x16x32_bf16 v[228:231], v[96:99], v[44:47], v[228:231]
  ds_read_b64_tr_b16 v[96:97], v16 offset:8192
  v_mfma_f32_16x16x32_bf16 v[236:239], v[100:103], v[44:47], v[236:239]
  ds_read_b64_tr_b16 v[98:99], v16 offset:8704
  v_add_u32 v2, 0x80000, v2
  v_mfma_f32_16x16x32_bf16 v[232:235], v[100:103], v[40:43], v[232:235]
  ds_read_b64_tr_b16 v[100:101], v17 offset:8192
  v_add_u32 v3, 229376, v3
  v_mfma_f32_16x16x32_bf16 v[240:243], v[104:107], v[40:43], v[240:243]
  ds_read_b64_tr_b16 v[102:103], v17 offset:8704
  buffer_load_dwordx4 v[32:35], v12, s[44:47], 0 offen offset:0 sc1
  v_mfma_f32_16x16x32_bf16 v[244:247], v[104:107], v[44:47], v[244:247]
  ds_read_b64_tr_b16 v[104:105], v18 offset:8192
  buffer_load_dwordx4 v[36:39], v12, s[44:47], s69 offen offset:0 sc1
  v_mfma_f32_16x16x32_bf16 v[252:255], v[108:111], v[44:47], v[252:255]
  ds_read_b64_tr_b16 v[106:107], v18 offset:8704
  v_mfma_f32_16x16x32_bf16 v[248:251], v[108:111], v[40:43], v[248:251]
  ds_read_b64_tr_b16 v[108:109], v19 offset:8192
  ds_read_b64_tr_b16 v[110:111], v19 offset:8704
  s_waitcnt lgkmcnt(12)
  v_mfma_f32_16x16x32_bf16 v[160:163], v[64:67], v[48:51], v[160:163]
  v_mfma_f32_16x16x32_bf16 v[164:167], v[64:67], v[52:55], v[164:167]
  ds_read_b64_tr_b16 v[64:65], v4 offset:24576
  buffer_load_dwordx4 v[40:43], v12, s[44:47], 0 offen offset:512 sc1
  v_mfma_f32_16x16x32_bf16 v[172:175], v[68:71], v[52:55], v[172:175]
  ds_read_b64_tr_b16 v[66:67], v4 offset:25600
  v_mfma_f32_16x16x32_bf16 v[168:171], v[68:71], v[48:51], v[168:171]
  ds_read_b64_tr_b16 v[68:69], v5 offset:24576
  v_mfma_f32_16x16x32_bf16 v[176:179], v[72:75], v[48:51], v[176:179]
  ds_read_b64_tr_b16 v[70:71], v5 offset:25600
  buffer_load_dwordx4 v[44:47], v12, s[44:47], s69 offen offset:512 sc1
  v_mfma_f32_16x16x32_bf16 v[180:183], v[72:75], v[52:55], v[180:183]
  ds_read_b64_tr_b16 v[72:73], v6 offset:24576
  v_mfma_f32_16x16x32_bf16 v[188:191], v[76:79], v[52:55], v[188:191]
  ds_read_b64_tr_b16 v[74:75], v6 offset:25600
  v_mfma_f32_16x16x32_bf16 v[184:187], v[76:79], v[48:51], v[184:187]
  ds_read_b64_tr_b16 v[76:77], v7 offset:24576
  v_mfma_f32_16x16x32_bf16 v[192:195], v[80:83], v[48:51], v[192:195]
  ds_read_b64_tr_b16 v[78:79], v7 offset:25600
  v_add_u32 v12, 1024, v12
  v_mfma_f32_16x16x32_bf16 v[196:199], v[80:83], v[52:55], v[196:199]
  ds_read_b64_tr_b16 v[80:81], v8 offset:24576
  v_mfma_f32_16x16x32_bf16 v[204:207], v[84:87], v[52:55], v[204:207]
  ds_read_b64_tr_b16 v[82:83], v8 offset:25600
  v_mfma_f32_16x16x32_bf16 v[200:203], v[84:87], v[48:51], v[200:203]
  ds_read_b64_tr_b16 v[84:85], v9 offset:24576
  s_waitcnt lgkmcnt(11)
  v_mfma_f32_16x16x32_bf16 v[208:211], v[88:91], v[48:51], v[208:211]
  ds_read_b64_tr_b16 v[86:87], v9 offset:25600
  buffer_store_dwordx4 v[124:127], v14, s[44:47], s83 offen offset:1024 sc1
  v_mfma_f32_16x16x32_bf16 v[212:215], v[88:91], v[52:55], v[212:215]
  ds_read_b64_tr_b16 v[88:89], v10 offset:24576
  v_mfma_f32_16x16x32_bf16 v[220:223], v[92:95], v[52:55], v[220:223]
  ds_read_b64_tr_b16 v[90:91], v10 offset:25600
  v_mfma_f32_16x16x32_bf16 v[216:219], v[92:95], v[48:51], v[216:219]
  ds_read_b64_tr_b16 v[92:93], v11 offset:24576
  buffer_store_dwordx4 v[128:131], v14, s[44:47], s80 offen offset:2048 sc1
  v_mfma_f32_16x16x32_bf16 v[224:227], v[96:99], v[48:51], v[224:227]
  ds_read_b64_tr_b16 v[94:95], v11 offset:25600
  v_mfma_f32_16x16x32_bf16 v[228:231], v[96:99], v[52:55], v[228:231]
  ds_read_b64_tr_b16 v[96:97], v16 offset:12288
  v_mfma_f32_16x16x32_bf16 v[236:239], v[100:103], v[52:55], v[236:239]
  ds_read_b64_tr_b16 v[98:99], v16 offset:12800
  v_mfma_f32_16x16x32_bf16 v[232:235], v[100:103], v[48:51], v[232:235]
  ds_read_b64_tr_b16 v[100:101], v17 offset:12288
  buffer_store_dwordx4 v[132:135], v14, s[44:47], s81 offen offset:2048 sc1
  v_mfma_f32_16x16x32_bf16 v[240:243], v[104:107], v[48:51], v[240:243]
  ds_read_b64_tr_b16 v[102:103], v17 offset:12800
  v_mfma_f32_16x16x32_bf16 v[244:247], v[104:107], v[52:55], v[244:247]
  ds_read_b64_tr_b16 v[104:105], v18 offset:12288
  v_mfma_f32_16x16x32_bf16 v[252:255], v[108:111], v[52:55], v[252:255]
  ds_read_b64_tr_b16 v[106:107], v18 offset:12800
  v_mfma_f32_16x16x32_bf16 v[248:251], v[108:111], v[48:51], v[248:251]
  ds_read_b64_tr_b16 v[108:109], v19 offset:12288
  ds_read_b64_tr_b16 v[110:111], v19 offset:12800
  s_waitcnt vmcnt(10)
  s_barrier
  s_waitcnt lgkmcnt(12)
  v_mfma_f32_16x16x32_bf16 v[160:163], v[64:67], v[56:59], v[160:163]
  v_mfma_f32_16x16x32_bf16 v[164:167], v[64:67], v[60:63], v[164:167]
  ds_read_b64_tr_b16 v[64:65], v20 offset:0
  s_add_u32 m0, s67, 0
  v_mfma_f32_16x16x32_bf16 v[172:175], v[68:71], v[60:63], v[172:175]
  ds_read_b64_tr_b16 v[66:67], v20 offset:1024
  v_mfma_f32_16x16x32_bf16 v[168:171], v[68:71], v[56:59], v[168:171]
  ds_read_b64_tr_b16 v[68:69], v21 offset:0
  buffer_load_dwordx4 v2, s[32:35], s64 offen lds
  v_mfma_f32_16x16x32_bf16 v[176:179], v[72:75], v[56:59], v[176:179]
  ds_read_b64_tr_b16 v[70:71], v21 offset:1024
  v_mfma_f32_16x16x32_bf16 v[180:183], v[72:75], v[60:63], v[180:183]
  ds_read_b64_tr_b16 v[72:73], v22 offset:0
  s_add_u32 m0, s67, 1024
  v_mfma_f32_16x16x32_bf16 v[188:191], v[76:79], v[60:63], v[188:191]
  ds_read_b64_tr_b16 v[74:75], v22 offset:1024
  v_mfma_f32_16x16x32_bf16 v[184:187], v[76:79], v[56:59], v[184:187]
  ds_read_b64_tr_b16 v[76:77], v23 offset:0
  buffer_load_dwordx4 v2, s[32:35], s65 offen lds
  v_mfma_f32_16x16x32_bf16 v[192:195], v[80:83], v[56:59], v[192:195]
  ds_read_b64_tr_b16 v[78:79], v23 offset:1024
  v_mfma_f32_16x16x32_bf16 v[196:199], v[80:83], v[60:63], v[196:199]
  ds_read_b64_tr_b16 v[80:81], v24 offset:0
  s_add_u32 m0, s68, 0
  v_mfma_f32_16x16x32_bf16 v[204:207], v[84:87], v[60:63], v[204:207]
  ds_read_b64_tr_b16 v[82:83], v24 offset:1024
  v_mfma_f32_16x16x32_bf16 v[200:203], v[84:87], v[56:59], v[200:203]
  ds_read_b64_tr_b16 v[84:85], v25 offset:0
  s_waitcnt lgkmcnt(11)
  v_mfma_f32_16x16x32_bf16 v[208:211], v[88:91], v[56:59], v[208:211]
  ds_read_b64_tr_b16 v[86:87], v25 offset:1024
  buffer_load_dwordx4 v3, s[36:39], s66 offen lds
  v_mfma_f32_16x16x32_bf16 v[212:215], v[88:91], v[60:63], v[212:215]
  ds_read_b64_tr_b16 v[88:89], v26 offset:0
  v_mfma_f32_16x16x32_bf16 v[220:223], v[92:95], v[60:63], v[220:223]
  ds_read_b64_tr_b16 v[90:91], v26 offset:1024
  v_add_u32 v2, 0x80000, v2
  v_mfma_f32_16x16x32_bf16 v[216:219], v[92:95], v[56:59], v[216:219]
  ds_read_b64_tr_b16 v[92:93], v27 offset:0
  v_mfma_f32_16x16x32_bf16 v[224:227], v[96:99], v[56:59], v[224:227]
  ds_read_b64_tr_b16 v[94:95], v27 offset:1024
  v_add_u32 v3, 229376, v3
  v_mfma_f32_16x16x32_bf16 v[228:231], v[96:99], v[60:63], v[228:231]
  ds_read_b64_tr_b16 v[96:97], v16 offset:16384
  v_mfma_f32_16x16x32_bf16 v[236:239], v[100:103], v[60:63], v[236:239]
  ds_read_b64_tr_b16 v[98:99], v16 offset:16896
  buffer_load_dwordx4 v[48:51], v12, s[44:47], 0 offen offset:0 sc1
  v_mfma_f32_16x16x32_bf16 v[232:235], v[100:103], v[56:59], v[232:235]
  ds_read_b64_tr_b16 v[100:101], v17 offset:16384
  v_mfma_f32_16x16x32_bf16 v[240:243], v[104:107], v[56:59], v[240:243]
  ds_read_b64_tr_b16 v[102:103], v17 offset:16896
  buffer_load_dwordx4 v[52:55], v12, s[44:47], s69 offen offset:0 sc1
  v_mfma_f32_16x16x32_bf16 v[244:247], v[104:107], v[60:63], v[244:247]
  ds_read_b64_tr_b16 v[104:105], v18 offset:16384
  v_mfma_f32_16x16x32_bf16 v[252:255], v[108:111], v[60:63], v[252:255]
  ds_read_b64_tr_b16 v[106:107], v18 offset:16896
  v_mfma_f32_16x16x32_bf16 v[248:251], v[108:111], v[56:59], v[248:251]
  ds_read_b64_tr_b16 v[108:109], v19 offset:16384
  ds_read_b64_tr_b16 v[110:111], v19 offset:16896
  s_waitcnt vmcnt(10) lgkmcnt(12)
  v_mfma_f32_16x16x32_bf16 v[160:163], v[64:67], v[32:35], v[160:163]
  v_mfma_f32_16x16x32_bf16 v[164:167], v[64:67], v[36:39], v[164:167]
  ds_read_b64_tr_b16 v[64:65], v20 offset:8192
  buffer_load_dwordx4 v[56:59], v12, s[44:47], 0 offen offset:512 sc1
  v_mfma_f32_16x16x32_bf16 v[172:175], v[68:71], v[36:39], v[172:175]
  ds_read_b64_tr_b16 v[66:67], v20 offset:9216
  v_mfma_f32_16x16x32_bf16 v[168:171], v[68:71], v[32:35], v[168:171]
  ds_read_b64_tr_b16 v[68:69], v21 offset:8192
  v_mfma_f32_16x16x32_bf16 v[176:179], v[72:75], v[32:35], v[176:179]
  ds_read_b64_tr_b16 v[70:71], v21 offset:9216
  buffer_load_dwordx4 v[60:63], v12, s[44:47], s69 offen offset:512 sc1
  v_mfma_f32_16x16x32_bf16 v[180:183], v[72:75], v[36:39], v[180:183]
  ds_read_b64_tr_b16 v[72:73], v22 offset:8192
  v_mfma_f32_16x16x32_bf16 v[188:191], v[76:79], v[36:39], v[188:191]
  ds_read_b64_tr_b16 v[74:75], v22 offset:9216
  v_mfma_f32_16x16x32_bf16 v[184:187], v[76:79], v[32:35], v[184:187]
  ds_read_b64_tr_b16 v[76:77], v23 offset:8192
  v_mfma_f32_16x16x32_bf16 v[192:195], v[80:83], v[32:35], v[192:195]
  ds_read_b64_tr_b16 v[78:79], v23 offset:9216
  v_add_u32 v12, 1024, v12
  v_mfma_f32_16x16x32_bf16 v[196:199], v[80:83], v[36:39], v[196:199]
  ds_read_b64_tr_b16 v[80:81], v24 offset:8192
  v_mfma_f32_16x16x32_bf16 v[204:207], v[84:87], v[36:39], v[204:207]
  ds_read_b64_tr_b16 v[82:83], v24 offset:9216
  v_mfma_f32_16x16x32_bf16 v[200:203], v[84:87], v[32:35], v[200:203]
  ds_read_b64_tr_b16 v[84:85], v25 offset:8192
  s_waitcnt lgkmcnt(11)
  v_mfma_f32_16x16x32_bf16 v[208:211], v[88:91], v[32:35], v[208:211]
  ds_read_b64_tr_b16 v[86:87], v25 offset:9216
  buffer_store_dwordx4 v[136:139], v14, s[44:47], s82 offen offset:2048 sc1
  v_mfma_f32_16x16x32_bf16 v[212:215], v[88:91], v[36:39], v[212:215]
  ds_read_b64_tr_b16 v[88:89], v26 offset:8192
  v_mfma_f32_16x16x32_bf16 v[220:223], v[92:95], v[36:39], v[220:223]
  ds_read_b64_tr_b16 v[90:91], v26 offset:9216
  v_mfma_f32_16x16x32_bf16 v[216:219], v[92:95], v[32:35], v[216:219]
  ds_read_b64_tr_b16 v[92:93], v27 offset:8192
  buffer_store_dwordx4 v[140:143], v14, s[44:47], s83 offen offset:2048 sc1
  v_mfma_f32_16x16x32_bf16 v[224:227], v[96:99], v[32:35], v[224:227]
  ds_read_b64_tr_b16 v[94:95], v27 offset:9216
  v_mfma_f32_16x16x32_bf16 v[228:231], v[96:99], v[36:39], v[228:231]
  ds_read_b64_tr_b16 v[96:97], v16 offset:20480
  v_mfma_f32_16x16x32_bf16 v[236:239], v[100:103], v[36:39], v[236:239]
  ds_read_b64_tr_b16 v[98:99], v16 offset:20992
  v_mfma_f32_16x16x32_bf16 v[232:235], v[100:103], v[32:35], v[232:235]
  ds_read_b64_tr_b16 v[100:101], v17 offset:20480
  buffer_store_dwordx4 v[144:147], v14, s[44:47], s80 offen offset:3072 sc1
  v_mfma_f32_16x16x32_bf16 v[240:243], v[104:107], v[32:35], v[240:243]
  ds_read_b64_tr_b16 v[102:103], v17 offset:20992
  v_mfma_f32_16x16x32_bf16 v[244:247], v[104:107], v[36:39], v[244:247]
  ds_read_b64_tr_b16 v[104:105], v18 offset:20480
  v_mfma_f32_16x16x32_bf16 v[252:255], v[108:111], v[36:39], v[252:255]
  ds_read_b64_tr_b16 v[106:107], v18 offset:20992
  v_mfma_f32_16x16x32_bf16 v[248:251], v[108:111], v[32:35], v[248:251]
  ds_read_b64_tr_b16 v[108:109], v19 offset:20480
  ds_read_b64_tr_b16 v[110:111], v19 offset:20992
  s_barrier
  s_waitcnt vmcnt(13) lgkmcnt(12)
  v_mfma_f32_16x16x32_bf16 v[160:163], v[64:67], v[40:43], v[160:163]
  v_mfma_f32_16x16x32_bf16 v[164:167], v[64:67], v[44:47], v[164:167]
  ds_read_b64_tr_b16 v[64:65], v20 offset:16384
  s_add_u32 m0, s67, 16384
  v_mfma_f32_16x16x32_bf16 v[172:175], v[68:71], v[44:47], v[172:175]
  ds_read_b64_tr_b16 v[66:67], v20 offset:17408
  v_mfma_f32_16x16x32_bf16 v[168:171], v[68:71], v[40:43], v[168:171]
  ds_read_b64_tr_b16 v[68:69], v21 offset:16384
  buffer_load_dwordx4 v2, s[32:35], s64 offen lds
  v_mfma_f32_16x16x32_bf16 v[176:179], v[72:75], v[40:43], v[176:179]
  ds_read_b64_tr_b16 v[70:71], v21 offset:17408
  v_mfma_f32_16x16x32_bf16 v[180:183], v[72:75], v[44:47], v[180:183]
  ds_read_b64_tr_b16 v[72:73], v22 offset:16384
  s_add_u32 m0, s67, 17408
  v_mfma_f32_16x16x32_bf16 v[188:191], v[76:79], v[44:47], v[188:191]
  ds_read_b64_tr_b16 v[74:75], v22 offset:17408
  v_mfma_f32_16x16x32_bf16 v[184:187], v[76:79], v[40:43], v[184:187]
  ds_read_b64_tr_b16 v[76:77], v23 offset:16384
  buffer_load_dwordx4 v2, s[32:35], s65 offen lds
  v_mfma_f32_16x16x32_bf16 v[192:195], v[80:83], v[40:43], v[192:195]
  ds_read_b64_tr_b16 v[78:79], v23 offset:17408
  v_mfma_f32_16x16x32_bf16 v[196:199], v[80:83], v[44:47], v[196:199]
  ds_read_b64_tr_b16 v[80:81], v24 offset:16384
  s_add_u32 m0, s68, 8192
  v_mfma_f32_16x16x32_bf16 v[204:207], v[84:87], v[44:47], v[204:207]
  ds_read_b64_tr_b16 v[82:83], v24 offset:17408
  v_mfma_f32_16x16x32_bf16 v[200:203], v[84:87], v[40:43], v[200:203]
  ds_read_b64_tr_b16 v[84:85], v25 offset:16384
  s_waitcnt lgkmcnt(11)
  v_mfma_f32_16x16x32_bf16 v[208:211], v[88:91], v[40:43], v[208:211]
  ds_read_b64_tr_b16 v[86:87], v25 offset:17408
  buffer_load_dwordx4 v3, s[36:39], s66 offen lds
  v_mfma_f32_16x16x32_bf16 v[212:215], v[88:91], v[44:47], v[212:215]
  ds_read_b64_tr_b16 v[88:89], v26 offset:16384
  v_mfma_f32_16x16x32_bf16 v[220:223], v[92:95], v[44:47], v[220:223]
  ds_read_b64_tr_b16 v[90:91], v26 offset:17408
  v_add_u32 v2, 0x80000, v2
  v_mfma_f32_16x16x32_bf16 v[216:219], v[92:95], v[40:43], v[216:219]
  ds_read_b64_tr_b16 v[92:93], v27 offset:16384
  v_mfma_f32_16x16x32_bf16 v[224:227], v[96:99], v[40:43], v[224:227]
  ds_read_b64_tr_b16 v[94:95], v27 offset:17408
  v_add_u32 v3, 229376, v3
  v_mfma_f32_16x16x32_bf16 v[228:231], v[96:99], v[44:47], v[228:231]
  ds_read_b64_tr_b16 v[96:97], v16 offset:24576
  v_mfma_f32_16x16x32_bf16 v[236:239], v[100:103], v[44:47], v[236:239]
  ds_read_b64_tr_b16 v[98:99], v16 offset:25088
  buffer_load_dwordx4 v[32:35], v12, s[44:47], 0 offen offset:0 sc1
  v_mfma_f32_16x16x32_bf16 v[232:235], v[100:103], v[40:43], v[232:235]
  ds_read_b64_tr_b16 v[100:101], v17 offset:24576
  v_mfma_f32_16x16x32_bf16 v[240:243], v[104:107], v[40:43], v[240:243]
  ds_read_b64_tr_b16 v[102:103], v17 offset:25088
  buffer_load_dwordx4 v[36:39], v12, s[44:47], s69 offen offset:0 sc1
  v_mfma_f32_16x16x32_bf16 v[244:247], v[104:107], v[44:47], v[244:247]
  ds_read_b64_tr_b16 v[104:105], v18 offset:24576
  v_mfma_f32_16x16x32_bf16 v[252:255], v[108:111], v[44:47], v[252:255]
  ds_read_b64_tr_b16 v[106:107], v18 offset:25088
  v_mfma_f32_16x16x32_bf16 v[248:251], v[108:111], v[40:43], v[248:251]
  ds_read_b64_tr_b16 v[108:109], v19 offset:24576
  ds_read_b64_tr_b16 v[110:111], v19 offset:25088
  s_waitcnt vmcnt(10) lgkmcnt(12)
  v_mfma_f32_16x16x32_bf16 v[160:163], v[64:67], v[48:51], v[160:163]
  v_mfma_f32_16x16x32_bf16 v[164:167], v[64:67], v[52:55], v[164:167]
  ds_read_b64_tr_b16 v[64:65], v20 offset:24576
  buffer_load_dwordx4 v[40:43], v12, s[44:47], 0 offen offset:512 sc1
  v_mfma_f32_16x16x32_bf16 v[172:175], v[68:71], v[52:55], v[172:175]
  ds_read_b64_tr_b16 v[66:67], v20 offset:25600
  v_mfma_f32_16x16x32_bf16 v[168:171], v[68:71], v[48:51], v[168:171]
  ds_read_b64_tr_b16 v[68:69], v21 offset:24576
  v_mfma_f32_16x16x32_bf16 v[176:179], v[72:75], v[48:51], v[176:179]
  ds_read_b64_tr_b16 v[70:71], v21 offset:25600
  buffer_load_dwordx4 v[44:47], v12, s[44:47], s69 offen offset:512 sc1
  v_mfma_f32_16x16x32_bf16 v[180:183], v[72:75], v[52:55], v[180:183]
  ds_read_b64_tr_b16 v[72:73], v22 offset:24576
  v_mfma_f32_16x16x32_bf16 v[188:191], v[76:79], v[52:55], v[188:191]
  ds_read_b64_tr_b16 v[74:75], v22 offset:25600
  v_mfma_f32_16x16x32_bf16 v[184:187], v[76:79], v[48:51], v[184:187]
  ds_read_b64_tr_b16 v[76:77], v23 offset:24576
  v_mfma_f32_16x16x32_bf16 v[192:195], v[80:83], v[48:51], v[192:195]
  ds_read_b64_tr_b16 v[78:79], v23 offset:25600
  v_add_u32 v12, 1024, v12
  v_mfma_f32_16x16x32_bf16 v[196:199], v[80:83], v[52:55], v[196:199]
  ds_read_b64_tr_b16 v[80:81], v24 offset:24576
  v_mfma_f32_16x16x32_bf16 v[204:207], v[84:87], v[52:55], v[204:207]
  ds_read_b64_tr_b16 v[82:83], v24 offset:25600
  v_mfma_f32_16x16x32_bf16 v[200:203], v[84:87], v[48:51], v[200:203]
  ds_read_b64_tr_b16 v[84:85], v25 offset:24576
  s_waitcnt lgkmcnt(11)
  v_mfma_f32_16x16x32_bf16 v[208:211], v[88:91], v[48:51], v[208:211]
  ds_read_b64_tr_b16 v[86:87], v25 offset:25600
  buffer_store_dwordx4 v[148:151], v14, s[44:47], s81 offen offset:3072 sc1
  v_mfma_f32_16x16x32_bf16 v[212:215], v[88:91], v[52:55], v[212:215]
  ds_read_b64_tr_b16 v[88:89], v26 offset:24576
  v_mfma_f32_16x16x32_bf16 v[220:223], v[92:95], v[52:55], v[220:223]
  ds_read_b64_tr_b16 v[90:91], v26 offset:25600
  v_mfma_f32_16x16x32_bf16 v[216:219], v[92:95], v[48:51], v[216:219]
  ds_read_b64_tr_b16 v[92:93], v27 offset:24576
  buffer_store_dwordx4 v[152:155], v14, s[44:47], s82 offen offset:3072 sc1
  v_mfma_f32_16x16x32_bf16 v[224:227], v[96:99], v[48:51], v[224:227]
  ds_read_b64_tr_b16 v[94:95], v27 offset:25600
  v_mfma_f32_16x16x32_bf16 v[228:231], v[96:99], v[52:55], v[228:231]
  ds_read_b64_tr_b16 v[96:97], v16 offset:28672
  v_mfma_f32_16x16x32_bf16 v[236:239], v[100:103], v[52:55], v[236:239]
  ds_read_b64_tr_b16 v[98:99], v16 offset:29184
  v_mfma_f32_16x16x32_bf16 v[232:235], v[100:103], v[48:51], v[232:235]
  ds_read_b64_tr_b16 v[100:101], v17 offset:28672
  buffer_store_dwordx4 v[156:159], v14, s[44:47], s83 offen offset:3072 sc1
  v_mfma_f32_16x16x32_bf16 v[240:243], v[104:107], v[48:51], v[240:243]
  ds_read_b64_tr_b16 v[102:103], v17 offset:29184
  v_mfma_f32_16x16x32_bf16 v[244:247], v[104:107], v[52:55], v[244:247]
  ds_read_b64_tr_b16 v[104:105], v18 offset:28672
  v_mfma_f32_16x16x32_bf16 v[252:255], v[108:111], v[52:55], v[252:255]
  ds_read_b64_tr_b16 v[106:107], v18 offset:29184
  v_mfma_f32_16x16x32_bf16 v[248:251], v[108:111], v[48:51], v[248:251]
  ds_read_b64_tr_b16 v[108:109], v19 offset:28672
  ds_read_b64_tr_b16 v[110:111], v19 offset:29184
  s_barrier
  s_waitcnt vmcnt(13) lgkmcnt(12)
  v_mfma_f32_16x16x32_bf16 v[160:163], v[64:67], v[56:59], v[160:163]
  v_mfma_f32_16x16x32_bf16 v[164:167], v[64:67], v[60:63], v[164:167]
  ds_read_b64_tr_b16 v[64:65], v4 offset:0
  s_add_u32 m0, s67, 65536
  v_mfma_f32_16x16x32_bf16 v[172:175], v[68:71], v[60:63], v[172:175]
  ds_read_b64_tr_b16 v[66:67], v4 offset:1024
  v_mfma_f32_16x16x32_bf16 v[168:171], v[68:71], v[56:59], v[168:171]
  ds_read_b64_tr_b16 v[68:69], v5 offset:0
  buffer_load_dwordx4 v2, s[32:35], s64 offen lds
  v_mfma_f32_16x16x32_bf16 v[176:179], v[72:75], v[56:59], v[176:179]
  ds_read_b64_tr_b16 v[70:71], v5 offset:1024
  v_mfma_f32_16x16x32_bf16 v[180:183], v[72:75], v[60:63], v[180:183]
  ds_read_b64_tr_b16 v[72:73], v6 offset:0
  s_add_u32 m0, s67, 66560
  v_mfma_f32_16x16x32_bf16 v[188:191], v[76:79], v[60:63], v[188:191]
  ds_read_b64_tr_b16 v[74:75], v6 offset:1024
  v_mfma_f32_16x16x32_bf16 v[184:187], v[76:79], v[56:59], v[184:187]
  ds_read_b64_tr_b16 v[76:77], v7 offset:0
  buffer_load_dwordx4 v2, s[32:35], s65 offen lds
  v_mfma_f32_16x16x32_bf16 v[192:195], v[80:83], v[56:59], v[192:195]
  ds_read_b64_tr_b16 v[78:79], v7 offset:1024
  v_mfma_f32_16x16x32_bf16 v[196:199], v[80:83], v[60:63], v[196:199]
  ds_read_b64_tr_b16 v[80:81], v8 offset:0
  s_add_u32 m0, s68, 16384
  v_mfma_f32_16x16x32_bf16 v[204:207], v[84:87], v[60:63], v[204:207]
  ds_read_b64_tr_b16 v[82:83], v8 offset:1024
  v_mfma_f32_16x16x32_bf16 v[200:203], v[84:87], v[56:59], v[200:203]
  ds_read_b64_tr_b16 v[84:85], v9 offset:0
  s_waitcnt lgkmcnt(11)
  v_mfma_f32_16x16x32_bf16 v[208:211], v[88:91], v[56:59], v[208:211]
  ds_read_b64_tr_b16 v[86:87], v9 offset:1024
  buffer_load_dwordx4 v3, s[36:39], s66 offen lds
  v_mfma_f32_16x16x32_bf16 v[212:215], v[88:91], v[60:63], v[212:215]
  ds_read_b64_tr_b16 v[88:89], v10 offset:0
  v_mfma_f32_16x16x32_bf16 v[220:223], v[92:95], v[60:63], v[220:223]
  ds_read_b64_tr_b16 v[90:91], v10 offset:1024
  v_add_u32 v2, 0x80000, v2
  v_mfma_f32_16x16x32_bf16 v[216:219], v[92:95], v[56:59], v[216:219]
  ds_read_b64_tr_b16 v[92:93], v11 offset:0
  v_mfma_f32_16x16x32_bf16 v[224:227], v[96:99], v[56:59], v[224:227]
  ds_read_b64_tr_b16 v[94:95], v11 offset:1024
  v_add_u32 v3, 229376, v3
  v_mfma_f32_16x16x32_bf16 v[228:231], v[96:99], v[60:63], v[228:231]
  ds_read_b64_tr_b16 v[96:97], v16 offset:0
  v_mfma_f32_16x16x32_bf16 v[236:239], v[100:103], v[60:63], v[236:239]
  ds_read_b64_tr_b16 v[98:99], v16 offset:512
  buffer_load_dwordx4 v[48:51], v12, s[44:47], 0 offen offset:0 sc1
  v_mfma_f32_16x16x32_bf16 v[232:235], v[100:103], v[56:59], v[232:235]
  ds_read_b64_tr_b16 v[100:101], v17 offset:0
  v_mfma_f32_16x16x32_bf16 v[240:243], v[104:107], v[56:59], v[240:243]
  ds_read_b64_tr_b16 v[102:103], v17 offset:512
  buffer_load_dwordx4 v[52:55], v12, s[44:47], s69 offen offset:0 sc1
  v_mfma_f32_16x16x32_bf16 v[244:247], v[104:107], v[60:63], v[244:247]
  ds_read_b64_tr_b16 v[104:105], v18 offset:0
  v_mfma_f32_16x16x32_bf16 v[252:255], v[108:111], v[60:63], v[252:255]
  ds_read_b64_tr_b16 v[106:107], v18 offset:512
  v_mfma_f32_16x16x32_bf16 v[248:251], v[108:111], v[56:59], v[248:251]
  ds_read_b64_tr_b16 v[108:109], v19 offset:0
  ds_read_b64_tr_b16 v[110:111], v19 offset:512
  s_waitcnt vmcnt(10) lgkmcnt(12)
  v_mfma_f32_16x16x32_bf16 v[160:163], v[64:67], v[32:35], v[160:163]
  v_mfma_f32_16x16x32_bf16 v[164:167], v[64:67], v[36:39], v[164:167]
  ds_read_b64_tr_b16 v[64:65], v4 offset:8192
  buffer_load_dwordx4 v[56:59], v12, s[44:47], 0 offen offset:512 sc1
  v_mfma_f32_16x16x32_bf16 v[172:175], v[68:71], v[36:39], v[172:175]
  ds_read_b64_tr_b16 v[66:67], v4 offset:9216
  v_mfma_f32_16x16x32_bf16 v[168:171], v[68:71], v[32:35], v[168:171]
  ds_read_b64_tr_b16 v[68:69], v5 offset:8192
  v_mfma_f32_16x16x32_bf16 v[176:179], v[72:75], v[32:35], v[176:179]
  ds_read_b64_tr_b16 v[70:71], v5 offset:9216
  v_mfma_f32_16x16x32_bf16 v[180:183], v[72:75], v[36:39], v[180:183]
  ds_read_b64_tr_b16 v[72:73], v6 offset:8192
  v_mfma_f32_16x16x32_bf16 v[188:191], v[76:79], v[36:39], v[188:191]
  ds_read_b64_tr_b16 v[74:75], v6 offset:9216
  v_mfma_f32_16x16x32_bf16 v[184:187], v[76:79], v[32:35], v[184:187]
  ds_read_b64_tr_b16 v[76:77], v7 offset:8192
  v_mfma_f32_16x16x32_bf16 v[192:195], v[80:83], v[32:35], v[192:195]
  ds_read_b64_tr_b16 v[78:79], v7 offset:9216
  buffer_load_dwordx4 v[60:63], v12, s[44:47], s69 offen offset:512 sc1
  v_mfma_f32_16x16x32_bf16 v[196:199], v[80:83], v[36:39], v[196:199]
  ds_read_b64_tr_b16 v[80:81], v8 offset:8192
  v_mfma_f32_16x16x32_bf16 v[204:207], v[84:87], v[36:39], v[204:207]
  ds_read_b64_tr_b16 v[82:83], v8 offset:9216
  v_mfma_f32_16x16x32_bf16 v[200:203], v[84:87], v[32:35], v[200:203]
  ds_read_b64_tr_b16 v[84:85], v9 offset:8192
  s_waitcnt lgkmcnt(11)
  v_mfma_f32_16x16x32_bf16 v[208:211], v[88:91], v[32:35], v[208:211]
  ds_read_b64_tr_b16 v[86:87], v9 offset:9216
  v_mfma_f32_16x16x32_bf16 v[212:215], v[88:91], v[36:39], v[212:215]
  ds_read_b64_tr_b16 v[88:89], v10 offset:8192
  v_mfma_f32_16x16x32_bf16 v[220:223], v[92:95], v[36:39], v[220:223]
  ds_read_b64_tr_b16 v[90:91], v10 offset:9216
  v_mfma_f32_16x16x32_bf16 v[216:219], v[92:95], v[32:35], v[216:219]
  ds_read_b64_tr_b16 v[92:93], v11 offset:8192
  v_add_u32 v12, 1024, v12
  v_mfma_f32_16x16x32_bf16 v[224:227], v[96:99], v[32:35], v[224:227]
  ds_read_b64_tr_b16 v[94:95], v11 offset:9216
  v_mfma_f32_16x16x32_bf16 v[228:231], v[96:99], v[36:39], v[228:231]
  ds_read_b64_tr_b16 v[96:97], v16 offset:4096
  v_mfma_f32_16x16x32_bf16 v[236:239], v[100:103], v[36:39], v[236:239]
  ds_read_b64_tr_b16 v[98:99], v16 offset:4608
  v_mfma_f32_16x16x32_bf16 v[232:235], v[100:103], v[32:35], v[232:235]
  ds_read_b64_tr_b16 v[100:101], v17 offset:4096
  v_mfma_f32_16x16x32_bf16 v[240:243], v[104:107], v[32:35], v[240:243]
  ds_read_b64_tr_b16 v[102:103], v17 offset:4608
  v_mfma_f32_16x16x32_bf16 v[244:247], v[104:107], v[36:39], v[244:247]
  ds_read_b64_tr_b16 v[104:105], v18 offset:4096
  v_mfma_f32_16x16x32_bf16 v[252:255], v[108:111], v[36:39], v[252:255]
  ds_read_b64_tr_b16 v[106:107], v18 offset:4608
  v_mfma_f32_16x16x32_bf16 v[248:251], v[108:111], v[32:35], v[248:251]
  ds_read_b64_tr_b16 v[108:109], v19 offset:4096
  ds_read_b64_tr_b16 v[110:111], v19 offset:4608
  s_barrier
  s_waitcnt vmcnt(10) lgkmcnt(12)
  v_mfma_f32_16x16x32_bf16 v[160:163], v[64:67], v[40:43], v[160:163]
  v_mfma_f32_16x16x32_bf16 v[164:167], v[64:67], v[44:47], v[164:167]
  ds_read_b64_tr_b16 v[64:65], v4 offset:16384
  s_add_u32 m0, s67, 81920
  v_mfma_f32_16x16x32_bf16 v[172:175], v[68:71], v[44:47], v[172:175]
  ds_read_b64_tr_b16 v[66:67], v4 offset:17408
  v_mfma_f32_16x16x32_bf16 v[168:171], v[68:71], v[40:43], v[168:171]
  ds_read_b64_tr_b16 v[68:69], v5 offset:16384
  buffer_load_dwordx4 v2, s[32:35], s64 offen lds
  v_mfma_f32_16x16x32_bf16 v[176:179], v[72:75], v[40:43], v[176:179]
  ds_read_b64_tr_b16 v[70:71], v5 offset:17408
  v_mfma_f32_16x16x32_bf16 v[180:183], v[72:75], v[44:47], v[180:183]
  ds_read_b64_tr_b16 v[72:73], v6 offset:16384
  s_add_u32 m0, s67, 82944
  v_mfma_f32_16x16x32_bf16 v[188:191], v[76:79], v[44:47], v[188:191]
  ds_read_b64_tr_b16 v[74:75], v6 offset:17408
  v_mfma_f32_16x16x32_bf16 v[184:187], v[76:79], v[40:43], v[184:187]
  ds_read_b64_tr_b16 v[76:77], v7 offset:16384
  buffer_load_dwordx4 v2, s[32:35], s65 offen lds
  v_mfma_f32_16x16x32_bf16 v[192:195], v[80:83], v[40:43], v[192:195]
  ds_read_b64_tr_b16 v[78:79], v7 offset:17408
  v_mfma_f32_16x16x32_bf16 v[196:199], v[80:83], v[44:47], v[196:199]
  ds_read_b64_tr_b16 v[80:81], v8 offset:16384
  s_add_u32 m0, s68, 24576
  v_mfma_f32_16x16x32_bf16 v[204:207], v[84:87], v[44:47], v[204:207]
  ds_read_b64_tr_b16 v[82:83], v8 offset:17408
  v_mfma_f32_16x16x32_bf16 v[200:203], v[84:87], v[40:43], v[200:203]
  ds_read_b64_tr_b16 v[84:85], v9 offset:16384
  s_waitcnt lgkmcnt(11)
  v_mfma_f32_16x16x32_bf16 v[208:211], v[88:91], v[40:43], v[208:211]
  ds_read_b64_tr_b16 v[86:87], v9 offset:17408
  buffer_load_dwordx4 v3, s[36:39], s66 offen lds
  v_mfma_f32_16x16x32_bf16 v[212:215], v[88:91], v[44:47], v[212:215]
  ds_read_b64_tr_b16 v[88:89], v10 offset:16384
  v_mfma_f32_16x16x32_bf16 v[220:223], v[92:95], v[44:47], v[220:223]
  ds_read_b64_tr_b16 v[90:91], v10 offset:17408
  v_add_u32 v2, 0x80000, v2
  v_mfma_f32_16x16x32_bf16 v[216:219], v[92:95], v[40:43], v[216:219]
  ds_read_b64_tr_b16 v[92:93], v11 offset:16384
  v_mfma_f32_16x16x32_bf16 v[224:227], v[96:99], v[40:43], v[224:227]
  ds_read_b64_tr_b16 v[94:95], v11 offset:17408
  v_add_u32 v3, 229376, v3
  v_mfma_f32_16x16x32_bf16 v[228:231], v[96:99], v[44:47], v[228:231]
  ds_read_b64_tr_b16 v[96:97], v16 offset:8192
  v_mfma_f32_16x16x32_bf16 v[236:239], v[100:103], v[44:47], v[236:239]
  ds_read_b64_tr_b16 v[98:99], v16 offset:8704
  buffer_load_dwordx4 v[32:35], v12, s[44:47], 0 offen offset:0 sc1
  v_mfma_f32_16x16x32_bf16 v[232:235], v[100:103], v[40:43], v[232:235]
  ds_read_b64_tr_b16 v[100:101], v17 offset:8192
  v_mfma_f32_16x16x32_bf16 v[240:243], v[104:107], v[40:43], v[240:243]
  ds_read_b64_tr_b16 v[102:103], v17 offset:8704
  buffer_load_dwordx4 v[36:39], v12, s[44:47], s69 offen offset:0 sc1
  v_mfma_f32_16x16x32_bf16 v[244:247], v[104:107], v[44:47], v[244:247]
  ds_read_b64_tr_b16 v[104:105], v18 offset:8192
  v_mfma_f32_16x16x32_bf16 v[252:255], v[108:111], v[44:47], v[252:255]
  ds_read_b64_tr_b16 v[106:107], v18 offset:8704
  v_mfma_f32_16x16x32_bf16 v[248:251], v[108:111], v[40:43], v[248:251]
  ds_read_b64_tr_b16 v[108:109], v19 offset:8192
  ds_read_b64_tr_b16 v[110:111], v19 offset:8704
  s_waitcnt vmcnt(7) lgkmcnt(12)
  v_mfma_f32_16x16x32_bf16 v[160:163], v[64:67], v[48:51], v[160:163]
  v_mfma_f32_16x16x32_bf16 v[164:167], v[64:67], v[52:55], v[164:167]
  ds_read_b64_tr_b16 v[64:65], v4 offset:24576
  buffer_load_dwordx4 v[40:43], v12, s[44:47], 0 offen offset:512 sc1
  v_mfma_f32_16x16x32_bf16 v[172:175], v[68:71], v[52:55], v[172:175]
  ds_read_b64_tr_b16 v[66:67], v4 offset:25600
  v_mfma_f32_16x16x32_bf16 v[168:171], v[68:71], v[48:51], v[168:171]
  ds_read_b64_tr_b16 v[68:69], v5 offset:24576
  v_mfma_f32_16x16x32_bf16 v[176:179], v[72:75], v[48:51], v[176:179]
  ds_read_b64_tr_b16 v[70:71], v5 offset:25600
  v_mfma_f32_16x16x32_bf16 v[180:183], v[72:75], v[52:55], v[180:183]
  ds_read_b64_tr_b16 v[72:73], v6 offset:24576
  v_mfma_f32_16x16x32_bf16 v[188:191], v[76:79], v[52:55], v[188:191]
  ds_read_b64_tr_b16 v[74:75], v6 offset:25600
  v_mfma_f32_16x16x32_bf16 v[184:187], v[76:79], v[48:51], v[184:187]
  ds_read_b64_tr_b16 v[76:77], v7 offset:24576
  v_mfma_f32_16x16x32_bf16 v[192:195], v[80:83], v[48:51], v[192:195]
  ds_read_b64_tr_b16 v[78:79], v7 offset:25600
  buffer_load_dwordx4 v[44:47], v12, s[44:47], s69 offen offset:512 sc1
  v_mfma_f32_16x16x32_bf16 v[196:199], v[80:83], v[52:55], v[196:199]
  ds_read_b64_tr_b16 v[80:81], v8 offset:24576
  v_mfma_f32_16x16x32_bf16 v[204:207], v[84:87], v[52:55], v[204:207]
  ds_read_b64_tr_b16 v[82:83], v8 offset:25600
  v_mfma_f32_16x16x32_bf16 v[200:203], v[84:87], v[48:51], v[200:203]
  ds_read_b64_tr_b16 v[84:85], v9 offset:24576
  s_waitcnt lgkmcnt(11)
  v_mfma_f32_16x16x32_bf16 v[208:211], v[88:91], v[48:51], v[208:211]
  ds_read_b64_tr_b16 v[86:87], v9 offset:25600
  v_mfma_f32_16x16x32_bf16 v[212:215], v[88:91], v[52:55], v[212:215]
  ds_read_b64_tr_b16 v[88:89], v10 offset:24576
  v_mfma_f32_16x16x32_bf16 v[220:223], v[92:95], v[52:55], v[220:223]
  ds_read_b64_tr_b16 v[90:91], v10 offset:25600
  v_mfma_f32_16x16x32_bf16 v[216:219], v[92:95], v[48:51], v[216:219]
  ds_read_b64_tr_b16 v[92:93], v11 offset:24576
  v_add_u32 v12, 1024, v12
  v_mfma_f32_16x16x32_bf16 v[224:227], v[96:99], v[48:51], v[224:227]
  ds_read_b64_tr_b16 v[94:95], v11 offset:25600
  v_mfma_f32_16x16x32_bf16 v[228:231], v[96:99], v[52:55], v[228:231]
  ds_read_b64_tr_b16 v[96:97], v16 offset:12288
  v_mfma_f32_16x16x32_bf16 v[236:239], v[100:103], v[52:55], v[236:239]
  ds_read_b64_tr_b16 v[98:99], v16 offset:12800
  v_mfma_f32_16x16x32_bf16 v[232:235], v[100:103], v[48:51], v[232:235]
  ds_read_b64_tr_b16 v[100:101], v17 offset:12288
  v_mfma_f32_16x16x32_bf16 v[240:243], v[104:107], v[48:51], v[240:243]
  ds_read_b64_tr_b16 v[102:103], v17 offset:12800
  v_mfma_f32_16x16x32_bf16 v[244:247], v[104:107], v[52:55], v[244:247]
  ds_read_b64_tr_b16 v[104:105], v18 offset:12288
  v_mfma_f32_16x16x32_bf16 v[252:255], v[108:111], v[52:55], v[252:255]
  ds_read_b64_tr_b16 v[106:107], v18 offset:12800
  v_mfma_f32_16x16x32_bf16 v[248:251], v[108:111], v[48:51], v[248:251]
  ds_read_b64_tr_b16 v[108:109], v19 offset:12288
  ds_read_b64_tr_b16 v[110:111], v19 offset:12800
  s_barrier
  v_mov_b32 v30, 1
  s_lshl_b32 s60, s2, 10
  s_cmp_eq_u32 s56, 0
  s_cselect_b32 s60, s60, 0x40000
  buffer_store_dword v30, off, s[88:91], s60 offset:0 sc1
  s_waitcnt vmcnt(8) lgkmcnt(12)
  v_mfma_f32_16x16x32_bf16 v[160:163], v[64:67], v[56:59], v[160:163]
  v_mfma_f32_16x16x32_bf16 v[164:167], v[64:67], v[60:63], v[164:167]
  ds_read_b64_tr_b16 v[64:65], v20 offset:0
  buffer_load_dwordx4 v[48:51], v12, s[44:47], 0 offen offset:0 sc1
  v_mfma_f32_16x16x32_bf16 v[172:175], v[68:71], v[60:63], v[172:175]
  ds_read_b64_tr_b16 v[66:67], v20 offset:1024
  v_mfma_f32_16x16x32_bf16 v[168:171], v[68:71], v[56:59], v[168:171]
  ds_read_b64_tr_b16 v[68:69], v21 offset:0
  v_mfma_f32_16x16x32_bf16 v[176:179], v[72:75], v[56:59], v[176:179]
  ds_read_b64_tr_b16 v[70:71], v21 offset:1024
  v_mfma_f32_16x16x32_bf16 v[180:183], v[72:75], v[60:63], v[180:183]
  ds_read_b64_tr_b16 v[72:73], v22 offset:0
  v_mfma_f32_16x16x32_bf16 v[188:191], v[76:79], v[60:63], v[188:191]
  ds_read_b64_tr_b16 v[74:75], v22 offset:1024
  v_mfma_f32_16x16x32_bf16 v[184:187], v[76:79], v[56:59], v[184:187]
  ds_read_b64_tr_b16 v[76:77], v23 offset:0
  v_mfma_f32_16x16x32_bf16 v[192:195], v[80:83], v[56:59], v[192:195]
  ds_read_b64_tr_b16 v[78:79], v23 offset:1024
  v_mfma_f32_16x16x32_bf16 v[196:199], v[80:83], v[60:63], v[196:199]
  ds_read_b64_tr_b16 v[80:81], v24 offset:0
  v_mfma_f32_16x16x32_bf16 v[204:207], v[84:87], v[60:63], v[204:207]
  ds_read_b64_tr_b16 v[82:83], v24 offset:1024
  v_mfma_f32_16x16x32_bf16 v[200:203], v[84:87], v[56:59], v[200:203]
  ds_read_b64_tr_b16 v[84:85], v25 offset:0
  s_waitcnt lgkmcnt(11)
  v_mfma_f32_16x16x32_bf16 v[208:211], v[88:91], v[56:59], v[208:211]
  ds_read_b64_tr_b16 v[86:87], v25 offset:1024
  buffer_load_dwordx4 v[52:55], v12, s[44:47], s69 offen offset:0 sc1
  v_mfma_f32_16x16x32_bf16 v[212:215], v[88:91], v[60:63], v[212:215]
  ds_read_b64_tr_b16 v[88:89], v26 offset:0
  v_mfma_f32_16x16x32_bf16 v[220:223], v[92:95], v[60:63], v[220:223]
  ds_read_b64_tr_b16 v[90:91], v26 offset:1024
  v_mfma_f32_16x16x32_bf16 v[216:219], v[92:95], v[56:59], v[216:219]
  ds_read_b64_tr_b16 v[92:93], v27 offset:0
  v_mfma_f32_16x16x32_bf16 v[224:227], v[96:99], v[56:59], v[224:227]
  ds_read_b64_tr_b16 v[94:95], v27 offset:1024
  v_mfma_f32_16x16x32_bf16 v[228:231], v[96:99], v[60:63], v[228:231]
  ds_read_b64_tr_b16 v[96:97], v16 offset:16384
  v_mfma_f32_16x16x32_bf16 v[236:239], v[100:103], v[60:63], v[236:239]
  ds_read_b64_tr_b16 v[98:99], v16 offset:16896
  v_mfma_f32_16x16x32_bf16 v[232:235], v[100:103], v[56:59], v[232:235]
  ds_read_b64_tr_b16 v[100:101], v17 offset:16384
  v_mfma_f32_16x16x32_bf16 v[240:243], v[104:107], v[56:59], v[240:243]
  ds_read_b64_tr_b16 v[102:103], v17 offset:16896
  v_mfma_f32_16x16x32_bf16 v[244:247], v[104:107], v[60:63], v[244:247]
  ds_read_b64_tr_b16 v[104:105], v18 offset:16384
  v_mfma_f32_16x16x32_bf16 v[252:255], v[108:111], v[60:63], v[252:255]
  ds_read_b64_tr_b16 v[106:107], v18 offset:16896
  v_mfma_f32_16x16x32_bf16 v[248:251], v[108:111], v[56:59], v[248:251]
  ds_read_b64_tr_b16 v[108:109], v19 offset:16384
  ds_read_b64_tr_b16 v[110:111], v19 offset:16896
  s_waitcnt vmcnt(5) lgkmcnt(12)
  v_mfma_f32_16x16x32_bf16 v[160:163], v[64:67], v[32:35], v[160:163]
  v_mfma_f32_16x16x32_bf16 v[164:167], v[64:67], v[36:39], v[164:167]
  ds_read_b64_tr_b16 v[64:65], v20 offset:8192
  buffer_load_dwordx4 v[56:59], v12, s[44:47], 0 offen offset:512 sc1
  v_mfma_f32_16x16x32_bf16 v[172:175], v[68:71], v[36:39], v[172:175]
  ds_read_b64_tr_b16 v[66:67], v20 offset:9216
  v_mfma_f32_16x16x32_bf16 v[168:171], v[68:71], v[32:35], v[168:171]
  ds_read_b64_tr_b16 v[68:69], v21 offset:8192
  v_mfma_f32_16x16x32_bf16 v[176:179], v[72:75], v[32:35], v[176:179]
  ds_read_b64_tr_b16 v[70:71], v21 offset:9216
  v_mfma_f32_16x16x32_bf16 v[180:183], v[72:75], v[36:39], v[180:183]
  ds_read_b64_tr_b16 v[72:73], v22 offset:8192
  v_mfma_f32_16x16x32_bf16 v[188:191], v[76:79], v[36:39], v[188:191]
  ds_read_b64_tr_b16 v[74:75], v22 offset:9216
  v_mfma_f32_16x16x32_bf16 v[184:187], v[76:79], v[32:35], v[184:187]
  ds_read_b64_tr_b16 v[76:77], v23 offset:8192
  v_mfma_f32_16x16x32_bf16 v[192:195], v[80:83], v[32:35], v[192:195]
  ds_read_b64_tr_b16 v[78:79], v23 offset:9216
  buffer_load_dwordx4 v[60:63], v12, s[44:47], s69 offen offset:512 sc1
  v_mfma_f32_16x16x32_bf16 v[196:199], v[80:83], v[36:39], v[196:199]
  ds_read_b64_tr_b16 v[80:81], v24 offset:8192
  v_mfma_f32_16x16x32_bf16 v[204:207], v[84:87], v[36:39], v[204:207]
  ds_read_b64_tr_b16 v[82:83], v24 offset:9216
  v_mfma_f32_16x16x32_bf16 v[200:203], v[84:87], v[32:35], v[200:203]
  ds_read_b64_tr_b16 v[84:85], v25 offset:8192
  s_waitcnt lgkmcnt(11)
  v_mfma_f32_16x16x32_bf16 v[208:211], v[88:91], v[32:35], v[208:211]
  ds_read_b64_tr_b16 v[86:87], v25 offset:9216
  v_mfma_f32_16x16x32_bf16 v[212:215], v[88:91], v[36:39], v[212:215]
  ds_read_b64_tr_b16 v[88:89], v26 offset:8192
  v_mfma_f32_16x16x32_bf16 v[220:223], v[92:95], v[36:39], v[220:223]
  ds_read_b64_tr_b16 v[90:91], v26 offset:9216
  v_mfma_f32_16x16x32_bf16 v[216:219], v[92:95], v[32:35], v[216:219]
  ds_read_b64_tr_b16 v[92:93], v27 offset:8192
  v_add_u32 v12, 1024, v12
  v_mfma_f32_16x16x32_bf16 v[224:227], v[96:99], v[32:35], v[224:227]
  ds_read_b64_tr_b16 v[94:95], v27 offset:9216
  v_mfma_f32_16x16x32_bf16 v[228:231], v[96:99], v[36:39], v[228:231]
  ds_read_b64_tr_b16 v[96:97], v16 offset:20480
  v_mfma_f32_16x16x32_bf16 v[236:239], v[100:103], v[36:39], v[236:239]
  ds_read_b64_tr_b16 v[98:99], v16 offset:20992
  v_mfma_f32_16x16x32_bf16 v[232:235], v[100:103], v[32:35], v[232:235]
  ds_read_b64_tr_b16 v[100:101], v17 offset:20480
  v_mfma_f32_16x16x32_bf16 v[240:243], v[104:107], v[32:35], v[240:243]
  ds_read_b64_tr_b16 v[102:103], v17 offset:20992
  v_mfma_f32_16x16x32_bf16 v[244:247], v[104:107], v[36:39], v[244:247]
  ds_read_b64_tr_b16 v[104:105], v18 offset:20480
  v_mfma_f32_16x16x32_bf16 v[252:255], v[108:111], v[36:39], v[252:255]
  ds_read_b64_tr_b16 v[106:107], v18 offset:20992
  v_mfma_f32_16x16x32_bf16 v[248:251], v[108:111], v[32:35], v[248:251]
  ds_read_b64_tr_b16 v[108:109], v19 offset:20480
  ds_read_b64_tr_b16 v[110:111], v19 offset:20992
  s_barrier
  s_waitcnt vmcnt(5) lgkmcnt(12)
  v_mfma_f32_16x16x32_bf16 v[160:163], v[64:67], v[40:43], v[160:163]
  v_mfma_f32_16x16x32_bf16 v[164:167], v[64:67], v[44:47], v[164:167]
  ds_read_b64_tr_b16 v[64:65], v20 offset:16384
  s_and_b32 s60, s2, 7
  s_lshr_b32 s61, s2, 3
  v_mfma_f32_16x16x32_bf16 v[172:175], v[68:71], v[44:47], v[172:175]
  ds_read_b64_tr_b16 v[66:67], v20 offset:17408
  s_and_b32 s6, s60, 3
  v_mfma_f32_16x16x32_bf16 v[168:171], v[68:71], v[40:43], v[168:171]
  ds_read_b64_tr_b16 v[68:69], v21 offset:16384
  s_lshr_b32 s60, s60, 2
  v_mfma_f32_16x16x32_bf16 v[176:179], v[72:75], v[40:43], v[176:179]
  ds_read_b64_tr_b16 v[70:71], v21 offset:17408
  s_lshl_b32 s60, s60, 3
  s_lshr_b32 s7, s61, 2
  v_mfma_f32_16x16x32_bf16 v[180:183], v[72:75], v[44:47], v[180:183]
  ds_read_b64_tr_b16 v[72:73], v22 offset:16384
  s_add_u32 s7, s7, s60
  v_mfma_f32_16x16x32_bf16 v[188:191], v[76:79], v[44:47], v[188:191]
  ds_read_b64_tr_b16 v[74:75], v22 offset:17408
  s_and_b32 s8, s61, 3
  v_mfma_f32_16x16x32_bf16 v[184:187], v[76:79], v[40:43], v[184:187]
  ds_read_b64_tr_b16 v[76:77], v23 offset:16384
  s_lshl_b32 s9, s7, 2
  v_mfma_f32_16x16x32_bf16 v[192:195], v[80:83], v[40:43], v[192:195]
  ds_read_b64_tr_b16 v[78:79], v23 offset:17408
  s_add_u32 s9, s9, s8
  s_sub_u32 s60, 15, s7
  v_mfma_f32_16x16x32_bf16 v[196:199], v[80:83], v[44:47], v[196:199]
  ds_read_b64_tr_b16 v[80:81], v24 offset:16384
  s_min_u32 s20, s60, s7
  v_mfma_f32_16x16x32_bf16 v[204:207], v[84:87], v[44:47], v[204:207]
  ds_read_b64_tr_b16 v[82:83], v24 offset:17408
  s_mov_b32 s32, s22
  v_mfma_f32_16x16x32_bf16 v[200:203], v[84:87], v[40:43], v[200:203]
  ds_read_b64_tr_b16 v[84:85], v25 offset:16384
  s_mov_b32 s33, s23
  s_waitcnt lgkmcnt(11)
  v_mfma_f32_16x16x32_bf16 v[208:211], v[88:91], v[40:43], v[208:211]
  ds_read_b64_tr_b16 v[86:87], v25 offset:17408
  s_mov_b32 s34, 0x1c0000
  s_mov_b32 s35, 0x20000
  v_mfma_f32_16x16x32_bf16 v[212:215], v[88:91], v[44:47], v[212:215]
  ds_read_b64_tr_b16 v[88:89], v26 offset:16384
  s_mov_b32 s36, s14
  v_mfma_f32_16x16x32_bf16 v[220:223], v[92:95], v[44:47], v[220:223]
  ds_read_b64_tr_b16 v[90:91], v26 offset:17408
  s_mov_b32 s37, s15
  v_mfma_f32_16x16x32_bf16 v[216:219], v[92:95], v[40:43], v[216:219]
  ds_read_b64_tr_b16 v[92:93], v27 offset:16384
  s_mov_b32 s38, 0x400000
  s_mov_b32 s39, 0x20000
  v_mfma_f32_16x16x32_bf16 v[224:227], v[96:99], v[40:43], v[224:227]
  ds_read_b64_tr_b16 v[94:95], v27 offset:17408
  s_add_u32 s40, s30, 0x2200000
  s_addc_u32 s41, s31, 0
  v_mfma_f32_16x16x32_bf16 v[228:231], v[96:99], v[44:47], v[228:231]
  ds_read_b64_tr_b16 v[96:97], v16 offset:24576
  s_mov_b32 s42, 0x700000
  v_mfma_f32_16x16x32_bf16 v[236:239], v[100:103], v[44:47], v[236:239]
  ds_read_b64_tr_b16 v[98:99], v16 offset:25088
  s_mov_b32 s43, 0x20000
  v_mfma_f32_16x16x32_bf16 v[232:235], v[100:103], v[40:43], v[232:235]
  ds_read_b64_tr_b16 v[100:101], v17 offset:24576
  s_add_u32 s84, s30, 0x3900000
  s_addc_u32 s85, s31, 0
  s_mov_b32 s86, 0x800000
  v_mfma_f32_16x16x32_bf16 v[240:243], v[104:107], v[40:43], v[240:243]
  ds_read_b64_tr_b16 v[102:103], v17 offset:25088
  s_mov_b32 s87, 0x20000
  v_mfma_f32_16x16x32_bf16 v[244:247], v[104:107], v[44:47], v[244:247]
  ds_read_b64_tr_b16 v[104:105], v18 offset:24576
  s_cmp_lt_u32 s56, 4
  s_cselect_b32 s60, 0, 0x1000000
  v_mfma_f32_16x16x32_bf16 v[252:255], v[108:111], v[44:47], v[252:255]
  ds_read_b64_tr_b16 v[106:107], v18 offset:25088
  s_add_u32 s84, s84, s60
  s_addc_u32 s85, s85, 0
  v_mfma_f32_16x16x32_bf16 v[248:251], v[108:111], v[40:43], v[248:251]
  ds_read_b64_tr_b16 v[108:109], v19 offset:24576
  ds_read_b64_tr_b16 v[110:111], v19 offset:25088
  s_waitcnt vmcnt(2) lgkmcnt(12)
  v_mfma_f32_16x16x32_bf16 v[160:163], v[64:67], v[48:51], v[160:163]
  v_mfma_f32_16x16x32_bf16 v[164:167], v[64:67], v[52:55], v[164:167]
  ds_read_b64_tr_b16 v[64:65], v20 offset:24576
  v_and_b32 v29, 1, v1
  v_mfma_f32_16x16x32_bf16 v[172:175], v[68:71], v[52:55], v[172:175]
  ds_read_b64_tr_b16 v[66:67], v20 offset:25600
  v_mfma_f32_16x16x32_bf16 v[168:171], v[68:71], v[48:51], v[168:171]
  ds_read_b64_tr_b16 v[68:69], v21 offset:24576
  v_mfma_f32_16x16x32_bf16 v[176:179], v[72:75], v[48:51], v[176:179]
  ds_read_b64_tr_b16 v[70:71], v21 offset:25600
  v_lshlrev_b32 v29, 15, v29
  v_mfma_f32_16x16x32_bf16 v[180:183], v[72:75], v[52:55], v[180:183]
  ds_read_b64_tr_b16 v[72:73], v22 offset:24576
  v_mfma_f32_16x16x32_bf16 v[188:191], v[76:79], v[52:55], v[188:191]
  ds_read_b64_tr_b16 v[74:75], v22 offset:25600
  v_mfma_f32_16x16x32_bf16 v[184:187], v[76:79], v[48:51], v[184:187]
  ds_read_b64_tr_b16 v[76:77], v23 offset:24576
  v_mfma_f32_16x16x32_bf16 v[192:195], v[80:83], v[48:51], v[192:195]
  ds_read_b64_tr_b16 v[78:79], v23 offset:25600
  s_and_b32 s74, s2, 31
  v_mfma_f32_16x16x32_bf16 v[196:199], v[80:83], v[52:55], v[196:199]
  ds_read_b64_tr_b16 v[80:81], v24 offset:24576
  v_mfma_f32_16x16x32_bf16 v[204:207], v[84:87], v[52:55], v[204:207]
  ds_read_b64_tr_b16 v[82:83], v24 offset:25600
  v_mfma_f32_16x16x32_bf16 v[200:203], v[84:87], v[48:51], v[200:203]
  ds_read_b64_tr_b16 v[84:85], v25 offset:24576
  s_waitcnt lgkmcnt(11)
  v_mfma_f32_16x16x32_bf16 v[208:211], v[88:91], v[48:51], v[208:211]
  ds_read_b64_tr_b16 v[86:87], v25 offset:25600
  s_lshl_b32 s74, s74, 10
  v_mfma_f32_16x16x32_bf16 v[212:215], v[88:91], v[52:55], v[212:215]
  ds_read_b64_tr_b16 v[88:89], v26 offset:24576
  v_mfma_f32_16x16x32_bf16 v[220:223], v[92:95], v[52:55], v[220:223]
  ds_read_b64_tr_b16 v[90:91], v26 offset:25600
  v_mfma_f32_16x16x32_bf16 v[216:219], v[92:95], v[48:51], v[216:219]
  ds_read_b64_tr_b16 v[92:93], v27 offset:24576
  s_cmp_lt_u32 s56, 4
  s_cselect_b32 s74, s74, 0x40000
  v_mfma_f32_16x16x32_bf16 v[224:227], v[96:99], v[48:51], v[224:227]
  ds_read_b64_tr_b16 v[94:95], v27 offset:25600
  v_mfma_f32_16x16x32_bf16 v[228:231], v[96:99], v[52:55], v[228:231]
  ds_read_b64_tr_b16 v[96:97], v16 offset:28672
  v_mfma_f32_16x16x32_bf16 v[236:239], v[100:103], v[52:55], v[236:239]
  ds_read_b64_tr_b16 v[98:99], v16 offset:29184
  v_mfma_f32_16x16x32_bf16 v[232:235], v[100:103], v[48:51], v[232:235]
  ds_read_b64_tr_b16 v[100:101], v17 offset:28672
  buffer_load_dword v28, v29, s[88:91], s74 offen sc1
  v_mfma_f32_16x16x32_bf16 v[240:243], v[104:107], v[48:51], v[240:243]
  ds_read_b64_tr_b16 v[102:103], v17 offset:29184
  v_mfma_f32_16x16x32_bf16 v[244:247], v[104:107], v[52:55], v[244:247]
  ds_read_b64_tr_b16 v[104:105], v18 offset:28672
  v_mfma_f32_16x16x32_bf16 v[252:255], v[108:111], v[52:55], v[252:255]
  ds_read_b64_tr_b16 v[106:107], v18 offset:29184
  v_mfma_f32_16x16x32_bf16 v[248:251], v[108:111], v[48:51], v[248:251]
  ds_read_b64_tr_b16 v[108:109], v19 offset:28672
  ds_read_b64_tr_b16 v[110:111], v19 offset:29184
  s_waitcnt vmcnt(1) lgkmcnt(12)
  v_mfma_f32_16x16x32_bf16 v[160:163], v[64:67], v[56:59], v[160:163]
  s_sub_u32 s64, 16, s58
  s_lshl_b32 s64, s64, 1
  v_mfma_f32_16x16x32_bf16 v[164:167], v[64:67], v[60:63], v[164:167]
  s_lshl_b32 s60, s57, 20
  s_add_u32 s60, s60, 0x200000
  v_mfma_f32_16x16x32_bf16 v[172:175], v[68:71], v[60:63], v[172:175]
  s_add_u32 s48, s30, s60
  v_mfma_f32_16x16x32_bf16 v[168:171], v[68:71], v[56:59], v[168:171]
  s_addc_u32 s49, s31, 0
  s_lshl_b32 s50, s64, 15
  v_mfma_f32_16x16x32_bf16 v[176:179], v[72:75], v[56:59], v[176:179]
  s_mov_b32 s51, 0x20000
  v_mfma_f32_16x16x32_bf16 v[180:183], v[72:75], v[60:63], v[180:183]
  s_add_u32 s52, s30, 0x2900000
  s_addc_u32 s53, s31, 0
  v_mfma_f32_16x16x32_bf16 v[188:191], v[76:79], v[60:63], v[188:191]
  s_mov_b32 s54, 0x1000000
  v_mfma_f32_16x16x32_bf16 v[184:187], v[76:79], v[56:59], v[184:187]
  s_mov_b32 s55, 0x20000
  s_lshr_b32 s72, s76, 5
  v_mfma_f32_16x16x32_bf16 v[192:195], v[80:83], v[56:59], v[192:195]
  s_mov_b32 s70, 0
  v_mfma_f32_16x16x32_bf16 v[196:199], v[80:83], v[60:63], v[196:199]
  s_lshl_b32 s60, s59, 13
  v_add_u32 v30, s60, v14
  v_mfma_f32_16x16x32_bf16 v[204:207], v[84:87], v[60:63], v[204:207]
  s_lshl_b32 s67, s59, 13
  v_mfma_f32_16x16x32_bf16 v[200:203], v[84:87], v[56:59], v[200:203]
  s_add_u32 s67, s67, 0x8000
  s_mov_b32 s68, 0x10000
  s_waitcnt lgkmcnt(0)
  v_mfma_f32_16x16x32_bf16 v[208:211], v[88:91], v[56:59], v[208:211]
  s_mov_b32 s69, 0
  v_mfma_f32_16x16x32_bf16 v[212:215], v[88:91], v[60:63], v[212:215]
  v_mov_b32 v7, 0xff800000
  v_mfma_f32_16x16x32_bf16 v[220:223], v[92:95], v[60:63], v[220:223]
  v_and_b32 v5, 15, v1
  v_mfma_f32_16x16x32_bf16 v[216:219], v[92:95], v[56:59], v[216:219]
  v_lshrrev_b32 v6, 4, v1
  v_mfma_f32_16x16x32_bf16 v[224:227], v[96:99], v[56:59], v[224:227]
  v_lshlrev_b32 v6, 2, v6
  v_mfma_f32_16x16x32_bf16 v[228:231], v[96:99], v[60:63], v[228:231]
  v_cmp_gt_u32 s[80:81], v6, v5
  v_mfma_f32_16x16x32_bf16 v[236:239], v[100:103], v[60:63], v[236:239]
  v_add_u32 v6, 1, v6
  v_mfma_f32_16x16x32_bf16 v[232:235], v[100:103], v[56:59], v[232:235]
  v_cmp_gt_u32 s[82:83], v6, v5
  v_mfma_f32_16x16x32_bf16 v[240:243], v[104:107], v[56:59], v[240:243]
  v_add_u32 v6, 1, v6
  v_mfma_f32_16x16x32_bf16 v[244:247], v[104:107], v[60:63], v[244:247]
  v_cmp_gt_u32 s[84:85], v6, v5
  v_mfma_f32_16x16x32_bf16 v[252:255], v[108:111], v[60:63], v[252:255]
  v_add_u32 v6, 1, v6
  v_mfma_f32_16x16x32_bf16 v[248:251], v[108:111], v[56:59], v[248:251]
  v_cmp_gt_u32 s[86:87], v6, v5
  s_cmp_ge_u32 s56, 4
  s_cbranch_scc1 LF_nokvE
  s_waitcnt vmcnt(0)
  v_cmp_gt_u32 vcc, 1, v28
  s_nop 0
  s_cbranch_vccz L_poll2_ok
  s_mov_b32 s3, 0x10000
L_poll2:
  s_sleep 2
  buffer_load_dword v28, v29, s[88:91], s74 offen sc1
  s_waitcnt vmcnt(0)
  v_cmp_gt_u32 vcc, 1, v28
  s_sub_u32 s3, s3, 1
  s_cbranch_scc1 L_poll2_ok
  s_cbranch_vccnz L_poll2
L_poll2_ok:
  s_mov_b32 m0, s67
  s_nop 0
  buffer_load_dwordx4 v30, s[48:51], s69 offen offset:0 sc1 lds
  buffer_load_dwordx4 v30, s[48:51], s69 offen offset:1024 sc1 lds
  buffer_load_dwordx4 v30, s[48:51], s69 offen offset:2048 sc1 lds
  buffer_load_dwordx4 v30, s[48:51], s69 offen offset:3072 sc1 lds
  s_add_u32 s69, s69, 4096
  s_add_u32 m0, s67, 4096
  s_nop 0
  buffer_load_dwordx4 v30, s[48:51], s69 offen offset:0 sc1 lds
  buffer_load_dwordx4 v30, s[48:51], s69 offen offset:1024 sc1 lds
  buffer_load_dwordx4 v30, s[48:51], s69 offen offset:2048 sc1 lds
  buffer_load_dwordx4 v30, s[48:51], s69 offen offset:3072 sc1 lds
  s_add_u32 s69, s69, 28672
  s_xor_b32 s67, s67, s68
  s_xor_b32 s68, s68, 0x18000
  s_mov_b32 m0, s67
  s_nop 0
  buffer_load_dwordx4 v30, s[48:51], s69 offen offset:0 sc1 lds
  buffer_load_dwordx4 v30, s[48:51], s69 offen offset:1024 sc1 lds
  buffer_load_dwordx4 v30, s[48:51], s69 offen offset:2048 sc1 lds
  buffer_load_dwordx4 v30, s[48:51], s69 offen offset:3072 sc1 lds
  s_add_u32 s69, s69, 4096
  s_add_u32 m0, s67, 4096
  s_nop 0
  buffer_load_dwordx4 v30, s[48:51], s69 offen offset:0 sc1 lds
  buffer_load_dwordx4 v30, s[48:51], s69 offen offset:1024 sc1 lds
  buffer_load_dwordx4 v30, s[48:51], s69 offen offset:2048 sc1 lds
  buffer_load_dwordx4 v30, s[48:51], s69 offen offset:3072 sc1 lds
  s_add_u32 s69, s69, 28672
  s_xor_b32 s67, s67, s68
  s_xor_b32 s68, s68, 0x18000
LF_nokvE:
  s_branch LF2_done
LF2_late:
  ds_read_b64_tr_b16 v[64:65], v4 offset:0
  ds_read_b64_tr_b16 v[66:67], v4 offset:1024
  ds_read_b64_tr_b16 v[68:69], v5 offset:0
  ds_read_b64_tr_b16 v[70:71], v5 offset:1024
  ds_read_b64_tr_b16 v[72:73], v6 offset:0
  ds_read_b64_tr_b16 v[74:75], v6 offset:1024
  ds_read_b64_tr_b16 v[76:77], v7 offset:0
  ds_read_b64_tr_b16 v[78:79], v7 offset:1024
  ds_read_b64_tr_b16 v[80:81], v8 offset:0
  ds_read_b64_tr_b16 v[82:83], v8 offset:1024
  ds_read_b64_tr_b16 v[84:85], v9 offset:0
  ds_read_b64_tr_b16 v[86:87], v9 offset:1024
  ds_read_b64_tr_b16 v[88:89], v10 offset:0
  ds_read_b64_tr_b16 v[90:91], v10 offset:1024
  ds_read_b64_tr_b16 v[92:93], v11 offset:0
  ds_read_b64_tr_b16 v[94:95], v11 offset:1024
  ds_read_b64_tr_b16 v[96:97], v16 offset:0
  ds_read_b64_tr_b16 v[98:99], v16 offset:512
  ds_read_b64_tr_b16 v[100:101], v17 offset:0
  ds_read_b64_tr_b16 v[102:103], v17 offset:512
  ds_read_b64_tr_b16 v[104:105], v18 offset:0
  ds_read_b64_tr_b16 v[106:107], v18 offset:512
  ds_read_b64_tr_b16 v[108:109], v19 offset:0
  ds_read_b64_tr_b16 v[110:111], v19 offset:512
  s_waitcnt lgkmcnt(12)
  v_mfma_f32_16x16x32_bf16 v[160:163], v[64:67], v[32:35], 0
  v_mfma_f32_16x16x32_bf16 v[164:167], v[64:67], v[36:39], 0
  ds_read_b64_tr_b16 v[64:65], v4 offset:8192
  buffer_load_dwordx4 v[56:59], v12, s[44:47], 0 offen offset:512 sc1
  v_mfma_f32_16x16x32_bf16 v[172:175], v[68:71], v[36:39], 0
  ds_read_b64_tr_b16 v[66:67], v4 offset:9216
  v_mfma_f32_16x16x32_bf16 v[168:171], v[68:71], v[32:35], 0
  ds_read_b64_tr_b16 v[68:69], v5 offset:8192
  v_mfma_f32_16x16x32_bf16 v[176:179], v[72:75], v[32:35], 0
  ds_read_b64_tr_b16 v[70:71], v5 offset:9216
  v_mfma_f32_16x16x32_bf16 v[180:183], v[72:75], v[36:39], 0
  ds_read_b64_tr_b16 v[72:73], v6 offset:8192
  buffer_load_dwordx4 v[60:63], v12, s[44:47], s69 offen offset:512 sc1
  v_mfma_f32_16x16x32_bf16 v[188:191], v[76:79], v[36:39], 0
  ds_read_b64_tr_b16 v[74:75], v6 offset:9216
  v_mfma_f32_16x16x32_bf16 v[184:187], v[76:79], v[32:35], 0
  ds_read_b64_tr_b16 v[76:77], v7 offset:8192
  v_mfma_f32_16x16x32_bf16 v[192:195], v[80:83], v[32:35], 0
  ds_read_b64_tr_b16 v[78:79], v7 offset:9216
  v_mfma_f32_16x16x32_bf16 v[196:199], v[80:83], v[36:39], 0
  ds_read_b64_tr_b16 v[80:81], v8 offset:8192
  v_add_u32 v12, 1024, v12
  v_mfma_f32_16x16x32_bf16 v[204:207], v[84:87], v[36:39], 0
  ds_read_b64_tr_b16 v[82:83], v8 offset:9216
  v_mfma_f32_16x16x32_bf16 v[200:203], v[84:87], v[32:35], 0
  ds_read_b64_tr_b16 v[84:85], v9 offset:8192
  s_waitcnt lgkmcnt(11)
  v_mfma_f32_16x16x32_bf16 v[208:211], v[88:91], v[32:35], 0
  ds_read_b64_tr_b16 v[86:87], v9 offset:9216
  v_mfma_f32_16x16x32_bf16 v[212:215], v[88:91], v[36:39], 0
  ds_read_b64_tr_b16 v[88:89], v10 offset:8192
  v_mfma_f32_16x16x32_bf16 v[220:223], v[92:95], v[36:39], 0
  ds_read_b64_tr_b16 v[90:91], v10 offset:9216
  buffer_store_dwordx4 v[112:115], v14, s[44:47], s80 offen offset:1024 sc1
  v_mfma_f32_16x16x32_bf16 v[216:219], v[92:95], v[32:35], 0
  ds_read_b64_tr_b16 v[92:93], v11 offset:8192
  v_mfma_f32_16x16x32_bf16 v[224:227], v[96:99], v[32:35], v[224:227]
  ds_read_b64_tr_b16 v[94:95], v11 offset:9216
  v_mfma_f32_16x16x32_bf16 v[228:231], v[96:99], v[36:39], v[228:231]
  ds_read_b64_tr_b16 v[96:97], v16 offset:4096
  v_mfma_f32_16x16x32_bf16 v[236:239], v[100:103], v[36:39], v[236:239]
  ds_read_b64_tr_b16 v[98:99], v16 offset:4608
  buffer_store_dwordx4 v[116:119], v14, s[44:47], s81 offen offset:1024 sc1
  v_mfma_f32_16x16x32_bf16 v[232:235], v[100:103], v[32:35], v[232:235]
  ds_read_b64_tr_b16 v[100:101], v17 offset:4096
  v_mfma_f32_16x16x32_bf16 v[240:243], v[104:107], v[32:35], v[240:243]
  ds_read_b64_tr_b16 v[102:103], v17 offset:4608
  v_mfma_f32_16x16x32_bf16 v[244:247], v[104:107], v[36:39], v[244:247]
  ds_read_b64_tr_b16 v[104:105], v18 offset:4096
  v_mfma_f32_16x16x32_bf16 v[252:255], v[108:111], v[36:39], v[252:255]
  ds_read_b64_tr_b16 v[106:107], v18 offset:4608
  v_mfma_f32_16x16x32_bf16 v[248:251], v[108:111], v[32:35], v[248:251]
  ds_read_b64_tr_b16 v[108:109], v19 offset:4096
  ds_read_b64_tr_b16 v[110:111], v19 offset:4608
  s_barrier
  s_waitcnt lgkmcnt(12)
  v_mfma_f32_16x16x32_bf16 v[160:163], v[64:67], v[40:43], v[160:163]
  v_mfma_f32_16x16x32_bf16 v[164:167], v[64:67], v[44:47], v[164:167]
  ds_read_b64_tr_b16 v[64:65], v4 offset:16384
  s_add_u32 m0, s67, 65536
  v_mfma_f32_16x16x32_bf16 v[172:175], v[68:71], v[44:47], v[172:175]
  ds_read_b64_tr_b16 v[66:67], v4 offset:17408
  buffer_load_dwordx4 v2, s[32:35], s64 offen lds
  v_mfma_f32_16x16x32_bf16 v[168:171], v[68:71], v[40:43], v[168:171]
  ds_read_b64_tr_b16 v[68:69], v5 offset:16384
  s_add_u32 m0, s67, 66560
  v_mfma_f32_16x16x32_bf16 v[176:179], v[72:75], v[40:43], v[176:179]
  ds_read_b64_tr_b16 v[70:71], v5 offset:17408
  buffer_load_dwordx4 v2, s[32:35], s65 offen lds
  v_mfma_f32_16x16x32_bf16 v[180:183], v[72:75], v[44:47], v[180:183]
  ds_read_b64_tr_b16 v[72:73], v6 offset:16384
  s_add_u32 m0, s68, 16384
  v_mfma_f32_16x16x32_bf16 v[188:191], v[76:79], v[44:47], v[188:191]
  ds_read_b64_tr_b16 v[74:75], v6 offset:17408
  v_mfma_f32_16x16x32_bf16 v[184:187], v[76:79], v[40:43], v[184:187]
  ds_read_b64_tr_b16 v[76:77], v7 offset:16384
  buffer_load_dwordx4 v3, s[36:39], s66 offen lds
  v_mfma_f32_16x16x32_bf16 v[192:195], v[80:83], v[40:43], v[192:195]
  ds_read_b64_tr_b16 v[78:79], v7 offset:17408
  v_add_u32 v2, 0x80000, v2
  v_mfma_f32_16x16x32_bf16 v[196:199], v[80:83], v[44:47], v[196:199]
  ds_read_b64_tr_b16 v[80:81], v8 offset:16384
  v_add_u32 v3, 229376, v3
  v_mfma_f32_16x16x32_bf16 v[204:207], v[84:87], v[44:47], v[204:207]
  ds_read_b64_tr_b16 v[82:83], v8 offset:17408
  s_add_u32 m0, s67, 81920
  v_mfma_f32_16x16x32_bf16 v[200:203], v[84:87], v[40:43], v[200:203]
  ds_read_b64_tr_b16 v[84:85], v9 offset:16384
  s_waitcnt lgkmcnt(11)
  v_mfma_f32_16x16x32_bf16 v[208:211], v[88:91], v[40:43], v[208:211]
  ds_read_b64_tr_b16 v[86:87], v9 offset:17408
  buffer_load_dwordx4 v2, s[32:35], s64 offen lds
  v_mfma_f32_16x16x32_bf16 v[212:215], v[88:91], v[44:47], v[212:215]
  ds_read_b64_tr_b16 v[88:89], v10 offset:16384
  s_add_u32 m0, s67, 82944
  v_mfma_f32_16x16x32_bf16 v[220:223], v[92:95], v[44:47], v[220:223]
  ds_read_b64_tr_b16 v[90:91], v10 offset:17408
  buffer_load_dwordx4 v2, s[32:35], s65 offen lds
  v_mfma_f32_16x16x32_bf16 v[216:219], v[92:95], v[40:43], v[216:219]
  ds_read_b64_tr_b16 v[92:93], v11 offset:16384
  s_add_u32 m0, s68, 24576
  v_mfma_f32_16x16x32_bf16 v[224:227], v[96:99], v[40:43], v[224:227]
  ds_read_b64_tr_b16 v[94:95], v11 offset:17408
  buffer_load_dwordx4 v3, s[36:39], s66 offen lds
  v_mfma_f32_16x16x32_bf16 v[228:231], v[96:99], v[44:47], v[228:231]
  ds_read_b64_tr_b16 v[96:97], v16 offset:8192
  v_mfma_f32_16x16x32_bf16 v[236:239], v[100:103], v[44:47], v[236:239]
  ds_read_b64_tr_b16 v[98:99], v16 offset:8704
  v_add_u32 v2, 0x80000, v2
  v_mfma_f32_16x16x32_bf16 v[232:235], v[100:103], v[40:43], v[232:235]
  ds_read_b64_tr_b16 v[100:101], v17 offset:8192
  v_add_u32 v3, 229376, v3
  v_mfma_f32_16x16x32_bf16 v[240:243], v[104:107], v[40:43], v[240:243]
  ds_read_b64_tr_b16 v[102:103], v17 offset:8704
  buffer_load_dwordx4 v[32:35], v12, s[44:47], 0 offen offset:0 sc1
  v_mfma_f32_16x16x32_bf16 v[244:247], v[104:107], v[44:47], v[244:247]
  ds_read_b64_tr_b16 v[104:105], v18 offset:8192
  buffer_load_dwordx4 v[36:39], v12, s[44:47], s69 offen offset:0 sc1
  v_mfma_f32_16x16x32_bf16 v[252:255], v[108:111], v[44:47], v[252:255]
  ds_read_b64_tr_b16 v[106:107], v18 offset:8704
  v_mfma_f32_16x16x32_bf16 v[248:251], v[108:111], v[40:43], v[248:251]
  ds_read_b64_tr_b16 v[108:109], v19 offset:8192
  ds_read_b64_tr_b16 v[110:111], v19 offset:8704
  s_waitcnt lgkmcnt(12)
  v_mfma_f32_16x16x32_bf16 v[160:163], v[64:67], v[48:51], v[160:163]
  v_mfma_f32_16x16x32_bf16 v[164:167], v[64:67], v[52:55], v[164:167]
  ds_read_b64_tr_b16 v[64:65], v4 offset:24576
  buffer_load_dwordx4 v[40:43], v12, s[44:47], 0 offen offset:512 sc1
  v_mfma_f32_16x16x32_bf16 v[172:175], v[68:71], v[52:55], v[172:175]
  ds_read_b64_tr_b16 v[66:67], v4 offset:25600
  v_mfma_f32_16x16x32_bf16 v[168:171], v[68:71], v[48:51], v[168:171]
  ds_read_b64_tr_b16 v[68:69], v5 offset:24576
  v_mfma_f32_16x16x32_bf16 v[176:179], v[72:75], v[48:51], v[176:179]
  ds_read_b64_tr_b16 v[70:71], v5 offset:25600
  v_mfma_f32_16x16x32_bf16 v[180:183], v[72:75], v[52:55], v[180:183]
  ds_read_b64_tr_b16 v[72:73], v6 offset:24576
  v_mfma_f32_16x16x32_bf16 v[188:191], v[76:79], v[52:55], v[188:191]
  ds_read_b64_tr_b16 v[74:75], v6 offset:25600
  buffer_load_dwordx4 v[44:47], v12, s[44:47], s69 offen offset:512 sc1
  v_mfma_f32_16x16x32_bf16 v[184:187], v[76:79], v[48:51], v[184:187]
  ds_read_b64_tr_b16 v[76:77], v7 offset:24576
  v_mfma_f32_16x16x32_bf16 v[192:195], v[80:83], v[48:51], v[192:195]
  ds_read_b64_tr_b16 v[78:79], v7 offset:25600
  v_mfma_f32_16x16x32_bf16 v[196:199], v[80:83], v[52:55], v[196:199]
  ds_read_b64_tr_b16 v[80:81], v8 offset:24576
  v_mfma_f32_16x16x32_bf16 v[204:207], v[84:87], v[52:55], v[204:207]
  ds_read_b64_tr_b16 v[82:83], v8 offset:25600
  v_mfma_f32_16x16x32_bf16 v[200:203], v[84:87], v[48:51], v[200:203]
  ds_read_b64_tr_b16 v[84:85], v9 offset:24576
  s_waitcnt lgkmcnt(11)
  v_mfma_f32_16x16x32_bf16 v[208:211], v[88:91], v[48:51], v[208:211]
  ds_read_b64_tr_b16 v[86:87], v9 offset:25600
  v_add_u32 v12, 1024, v12
  v_mfma_f32_16x16x32_bf16 v[212:215], v[88:91], v[52:55], v[212:215]
  ds_read_b64_tr_b16 v[88:89], v10 offset:24576
  v_mfma_f32_16x16x32_bf16 v[220:223], v[92:95], v[52:55], v[220:223]
  ds_read_b64_tr_b16 v[90:91], v10 offset:25600
  v_mfma_f32_16x16x32_bf16 v[216:219], v[92:95], v[48:51], v[216:219]
  ds_read_b64_tr_b16 v[92:93], v11 offset:24576
  v_mfma_f32_16x16x32_bf16 v[224:227], v[96:99], v[48:51], v[224:227]
  ds_read_b64_tr_b16 v[94:95], v11 offset:25600
  v_mfma_f32_16x16x32_bf16 v[228:231], v[96:99], v[52:55], v[228:231]
  ds_read_b64_tr_b16 v[96:97], v16 offset:12288
  buffer_store_dwordx4 v[120:123], v14, s[44:47], s82 offen offset:1024 sc1
  v_mfma_f32_16x16x32_bf16 v[236:239], v[100:103], v[52:55], v[236:239]
  ds_read_b64_tr_b16 v[98:99], v16 offset:12800
  v_mfma_f32_16x16x32_bf16 v[232:235], v[100:103], v[48:51], v[232:235]
  ds_read_b64_tr_b16 v[100:101], v17 offset:12288
  v_mfma_f32_16x16x32_bf16 v[240:243], v[104:107], v[48:51], v[240:243]
  ds_read_b64_tr_b16 v[102:103], v17 offset:12800
  v_mfma_f32_16x16x32_bf16 v[244:247], v[104:107], v[52:55], v[244:247]
  ds_read_b64_tr_b16 v[104:105], v18 offset:12288
  v_mfma_f32_16x16x32_bf16 v[252:255], v[108:111], v[52:55], v[252:255]
  ds_read_b64_tr_b16 v[106:107], v18 offset:12800
  v_mfma_f32_16x16x32_bf16 v[248:251], v[108:111], v[48:51], v[248:251]
  ds_read_b64_tr_b16 v[108:109], v19 offset:12288
  ds_read_b64_tr_b16 v[110:111], v19 offset:12800
  s_waitcnt vmcnt(8)
  s_barrier
  s_waitcnt lgkmcnt(12)
  v_mfma_f32_16x16x32_bf16 v[160:163], v[64:67], v[56:59], v[160:163]
  v_mfma_f32_16x16x32_bf16 v[164:167], v[64:67], v[60:63], v[164:167]
  ds_read_b64_tr_b16 v[64:65], v20 offset:0
  s_add_u32 m0, s67, 0
  v_mfma_f32_16x16x32_bf16 v[172:175], v[68:71], v[60:63], v[172:175]
  ds_read_b64_tr_b16 v[66:67], v20 offset:1024
  v_mfma_f32_16x16x32_bf16 v[168:171], v[68:71], v[56:59], v[168:171]
  ds_read_b64_tr_b16 v[68:69], v21 offset:0
  buffer_load_dwordx4 v2, s[32:35], s64 offen lds
  v_mfma_f32_16x16x32_bf16 v[176:179], v[72:75], v[56:59], v[176:179]
  ds_read_b64_tr_b16 v[70:71], v21 offset:1024
  v_mfma_f32_16x16x32_bf16 v[180:183], v[72:75], v[60:63], v[180:183]
  ds_read_b64_tr_b16 v[72:73], v22 offset:0
  s_add_u32 m0, s67, 1024
  v_mfma_f32_16x16x32_bf16 v[188:191], v[76:79], v[60:63], v[188:191]
  ds_read_b64_tr_b16 v[74:75], v22 offset:1024
  v_mfma_f32_16x16x32_bf16 v[184:187], v[76:79], v[56:59], v[184:187]
  ds_read_b64_tr_b16 v[76:77], v23 offset:0
  buffer_load_dwordx4 v2, s[32:35], s65 offen lds
  v_mfma_f32_16x16x32_bf16 v[192:195], v[80:83], v[56:59], v[192:195]
  ds_read_b64_tr_b16 v[78:79], v23 offset:1024
  v_mfma_f32_16x16x32_bf16 v[196:199], v[80:83], v[60:63], v[196:199]
  ds_read_b64_tr_b16 v[80:81], v24 offset:0
  s_add_u32 m0, s68, 0
  v_mfma_f32_16x16x32_bf16 v[204:207], v[84:87], v[60:63], v[204:207]
  ds_read_b64_tr_b16 v[82:83], v24 offset:1024
  v_mfma_f32_16x16x32_bf16 v[200:203], v[84:87], v[56:59], v[200:203]
  ds_read_b64_tr_b16 v[84:85], v25 offset:0
  s_waitcnt lgkmcnt(11)
  v_mfma_f32_16x16x32_bf16 v[208:211], v[88:91], v[56:59], v[208:211]
  ds_read_b64_tr_b16 v[86:87], v25 offset:1024
  buffer_load_dwordx4 v3, s[36:39], s66 offen lds
  v_mfma_f32_16x16x32_bf16 v[212:215], v[88:91], v[60:63], v[212:215]
  ds_read_b64_tr_b16 v[88:89], v26 offset:0
  v_mfma_f32_16x16x32_bf16 v[220:223], v[92:95], v[60:63], v[220:223]
  ds_read_b64_tr_b16 v[90:91], v26 offset:1024
  v_add_u32 v2, 0x80000, v2
  v_mfma_f32_16x16x32_bf16 v[216:219], v[92:95], v[56:59], v[216:219]
  ds_read_b64_tr_b16 v[92:93], v27 offset:0
  v_mfma_f32_16x16x32_bf16 v[224:227], v[96:99], v[56:59], v[224:227]
  ds_read_b64_tr_b16 v[94:95], v27 offset:1024
  v_add_u32 v3, 229376, v3
  v_mfma_f32_16x16x32_bf16 v[228:231], v[96:99], v[60:63], v[228:231]
  ds_read_b64_tr_b16 v[96:97], v16 offset:16384
  v_mfma_f32_16x16x32_bf16 v[236:239], v[100:103], v[60:63], v[236:239]
  ds_read_b64_tr_b16 v[98:99], v16 offset:16896
  buffer_load_dwordx4 v[48:51], v12, s[44:47], 0 offen offset:0 sc1
  v_mfma_f32_16x16x32_bf16 v[232:235], v[100:103], v[56:59], v[232:235]
  ds_read_b64_tr_b16 v[100:101], v17 offset:16384
  v_mfma_f32_16x16x32_bf16 v[240:243], v[104:107], v[56:59], v[240:243]
  ds_read_b64_tr_b16 v[102:103], v17 offset:16896
  buffer_load_dwordx4 v[52:55], v12, s[44:47], s69 offen offset:0 sc1
  v_mfma_f32_16x16x32_bf16 v[244:247], v[104:107], v[60:63], v[244:247]
  ds_read_b64_tr_b16 v[104:105], v18 offset:16384
  v_mfma_f32_16x16x32_bf16 v[252:255], v[108:111], v[60:63], v[252:255]
  ds_read_b64_tr_b16 v[106:107], v18 offset:16896
  v_mfma_f32_16x16x32_bf16 v[248:251], v[108:111], v[56:59], v[248:251]
  ds_read_b64_tr_b16 v[108:109], v19 offset:16384
  ds_read_b64_tr_b16 v[110:111], v19 offset:16896
  s_waitcnt vmcnt(8) lgkmcnt(12)
  v_mfma_f32_16x16x32_bf16 v[160:163], v[64:67], v[32:35], v[160:163]
  v_mfma_f32_16x16x32_bf16 v[164:167], v[64:67], v[36:39], v[164:167]
  ds_read_b64_tr_b16 v[64:65], v20 offset:8192
  buffer_load_dwordx4 v[56:59], v12, s[44:47], 0 offen offset:512 sc1
  v_mfma_f32_16x16x32_bf16 v[172:175], v[68:71], v[36:39], v[172:175]
  ds_read_b64_tr_b16 v[66:67], v20 offset:9216
  v_mfma_f32_16x16x32_bf16 v[168:171], v[68:71], v[32:35], v[168:171]
  ds_read_b64_tr_b16 v[68:69], v21 offset:8192
  v_mfma_f32_16x16x32_bf16 v[176:179], v[72:75], v[32:35], v[176:179]
  ds_read_b64_tr_b16 v[70:71], v21 offset:9216
  v_mfma_f32_16x16x32_bf16 v[180:183], v[72:75], v[36:39], v[180:183]
  ds_read_b64_tr_b16 v[72:73], v22 offset:8192
  buffer_load_dwordx4 v[60:63], v12, s[44:47], s69 offen offset:512 sc1
  v_mfma_f32_16x16x32_bf16 v[188:191], v[76:79], v[36:39], v[188:191]
  ds_read_b64_tr_b16 v[74:75], v22 offset:9216
  v_mfma_f32_16x16x32_bf16 v[184:187], v[76:79], v[32:35], v[184:187]
  ds_read_b64_tr_b16 v[76:77], v23 offset:8192
  v_mfma_f32_16x16x32_bf16 v[192:195], v[80:83], v[32:35], v[192:195]
  ds_read_b64_tr_b16 v[78:79], v23 offset:9216
  v_mfma_f32_16x16x32_bf16 v[196:199], v[80:83], v[36:39], v[196:199]
  ds_read_b64_tr_b16 v[80:81], v24 offset:8192
  v_add_u32 v12, 1024, v12
  v_mfma_f32_16x16x32_bf16 v[204:207], v[84:87], v[36:39], v[204:207]
  ds_read_b64_tr_b16 v[82:83], v24 offset:9216
  v_mfma_f32_16x16x32_bf16 v[200:203], v[84:87], v[32:35], v[200:203]
  ds_read_b64_tr_b16 v[84:85], v25 offset:8192
  s_waitcnt lgkmcnt(11)
  v_mfma_f32_16x16x32_bf16 v[208:211], v[88:91], v[32:35], v[208:211]
  ds_read_b64_tr_b16 v[86:87], v25 offset:9216
  v_mfma_f32_16x16x32_bf16 v[212:215], v[88:91], v[36:39], v[212:215]
  ds_read_b64_tr_b16 v[88:89], v26 offset:8192
  v_mfma_f32_16x16x32_bf16 v[220:223], v[92:95], v[36:39], v[220:223]
  ds_read_b64_tr_b16 v[90:91], v26 offset:9216
  buffer_store_dwordx4 v[124:127], v14, s[44:47], s83 offen offset:1024 sc1
  v_mfma_f32_16x16x32_bf16 v[216:219], v[92:95], v[32:35], v[216:219]
  ds_read_b64_tr_b16 v[92:93], v27 offset:8192
  v_mfma_f32_16x16x32_bf16 v[224:227], v[96:99], v[32:35], v[224:227]
  ds_read_b64_tr_b16 v[94:95], v27 offset:9216
  v_mfma_f32_16x16x32_bf16 v[228:231], v[96:99], v[36:39], v[228:231]
  ds_read_b64_tr_b16 v[96:97], v16 offset:20480
  v_mfma_f32_16x16x32_bf16 v[236:239], v[100:103], v[36:39], v[236:239]
  ds_read_b64_tr_b16 v[98:99], v16 offset:20992
  buffer_store_dwordx4 v[128:131], v14, s[44:47], s80 offen offset:2048 sc1
  v_mfma_f32_16x16x32_bf16 v[232:235], v[100:103], v[32:35], v[232:235]
  ds_read_b64_tr_b16 v[100:101], v17 offset:20480
  v_mfma_f32_16x16x32_bf16 v[240:243], v[104:107], v[32:35], v[240:243]
  ds_read_b64_tr_b16 v[102:103], v17 offset:20992
  v_mfma_f32_16x16x32_bf16 v[244:247], v[104:107], v[36:39], v[244:247]
  ds_read_b64_tr_b16 v[104:105], v18 offset:20480
  v_mfma_f32_16x16x32_bf16 v[252:255], v[108:111], v[36:39], v[252:255]
  ds_read_b64_tr_b16 v[106:107], v18 offset:20992
  v_mfma_f32_16x16x32_bf16 v[248:251], v[108:111], v[32:35], v[248:251]
  ds_read_b64_tr_b16 v[108:109], v19 offset:20480
  ds_read_b64_tr_b16 v[110:111], v19 offset:20992
  s_barrier
  s_waitcnt vmcnt(10) lgkmcnt(12)
  v_mfma_f32_16x16x32_bf16 v[160:163], v[64:67], v[40:43], v[160:163]
  v_mfma_f32_16x16x32_bf16 v[164:167], v[64:67], v[44:47], v[164:167]
  ds_read_b64_tr_b16 v[64:65], v20 offset:16384
  s_add_u32 m0, s67, 16384
  v_mfma_f32_16x16x32_bf16 v[172:175], v[68:71], v[44:47], v[172:175]
  ds_read_b64_tr_b16 v[66:67], v20 offset:17408
  v_mfma_f32_16x16x32_bf16 v[168:171], v[68:71], v[40:43], v[168:171]
  ds_read_b64_tr_b16 v[68:69], v21 offset:16384
  buffer_load_dwordx4 v2, s[32:35], s64 offen lds
  v_mfma_f32_16x16x32_bf16 v[176:179], v[72:75], v[40:43], v[176:179]
  ds_read_b64_tr_b16 v[70:71], v21 offset:17408
  v_mfma_f32_16x16x32_bf16 v[180:183], v[72:75], v[44:47], v[180:183]
  ds_read_b64_tr_b16 v[72:73], v22 offset:16384
  s_add_u32 m0, s67, 17408
  v_mfma_f32_16x16x32_bf16 v[188:191], v[76:79], v[44:47], v[188:191]
  ds_read_b64_tr_b16 v[74:75], v22 offset:17408
  v_mfma_f32_16x16x32_bf16 v[184:187], v[76:79], v[40:43], v[184:187]
  ds_read_b64_tr_b16 v[76:77], v23 offset:16384
  buffer_load_dwordx4 v2, s[32:35], s65 offen lds
  v_mfma_f32_16x16x32_bf16 v[192:195], v[80:83], v[40:43], v[192:195]
  ds_read_b64_tr_b16 v[78:79], v23 offset:17408
  v_mfma_f32_16x16x32_bf16 v[196:199], v[80:83], v[44:47], v[196:199]
  ds_read_b64_tr_b16 v[80:81], v24 offset:16384
  s_add_u32 m0, s68, 8192
  v_mfma_f32_16x16x32_bf16 v[204:207], v[84:87], v[44:47], v[204:207]
  ds_read_b64_tr_b16 v[82:83], v24 offset:17408
  v_mfma_f32_16x16x32_bf16 v[200:203], v[84:87], v[40:43], v[200:203]
  ds_read_b64_tr_b16 v[84:85], v25 offset:16384
  s_waitcnt lgkmcnt(11)
  v_mfma_f32_16x16x32_bf16 v[208:211], v[88:91], v[40:43], v[208:211]
  ds_read_b64_tr_b16 v[86:87], v25 offset:17408
  buffer_load_dwordx4 v3, s[36:39], s66 offen lds
  v_mfma_f32_16x16x32_bf16 v[212:215], v[88:91], v[44:47], v[212:215]
  ds_read_b64_tr_b16 v[88:89], v26 offset:16384
  v_mfma_f32_16x16x32_bf16 v[220:223], v[92:95], v[44:47], v[220:223]
  ds_read_b64_tr_b16 v[90:91], v26 offset:17408
  v_add_u32 v2, 0x80000, v2
  v_mfma_f32_16x16x32_bf16 v[216:219], v[92:95], v[40:43], v[216:219]
  ds_read_b64_tr_b16 v[92:93], v27 offset:16384
  v_mfma_f32_16x16x32_bf16 v[224:227], v[96:99], v[40:43], v[224:227]
  ds_read_b64_tr_b16 v[94:95], v27 offset:17408
  v_add_u32 v3, 229376, v3
  v_mfma_f32_16x16x32_bf16 v[228:231], v[96:99], v[44:47], v[228:231]
  ds_read_b64_tr_b16 v[96:97], v16 offset:24576
  v_mfma_f32_16x16x32_bf16 v[236:239], v[100:103], v[44:47], v[236:239]
  ds_read_b64_tr_b16 v[98:99], v16 offset:25088
  buffer_load_dwordx4 v[32:35], v12, s[44:47], 0 offen offset:0 sc1
  v_mfma_f32_16x16x32_bf16 v[232:235], v[100:103], v[40:43], v[232:235]
  ds_read_b64_tr_b16 v[100:101], v17 offset:24576
  v_mfma_f32_16x16x32_bf16 v[240:243], v[104:107], v[40:43], v[240:243]
  ds_read_b64_tr_b16 v[102:103], v17 offset:25088
  buffer_load_dwordx4 v[36:39], v12, s[44:47], s69 offen offset:0 sc1
  v_mfma_f32_16x16x32_bf16 v[244:247], v[104:107], v[44:47], v[244:247]
  ds_read_b64_tr_b16 v[104:105], v18 offset:24576
  v_mfma_f32_16x16x32_bf16 v[252:255], v[108:111], v[44:47], v[252:255]
  ds_read_b64_tr_b16 v[106:107], v18 offset:25088
  v_mfma_f32_16x16x32_bf16 v[248:251], v[108:111], v[40:43], v[248:251]
  ds_read_b64_tr_b16 v[108:109], v19 offset:24576
  ds_read_b64_tr_b16 v[110:111], v19 offset:25088
  s_waitcnt vmcnt(9) lgkmcnt(12)
  v_mfma_f32_16x16x32_bf16 v[160:163], v[64:67], v[48:51], v[160:163]
  v_mfma_f32_16x16x32_bf16 v[164:167], v[64:67], v[52:55], v[164:167]
  ds_read_b64_tr_b16 v[64:65], v20 offset:24576
  buffer_load_dwordx4 v[40:43], v12, s[44:47], 0 offen offset:512 sc1
  v_mfma_f32_16x16x32_bf16 v[172:175], v[68:71], v[52:55], v[172:175]
  ds_read_b64_tr_b16 v[66:67], v20 offset:25600
  v_mfma_f32_16x16x32_bf16 v[168:171], v[68:71], v[48:51], v[168:171]
  ds_read_b64_tr_b16 v[68:69], v21 offset:24576
  v_mfma_f32_16x16x32_bf16 v[176:179], v[72:75], v[48:51], v[176:179]
  ds_read_b64_tr_b16 v[70:71], v21 offset:25600
  v_mfma_f32_16x16x32_bf16 v[180:183], v[72:75], v[52:55], v[180:183]
  ds_read_b64_tr_b16 v[72:73], v22 offset:24576
  v_mfma_f32_16x16x32_bf16 v[188:191], v[76:79], v[52:55], v[188:191]
  ds_read_b64_tr_b16 v[74:75], v22 offset:25600
  buffer_load_dwordx4 v[44:47], v12, s[44:47], s69 offen offset:512 sc1
  v_mfma_f32_16x16x32_bf16 v[184:187], v[76:79], v[48:51], v[184:187]
  ds_read_b64_tr_b16 v[76:77], v23 offset:24576
  v_mfma_f32_16x16x32_bf16 v[192:195], v[80:83], v[48:51], v[192:195]
  ds_read_b64_tr_b16 v[78:79], v23 offset:25600
  v_mfma_f32_16x16x32_bf16 v[196:199], v[80:83], v[52:55], v[196:199]
  ds_read_b64_tr_b16 v[80:81], v24 offset:24576
  v_mfma_f32_16x16x32_bf16 v[204:207], v[84:87], v[52:55], v[204:207]
  ds_read_b64_tr_b16 v[82:83], v24 offset:25600
  v_mfma_f32_16x16x32_bf16 v[200:203], v[84:87], v[48:51], v[200:203]
  ds_read_b64_tr_b16 v[84:85], v25 offset:24576
  s_waitcnt lgkmcnt(11)
  v_mfma_f32_16x16x32_bf16 v[208:211], v[88:91], v[48:51], v[208:211]
  ds_read_b64_tr_b16 v[86:87], v25 offset:25600
  v_add_u32 v12, 1024, v12
  v_mfma_f32_16x16x32_bf16 v[212:215], v[88:91], v[52:55], v[212:215]
  ds_read_b64_tr_b16 v[88:89], v26 offset:24576
  v_mfma_f32_16x16x32_bf16 v[220:223], v[92:95], v[52:55], v[220:223]
  ds_read_b64_tr_b16 v[90:91], v26 offset:25600
  v_mfma_f32_16x16x32_bf16 v[216:219], v[92:95], v[48:51], v[216:219]
  ds_read_b64_tr_b16 v[92:93], v27 offset:24576
  v_mfma_f32_16x16x32_bf16 v[224:227], v[96:99], v[48:51], v[224:227]
  ds_read_b64_tr_b16 v[94:95], v27 offset:25600
  v_mfma_f32_16x16x32_bf16 v[228:231], v[96:99], v[52:55], v[228:231]
  ds_read_b64_tr_b16 v[96:97], v16 offset:28672
  buffer_store_dwordx4 v[132:135], v14, s[44:47], s81 offen offset:2048 sc1
  v_mfma_f32_16x16x32_bf16 v[236:239], v[100:103], v[52:55], v[236:239]
  ds_read_b64_tr_b16 v[98:99], v16 offset:29184
  v_mfma_f32_16x16x32_bf16 v[232:235], v[100:103], v[48:51], v[232:235]
  ds_read_b64_tr_b16 v[100:101], v17 offset:28672
  v_mfma_f32_16x16x32_bf16 v[240:243], v[104:107], v[48:51], v[240:243]
  ds_read_b64_tr_b16 v[102:103], v17 offset:29184
  v_mfma_f32_16x16x32_bf16 v[244:247], v[104:107], v[52:55], v[244:247]
  ds_read_b64_tr_b16 v[104:105], v18 offset:28672
  v_mfma_f32_16x16x32_bf16 v[252:255], v[108:111], v[52:55], v[252:255]
  ds_read_b64_tr_b16 v[106:107], v18 offset:29184
  v_mfma_f32_16x16x32_bf16 v[248:251], v[108:111], v[48:51], v[248:251]
  ds_read_b64_tr_b16 v[108:109], v19 offset:28672
  ds_read_b64_tr_b16 v[110:111], v19 offset:29184
  s_barrier
  s_waitcnt vmcnt(10) lgkmcnt(12)
  v_mfma_f32_16x16x32_bf16 v[160:163], v[64:67], v[56:59], v[160:163]
  v_mfma_f32_16x16x32_bf16 v[164:167], v[64:67], v[60:63], v[164:167]
  ds_read_b64_tr_b16 v[64:65], v4 offset:0
  s_add_u32 m0, s67, 65536
  v_mfma_f32_16x16x32_bf16 v[172:175], v[68:71], v[60:63], v[172:175]
  ds_read_b64_tr_b16 v[66:67], v4 offset:1024
  v_mfma_f32_16x16x32_bf16 v[168:171], v[68:71], v[56:59], v[168:171]
  ds_read_b64_tr_b16 v[68:69], v5 offset:0
  buffer_load_dwordx4 v2, s[32:35], s64 offen lds
  v_mfma_f32_16x16x32_bf16 v[176:179], v[72:75], v[56:59], v[176:179]
  ds_read_b64_tr_b16 v[70:71], v5 offset:1024
  v_mfma_f32_16x16x32_bf16 v[180:183], v[72:75], v[60:63], v[180:183]
  ds_read_b64_tr_b16 v[72:73], v6 offset:0
  s_add_u32 m0, s67, 66560
  v_mfma_f32_16x16x32_bf16 v[188:191], v[76:79], v[60:63], v[188:191]
  ds_read_b64_tr_b16 v[74:75], v6 offset:1024
  v_mfma_f32_16x16x32_bf16 v[184:187], v[76:79], v[56:59], v[184:187]
  ds_read_b64_tr_b16 v[76:77], v7 offset:0
  buffer_load_dwordx4 v2, s[32:35], s65 offen lds
  v_mfma_f32_16x16x32_bf16 v[192:195], v[80:83], v[56:59], v[192:195]
  ds_read_b64_tr_b16 v[78:79], v7 offset:1024
  v_mfma_f32_16x16x32_bf16 v[196:199], v[80:83], v[60:63], v[196:199]
  ds_read_b64_tr_b16 v[80:81], v8 offset:0
  s_add_u32 m0, s68, 16384
  v_mfma_f32_16x16x32_bf16 v[204:207], v[84:87], v[60:63], v[204:207]
  ds_read_b64_tr_b16 v[82:83], v8 offset:1024
  v_mfma_f32_16x16x32_bf16 v[200:203], v[84:87], v[56:59], v[200:203]
  ds_read_b64_tr_b16 v[84:85], v9 offset:0
  s_waitcnt lgkmcnt(11)
  v_mfma_f32_16x16x32_bf16 v[208:211], v[88:91], v[56:59], v[208:211]
  ds_read_b64_tr_b16 v[86:87], v9 offset:1024
  buffer_load_dwordx4 v3, s[36:39], s66 offen lds
  v_mfma_f32_16x16x32_bf16 v[212:215], v[88:91], v[60:63], v[212:215]
  ds_read_b64_tr_b16 v[88:89], v10 offset:0
  v_mfma_f32_16x16x32_bf16 v[220:223], v[92:95], v[60:63], v[220:223]
  ds_read_b64_tr_b16 v[90:91], v10 offset:1024
  v_add_u32 v2, 0x80000, v2
  v_mfma_f32_16x16x32_bf16 v[216:219], v[92:95], v[56:59], v[216:219]
  ds_read_b64_tr_b16 v[92:93], v11 offset:0
  v_mfma_f32_16x16x32_bf16 v[224:227], v[96:99], v[56:59], v[224:227]
  ds_read_b64_tr_b16 v[94:95], v11 offset:1024
  v_add_u32 v3, 229376, v3
  v_mfma_f32_16x16x32_bf16 v[228:231], v[96:99], v[60:63], v[228:231]
  ds_read_b64_tr_b16 v[96:97], v16 offset:0
  v_mfma_f32_16x16x32_bf16 v[236:239], v[100:103], v[60:63], v[236:239]
  ds_read_b64_tr_b16 v[98:99], v16 offset:512
  buffer_load_dwordx4 v[48:51], v12, s[44:47], 0 offen offset:0 sc1
  v_mfma_f32_16x16x32_bf16 v[232:235], v[100:103], v[56:59], v[232:235]
  ds_read_b64_tr_b16 v[100:101], v17 offset:0
  v_mfma_f32_16x16x32_bf16 v[240:243], v[104:107], v[56:59], v[240:243]
  ds_read_b64_tr_b16 v[102:103], v17 offset:512
  buffer_load_dwordx4 v[52:55], v12, s[44:47], s69 offen offset:0 sc1
  v_mfma_f32_16x16x32_bf16 v[244:247], v[104:107], v[60:63], v[244:247]
  ds_read_b64_tr_b16 v[104:105], v18 offset:0
  v_mfma_f32_16x16x32_bf16 v[252:255], v[108:111], v[60:63], v[252:255]
  ds_read_b64_tr_b16 v[106:107], v18 offset:512
  v_mfma_f32_16x16x32_bf16 v[248:251], v[108:111], v[56:59], v[248:251]
  ds_read_b64_tr_b16 v[108:109], v19 offset:0
  ds_read_b64_tr_b16 v[110:111], v19 offset:512
  s_waitcnt vmcnt(8) lgkmcnt(12)
  v_mfma_f32_16x16x32_bf16 v[160:163], v[64:67], v[32:35], v[160:163]
  v_mfma_f32_16x16x32_bf16 v[164:167], v[64:67], v[36:39], v[164:167]
  ds_read_b64_tr_b16 v[64:65], v4 offset:8192
  buffer_load_dwordx4 v[56:59], v12, s[44:47], 0 offen offset:512 sc1
  v_mfma_f32_16x16x32_bf16 v[172:175], v[68:71], v[36:39], v[172:175]
  ds_read_b64_tr_b16 v[66:67], v4 offset:9216
  v_mfma_f32_16x16x32_bf16 v[168:171], v[68:71], v[32:35], v[168:171]
  ds_read_b64_tr_b16 v[68:69], v5 offset:8192
  v_mfma_f32_16x16x32_bf16 v[176:179], v[72:75], v[32:35], v[176:179]
  ds_read_b64_tr_b16 v[70:71], v5 offset:9216
  v_mfma_f32_16x16x32_bf16 v[180:183], v[72:75], v[36:39], v[180:183]
  ds_read_b64_tr_b16 v[72:73], v6 offset:8192
  buffer_load_dwordx4 v[60:63], v12, s[44:47], s69 offen offset:512 sc1
  v_mfma_f32_16x16x32_bf16 v[188:191], v[76:79], v[36:39], v[188:191]
  ds_read_b64_tr_b16 v[74:75], v6 offset:9216
  v_mfma_f32_16x16x32_bf16 v[184:187], v[76:79], v[32:35], v[184:187]
  ds_read_b64_tr_b16 v[76:77], v7 offset:8192
  v_mfma_f32_16x16x32_bf16 v[192:195], v[80:83], v[32:35], v[192:195]
  ds_read_b64_tr_b16 v[78:79], v7 offset:9216
  v_mfma_f32_16x16x32_bf16 v[196:199], v[80:83], v[36:39], v[196:199]
  ds_read_b64_tr_b16 v[80:81], v8 offset:8192
  v_add_u32 v12, 1024, v12
  v_mfma_f32_16x16x32_bf16 v[204:207], v[84:87], v[36:39], v[204:207]
  ds_read_b64_tr_b16 v[82:83], v8 offset:9216
  v_mfma_f32_16x16x32_bf16 v[200:203], v[84:87], v[32:35], v[200:203]
  ds_read_b64_tr_b16 v[84:85], v9 offset:8192
  s_waitcnt lgkmcnt(11)
  v_mfma_f32_16x16x32_bf16 v[208:211], v[88:91], v[32:35], v[208:211]
  ds_read_b64_tr_b16 v[86:87], v9 offset:9216
  v_mfma_f32_16x16x32_bf16 v[212:215], v[88:91], v[36:39], v[212:215]
  ds_read_b64_tr_b16 v[88:89], v10 offset:8192
  v_mfma_f32_16x16x32_bf16 v[220:223], v[92:95], v[36:39], v[220:223]
  ds_read_b64_tr_b16 v[90:91], v10 offset:9216
  buffer_store_dwordx4 v[136:139], v14, s[44:47], s82 offen offset:2048 sc1
  v_mfma_f32_16x16x32_bf16 v[216:219], v[92:95], v[32:35], v[216:219]
  ds_read_b64_tr_b16 v[92:93], v11 offset:8192
  v_mfma_f32_16x16x32_bf16 v[224:227], v[96:99], v[32:35], v[224:227]
  ds_read_b64_tr_b16 v[94:95], v11 offset:9216
  v_mfma_f32_16x16x32_bf16 v[228:231], v[96:99], v[36:39], v[228:231]
  ds_read_b64_tr_b16 v[96:97], v16 offset:4096
  v_mfma_f32_16x16x32_bf16 v[236:239], v[100:103], v[36:39], v[236:239]
  ds_read_b64_tr_b16 v[98:99], v16 offset:4608
  buffer_store_dwordx4 v[140:143], v14, s[44:47], s83 offen offset:2048 sc1
  v_mfma_f32_16x16x32_bf16 v[232:235], v[100:103], v[32:35], v[232:235]
  ds_read_b64_tr_b16 v[100:101], v17 offset:4096
  v_mfma_f32_16x16x32_bf16 v[240:243], v[104:107], v[32:35], v[240:243]
  ds_read_b64_tr_b16 v[102:103], v17 offset:4608
  v_mfma_f32_16x16x32_bf16 v[244:247], v[104:107], v[36:39], v[244:247]
  ds_read_b64_tr_b16 v[104:105], v18 offset:4096
  v_mfma_f32_16x16x32_bf16 v[252:255], v[108:111], v[36:39], v[252:255]
  ds_read_b64_tr_b16 v[106:107], v18 offset:4608
  v_mfma_f32_16x16x32_bf16 v[248:251], v[108:111], v[32:35], v[248:251]
  ds_read_b64_tr_b16 v[108:109], v19 offset:4096
  ds_read_b64_tr_b16 v[110:111], v19 offset:4608
  s_barrier
  s_waitcnt vmcnt(10) lgkmcnt(12)
  v_mfma_f32_16x16x32_bf16 v[160:163], v[64:67], v[40:43], v[160:163]
  v_mfma_f32_16x16x32_bf16 v[164:167], v[64:67], v[44:47], v[164:167]
  ds_read_b64_tr_b16 v[64:65], v4 offset:16384
  s_add_u32 m0, s67, 81920
  v_mfma_f32_16x16x32_bf16 v[172:175], v[68:71], v[44:47], v[172:175]
  ds_read_b64_tr_b16 v[66:67], v4 offset:17408
  v_mfma_f32_16x16x32_bf16 v[168:171], v[68:71], v[40:43], v[168:171]
  ds_read_b64_tr_b16 v[68:69], v5 offset:16384
  buffer_load_dwordx4 v2, s[32:35], s64 offen lds
  v_mfma_f32_16x16x32_bf16 v[176:179], v[72:75], v[40:43], v[176:179]
  ds_read_b64_tr_b16 v[70:71], v5 offset:17408
  v_mfma_f32_16x16x32_bf16 v[180:183], v[72:75], v[44:47], v[180:183]
  ds_read_b64_tr_b16 v[72:73], v6 offset:16384
  s_add_u32 m0, s67, 82944
  v_mfma_f32_16x16x32_bf16 v[188:191], v[76:79], v[44:47], v[188:191]
  ds_read_b64_tr_b16 v[74:75], v6 offset:17408
  v_mfma_f32_16x16x32_bf16 v[184:187], v[76:79], v[40:43], v[184:187]
  ds_read_b64_tr_b16 v[76:77], v7 offset:16384
  buffer_load_dwordx4 v2, s[32:35], s65 offen lds
  v_mfma_f32_16x16x32_bf16 v[192:195], v[80:83], v[40:43], v[192:195]
  ds_read_b64_tr_b16 v[78:79], v7 offset:17408
  v_mfma_f32_16x16x32_bf16 v[196:199], v[80:83], v[44:47], v[196:199]
  ds_read_b64_tr_b16 v[80:81], v8 offset:16384
  s_add_u32 m0, s68, 24576
  v_mfma_f32_16x16x32_bf16 v[204:207], v[84:87], v[44:47], v[204:207]
  ds_read_b64_tr_b16 v[82:83], v8 offset:17408
  v_mfma_f32_16x16x32_bf16 v[200:203], v[84:87], v[40:43], v[200:203]
  ds_read_b64_tr_b16 v[84:85], v9 offset:16384
  s_waitcnt lgkmcnt(11)
  v_mfma_f32_16x16x32_bf16 v[208:211], v[88:91], v[40:43], v[208:211]
  ds_read_b64_tr_b16 v[86:87], v9 offset:17408
  buffer_load_dwordx4 v3, s[36:39], s66 offen lds
  v_mfma_f32_16x16x32_bf16 v[212:215], v[88:91], v[44:47], v[212:215]
  ds_read_b64_tr_b16 v[88:89], v10 offset:16384
  v_mfma_f32_16x16x32_bf16 v[220:223], v[92:95], v[44:47], v[220:223]
  ds_read_b64_tr_b16 v[90:91], v10 offset:17408
  v_add_u32 v2, 0x80000, v2
  v_mfma_f32_16x16x32_bf16 v[216:219], v[92:95], v[40:43], v[216:219]
  ds_read_b64_tr_b16 v[92:93], v11 offset:16384
  v_mfma_f32_16x16x32_bf16 v[224:227], v[96:99], v[40:43], v[224:227]
  ds_read_b64_tr_b16 v[94:95], v11 offset:17408
  v_add_u32 v3, 229376, v3
  v_mfma_f32_16x16x32_bf16 v[228:231], v[96:99], v[44:47], v[228:231]
  ds_read_b64_tr_b16 v[96:97], v16 offset:8192
  v_mfma_f32_16x16x32_bf16 v[236:239], v[100:103], v[44:47], v[236:239]
  ds_read_b64_tr_b16 v[98:99], v16 offset:8704
  buffer_load_dwordx4 v[32:35], v12, s[44:47], 0 offen offset:0 sc1
  v_mfma_f32_16x16x32_bf16 v[232:235], v[100:103], v[40:43], v[232:235]
  ds_read_b64_tr_b16 v[100:101], v17 offset:8192
  v_mfma_f32_16x16x32_bf16 v[240:243], v[104:107], v[40:43], v[240:243]
  ds_read_b64_tr_b16 v[102:103], v17 offset:8704
  buffer_load_dwordx4 v[36:39], v12, s[44:47], s69 offen offset:0 sc1
  v_mfma_f32_16x16x32_bf16 v[244:247], v[104:107], v[44:47], v[244:247]
  ds_read_b64_tr_b16 v[104:105], v18 offset:8192
  v_mfma_f32_16x16x32_bf16 v[252:255], v[108:111], v[44:47], v[252:255]
  ds_read_b64_tr_b16 v[106:107], v18 offset:8704
  v_mfma_f32_16x16x32_bf16 v[248:251], v[108:111], v[40:43], v[248:251]
  ds_read_b64_tr_b16 v[108:109], v19 offset:8192
  ds_read_b64_tr_b16 v[110:111], v19 offset:8704
  s_waitcnt vmcnt(9) lgkmcnt(12)
  v_mfma_f32_16x16x32_bf16 v[160:163], v[64:67], v[48:51], v[160:163]
  v_mfma_f32_16x16x32_bf16 v[164:167], v[64:67], v[52:55], v[164:167]
  ds_read_b64_tr_b16 v[64:65], v4 offset:24576
  buffer_load_dwordx4 v[40:43], v12, s[44:47], 0 offen offset:512 sc1
  v_mfma_f32_16x16x32_bf16 v[172:175], v[68:71], v[52:55], v[172:175]
  ds_read_b64_tr_b16 v[66:67], v4 offset:25600
  v_mfma_f32_16x16x32_bf16 v[168:171], v[68:71], v[48:51], v[168:171]
  ds_read_b64_tr_b16 v[68:69], v5 offset:24576
  v_mfma_f32_16x16x32_bf16 v[176:179], v[72:75], v[48:51], v[176:179]
  ds_read_b64_tr_b16 v[70:71], v5 offset:25600
  v_mfma_f32_16x16x32_bf16 v[180:183], v[72:75], v[52:55], v[180:183]
  ds_read_b64_tr_b16 v[72:73], v6 offset:24576
  v_mfma_f32_16x16x32_bf16 v[188:191], v[76:79], v[52:55], v[188:191]
  ds_read_b64_tr_b16 v[74:75], v6 offset:25600
  buffer_load_dwordx4 v[44:47], v12, s[44:47], s69 offen offset:512 sc1
  v_mfma_f32_16x16x32_bf16 v[184:187], v[76:79], v[48:51], v[184:187]
  ds_read_b64_tr_b16 v[76:77], v7 offset:24576
  v_mfma_f32_16x16x32_bf16 v[192:195], v[80:83], v[48:51], v[192:195]
  ds_read_b64_tr_b16 v[78:79], v7 offset:25600
  v_mfma_f32_16x16x32_bf16 v[196:199], v[80:83], v[52:55], v[196:199]
  ds_read_b64_tr_b16 v[80:81], v8 offset:24576
  v_mfma_f32_16x16x32_bf16 v[204:207], v[84:87], v[52:55], v[204:207]
  ds_read_b64_tr_b16 v[82:83], v8 offset:25600
  v_mfma_f32_16x16x32_bf16 v[200:203], v[84:87], v[48:51], v[200:203]
  ds_read_b64_tr_b16 v[84:85], v9 offset:24576
  s_waitcnt lgkmcnt(11)
  v_mfma_f32_16x16x32_bf16 v[208:211], v[88:91], v[48:51], v[208:211]
  ds_read_b64_tr_b16 v[86:87], v9 offset:25600
  v_add_u32 v12, 1024, v12
  v_mfma_f32_16x16x32_bf16 v[212:215], v[88:91], v[52:55], v[212:215]
  ds_read_b64_tr_b16 v[88:89], v10 offset:24576
  v_mfma_f32_16x16x32_bf16 v[220:223], v[92:95], v[52:55], v[220:223]
  ds_read_b64_tr_b16 v[90:91], v10 offset:25600
  v_mfma_f32_16x16x32_bf16 v[216:219], v[92:95], v[48:51], v[216:219]
  ds_read_b64_tr_b16 v[92:93], v11 offset:24576
  v_mfma_f32_16x16x32_bf16 v[224:227], v[96:99], v[48:51], v[224:227]
  ds_read_b64_tr_b16 v[94:95], v11 offset:25600
  v_mfma_f32_16x16x32_bf16 v[228:231], v[96:99], v[52:55], v[228:231]
  ds_read_b64_tr_b16 v[96:97], v16 offset:12288
  buffer_store_dwordx4 v[144:147], v14, s[44:47], s80 offen offset:3072 sc1
  v_mfma_f32_16x16x32_bf16 v[236:239], v[100:103], v[52:55], v[236:239]
  ds_read_b64_tr_b16 v[98:99], v16 offset:12800
  v_mfma_f32_16x16x32_bf16 v[232:235], v[100:103], v[48:51], v[232:235]
  ds_read_b64_tr_b16 v[100:101], v17 offset:12288
  v_mfma_f32_16x16x32_bf16 v[240:243], v[104:107], v[48:51], v[240:243]
  ds_read_b64_tr_b16 v[102:103], v17 offset:12800
  v_mfma_f32_16x16x32_bf16 v[244:247], v[104:107], v[52:55], v[244:247]
  ds_read_b64_tr_b16 v[104:105], v18 offset:12288
  v_mfma_f32_16x16x32_bf16 v[252:255], v[108:111], v[52:55], v[252:255]
  ds_read_b64_tr_b16 v[106:107], v18 offset:12800
  v_mfma_f32_16x16x32_bf16 v[248:251], v[108:111], v[48:51], v[248:251]
  ds_read_b64_tr_b16 v[108:109], v19 offset:12288
  ds_read_b64_tr_b16 v[110:111], v19 offset:12800
  s_barrier
  s_waitcnt vmcnt(10) lgkmcnt(12)
  v_mfma_f32_16x16x32_bf16 v[160:163], v[64:67], v[56:59], v[160:163]
  v_mfma_f32_16x16x32_bf16 v[164:167], v[64:67], v[60:63], v[164:167]
  ds_read_b64_tr_b16 v[64:65], v20 offset:0
  buffer_load_dwordx4 v[48:51], v12, s[44:47], 0 offen offset:0 sc1
  v_mfma_f32_16x16x32_bf16 v[172:175], v[68:71], v[60:63], v[172:175]
  ds_read_b64_tr_b16 v[66:67], v20 offset:1024
  v_mfma_f32_16x16x32_bf16 v[168:171], v[68:71], v[56:59], v[168:171]
  ds_read_b64_tr_b16 v[68:69], v21 offset:0
  v_mfma_f32_16x16x32_bf16 v[176:179], v[72:75], v[56:59], v[176:179]
  ds_read_b64_tr_b16 v[70:71], v21 offset:1024
  v_mfma_f32_16x16x32_bf16 v[180:183], v[72:75], v[60:63], v[180:183]
  ds_read_b64_tr_b16 v[72:73], v22 offset:0
  v_mfma_f32_16x16x32_bf16 v[188:191], v[76:79], v[60:63], v[188:191]
  ds_read_b64_tr_b16 v[74:75], v22 offset:1024
  v_mfma_f32_16x16x32_bf16 v[184:187], v[76:79], v[56:59], v[184:187]
  ds_read_b64_tr_b16 v[76:77], v23 offset:0
  v_mfma_f32_16x16x32_bf16 v[192:195], v[80:83], v[56:59], v[192:195]
  ds_read_b64_tr_b16 v[78:79], v23 offset:1024
  v_mfma_f32_16x16x32_bf16 v[196:199], v[80:83], v[60:63], v[196:199]
  ds_read_b64_tr_b16 v[80:81], v24 offset:0
  v_mfma_f32_16x16x32_bf16 v[204:207], v[84:87], v[60:63], v[204:207]
  ds_read_b64_tr_b16 v[82:83], v24 offset:1024
  v_mfma_f32_16x16x32_bf16 v[200:203], v[84:87], v[56:59], v[200:203]
  ds_read_b64_tr_b16 v[84:85], v25 offset:0
  s_waitcnt lgkmcnt(11)
  v_mfma_f32_16x16x32_bf16 v[208:211], v[88:91], v[56:59], v[208:211]
  ds_read_b64_tr_b16 v[86:87], v25 offset:1024
  buffer_load_dwordx4 v[52:55], v12, s[44:47], s69 offen offset:0 sc1
  v_mfma_f32_16x16x32_bf16 v[212:215], v[88:91], v[60:63], v[212:215]
  ds_read_b64_tr_b16 v[88:89], v26 offset:0
  v_mfma_f32_16x16x32_bf16 v[220:223], v[92:95], v[60:63], v[220:223]
  ds_read_b64_tr_b16 v[90:91], v26 offset:1024
  v_mfma_f32_16x16x32_bf16 v[216:219], v[92:95], v[56:59], v[216:219]
  ds_read_b64_tr_b16 v[92:93], v27 offset:0
  v_mfma_f32_16x16x32_bf16 v[224:227], v[96:99], v[56:59], v[224:227]
  ds_read_b64_tr_b16 v[94:95], v27 offset:1024
  v_mfma_f32_16x16x32_bf16 v[228:231], v[96:99], v[60:63], v[228:231]
  ds_read_b64_tr_b16 v[96:97], v16 offset:16384
  v_mfma_f32_16x16x32_bf16 v[236:239], v[100:103], v[60:63], v[236:239]
  ds_read_b64_tr_b16 v[98:99], v16 offset:16896
  v_mfma_f32_16x16x32_bf16 v[232:235], v[100:103], v[56:59], v[232:235]
  ds_read_b64_tr_b16 v[100:101], v17 offset:16384
  v_mfma_f32_16x16x32_bf16 v[240:243], v[104:107], v[56:59], v[240:243]
  ds_read_b64_tr_b16 v[102:103], v17 offset:16896
  v_mfma_f32_16x16x32_bf16 v[244:247], v[104:107], v[60:63], v[244:247]
  ds_read_b64_tr_b16 v[104:105], v18 offset:16384
  v_mfma_f32_16x16x32_bf16 v[252:255], v[108:111], v[60:63], v[252:255]
  ds_read_b64_tr_b16 v[106:107], v18 offset:16896
  v_mfma_f32_16x16x32_bf16 v[248:251], v[108:111], v[56:59], v[248:251]
  ds_read_b64_tr_b16 v[108:109], v19 offset:16384
  ds_read_b64_tr_b16 v[110:111], v19 offset:16896
  s_waitcnt vmcnt(5) lgkmcnt(12)
  v_mfma_f32_16x16x32_bf16 v[160:163], v[64:67], v[32:35], v[160:163]
  v_mfma_f32_16x16x32_bf16 v[164:167], v[64:67], v[36:39], v[164:167]
  ds_read_b64_tr_b16 v[64:65], v20 offset:8192
  buffer_load_dwordx4 v[56:59], v12, s[44:47], 0 offen offset:512 sc1
  v_mfma_f32_16x16x32_bf16 v[172:175], v[68:71], v[36:39], v[172:175]
  ds_read_b64_tr_b16 v[66:67], v20 offset:9216
  v_mfma_f32_16x16x32_bf16 v[168:171], v[68:71], v[32:35], v[168:171]
  ds_read_b64_tr_b16 v[68:69], v21 offset:8192
  v_mfma_f32_16x16x32_bf16 v[176:179], v[72:75], v[32:35], v[176:179]
  ds_read_b64_tr_b16 v[70:71], v21 offset:9216
  v_mfma_f32_16x16x32_bf16 v[180:183], v[72:75], v[36:39], v[180:183]
  ds_read_b64_tr_b16 v[72:73], v22 offset:8192
  v_mfma_f32_16x16x32_bf16 v[188:191], v[76:79], v[36:39], v[188:191]
  ds_read_b64_tr_b16 v[74:75], v22 offset:9216
  buffer_load_dwordx4 v[60:63], v12, s[44:47], s69 offen offset:512 sc1
  v_mfma_f32_16x16x32_bf16 v[184:187], v[76:79], v[32:35], v[184:187]
  ds_read_b64_tr_b16 v[76:77], v23 offset:8192
  v_mfma_f32_16x16x32_bf16 v[192:195], v[80:83], v[32:35], v[192:195]
  ds_read_b64_tr_b16 v[78:79], v23 offset:9216
  v_mfma_f32_16x16x32_bf16 v[196:199], v[80:83], v[36:39], v[196:199]
  ds_read_b64_tr_b16 v[80:81], v24 offset:8192
  v_mfma_f32_16x16x32_bf16 v[204:207], v[84:87], v[36:39], v[204:207]
  ds_read_b64_tr_b16 v[82:83], v24 offset:9216
  v_mfma_f32_16x16x32_bf16 v[200:203], v[84:87], v[32:35], v[200:203]
  ds_read_b64_tr_b16 v[84:85], v25 offset:8192
  s_waitcnt lgkmcnt(11)
  v_mfma_f32_16x16x32_bf16 v[208:211], v[88:91], v[32:35], v[208:211]
  ds_read_b64_tr_b16 v[86:87], v25 offset:9216
  v_add_u32 v12, 1024, v12
  v_mfma_f32_16x16x32_bf16 v[212:215], v[88:91], v[36:39], v[212:215]
  ds_read_b64_tr_b16 v[88:89], v26 offset:8192
  v_mfma_f32_16x16x32_bf16 v[220:223], v[92:95], v[36:39], v[220:223]
  ds_read_b64_tr_b16 v[90:91], v26 offset:9216
  v_mfma_f32_16x16x32_bf16 v[216:219], v[92:95], v[32:35], v[216:219]
  ds_read_b64_tr_b16 v[92:93], v27 offset:8192
  v_mfma_f32_16x16x32_bf16 v[224:227], v[96:99], v[32:35], v[224:227]
  ds_read_b64_tr_b16 v[94:95], v27 offset:9216
  v_mfma_f32_16x16x32_bf16 v[228:231], v[96:99], v[36:39], v[228:231]
  ds_read_b64_tr_b16 v[96:97], v16 offset:20480
  buffer_store_dwordx4 v[148:151], v14, s[44:47], s81 offen offset:3072 sc1
  v_mfma_f32_16x16x32_bf16 v[236:239], v[100:103], v[36:39], v[236:239]
  ds_read_b64_tr_b16 v[98:99], v16 offset:20992
  v_mfma_f32_16x16x32_bf16 v[232:235], v[100:103], v[32:35], v[232:235]
  ds_read_b64_tr_b16 v[100:101], v17 offset:20480
  v_mfma_f32_16x16x32_bf16 v[240:243], v[104:107], v[32:35], v[240:243]
  ds_read_b64_tr_b16 v[102:103], v17 offset:20992
  v_mfma_f32_16x16x32_bf16 v[244:247], v[104:107], v[36:39], v[244:247]
  ds_read_b64_tr_b16 v[104:105], v18 offset:20480
  v_mfma_f32_16x16x32_bf16 v[252:255], v[108:111], v[36:39], v[252:255]
  ds_read_b64_tr_b16 v[106:107], v18 offset:20992
  v_mfma_f32_16x16x32_bf16 v[248:251], v[108:111], v[32:35], v[248:251]
  ds_read_b64_tr_b16 v[108:109], v19 offset:20480
  ds_read_b64_tr_b16 v[110:111], v19 offset:20992
  s_barrier
  s_waitcnt vmcnt(6) lgkmcnt(12)
  v_mfma_f32_16x16x32_bf16 v[160:163], v[64:67], v[40:43], v[160:163]
  v_mfma_f32_16x16x32_bf16 v[164:167], v[64:67], v[44:47], v[164:167]
  ds_read_b64_tr_b16 v[64:65], v20 offset:16384
  s_and_b32 s60, s2, 7
  s_lshr_b32 s61, s2, 3
  v_mfma_f32_16x16x32_bf16 v[172:175], v[68:71], v[44:47], v[172:175]
  ds_read_b64_tr_b16 v[66:67], v20 offset:17408
  s_and_b32 s6, s60, 3
  v_mfma_f32_16x16x32_bf16 v[168:171], v[68:71], v[40:43], v[168:171]
  ds_read_b64_tr_b16 v[68:69], v21 offset:16384
  s_lshr_b32 s60, s60, 2
  v_mfma_f32_16x16x32_bf16 v[176:179], v[72:75], v[40:43], v[176:179]
  ds_read_b64_tr_b16 v[70:71], v21 offset:17408
  s_lshl_b32 s60, s60, 3
  s_lshr_b32 s7, s61, 2
  v_mfma_f32_16x16x32_bf16 v[180:183], v[72:75], v[44:47], v[180:183]
  ds_read_b64_tr_b16 v[72:73], v22 offset:16384
  s_add_u32 s7, s7, s60
  v_mfma_f32_16x16x32_bf16 v[188:191], v[76:79], v[44:47], v[188:191]
  ds_read_b64_tr_b16 v[74:75], v22 offset:17408
  s_and_b32 s8, s61, 3
  v_mfma_f32_16x16x32_bf16 v[184:187], v[76:79], v[40:43], v[184:187]
  ds_read_b64_tr_b16 v[76:77], v23 offset:16384
  s_lshl_b32 s9, s7, 2
  v_mfma_f32_16x16x32_bf16 v[192:195], v[80:83], v[40:43], v[192:195]
  ds_read_b64_tr_b16 v[78:79], v23 offset:17408
  s_add_u32 s9, s9, s8
  s_sub_u32 s60, 15, s7
  v_mfma_f32_16x16x32_bf16 v[196:199], v[80:83], v[44:47], v[196:199]
  ds_read_b64_tr_b16 v[80:81], v24 offset:16384
  s_min_u32 s20, s60, s7
  v_mfma_f32_16x16x32_bf16 v[204:207], v[84:87], v[44:47], v[204:207]
  ds_read_b64_tr_b16 v[82:83], v24 offset:17408
  s_mov_b32 s32, s22
  v_mfma_f32_16x16x32_bf16 v[200:203], v[84:87], v[40:43], v[200:203]
  ds_read_b64_tr_b16 v[84:85], v25 offset:16384
  s_mov_b32 s33, s23
  s_waitcnt lgkmcnt(11)
  v_mfma_f32_16x16x32_bf16 v[208:211], v[88:91], v[40:43], v[208:211]
  ds_read_b64_tr_b16 v[86:87], v25 offset:17408
  s_mov_b32 s34, 0x1c0000
  s_mov_b32 s35, 0x20000
  v_mfma_f32_16x16x32_bf16 v[212:215], v[88:91], v[44:47], v[212:215]
  ds_read_b64_tr_b16 v[88:89], v26 offset:16384
  s_mov_b32 s36, s14
  v_mfma_f32_16x16x32_bf16 v[220:223], v[92:95], v[44:47], v[220:223]
  ds_read_b64_tr_b16 v[90:91], v26 offset:17408
  s_mov_b32 s37, s15
  v_mfma_f32_16x16x32_bf16 v[216:219], v[92:95], v[40:43], v[216:219]
  ds_read_b64_tr_b16 v[92:93], v27 offset:16384
  s_mov_b32 s38, 0x400000
  s_mov_b32 s39, 0x20000
  v_mfma_f32_16x16x32_bf16 v[224:227], v[96:99], v[40:43], v[224:227]
  ds_read_b64_tr_b16 v[94:95], v27 offset:17408
  s_add_u32 s40, s30, 0x2200000
  s_addc_u32 s41, s31, 0
  v_mfma_f32_16x16x32_bf16 v[228:231], v[96:99], v[44:47], v[228:231]
  ds_read_b64_tr_b16 v[96:97], v16 offset:24576
  s_mov_b32 s42, 0x700000
  v_mfma_f32_16x16x32_bf16 v[236:239], v[100:103], v[44:47], v[236:239]
  ds_read_b64_tr_b16 v[98:99], v16 offset:25088
  s_mov_b32 s43, 0x20000
  v_mfma_f32_16x16x32_bf16 v[232:235], v[100:103], v[40:43], v[232:235]
  ds_read_b64_tr_b16 v[100:101], v17 offset:24576
  s_add_u32 s84, s30, 0x3900000
  s_addc_u32 s85, s31, 0
  s_mov_b32 s86, 0x800000
  v_mfma_f32_16x16x32_bf16 v[240:243], v[104:107], v[40:43], v[240:243]
  ds_read_b64_tr_b16 v[102:103], v17 offset:25088
  s_mov_b32 s87, 0x20000
  v_mfma_f32_16x16x32_bf16 v[244:247], v[104:107], v[44:47], v[244:247]
  ds_read_b64_tr_b16 v[104:105], v18 offset:24576
  s_cmp_lt_u32 s56, 4
  s_cselect_b32 s60, 0, 0x1000000
  v_mfma_f32_16x16x32_bf16 v[252:255], v[108:111], v[44:47], v[252:255]
  ds_read_b64_tr_b16 v[106:107], v18 offset:25088
  s_add_u32 s84, s84, s60
  s_addc_u32 s85, s85, 0
  v_mfma_f32_16x16x32_bf16 v[248:251], v[108:111], v[40:43], v[248:251]
  ds_read_b64_tr_b16 v[108:109], v19 offset:24576
  ds_read_b64_tr_b16 v[110:111], v19 offset:25088
  s_cmp_lg_u32 s58, 7
  s_cbranch_scc1 LF_noarm7
  s_cmp_eq_u32 s59, s6
  s_cbranch_scc1 LF_noarm7
  s_lshl_b32 s60, s9, 2
  s_add_u32 s60, s60, s6
  s_lshl_b32 s60, s60, 2
  s_add_u32 s60, s60, s59
  s_lshl_b32 s60, s60, 13
  s_add_u32 s61, s60, 4096
  v_mov_b32 v112, -1
  v_mov_b32 v113, -1
  v_mov_b32 v114, -1
  v_mov_b32 v115, -1
  buffer_store_dwordx4 v[112:115], v14, s[84:87], s60 offen offset:0 sc1
  buffer_store_dwordx4 v[112:115], v14, s[84:87], s60 offen offset:1024 sc1
  buffer_store_dwordx4 v[112:115], v14, s[84:87], s60 offen offset:2048 sc1
  buffer_store_dwordx4 v[112:115], v14, s[84:87], s60 offen offset:3072 sc1
  buffer_store_dwordx4 v[112:115], v14, s[84:87], s61 offen offset:0 sc1
  buffer_store_dwordx4 v[112:115], v14, s[84:87], s61 offen offset:1024 sc1
  buffer_store_dwordx4 v[112:115], v14, s[84:87], s61 offen offset:2048 sc1
  buffer_store_dwordx4 v[112:115], v14, s[84:87], s61 offen offset:3072 sc1
LF_noarm7:
  s_waitcnt vmcnt(3) lgkmcnt(12)
  v_mfma_f32_16x16x32_bf16 v[160:163], v[64:67], v[48:51], v[160:163]
  v_mfma_f32_16x16x32_bf16 v[164:167], v[64:67], v[52:55], v[164:167]
  ds_read_b64_tr_b16 v[64:65], v20 offset:24576
  v_and_b32 v29, 1, v1
  v_mfma_f32_16x16x32_bf16 v[172:175], v[68:71], v[52:55], v[172:175]
  ds_read_b64_tr_b16 v[66:67], v20 offset:25600
  v_mfma_f32_16x16x32_bf16 v[168:171], v[68:71], v[48:51], v[168:171]
  ds_read_b64_tr_b16 v[68:69], v21 offset:24576
  v_lshlrev_b32 v29, 15, v29
  v_mfma_f32_16x16x32_bf16 v[176:179], v[72:75], v[48:51], v[176:179]
  ds_read_b64_tr_b16 v[70:71], v21 offset:25600
  v_mfma_f32_16x16x32_bf16 v[180:183], v[72:75], v[52:55], v[180:183]
  ds_read_b64_tr_b16 v[72:73], v22 offset:24576
  v_mfma_f32_16x16x32_bf16 v[188:191], v[76:79], v[52:55], v[188:191]
  ds_read_b64_tr_b16 v[74:75], v22 offset:25600
  s_and_b32 s74, s2, 31
  v_mfma_f32_16x16x32_bf16 v[184:187], v[76:79], v[48:51], v[184:187]
  ds_read_b64_tr_b16 v[76:77], v23 offset:24576
  v_mfma_f32_16x16x32_bf16 v[192:195], v[80:83], v[48:51], v[192:195]
  ds_read_b64_tr_b16 v[78:79], v23 offset:25600
  v_mfma_f32_16x16x32_bf16 v[196:199], v[80:83], v[52:55], v[196:199]
  ds_read_b64_tr_b16 v[80:81], v24 offset:24576
  s_lshl_b32 s74, s74, 10
  v_mfma_f32_16x16x32_bf16 v[204:207], v[84:87], v[52:55], v[204:207]
  ds_read_b64_tr_b16 v[82:83], v24 offset:25600
  v_mfma_f32_16x16x32_bf16 v[200:203], v[84:87], v[48:51], v[200:203]
  ds_read_b64_tr_b16 v[84:85], v25 offset:24576
  s_waitcnt lgkmcnt(11)
  v_mfma_f32_16x16x32_bf16 v[208:211], v[88:91], v[48:51], v[208:211]
  ds_read_b64_tr_b16 v[86:87], v25 offset:25600
  s_cmp_lt_u32 s56, 4
  s_cselect_b32 s74, s74, 0x40000
  v_mfma_f32_16x16x32_bf16 v[212:215], v[88:91], v[52:55], v[212:215]
  ds_read_b64_tr_b16 v[88:89], v26 offset:24576
  v_mfma_f32_16x16x32_bf16 v[220:223], v[92:95], v[52:55], v[220:223]
  ds_read_b64_tr_b16 v[90:91], v26 offset:25600
  buffer_load_dword v28, v29, s[88:91], s74 offen sc1
  v_mfma_f32_16x16x32_bf16 v[216:219], v[92:95], v[48:51], v[216:219]
  ds_read_b64_tr_b16 v[92:93], v27 offset:24576
  v_mfma_f32_16x16x32_bf16 v[224:227], v[96:99], v[48:51], v[224:227]
  ds_read_b64_tr_b16 v[94:95], v27 offset:25600
  v_mfma_f32_16x16x32_bf16 v[228:231], v[96:99], v[52:55], v[228:231]
  ds_read_b64_tr_b16 v[96:97], v16 offset:28672
  buffer_store_dwordx4 v[152:155], v14, s[44:47], s82 offen offset:3072 sc1
  v_mfma_f32_16x16x32_bf16 v[236:239], v[100:103], v[52:55], v[236:239]
  ds_read_b64_tr_b16 v[98:99], v16 offset:29184
  v_mfma_f32_16x16x32_bf16 v[232:235], v[100:103], v[48:51], v[232:235]
  ds_read_b64_tr_b16 v[100:101], v17 offset:28672
  v_mfma_f32_16x16x32_bf16 v[240:243], v[104:107], v[48:51], v[240:243]
  ds_read_b64_tr_b16 v[102:103], v17 offset:29184
  buffer_store_dwordx4 v[156:159], v14, s[44:47], s83 offen offset:3072 sc1
  v_mfma_f32_16x16x32_bf16 v[244:247], v[104:107], v[52:55], v[244:247]
  ds_read_b64_tr_b16 v[104:105], v18 offset:28672
  v_mfma_f32_16x16x32_bf16 v[252:255], v[108:111], v[52:55], v[252:255]
  ds_read_b64_tr_b16 v[106:107], v18 offset:29184
  v_mfma_f32_16x16x32_bf16 v[248:251], v[108:111], v[48:51], v[248:251]
  ds_read_b64_tr_b16 v[108:109], v19 offset:28672
  ds_read_b64_tr_b16 v[110:111], v19 offset:29184
  s_waitcnt vmcnt(4) lgkmcnt(12)
  v_mfma_f32_16x16x32_bf16 v[160:163], v[64:67], v[56:59], v[160:163]
  s_sub_u32 s64, 16, s58
  s_lshl_b32 s64, s64, 1
  v_mfma_f32_16x16x32_bf16 v[164:167], v[64:67], v[60:63], v[164:167]
  s_lshl_b32 s60, s57, 20
  s_add_u32 s60, s60, 0x200000
  v_mfma_f32_16x16x32_bf16 v[172:175], v[68:71], v[60:63], v[172:175]
  s_add_u32 s48, s30, s60
  v_mfma_f32_16x16x32_bf16 v[168:171], v[68:71], v[56:59], v[168:171]
  s_addc_u32 s49, s31, 0
  s_lshl_b32 s50, s64, 15
  v_mfma_f32_16x16x32_bf16 v[176:179], v[72:75], v[56:59], v[176:179]
  s_mov_b32 s51, 0x20000
  v_mfma_f32_16x16x32_bf16 v[180:183], v[72:75], v[60:63], v[180:183]
  s_add_u32 s52, s30, 0x2900000
  s_addc_u32 s53, s31, 0
  v_mfma_f32_16x16x32_bf16 v[188:191], v[76:79], v[60:63], v[188:191]
  s_mov_b32 s54, 0x1000000
  v_mfma_f32_16x16x32_bf16 v[184:187], v[76:79], v[56:59], v[184:187]
  s_mov_b32 s55, 0x20000
  s_lshr_b32 s72, s76, 5
  v_mfma_f32_16x16x32_bf16 v[192:195], v[80:83], v[56:59], v[192:195]
  s_mov_b32 s70, 0
  v_mfma_f32_16x16x32_bf16 v[196:199], v[80:83], v[60:63], v[196:199]
  s_lshl_b32 s60, s59, 13
  v_add_u32 v30, s60, v14
  v_mfma_f32_16x16x32_bf16 v[204:207], v[84:87], v[60:63], v[204:207]
  s_lshl_b32 s67, s59, 13
  v_mfma_f32_16x16x32_bf16 v[200:203], v[84:87], v[56:59], v[200:203]
  s_add_u32 s67, s67, 0x8000
  s_mov_b32 s68, 0x10000
  s_waitcnt lgkmcnt(0)
  v_mfma_f32_16x16x32_bf16 v[208:211], v[88:91], v[56:59], v[208:211]
  s_mov_b32 s69, 0
  v_mfma_f32_16x16x32_bf16 v[212:215], v[88:91], v[60:63], v[212:215]
  v_mov_b32 v7, 0xff800000
  v_mfma_f32_16x16x32_bf16 v[220:223], v[92:95], v[60:63], v[220:223]
  v_and_b32 v5, 15, v1
  v_mfma_f32_16x16x32_bf16 v[216:219], v[92:95], v[56:59], v[216:219]
  v_lshrrev_b32 v6, 4, v1
  v_mfma_f32_16x16x32_bf16 v[224:227], v[96:99], v[56:59], v[224:227]
  v_lshlrev_b32 v6, 2, v6
  v_mfma_f32_16x16x32_bf16 v[228:231], v[96:99], v[60:63], v[228:231]
  v_cmp_gt_u32 s[80:81], v6, v5
  v_mfma_f32_16x16x32_bf16 v[236:239], v[100:103], v[60:63], v[236:239]
  v_add_u32 v6, 1, v6
  v_mfma_f32_16x16x32_bf16 v[232:235], v[100:103], v[56:59], v[232:235]
  v_cmp_gt_u32 s[82:83], v6, v5
  v_mfma_f32_16x16x32_bf16 v[240:243], v[104:107], v[56:59], v[240:243]
  v_add_u32 v6, 1, v6
  v_mfma_f32_16x16x32_bf16 v[244:247], v[104:107], v[60:63], v[244:247]
  v_cmp_gt_u32 s[84:85], v6, v5
  v_mfma_f32_16x16x32_bf16 v[252:255], v[108:111], v[60:63], v[252:255]
  v_add_u32 v6, 1, v6
  v_mfma_f32_16x16x32_bf16 v[248:251], v[108:111], v[56:59], v[248:251]
  v_cmp_gt_u32 s[86:87], v6, v5
  s_cmp_ge_u32 s56, 4
  s_cbranch_scc1 LF_nokvL
  s_waitcnt vmcnt(2)
  v_cmp_gt_u32 vcc, 1, v28
  s_nop 0
  s_cbranch_vccz L_poll3_ok
  s_mov_b32 s3, 0x10000
L_poll3:
  s_sleep 2
  buffer_load_dword v28, v29, s[88:91], s74 offen sc1
  s_waitcnt vmcnt(0)
  v_cmp_gt_u32 vcc, 1, v28
  s_sub_u32 s3, s3, 1
  s_cbranch_scc1 L_poll3_ok
  s_cbranch_vccnz L_poll3
L_poll3_ok:
  s_mov_b32 m0, s67
  s_nop 0
  buffer_load_dwordx4 v30, s[48:51], s69 offen offset:0 sc1 lds
  buffer_load_dwordx4 v30, s[48:51], s69 offen offset:1024 sc1 lds
  buffer_load_dwordx4 v30, s[48:51], s69 offen offset:2048 sc1 lds
  buffer_load_dwordx4 v30, s[48:51], s69 offen offset:3072 sc1 lds
  s_add_u32 s69, s69, 4096
  s_add_u32 m0, s67, 4096
  s_nop 0
  buffer_load_dwordx4 v30, s[48:51], s69 offen offset:0 sc1 lds
  buffer_load_dwordx4 v30, s[48:51], s69 offen offset:1024 sc1 lds
  buffer_load_dwordx4 v30, s[48:51], s69 offen offset:2048 sc1 lds
  buffer_load_dwordx4 v30, s[48:51], s69 offen offset:3072 sc1 lds
  s_add_u32 s69, s69, 28672
  s_xor_b32 s67, s67, s68
  s_xor_b32 s68, s68, 0x18000
  s_mov_b32 m0, s67
  s_nop 0
  buffer_load_dwordx4 v30, s[48:51], s69 offen offset:0 sc1 lds
  buffer_load_dwordx4 v30, s[48:51], s69 offen offset:1024 sc1 lds
  buffer_load_dwordx4 v30, s[48:51], s69 offen offset:2048 sc1 lds
  buffer_load_dwordx4 v30, s[48:51], s69 offen offset:3072 sc1 lds
  s_add_u32 s69, s69, 4096
  s_add_u32 m0, s67, 4096
  s_nop 0
  buffer_load_dwordx4 v30, s[48:51], s69 offen offset:0 sc1 lds
  buffer_load_dwordx4 v30, s[48:51], s69 offen offset:1024 sc1 lds
  buffer_load_dwordx4 v30, s[48:51], s69 offen offset:2048 sc1 lds
  buffer_load_dwordx4 v30, s[48:51], s69 offen offset:3072 sc1 lds
  s_add_u32 s69, s69, 28672
  s_xor_b32 s67, s67, s68
  s_xor_b32 s68, s68, 0x18000
LF_nokvL:
LF2_done:
  v_mov_b32 v4, v30
  v_mov_b32 v136, 0
  v_mov_b32 v137, 0
  v_mov_b32 v138, 0
  v_mov_b32 v139, 0
  s_mov_b32 s63, 0x3e0293ee
  s_mov_b32 s62, s63
  v_mul_f32 v160, s63, v160
  v_mul_f32 v161, s63, v161
  v_mul_f32 v162, s63, v162
  v_mul_f32 v163, s63, v163
  v_cvt_pk_bf16_f32 v32, v160, v161
  v_cvt_pk_bf16_f32 v33, v162, v163
  v_mul_f32 v168, s63, v168
  v_mul_f32 v169, s63, v169
  v_mul_f32 v170, s63, v170
  v_mul_f32 v171, s63, v171
  v_cvt_pk_bf16_f32 v34, v168, v169
  v_cvt_pk_bf16_f32 v35, v170, v171
  v_mul_f32 v176, s63, v176
  v_mul_f32 v177, s63, v177
  v_mul_f32 v178, s63, v178
  v_mul_f32 v179, s63, v179
  v_cvt_pk_bf16_f32 v36, v176, v177
  v_cvt_pk_bf16_f32 v37, v178, v179
  v_mul_f32 v184, s63, v184
  v_mul_f32 v185, s63, v185
  v_mul_f32 v186, s63, v186
  v_mul_f32 v187, s63, v187
  v_cvt_pk_bf16_f32 v38, v184, v185
  v_cvt_pk_bf16_f32 v39, v186, v187
  v_mul_f32 v192, s63, v192
  v_mul_f32 v193, s63, v193
  v_mul_f32 v194, s63, v194
  v_mul_f32 v195, s63, v195
  v_cvt_pk_bf16_f32 v40, v192, v193
  v_cvt_pk_bf16_f32 v41, v194, v195
  v_mul_f32 v200, s63, v200
  v_mul_f32 v201, s63, v201
  v_mul_f32 v202, s63, v202
  v_mul_f32 v203, s63, v203
  v_cvt_pk_bf16_f32 v42, v200, v201
  v_cvt_pk_bf16_f32 v43, v202, v203
  v_mul_f32 v208, s63, v208
  v_mul_f32 v209, s63, v209
  v_mul_f32 v210, s63, v210
  v_mul_f32 v211, s63, v211
  v_cvt_pk_bf16_f32 v44, v208, v209
  v_cvt_pk_bf16_f32 v45, v210, v211
  v_mul_f32 v216, s63, v216
  v_mul_f32 v217, s63, v217
  v_mul_f32 v218, s63, v218
  v_mul_f32 v219, s63, v219
  v_cvt_pk_bf16_f32 v46, v216, v217
  v_cvt_pk_bf16_f32 v47, v218, v219
  v_mul_f32 v164, s63, v164
  v_mul_f32 v165, s63, v165
  v_mul_f32 v166, s63, v166
  v_mul_f32 v167, s63, v167
  v_cvt_pk_bf16_f32 v48, v164, v165
  v_cvt_pk_bf16_f32 v49, v166, v167
  v_mul_f32 v172, s63, v172
  v_mul_f32 v173, s63, v173
  v_mul_f32 v174, s63, v174
  v_mul_f32 v175, s63, v175
  v_cvt_pk_bf16_f32 v50, v172, v173
  v_cvt_pk_bf16_f32 v51, v174, v175
  v_mul_f32 v180, s63, v180
  v_mul_f32 v181, s63, v181
  v_mul_f32 v182, s63, v182
  v_mul_f32 v183, s63, v183
  v_cvt_pk_bf16_f32 v52, v180, v181
  v_cvt_pk_bf16_f32 v53, v182, v183
  v_mul_f32 v188, s63, v188
  v_mul_f32 v189, s63, v189
  v_mul_f32 v190, s63, v190
  v_mul_f32 v191, s63, v191
  v_cvt_pk_bf16_f32 v54, v188, v189
  v_cvt_pk_bf16_f32 v55, v190, v191
  v_mul_f32 v196, s63, v196
  v_mul_f32 v197, s63, v197
  v_mul_f32 v198, s63, v198
  v_mul_f32 v199, s63, v199
  v_cvt_pk_bf16_f32 v56, v196, v197
  v_cvt_pk_bf16_f32 v57, v198, v199
  v_mul_f32 v204, s63, v204
  v_mul_f32 v205, s63, v205
  v_mul_f32 v206, s63, v206
  v_mul_f32 v207, s63, v207
  v_cvt_pk_bf16_f32 v58, v204, v205
  v_cvt_pk_bf16_f32 v59, v206, v207
  v_mul_f32 v212, s63, v212
  v_mul_f32 v213, s63, v213
  v_mul_f32 v214, s63, v214
  v_mul_f32 v215, s63, v215
  v_cvt_pk_bf16_f32 v60, v212, v213
  v_cvt_pk_bf16_f32 v61, v214, v215
  v_mul_f32 v220, s63, v220
  v_mul_f32 v221, s63, v221
  v_mul_f32 v222, s63, v222
  v_mul_f32 v223, s63, v223
  v_cvt_pk_bf16_f32 v62, v220, v221
  v_cvt_pk_bf16_f32 v63, v222, v223
  v_and_b32 v16, 3, v1
  v_cmp_eq_u32 vcc, 0, v16
  v_mov_b32 v17, 0x3f803f80
  s_nop 0
  v_cndmask_b32 v176, 0, v17, vcc
  v_mov_b32 v177, v176
  v_mov_b32 v178, v176
  v_mov_b32 v179, v176
  s_lshr_b32 s60, s76, 4
  s_mul_i32 s60, s60, 57344
  s_lshl_b32 s61, s57, 11
  s_add_u32 s60, s60, s61
  s_add_u32 s60, s60, 0x2200000
  s_cmp_lt_u32 s57, 28
  s_cselect_b32 s60, s60, 0x7ff00000
  s_mov_b32 s61, 57344
  s_add_u32 s61, s61, s60
  v_mfma_f32_16x16x32_bf16 v[64:67], v[136:139], v[136:139], 0
  v_max_f32 v224, 0, v224
  v_max_f32 v225, 0, v225
  v_max_f32 v226, 0, v226
  v_max_f32 v227, 0, v227
  v_mul_f32 v224, v224, v224
  v_mfma_f32_16x16x32_bf16 v[68:71], v[136:139], v[136:139], 0
  v_mul_f32 v225, v225, v225
  v_mul_f32 v226, v226, v226
  v_mul_f32 v227, v227, v227
  v_cvt_pk_bf16_f32 v152, v224, v225
  v_cvt_pk_bf16_f32 v153, v226, v227
  v_mfma_f32_16x16x32_bf16 v[72:75], v[136:139], v[136:139], 0
  v_max_f32 v232, 0, v232
  v_max_f32 v233, 0, v233
  v_max_f32 v234, 0, v234
  v_max_f32 v235, 0, v235
  v_mfma_f32_16x16x32_bf16 v[76:79], v[136:139], v[136:139], 0
  v_mul_f32 v232, v232, v232
  v_mul_f32 v233, v233, v233
  v_mul_f32 v234, v234, v234
  v_mul_f32 v235, v235, v235
  v_cvt_pk_bf16_f32 v154, v232, v233
  v_mfma_f32_16x16x32_bf16 v[80:83], v[136:139], v[136:139], 0
  v_cvt_pk_bf16_f32 v155, v234, v235
  buffer_store_dwordx4 v[152:155], v14, s[44:47], s60 offen offset:0 sc1
  v_max_f32 v240, 0, v240
  v_max_f32 v241, 0, v241
  v_max_f32 v242, 0, v242
  v_mfma_f32_16x16x32_bf16 v[84:87], v[136:139], v[136:139], 0
  v_max_f32 v243, 0, v243
  v_mul_f32 v240, v240, v240
  v_mul_f32 v241, v241, v241
  v_mul_f32 v242, v242, v242
  v_mfma_f32_16x16x32_bf16 v[88:91], v[136:139], v[136:139], 0
  v_mul_f32 v243, v243, v243
  v_cvt_pk_bf16_f32 v156, v240, v241
  v_cvt_pk_bf16_f32 v157, v242, v243
  v_max_f32 v248, 0, v248
  v_max_f32 v249, 0, v249
  v_mfma_f32_16x16x32_bf16 v[92:95], v[136:139], v[136:139], 0
  v_max_f32 v250, 0, v250
  v_max_f32 v251, 0, v251
  v_mul_f32 v248, v248, v248
  v_mul_f32 v249, v249, v249
  v_mul_f32 v250, v250, v250
  v_mfma_f32_16x16x32_bf16 v[96:99], v[136:139], v[136:139], 0
  v_mul_f32 v251, v251, v251
  v_cvt_pk_bf16_f32 v158, v248, v249
  v_cvt_pk_bf16_f32 v159, v250, v251
  buffer_store_dwordx4 v[156:159], v14, s[44:47], s60 offen offset:1024 sc1
  v_mfma_f32_16x16x32_bf16 v[100:103], v[136:139], v[136:139], 0
  v_max_f32 v228, 0, v228
  v_max_f32 v229, 0, v229
  v_max_f32 v230, 0, v230
  v_max_f32 v231, 0, v231
  v_mul_f32 v228, v228, v228
  v_mfma_f32_16x16x32_bf16 v[104:107], v[136:139], v[136:139], 0
  v_mul_f32 v229, v229, v229
  v_mul_f32 v230, v230, v230
  v_mul_f32 v231, v231, v231
  v_cvt_pk_bf16_f32 v160, v228, v229
  v_cvt_pk_bf16_f32 v161, v230, v231
  v_mfma_f32_16x16x32_bf16 v[108:111], v[136:139], v[136:139], 0
  v_max_f32 v236, 0, v236
  v_max_f32 v237, 0, v237
  v_max_f32 v238, 0, v238
  v_max_f32 v239, 0, v239
  v_mfma_f32_16x16x32_bf16 v[112:115], v[136:139], v[136:139], 0
  v_mul_f32 v236, v236, v236
  v_mul_f32 v237, v237, v237
  v_mul_f32 v238, v238, v238
  v_mul_f32 v239, v239, v239
  v_cvt_pk_bf16_f32 v162, v236, v237
  v_mfma_f32_16x16x32_bf16 v[116:119], v[136:139], v[136:139], 0
  v_cvt_pk_bf16_f32 v163, v238, v239
  buffer_store_dwordx4 v[160:163], v14, s[44:47], s61 offen offset:0 sc1
  v_max_f32 v244, 0, v244
  v_max_f32 v245, 0, v245
  v_max_f32 v246, 0, v246
  v_mfma_f32_16x16x32_bf16 v[120:123], v[136:139], v[136:139], 0
  v_max_f32 v247, 0, v247
  v_mul_f32 v244, v244, v244
  v_mul_f32 v245, v245, v245
  v_mul_f32 v246, v246, v246
  v_mfma_f32_16x16x32_bf16 v[124:127], v[136:139], v[136:139], 0
  v_mul_f32 v247, v247, v247
  v_cvt_pk_bf16_f32 v164, v244, v245
  v_cvt_pk_bf16_f32 v165, v246, v247
  v_max_f32 v252, 0, v252
  v_max_f32 v253, 0, v253
  v_mfma_f32_16x16x32_bf16 v[128:131], v[136:139], v[136:139], 0
  v_max_f32 v254, 0, v254
  v_max_f32 v255, 0, v255
  v_mul_f32 v252, v252, v252
  v_mul_f32 v253, v253, v253
  v_mul_f32 v254, v254, v254
  v_mfma_f32_16x16x32_bf16 v[132:135], v[136:139], v[136:139], 0
  v_mul_f32 v255, v255, v255
  v_cvt_pk_bf16_f32 v166, v252, v253
  v_cvt_pk_bf16_f32 v167, v254, v255
  buffer_store_dwordx4 v[164:167], v14, s[44:47], s61 offen offset:1024 sc1
  s_cmp_lt_u32 s56, 4
  s_cbranch_scc1 LF_nowarm
LF_nowarm:
  s_cmp_eq_u32 s56, 0
  s_cselect_b32 s73, 1, 0
LF3_start:
  v_add_u32 v2, 0x8000, v14
  s_mov_b32 s66, 0x10000
  s_add_u32 s60, s72, 1
  s_lshr_b32 s60, s60, 1
  s_add_u32 s60, s60, 1
  s_min_u32 s60, s60, s64
  s_sub_u32 s71, s64, s60
  v_mov_b32 v16, 131072
  v_mov_b32 v17, 0
  ds_write2_b32 v16, v17, v17 offset1:1
  s_waitcnt vmcnt(12) lgkmcnt(0)
  s_barrier
  ds_read_b128 v[180:183], v2 offset:0
  ds_read_b128 v[184:187], v2 offset:1024
  ds_read_b128 v[188:191], v2 offset:2048
  ds_read_b128 v[192:195], v2 offset:3072
  ds_read_b128 v[196:199], v2 offset:4096
  ds_read_b128 v[200:203], v2 offset:5120
  ds_read_b128 v[204:207], v2 offset:6144
  ds_read_b128 v[208:211], v2 offset:7168
  s_cmp_ge_u32 s56, 4
  s_cbranch_scc1 LF3_nodma2
  s_mov_b32 m0, s67
  s_nop 0
  buffer_load_dwordx4 v4, s[48:51], s69 offen offset:0 sc1 lds
  buffer_load_dwordx4 v4, s[48:51], s69 offen offset:1024 sc1 lds
  buffer_load_dwordx4 v4, s[48:51], s69 offen offset:2048 sc1 lds
  buffer_load_dwordx4 v4, s[48:51], s69 offen offset:3072 sc1 lds
  s_add_u32 s69, s69, 4096
  s_add_u32 m0, s67, 4096
  s_nop 0
  buffer_load_dwordx4 v4, s[48:51], s69 offen offset:0 sc1 lds
  buffer_load_dwordx4 v4, s[48:51], s69 offen offset:1024 sc1 lds
  buffer_load_dwordx4 v4, s[48:51], s69 offen offset:2048 sc1 lds
  buffer_load_dwordx4 v4, s[48:51], s69 offen offset:3072 sc1 lds
  s_add_u32 s69, s69, 28672
  s_xor_b32 s67, s67, s68
  s_xor_b32 s68, s68, 0x18000
LF3_nodma2:
  s_waitcnt lgkmcnt(7)
  v_mfma_f32_16x16x32_bf16 v[136:139], v[180:183], v[32:35], 0
  s_waitcnt lgkmcnt(6)
  v_mfma_f32_16x16x32_bf16 v[136:139], v[184:187], v[36:39], v[136:139]
  s_waitcnt lgkmcnt(5)
  v_mfma_f32_16x16x32_bf16 v[136:139], v[188:191], v[40:43], v[136:139]
  s_waitcnt lgkmcnt(4)
  v_mfma_f32_16x16x32_bf16 v[136:139], v[192:195], v[44:47], v[136:139]
  v_mfma_f32_16x16x32_bf16 v[140:143], v[180:183], v[48:51], 0
  v_mfma_f32_16x16x32_bf16 v[140:143], v[184:187], v[52:55], v[140:143]
  v_mfma_f32_16x16x32_bf16 v[140:143], v[188:191], v[56:59], v[140:143]
  v_mfma_f32_16x16x32_bf16 v[140:143], v[192:195], v[60:63], v[140:143]
  s_waitcnt lgkmcnt(3)
  v_mfma_f32_16x16x32_bf16 v[144:147], v[196:199], v[32:35], 0
  s_waitcnt lgkmcnt(2)
  v_mfma_f32_16x16x32_bf16 v[144:147], v[200:203], v[36:39], v[144:147]
  s_waitcnt lgkmcnt(1)
  v_mfma_f32_16x16x32_bf16 v[144:147], v[204:207], v[40:43], v[144:147]
  s_waitcnt lgkmcnt(0)
  v_mfma_f32_16x16x32_bf16 v[144:147], v[208:211], v[44:47], v[144:147]
  v_mfma_f32_16x16x32_bf16 v[148:151], v[196:199], v[48:51], 0
  v_mfma_f32_16x16x32_bf16 v[148:151], v[200:203], v[52:55], v[148:151]
  v_mfma_f32_16x16x32_bf16 v[148:151], v[204:207], v[56:59], v[148:151]
  v_mfma_f32_16x16x32_bf16 v[148:151], v[208:211], v[60:63], v[148:151]
  ds_read_b128 v[180:183], v2 offset:8192
  ds_read_b128 v[184:187], v2 offset:9216
  ds_read_b128 v[188:191], v2 offset:10240
  ds_read_b128 v[192:195], v2 offset:11264
  ds_read_b128 v[196:199], v2 offset:12288
  ds_read_b128 v[200:203], v2 offset:13312
  ds_read_b128 v[204:207], v2 offset:14336
  ds_read_b128 v[208:211], v2 offset:15360
  v_mov_b32 v3, v2
  s_nop 7
  s_cmp_lg_u32 s72, 0
  s_cbranch_scc1 LF3_nomask0
  v_cndmask_b32 v136, v136, v7, s[80:81]
  v_cndmask_b32 v137, v137, v7, s[82:83]
  v_cndmask_b32 v138, v138, v7, s[84:85]
  v_cndmask_b32 v139, v139, v7, s[86:87]
  v_cndmask_b32 v148, v148, v7, s[80:81]
  v_cndmask_b32 v149, v149, v7, s[82:83]
  v_cndmask_b32 v150, v150, v7, s[84:85]
  v_cndmask_b32 v151, v151, v7, s[86:87]
  v_mov_b32 v144, v7
  v_mov_b32 v145, v7
  v_mov_b32 v146, v7
  v_mov_b32 v147, v7
LF3_nomask0:
  v_max3_f32 v16, v136, v137, v138
  v_max3_f32 v16, v16, v139, v144
  v_max3_f32 v16, v16, v145, v146
  v_max_f32 v16, v16, v147
  v_mov_b32 v18, v16
  s_nop 1
  v_permlane16_swap_b32 v16, v18
  v_max_f32 v16, v16, v18
  v_mov_b32 v18, v16
  s_nop 1
  v_permlane32_swap_b32 v16, v18
  v_max_f32 v16, v16, v18
  v_sub_f32 v16, 0, v16
  v_max3_f32 v17, v140, v141, v142
  v_max3_f32 v17, v17, v143, v148
  v_max3_f32 v17, v17, v149, v150
  v_max_f32 v17, v17, v151
  v_mov_b32 v18, v17
  s_nop 1
  v_permlane16_swap_b32 v17, v18
  v_max_f32 v17, v17, v18
  v_mov_b32 v18, v17
  s_nop 1
  v_permlane32_swap_b32 v17, v18
  v_max_f32 v17, v17, v18
  v_sub_f32 v17, 0, v17
  s_cmp_eq_u32 s70, 0
  s_cbranch_scc1 LF3_standin
  v_mov_b32 v16, v5
  v_mov_b32 v17, v6
LF3_standin:
  v_mov_b32 v168, v16
  v_mov_b32 v169, v16
  v_mov_b32 v170, v16
  v_mov_b32 v171, v16
  v_mov_b32 v172, v17
  v_mov_b32 v173, v17
  v_mov_b32 v174, v17
  v_mov_b32 v175, v17
  v_add_f32 v136, v136, v16
  v_add_f32 v137, v137, v16
  v_add_f32 v138, v138, v16
  v_add_f32 v139, v139, v16
  v_add_f32 v140, v140, v17
  v_add_f32 v141, v141, v17
  v_add_f32 v142, v142, v17
  v_add_f32 v143, v143, v17
  v_add_f32 v144, v144, v16
  v_add_f32 v145, v145, v16
  v_add_f32 v146, v146, v16
  v_add_f32 v147, v147, v16
  v_add_f32 v148, v148, v17
  v_add_f32 v149, v149, v17
  v_add_f32 v150, v150, v17
  v_add_f32 v151, v151, v17
  v_exp_f32 v136, v136
  v_exp_f32 v137, v137
  v_exp_f32 v138, v138
  v_exp_f32 v139, v139
  v_cvt_pk_bf16_f32 v152, v136, v137
  v_cvt_pk_bf16_f32 v153, v138, v139
  v_exp_f32 v140, v140
  v_exp_f32 v141, v141
  v_exp_f32 v142, v142
  v_exp_f32 v143, v143
  v_cvt_pk_bf16_f32 v156, v140, v141
  v_cvt_pk_bf16_f32 v157, v142, v143
  v_exp_f32 v144, v144
  v_exp_f32 v145, v145
  v_exp_f32 v146, v146
  v_exp_f32 v147, v147
  v_cvt_pk_bf16_f32 v154, v144, v145
  v_cvt_pk_bf16_f32 v155, v146, v147
  v_exp_f32 v148, v148
  s_waitcnt lgkmcnt(4)
  s_sub_u32 s65, s72, 1
  s_cselect_b32 s60, 1, 0
  s_cmp_ge_u32 s56, 4
  s_cbranch_scc1 LF3_B
  s_setprio 2
  s_cmp_eq_u32 s60, 1
  s_cbranch_scc1 LF3_A_drain0
  s_sub_u32 s65, s65, 1
  s_cbranch_scc1 LF3_A_diag1
  .p2align 3
LF3_A_loop:
  v_mfma_f32_16x16x32_bf16 v[136:139], v[180:183], v[32:35], v[168:171]
  ds_read_b128 v[212:215], v3 offset:16384
  v_mfma_f32_16x16x32_bf16 v[136:139], v[184:187], v[36:39], v[136:139]
  v_exp_f32 v149, v149
  v_mfma_f32_16x16x32_bf16 v[136:139], v[188:191], v[40:43], v[136:139]
  ds_read_b128 v[216:219], v3 offset:20480
  v_cvt_pk_bf16_f32 v158, v148, v149
  v_mfma_f32_16x16x32_bf16 v[136:139], v[192:195], v[44:47], v[136:139]
  v_exp_f32 v150, v150
  v_mfma_f32_16x16x32_bf16 v[140:143], v[180:183], v[48:51], v[172:175]
  ds_read_b128 v[220:223], v3 offset:17408
  s_waitcnt lgkmcnt(3)
  v_mfma_f32_16x16x32_bf16 v[140:143], v[184:187], v[52:55], v[140:143]
  v_exp_f32 v151, v151
  v_mfma_f32_16x16x32_bf16 v[140:143], v[188:191], v[56:59], v[140:143]
  ds_read_b128 v[224:227], v3 offset:21504
  v_cvt_pk_bf16_f32 v159, v150, v151
  v_mfma_f32_16x16x32_bf16 v[140:143], v[192:195], v[60:63], v[140:143]
  v_exp_f32 v136, v136
  v_mfma_f32_16x16x32_bf16 v[144:147], v[196:199], v[32:35], v[168:171]
  ds_read_b128 v[228:231], v3 offset:18432
  v_xor_b32 v2, s66, v2
  v_mfma_f32_16x16x32_bf16 v[144:147], v[200:203], v[36:39], v[144:147]
  v_exp_f32 v137, v137
  v_mfma_f32_16x16x32_bf16 v[144:147], v[204:207], v[40:43], v[144:147]
  ds_read_b128 v[232:235], v3 offset:22528
  v_cvt_pk_bf16_f32 v160, v136, v137
  v_mfma_f32_16x16x32_bf16 v[144:147], v[208:211], v[44:47], v[144:147]
  v_exp_f32 v138, v138
  v_mfma_f32_16x16x32_bf16 v[148:151], v[196:199], v[48:51], v[172:175]
  ds_read_b128 v[236:239], v3 offset:19456
  s_xor_b32 s66, s66, 0x18000
  v_mfma_f32_16x16x32_bf16 v[148:151], v[200:203], v[52:55], v[148:151]
  v_exp_f32 v139, v139
  v_mfma_f32_16x16x32_bf16 v[148:151], v[204:207], v[56:59], v[148:151]
  ds_read_b128 v[240:243], v3 offset:23552
  v_cvt_pk_bf16_f32 v161, v138, v139
  v_mfma_f32_16x16x32_bf16 v[148:151], v[208:211], v[60:63], v[148:151]
  v_exp_f32 v140, v140
  v_mfma_f32_16x16x32_bf16 v[128:131], v[176:179], v[152:155], v[128:131]
  s_waitcnt vmcnt(8) lgkmcnt(2)
  s_barrier
  s_cmp_le_u32 s69, 262144
  s_cbranch_scc1 LF3_A_s_go
LF3_A_s_ret:
  v_mfma_f32_16x16x32_bf16 v[132:135], v[176:179], v[156:159], v[132:135]
  v_exp_f32 v141, v141
  s_mov_b32 m0, s67
  s_nop 0
  buffer_load_dwordx4 v4, s[48:51], s69 offen offset:0 sc1 lds
  v_mfma_f32_16x16x32_bf16 v[64:67], v[212:215], v[152:155], v[64:67]
  ds_read_b128 v[180:183], v2 offset:0
  v_cvt_pk_bf16_f32 v164, v140, v141
  buffer_load_dwordx4 v4, s[48:51], s69 offen offset:1024 sc1 lds
  v_mfma_f32_16x16x32_bf16 v[68:71], v[212:215], v[156:159], v[68:71]
  v_exp_f32 v142, v142
  buffer_load_dwordx4 v4, s[48:51], s69 offen offset:2048 sc1 lds
  v_mfma_f32_16x16x32_bf16 v[76:79], v[216:219], v[156:159], v[76:79]
  ds_read_b128 v[184:187], v2 offset:1024
  buffer_load_dwordx4 v4, s[48:51], s69 offen offset:3072 sc1 lds
  s_add_u32 s69, s69, 4096
  v_mfma_f32_16x16x32_bf16 v[72:75], v[216:219], v[152:155], v[72:75]
  v_exp_f32 v143, v143
  s_add_u32 m0, s67, 4096
  v_mfma_f32_16x16x32_bf16 v[80:83], v[220:223], v[152:155], v[80:83]
  ds_read_b128 v[188:191], v2 offset:2048
  v_cvt_pk_bf16_f32 v165, v142, v143
  buffer_load_dwordx4 v4, s[48:51], s69 offen offset:0 sc1 lds
  v_mfma_f32_16x16x32_bf16 v[84:87], v[220:223], v[156:159], v[84:87]
  v_exp_f32 v144, v144
  buffer_load_dwordx4 v4, s[48:51], s69 offen offset:1024 sc1 lds
  v_mfma_f32_16x16x32_bf16 v[92:95], v[224:227], v[156:159], v[92:95]
  ds_read_b128 v[192:195], v2 offset:3072
  buffer_load_dwordx4 v4, s[48:51], s69 offen offset:2048 sc1 lds
  buffer_load_dwordx4 v4, s[48:51], s69 offen offset:3072 sc1 lds
  s_waitcnt lgkmcnt(4)
  v_mfma_f32_16x16x32_bf16 v[88:91], v[224:227], v[152:155], v[88:91]
  v_exp_f32 v145, v145
  s_add_u32 s69, s69, 28672
  v_mfma_f32_16x16x32_bf16 v[96:99], v[228:231], v[152:155], v[96:99]
  ds_read_b128 v[196:199], v2 offset:4096
  v_cvt_pk_bf16_f32 v162, v144, v145
  s_xor_b32 s67, s67, s68
  v_mfma_f32_16x16x32_bf16 v[100:103], v[228:231], v[156:159], v[100:103]
  v_exp_f32 v146, v146
  s_xor_b32 s68, s68, 0x18000
  v_mfma_f32_16x16x32_bf16 v[108:111], v[232:235], v[156:159], v[108:111]
  ds_read_b128 v[200:203], v2 offset:5120
  s_sub_u32 s65, s65, 1
  v_mfma_f32_16x16x32_bf16 v[104:107], v[232:235], v[152:155], v[104:107]
  v_exp_f32 v147, v147
  v_mfma_f32_16x16x32_bf16 v[112:115], v[236:239], v[152:155], v[112:115]
  ds_read_b128 v[204:207], v2 offset:6144
  v_cvt_pk_bf16_f32 v163, v146, v147
  v_mfma_f32_16x16x32_bf16 v[116:119], v[236:239], v[156:159], v[116:119]
  v_exp_f32 v148, v148
  v_mfma_f32_16x16x32_bf16 v[124:127], v[240:243], v[156:159], v[124:127]
  ds_read_b128 v[208:211], v2 offset:7168
  v_mfma_f32_16x16x32_bf16 v[120:123], v[240:243], v[152:155], v[120:123]
  s_waitcnt lgkmcnt(4)
  s_cbranch_scc1 LF3_A_diag0
  v_mfma_f32_16x16x32_bf16 v[136:139], v[180:183], v[32:35], v[168:171]
  ds_read_b128 v[212:215], v3 offset:24576
  v_mfma_f32_16x16x32_bf16 v[136:139], v[184:187], v[36:39], v[136:139]
  v_exp_f32 v149, v149
  v_mfma_f32_16x16x32_bf16 v[136:139], v[188:191], v[40:43], v[136:139]
  ds_read_b128 v[216:219], v3 offset:28672
  v_cvt_pk_bf16_f32 v166, v148, v149
  v_mfma_f32_16x16x32_bf16 v[136:139], v[192:195], v[44:47], v[136:139]
  v_exp_f32 v150, v150
  v_mfma_f32_16x16x32_bf16 v[140:143], v[180:183], v[48:51], v[172:175]
  ds_read_b128 v[220:223], v3 offset:25600
  s_waitcnt lgkmcnt(3)
  v_mfma_f32_16x16x32_bf16 v[140:143], v[184:187], v[52:55], v[140:143]
  v_exp_f32 v151, v151
  v_mfma_f32_16x16x32_bf16 v[140:143], v[188:191], v[56:59], v[140:143]
  ds_read_b128 v[224:227], v3 offset:29696
  v_cvt_pk_bf16_f32 v167, v150, v151
  v_mfma_f32_16x16x32_bf16 v[140:143], v[192:195], v[60:63], v[140:143]
  v_exp_f32 v136, v136
  v_mfma_f32_16x16x32_bf16 v[144:147], v[196:199], v[32:35], v[168:171]
  ds_read_b128 v[228:231], v3 offset:26624
  v_mfma_f32_16x16x32_bf16 v[144:147], v[200:203], v[36:39], v[144:147]
  v_exp_f32 v137, v137
  v_mfma_f32_16x16x32_bf16 v[144:147], v[204:207], v[40:43], v[144:147]
  ds_read_b128 v[232:235], v3 offset:30720
  v_cvt_pk_bf16_f32 v152, v136, v137
  v_mfma_f32_16x16x32_bf16 v[144:147], v[208:211], v[44:47], v[144:147]
  v_exp_f32 v138, v138
  v_mfma_f32_16x16x32_bf16 v[148:151], v[196:199], v[48:51], v[172:175]
  ds_read_b128 v[236:239], v3 offset:27648
  v_mfma_f32_16x16x32_bf16 v[148:151], v[200:203], v[52:55], v[148:151]
  v_exp_f32 v139, v139
  v_mfma_f32_16x16x32_bf16 v[148:151], v[204:207], v[56:59], v[148:151]
  ds_read_b128 v[240:243], v3 offset:31744
  v_cvt_pk_bf16_f32 v153, v138, v139
  v_mfma_f32_16x16x32_bf16 v[148:151], v[208:211], v[60:63], v[148:151]
  v_exp_f32 v140, v140
  v_mfma_f32_16x16x32_bf16 v[128:131], v[176:179], v[160:163], v[128:131]
  s_waitcnt lgkmcnt(2)
  v_mfma_f32_16x16x32_bf16 v[132:135], v[176:179], v[164:167], v[132:135]
  v_exp_f32 v141, v141
  v_mfma_f32_16x16x32_bf16 v[64:67], v[212:215], v[160:163], v[64:67]
  ds_read_b128 v[180:183], v2 offset:8192
  v_cvt_pk_bf16_f32 v156, v140, v141
  v_mfma_f32_16x16x32_bf16 v[68:71], v[212:215], v[164:167], v[68:71]
  v_exp_f32 v142, v142
  v_mfma_f32_16x16x32_bf16 v[76:79], v[216:219], v[164:167], v[76:79]
  ds_read_b128 v[184:187], v2 offset:9216
  v_mfma_f32_16x16x32_bf16 v[72:75], v[216:219], v[160:163], v[72:75]
  v_exp_f32 v143, v143
  v_mfma_f32_16x16x32_bf16 v[80:83], v[220:223], v[160:163], v[80:83]
  ds_read_b128 v[188:191], v2 offset:10240
  v_cvt_pk_bf16_f32 v157, v142, v143
  v_mfma_f32_16x16x32_bf16 v[84:87], v[220:223], v[164:167], v[84:87]
  v_exp_f32 v144, v144
  v_mfma_f32_16x16x32_bf16 v[92:95], v[224:227], v[164:167], v[92:95]
  ds_read_b128 v[192:195], v2 offset:11264
  s_waitcnt lgkmcnt(4)
  v_mfma_f32_16x16x32_bf16 v[88:91], v[224:227], v[160:163], v[88:91]
  v_exp_f32 v145, v145
  v_mfma_f32_16x16x32_bf16 v[96:99], v[228:231], v[160:163], v[96:99]
  ds_read_b128 v[196:199], v2 offset:12288
  v_cvt_pk_bf16_f32 v154, v144, v145
  v_mfma_f32_16x16x32_bf16 v[100:103], v[228:231], v[164:167], v[100:103]
  v_exp_f32 v146, v146
  v_mfma_f32_16x16x32_bf16 v[108:111], v[232:235], v[164:167], v[108:111]
  ds_read_b128 v[200:203], v2 offset:13312
  s_sub_u32 s65, s65, 1
  v_mfma_f32_16x16x32_bf16 v[104:107], v[232:235], v[160:163], v[104:107]
  v_exp_f32 v147, v147
  v_mfma_f32_16x16x32_bf16 v[112:115], v[236:239], v[160:163], v[112:115]
  ds_read_b128 v[204:207], v2 offset:14336
  v_cvt_pk_bf16_f32 v155, v146, v147
  v_mfma_f32_16x16x32_bf16 v[116:119], v[236:239], v[164:167], v[116:119]
  v_exp_f32 v148, v148
  v_mfma_f32_16x16x32_bf16 v[124:127], v[240:243], v[164:167], v[124:127]
  ds_read_b128 v[208:211], v2 offset:15360
  v_mov_b32 v3, v2
  v_mfma_f32_16x16x32_bf16 v[120:123], v[240:243], v[160:163], v[120:123]
  s_waitcnt lgkmcnt(4)
  s_cbranch_scc0 LF3_A_loop
LF3_A_diag1:
  v_mfma_f32_16x16x32_bf16 v[136:139], v[180:183], v[32:35], v[168:171]
  ds_read_b128 v[212:215], v3 offset:16384
  v_mfma_f32_16x16x32_bf16 v[136:139], v[184:187], v[36:39], v[136:139]
  ds_read_b128 v[216:219], v3 offset:20480
  v_exp_f32 v149, v149
  v_mfma_f32_16x16x32_bf16 v[136:139], v[188:191], v[40:43], v[136:139]
  ds_read_b128 v[220:223], v3 offset:17408
  v_cvt_pk_bf16_f32 v158, v148, v149
  v_mfma_f32_16x16x32_bf16 v[136:139], v[192:195], v[44:47], v[136:139]
  ds_read_b128 v[224:227], v3 offset:21504
  v_exp_f32 v150, v150
  v_mfma_f32_16x16x32_bf16 v[140:143], v[180:183], v[48:51], v[172:175]
  ds_read_b128 v[228:231], v3 offset:18432
  s_waitcnt lgkmcnt(5)
  v_mfma_f32_16x16x32_bf16 v[140:143], v[184:187], v[52:55], v[140:143]
  ds_read_b128 v[232:235], v3 offset:22528
  v_exp_f32 v151, v151
  v_mfma_f32_16x16x32_bf16 v[140:143], v[188:191], v[56:59], v[140:143]
  ds_read_b128 v[236:239], v3 offset:19456
  v_cvt_pk_bf16_f32 v159, v150, v151
  v_mfma_f32_16x16x32_bf16 v[140:143], v[192:195], v[60:63], v[140:143]
  ds_read_b128 v[240:243], v3 offset:23552
  v_cndmask_b32 v136, v136, v7, s[80:81]
  v_cndmask_b32 v137, v137, v7, s[82:83]
  v_cndmask_b32 v138, v138, v7, s[84:85]
  v_cndmask_b32 v139, v139, v7, s[86:87]
  v_mfma_f32_16x16x32_bf16 v[148:151], v[196:199], v[48:51], v[172:175]
  v_exp_f32 v136, v136
  v_mfma_f32_16x16x32_bf16 v[148:151], v[200:203], v[52:55], v[148:151]
  v_exp_f32 v137, v137
  v_mfma_f32_16x16x32_bf16 v[148:151], v[204:207], v[56:59], v[148:151]
  v_cvt_pk_bf16_f32 v160, v136, v137
  v_mfma_f32_16x16x32_bf16 v[148:151], v[208:211], v[60:63], v[148:151]
  v_exp_f32 v138, v138
  v_mfma_f32_16x16x32_bf16 v[128:131], v[176:179], v[152:155], v[128:131]
  s_waitcnt vmcnt(8) lgkmcnt(2)
  s_barrier
  s_cmp_le_u32 s69, 262144
  s_cbranch_scc1 LF3_A_d1_s_go
LF3_A_d1_s_ret:
  v_mfma_f32_16x16x32_bf16 v[132:135], v[176:179], v[156:159], v[132:135]
  v_exp_f32 v139, v139
  s_mov_b32 m0, s67
  s_nop 0
  buffer_load_dwordx4 v4, s[48:51], s69 offen offset:0 sc1 lds
  v_mfma_f32_16x16x32_bf16 v[64:67], v[212:215], v[152:155], v[64:67]
  v_cvt_pk_bf16_f32 v161, v138, v139
  buffer_load_dwordx4 v4, s[48:51], s69 offen offset:1024 sc1 lds
  v_mfma_f32_16x16x32_bf16 v[68:71], v[212:215], v[156:159], v[68:71]
  v_exp_f32 v140, v140
  buffer_load_dwordx4 v4, s[48:51], s69 offen offset:2048 sc1 lds
  v_mfma_f32_16x16x32_bf16 v[76:79], v[216:219], v[156:159], v[76:79]
  buffer_load_dwordx4 v4, s[48:51], s69 offen offset:3072 sc1 lds
  s_add_u32 s69, s69, 4096
  v_mfma_f32_16x16x32_bf16 v[72:75], v[216:219], v[152:155], v[72:75]
  v_exp_f32 v141, v141
  s_add_u32 m0, s67, 4096
  v_mfma_f32_16x16x32_bf16 v[80:83], v[220:223], v[152:155], v[80:83]
  v_cvt_pk_bf16_f32 v164, v140, v141
  buffer_load_dwordx4 v4, s[48:51], s69 offen offset:0 sc1 lds
  v_mfma_f32_16x16x32_bf16 v[84:87], v[220:223], v[156:159], v[84:87]
  v_exp_f32 v142, v142
  buffer_load_dwordx4 v4, s[48:51], s69 offen offset:1024 sc1 lds
  v_mfma_f32_16x16x32_bf16 v[92:95], v[224:227], v[156:159], v[92:95]
  buffer_load_dwordx4 v4, s[48:51], s69 offen offset:2048 sc1 lds
  buffer_load_dwordx4 v4, s[48:51], s69 offen offset:3072 sc1 lds
  s_waitcnt lgkmcnt(0)
  v_mfma_f32_16x16x32_bf16 v[88:91], v[224:227], v[152:155], v[88:91]
  v_exp_f32 v143, v143
  s_add_u32 s69, s69, 28672
  v_mfma_f32_16x16x32_bf16 v[96:99], v[228:231], v[152:155], v[96:99]
  v_cvt_pk_bf16_f32 v165, v142, v143
  s_xor_b32 s67, s67, s68
  v_mfma_f32_16x16x32_bf16 v[100:103], v[228:231], v[156:159], v[100:103]
  v_mov_b32 v162, 0
  s_xor_b32 s68, s68, 0x18000
  v_mfma_f32_16x16x32_bf16 v[108:111], v[232:235], v[156:159], v[108:111]
  v_mov_b32 v163, 0
  v_mfma_f32_16x16x32_bf16 v[104:107], v[232:235], v[152:155], v[104:107]
  v_mfma_f32_16x16x32_bf16 v[112:115], v[236:239], v[152:155], v[112:115]
  v_cndmask_b32 v148, v148, v7, s[80:81]
  v_cndmask_b32 v149, v149, v7, s[82:83]
  v_cndmask_b32 v150, v150, v7, s[84:85]
  v_cndmask_b32 v151, v151, v7, s[86:87]
  v_mfma_f32_16x16x32_bf16 v[116:119], v[236:239], v[156:159], v[116:119]
  v_exp_f32 v148, v148
  v_mfma_f32_16x16x32_bf16 v[124:127], v[240:243], v[156:159], v[124:127]
  v_mfma_f32_16x16x32_bf16 v[120:123], v[240:243], v[152:155], v[120:123]
  ds_read_b128 v[212:215], v3 offset:24576
  ds_read_b128 v[216:219], v3 offset:28672
  ds_read_b128 v[220:223], v3 offset:25600
  ds_read_b128 v[224:227], v3 offset:29696
  ds_read_b128 v[228:231], v3 offset:26624
  ds_read_b128 v[232:235], v3 offset:30720
  ds_read_b128 v[236:239], v3 offset:27648
  ds_read_b128 v[240:243], v3 offset:31744
  v_exp_f32 v149, v149
  s_nop 0
  v_cvt_pk_bf16_f32 v166, v148, v149
  v_exp_f32 v150, v150
  v_exp_f32 v151, v151
  s_nop 0
  v_cvt_pk_bf16_f32 v167, v150, v151
  v_mfma_f32_16x16x32_bf16 v[128:131], v[176:179], v[160:163], v[128:131]
  s_nop 0
  v_mfma_f32_16x16x32_bf16 v[132:135], v[176:179], v[164:167], v[132:135]
  s_waitcnt lgkmcnt(7)
  v_mfma_f32_16x16x32_bf16 v[64:67], v[212:215], v[160:163], v[64:67]
  v_mfma_f32_16x16x32_bf16 v[68:71], v[212:215], v[164:167], v[68:71]
  s_waitcnt lgkmcnt(6)
  v_mfma_f32_16x16x32_bf16 v[76:79], v[216:219], v[164:167], v[76:79]
  v_mfma_f32_16x16x32_bf16 v[72:75], v[216:219], v[160:163], v[72:75]
  s_waitcnt lgkmcnt(5)
  v_mfma_f32_16x16x32_bf16 v[80:83], v[220:223], v[160:163], v[80:83]
  v_mfma_f32_16x16x32_bf16 v[84:87], v[220:223], v[164:167], v[84:87]
  s_waitcnt lgkmcnt(4)
  v_mfma_f32_16x16x32_bf16 v[92:95], v[224:227], v[164:167], v[92:95]
  v_mfma_f32_16x16x32_bf16 v[88:91], v[224:227], v[160:163], v[88:91]
  s_waitcnt lgkmcnt(3)
  v_mfma_f32_16x16x32_bf16 v[96:99], v[228:231], v[160:163], v[96:99]
  v_mfma_f32_16x16x32_bf16 v[100:103], v[228:231], v[164:167], v[100:103]
  s_waitcnt lgkmcnt(2)
  v_mfma_f32_16x16x32_bf16 v[108:111], v[232:235], v[164:167], v[108:111]
  v_mfma_f32_16x16x32_bf16 v[104:107], v[232:235], v[160:163], v[104:107]
  s_waitcnt lgkmcnt(1)
  v_mfma_f32_16x16x32_bf16 v[112:115], v[236:239], v[160:163], v[112:115]
  v_mfma_f32_16x16x32_bf16 v[116:119], v[236:239], v[164:167], v[116:119]
  s_waitcnt lgkmcnt(0)
  v_mfma_f32_16x16x32_bf16 v[124:127], v[240:243], v[164:167], v[124:127]
  v_mfma_f32_16x16x32_bf16 v[120:123], v[240:243], v[160:163], v[120:123]
  s_branch LF3_A_fin
LF3_A_diag0:
  v_mfma_f32_16x16x32_bf16 v[136:139], v[180:183], v[32:35], v[168:171]
  ds_read_b128 v[212:215], v3 offset:24576
  v_mfma_f32_16x16x32_bf16 v[136:139], v[184:187], v[36:39], v[136:139]
  ds_read_b128 v[216:219], v3 offset:28672
  v_exp_f32 v149, v149
  v_mfma_f32_16x16x32_bf16 v[136:139], v[188:191], v[40:43], v[136:139]
  ds_read_b128 v[220:223], v3 offset:25600
  v_cvt_pk_bf16_f32 v166, v148, v149
  v_mfma_f32_16x16x32_bf16 v[136:139], v[192:195], v[44:47], v[136:139]
  ds_read_b128 v[224:227], v3 offset:29696
  v_exp_f32 v150, v150
  v_mfma_f32_16x16x32_bf16 v[140:143], v[180:183], v[48:51], v[172:175]
  ds_read_b128 v[228:231], v3 offset:26624
  s_waitcnt lgkmcnt(5)
  v_mfma_f32_16x16x32_bf16 v[140:143], v[184:187], v[52:55], v[140:143]
  ds_read_b128 v[232:235], v3 offset:30720
  v_exp_f32 v151, v151
  v_mfma_f32_16x16x32_bf16 v[140:143], v[188:191], v[56:59], v[140:143]
  ds_read_b128 v[236:239], v3 offset:27648
  v_cvt_pk_bf16_f32 v167, v150, v151
  v_mfma_f32_16x16x32_bf16 v[140:143], v[192:195], v[60:63], v[140:143]
  ds_read_b128 v[240:243], v3 offset:31744
  v_cndmask_b32 v136, v136, v7, s[80:81]
  v_cndmask_b32 v137, v137, v7, s[82:83]
  v_cndmask_b32 v138, v138, v7, s[84:85]
  v_cndmask_b32 v139, v139, v7, s[86:87]
  v_mfma_f32_16x16x32_bf16 v[148:151], v[196:199], v[48:51], v[172:175]
  v_exp_f32 v136, v136
  v_mfma_f32_16x16x32_bf16 v[148:151], v[200:203], v[52:55], v[148:151]
  v_exp_f32 v137, v137
  v_mfma_f32_16x16x32_bf16 v[148:151], v[204:207], v[56:59], v[148:151]
  v_cvt_pk_bf16_f32 v152, v136, v137
  v_mfma_f32_16x16x32_bf16 v[148:151], v[208:211], v[60:63], v[148:151]
  v_exp_f32 v138, v138
  v_mfma_f32_16x16x32_bf16 v[128:131], v[176:179], v[160:163], v[128:131]
  s_waitcnt lgkmcnt(2)
  v_mfma_f32_16x16x32_bf16 v[132:135], v[176:179], v[164:167], v[132:135]
  v_exp_f32 v139, v139
  v_mfma_f32_16x16x32_bf16 v[64:67], v[212:215], v[160:163], v[64:67]
  v_cvt_pk_bf16_f32 v153, v138, v139
  v_mfma_f32_16x16x32_bf16 v[68:71], v[212:215], v[164:167], v[68:71]
  v_exp_f32 v140, v140
  v_mfma_f32_16x16x32_bf16 v[76:79], v[216:219], v[164:167], v[76:79]
  v_mfma_f32_16x16x32_bf16 v[72:75], v[216:219], v[160:163], v[72:75]
  v_exp_f32 v141, v141
  v_mfma_f32_16x16x32_bf16 v[80:83], v[220:223], v[160:163], v[80:83]
  v_cvt_pk_bf16_f32 v156, v140, v141
  v_mfma_f32_16x16x32_bf16 v[84:87], v[220:223], v[164:167], v[84:87]
  v_exp_f32 v142, v142
  v_mfma_f32_16x16x32_bf16 v[92:95], v[224:227], v[164:167], v[92:95]
  s_waitcnt lgkmcnt(0)
  v_mfma_f32_16x16x32_bf16 v[88:91], v[224:227], v[160:163], v[88:91]
  v_exp_f32 v143, v143
  v_mfma_f32_16x16x32_bf16 v[96:99], v[228:231], v[160:163], v[96:99]
  v_cvt_pk_bf16_f32 v157, v142, v143
  v_mfma_f32_16x16x32_bf16 v[100:103], v[228:231], v[164:167], v[100:103]
  v_mov_b32 v154, 0
  v_mfma_f32_16x16x32_bf16 v[108:111], v[232:235], v[164:167], v[108:111]
  v_mov_b32 v155, 0
  v_mfma_f32_16x16x32_bf16 v[104:107], v[232:235], v[160:163], v[104:107]
  v_mfma_f32_16x16x32_bf16 v[112:115], v[236:239], v[160:163], v[112:115]
  v_cndmask_b32 v148, v148, v7, s[80:81]
  v_cndmask_b32 v149, v149, v7, s[82:83]
  v_cndmask_b32 v150, v150, v7, s[84:85]
  v_cndmask_b32 v151, v151, v7, s[86:87]
  v_mfma_f32_16x16x32_bf16 v[116:119], v[236:239], v[164:167], v[116:119]
  v_exp_f32 v148, v148
  v_mfma_f32_16x16x32_bf16 v[124:127], v[240:243], v[164:167], v[124:127]
  v_mov_b32 v3, v2
  v_mfma_f32_16x16x32_bf16 v[120:123], v[240:243], v[160:163], v[120:123]
LF3_A_drain0:
  ds_read_b128 v[212:215], v3 offset:16384
  ds_read_b128 v[216:219], v3 offset:20480
  ds_read_b128 v[220:223], v3 offset:17408
  ds_read_b128 v[224:227], v3 offset:21504
  ds_read_b128 v[228:231], v3 offset:18432
  ds_read_b128 v[232:235], v3 offset:22528
  ds_read_b128 v[236:239], v3 offset:19456
  ds_read_b128 v[240:243], v3 offset:23552
  v_exp_f32 v149, v149
  s_nop 0
  v_cvt_pk_bf16_f32 v158, v148, v149
  v_exp_f32 v150, v150
  v_exp_f32 v151, v151
  s_nop 0
  v_cvt_pk_bf16_f32 v159, v150, v151
  v_mfma_f32_16x16x32_bf16 v[128:131], v[176:179], v[152:155], v[128:131]
  s_nop 0
  v_mfma_f32_16x16x32_bf16 v[132:135], v[176:179], v[156:159], v[132:135]
  s_waitcnt lgkmcnt(7)
  v_mfma_f32_16x16x32_bf16 v[64:67], v[212:215], v[152:155], v[64:67]
  v_mfma_f32_16x16x32_bf16 v[68:71], v[212:215], v[156:159], v[68:71]
  s_waitcnt lgkmcnt(6)
  v_mfma_f32_16x16x32_bf16 v[76:79], v[216:219], v[156:159], v[76:79]
  v_mfma_f32_16x16x32_bf16 v[72:75], v[216:219], v[152:155], v[72:75]
  s_waitcnt lgkmcnt(5)
  v_mfma_f32_16x16x32_bf16 v[80:83], v[220:223], v[152:155], v[80:83]
  v_mfma_f32_16x16x32_bf16 v[84:87], v[220:223], v[156:159], v[84:87]
  s_waitcnt lgkmcnt(4)
  v_mfma_f32_16x16x32_bf16 v[92:95], v[224:227], v[156:159], v[92:95]
  v_mfma_f32_16x16x32_bf16 v[88:91], v[224:227], v[152:155], v[88:91]
  s_waitcnt lgkmcnt(3)
  v_mfma_f32_16x16x32_bf16 v[96:99], v[228:231], v[152:155], v[96:99]
  v_mfma_f32_16x16x32_bf16 v[100:103], v[228:231], v[156:159], v[100:103]
  s_waitcnt lgkmcnt(2)
  v_mfma_f32_16x16x32_bf16 v[108:111], v[232:235], v[156:159], v[108:111]
  v_mfma_f32_16x16x32_bf16 v[104:107], v[232:235], v[152:155], v[104:107]
  s_waitcnt lgkmcnt(1)
  v_mfma_f32_16x16x32_bf16 v[112:115], v[236:239], v[152:155], v[112:115]
  v_mfma_f32_16x16x32_bf16 v[116:119], v[236:239], v[156:159], v[116:119]
  s_waitcnt lgkmcnt(0)
  v_mfma_f32_16x16x32_bf16 v[124:127], v[240:243], v[156:159], v[124:127]
  v_mfma_f32_16x16x32_bf16 v[120:123], v[240:243], v[152:155], v[120:123]
LF3_A_fin:
  s_waitcnt lgkmcnt(0)
  s_setprio 0
  s_mov_b32 s77, 1
  s_mul_i32 s63, s6, 7
  v_min_u32 v16, 6, v1
  v_add_u32 v16, s63, v16
  v_lshrrev_b32 v17, 2, v16
  v_and_b32 v16, 3, v16
  v_lshl_add_u32 v16, v16, 3, v17
  s_lshl_b32 s62, s20, 5
  v_add_u32 v16, s62, v16
  v_lshlrev_b32 v16, 10, v16
  v_add_u32 v12, 128, v16
  buffer_load_dword v11, v12, s[88:91], 0 offen sc1
  s_mov_b32 s75, 0
  s_mov_b32 s74, 0
  s_nop 7
LF3_A_ld:
  s_cmp_eq_u32 s71, 1
  s_cbranch_scc1 LF3_A_last
  s_add_u32 s60, s75, s74
  s_cmp_ge_u32 s60, 16
  s_cbranch_scc1 LF3_A_wn16
  s_cmp_ge_u32 s60, 8
  s_cbranch_scc1 LF3_A_wn8
  s_waitcnt vmcnt(8)
LF3_A_wn8:
  s_waitcnt vmcnt(16)
LF3_A_wn16:
  s_waitcnt vmcnt(24)
  s_mov_b32 s74, s75
  s_mov_b32 s75, 0
  s_barrier
  s_cmp_le_u32 s69, 262144
  s_cbranch_scc1 LF3_A_lds_go
LF3_A_lds_ret:
  s_mov_b32 m0, s67
  s_nop 0
  buffer_load_dwordx4 v4, s[48:51], s69 offen offset:0 sc1 lds
  buffer_load_dwordx4 v4, s[48:51], s69 offen offset:1024 sc1 lds
  buffer_load_dwordx4 v4, s[48:51], s69 offen offset:2048 sc1 lds
  buffer_load_dwordx4 v4, s[48:51], s69 offen offset:3072 sc1 lds
  s_add_u32 s69, s69, 4096
  s_add_u32 m0, s67, 4096
  s_nop 0
  buffer_load_dwordx4 v4, s[48:51], s69 offen offset:0 sc1 lds
  buffer_load_dwordx4 v4, s[48:51], s69 offen offset:1024 sc1 lds
  buffer_load_dwordx4 v4, s[48:51], s69 offen offset:2048 sc1 lds
  buffer_load_dwordx4 v4, s[48:51], s69 offen offset:3072 sc1 lds
  s_add_u32 s69, s69, 28672
  s_xor_b32 s67, s67, s68
  s_xor_b32 s68, s68, 0x18000
  s_branch LF3_A_post
LF3_A_last:
  s_mov_b32 s60, s75
  s_cmp_ge_u32 s60, 16
  s_cbranch_scc1 LF3_A_wl16
  s_cmp_ge_u32 s60, 8
  s_cbranch_scc1 LF3_A_wl8
  s_waitcnt vmcnt(0)
LF3_A_wl8:
  s_waitcnt vmcnt(8)
LF3_A_wl16:
  s_waitcnt vmcnt(16)
  s_mov_b32 s74, s75
  s_mov_b32 s75, 0
  s_barrier
  s_lshl_b32 s60, s58, 3
  s_add_u32 s60, s60, s56
  s_and_b32 s61, s60, 7
  s_cmp_eq_u32 s60, 56
  s_cselect_b32 s61, 1, s61
  s_cmp_eq_u32 s61, 0
  s_cselect_b32 s61, 0, 0x40000
  s_lshl_b32 s60, s2, 10
  s_add_u32 s60, s60, s61
  v_mov_b32 v16, 1
  buffer_store_dword v16, off, s[88:91], s60 offset:384 sc1
  s_mov_b32 s32, s22
  s_mov_b32 s33, s23
  s_mov_b32 s34, 0x1c0000
  s_mov_b32 s35, 0x20000
  s_and_b32 s62, s59, 1
  s_lshl_b32 s63, s62, 2
  v_lshrrev_b32 v17, 4, v1
  v_or_b32 v18, s63, v17
  v_lshlrev_b32 v18, 1, v18
  v_and_b32 v16, 15, v1
  v_xor_b32 v16, v16, v18
  v_lshlrev_b32 v16, 4, v16
  v_lshl_add_u32 v16, v17, 10, v16
  s_lshr_b32 s63, s59, 1
  s_lshl_b32 s63, s63, 4
  s_add_u32 s63, s63, s62
  s_and_b32 s60, s64, 2
  s_cmp_eq_u32 s60, 0
  s_mov_b32 s61, 0x10000
  s_cselect_b32 s60, 0x8000, s61
  s_lshl_b32 s18, s63, 10
  s_add_u32 s18, s18, s60
  s_lshl_b32 s63, s63, 12
  s_mul_i32 s62, s6, 458752
  s_add_u32 s63, s63, s62
  s_lshl_b32 s62, s8, 8
  s_add_u32 s63, s63, s62
  v_add_u32 v8, s63, v16
  s_mov_b32 s10, 8192
  s_mov_b32 s11, 16384
  s_mov_b32 s12, 24576
  s_mov_b32 s13, 32768
  s_mov_b32 s16, 40960
  s_mov_b32 s17, 49152
  s_mov_b32 s78, 57344
  s_add_u32 m0, s18, 0
  s_nop 0
  buffer_load_dwordx4 v8, s[32:35], 0 offen lds
  s_add_u32 m0, s18, 2048
  s_nop 0
  buffer_load_dwordx4 v8, s[32:35], s10 offen lds
  s_add_u32 m0, s18, 4096
  s_nop 0
  buffer_load_dwordx4 v8, s[32:35], s11 offen lds
  s_add_u32 m0, s18, 6144
  s_nop 0
  buffer_load_dwordx4 v8, s[32:35], s12 offen lds
  s_add_u32 m0, s18, 8192
  s_nop 0
  buffer_load_dwordx4 v8, s[32:35], s13 offen lds
  s_add_u32 m0, s18, 10240
  s_nop 0
  buffer_load_dwordx4 v8, s[32:35], s16 offen lds
  s_add_u32 m0, s18, 12288
  s_nop 0
  buffer_load_dwordx4 v8, s[32:35], s17 offen lds
  s_add_u32 m0, s18, 14336
  s_nop 0
  buffer_load_dwordx4 v8, s[32:35], s78 offen lds
  v_add_u32 v8, 0x20000, v8
  s_xor_b32 s18, s18, 0x10000
  s_add_u32 m0, s18, 0
  s_nop 0
  buffer_load_dwordx4 v8, s[32:35], 0 offen lds
  s_add_u32 m0, s18, 2048
  s_nop 0
  buffer_load_dwordx4 v8, s[32:35], s10 offen lds
  s_add_u32 m0, s18, 4096
  s_nop 0
  buffer_load_dwordx4 v8, s[32:35], s11 offen lds
  s_add_u32 m0, s18, 6144
  s_nop 0
  buffer_load_dwordx4 v8, s[32:35], s12 offen lds
  s_add_u32 m0, s18, 8192
  s_nop 0
  buffer_load_dwordx4 v8, s[32:35], s13 offen lds
  s_add_u32 m0, s18, 10240
  s_nop 0
  buffer_load_dwordx4 v8, s[32:35], s16 offen lds
  s_add_u32 m0, s18, 12288
  s_nop 0
  buffer_load_dwordx4 v8, s[32:35], s17 offen lds
  s_add_u32 m0, s18, 14336
  s_nop 0
  buffer_load_dwordx4 v8, s[32:35], s78 offen lds
  v_add_u32 v8, 0x20000, v8
  s_xor_b32 s18, s18, 0x8000
  s_and_b32 s60, s64, 2
  s_cmp_eq_u32 s60, 0
  s_mov_b32 s61, 0x10000
  s_cselect_b32 s60, 0x8000, s61
  s_xor_b32 s63, s60, 0x8000
  v_and_b32 v16, 15, v1
  v_lshrrev_b32 v17, 4, v1
  v_lshrrev_b32 v18, 2, v16
  v_lshl_add_u32 v18, v17, 2, v18
  v_and_b32 v19, 7, v18
  v_and_b32 v20, 3, v1
  v_lshlrev_b32 v20, 3, v20
  v_lshl_add_u32 v18, v18, 8, v20
  v_add_u32 v18, s60, v18
  v_xor_b32 v20, 0, v19
  v_lshl_add_u32 v27, v20, 5, v18
  v_xor_b32 v20, 1, v19
  v_lshl_add_u32 v28, v20, 5, v18
  v_xor_b32 v20, 2, v19
  v_lshl_add_u32 v29, v20, 5, v18
  v_xor_b32 v20, 3, v19
  v_lshl_add_u32 v30, v20, 5, v18
  v_xor_b32 v20, 4, v19
  v_lshl_add_u32 v5, v20, 5, v18
  v_xor_b32 v20, 5, v19
  v_lshl_add_u32 v6, v20, 5, v18
  v_xor_b32 v20, 6, v19
  v_lshl_add_u32 v21, v20, 5, v18
  v_xor_b32 v20, 7, v19
  v_lshl_add_u32 v2, v20, 5, v18
  v_xor_b32 v18, 0x8000, v18
  s_xor_b32 s73, s60, 0x3c000
  s_and_b32 s62, s59, 1
  s_lshl_b32 s62, s62, 2
  v_xor_b32 v19, s62, v19
  v_xor_b32 v20, 0, v19
  v_lshl_add_u32 v22, v20, 5, v18
  v_xor_b32 v20, 1, v19
  v_lshl_add_u32 v23, v20, 5, v18
  v_xor_b32 v20, 2, v19
  v_lshl_add_u32 v24, v20, 5, v18
  v_xor_b32 v20, 3, v19
  v_lshl_add_u32 v25, v20, 5, v18
  s_lshr_b32 s62, s59, 1
  s_lshl_b32 s62, s62, 13
  s_add_u32 s62, s62, 16384
  s_add_u32 s62, s62, s63
  v_add_u32 v26, s62, v14
  v_lshlrev_b32 v13, 3, v17
  v_lshl_add_u32 v10, v16, 10, v13
  s_and_b32 s62, s6, 1
  s_lshl_b32 s62, s62, 7
  s_lshl_b32 s61, s8, 8
  s_add_u32 s62, s62, s61
  v_add_u32 v13, s62, v13
  s_lshr_b32 s63, s6, 1
  s_lshl_b32 s63, s63, 2
  s_lshl_b32 s61, s7, 3
  s_add_u32 s63, s63, s61
  s_add_u32 s63, s63, s59
  s_lshl_b32 s63, s63, 14
  s_add_u32 s21, s63, s62
  s_mov_b32 s44, s4
  s_mov_b32 s45, s5
  s_mov_b32 s46, 0x200000
  s_mov_b32 s47, 0x20000
  buffer_load_dwordx2 v[240:241], v10, s[44:47], s21 offen offset:0
  buffer_load_dwordx2 v[242:243], v10, s[44:47], s21 offen offset:32
  buffer_load_dwordx2 v[244:245], v10, s[44:47], s21 offen offset:64
  buffer_load_dwordx2 v[246:247], v10, s[44:47], s21 offen offset:96
LF3_A_post:
  s_cmp_eq_u32 s77, 0
  s_cbranch_scc1 LF3_A_skip
  v_add_f32 v17, v128, v132
  v_mov_b32 v18, 0x5f800000
  v_cmp_nlt_f32 vcc, v17, v18
  v_mov_b32 v19, 131072
  v_mov_b32 v20, 1
  s_and_saveexec_b64 s[62:63], vcc
  ds_write_b32 v19, v20
  s_mov_b64 exec, s[62:63]
  v_rcp_f32 v16, v128
  v_rcp_f32 v17, v128
  s_lshl_b32 s60, s76, 13
  s_lshl_b32 s61, s57, 12
  s_add_u32 s60, s60, s61
  v_mul_f32 v64, v64, v16
  v_mul_f32 v65, v65, v16
  v_mul_f32 v66, v66, v16
  v_mul_f32 v67, v67, v16
  v_cvt_pk_bf16_f32 v180, v64, v65
  v_cvt_pk_bf16_f32 v181, v66, v67
  v_mul_f32 v72, v72, v16
  v_mul_f32 v73, v73, v16
  v_mul_f32 v74, v74, v16
  v_mul_f32 v75, v75, v16
  v_cvt_pk_bf16_f32 v182, v72, v73
  v_cvt_pk_bf16_f32 v183, v74, v75
  buffer_store_dwordx4 v[180:183], v14, s[52:55], s60 offen offset:0 sc1
  v_mul_f32 v80, v80, v16
  v_mul_f32 v81, v81, v16
  v_mul_f32 v82, v82, v16
  v_mul_f32 v83, v83, v16
  v_cvt_pk_bf16_f32 v184, v80, v81
  v_cvt_pk_bf16_f32 v185, v82, v83
  v_mul_f32 v88, v88, v16
  v_mul_f32 v89, v89, v16
  v_mul_f32 v90, v90, v16
  v_mul_f32 v91, v91, v16
  v_cvt_pk_bf16_f32 v186, v88, v89
  v_cvt_pk_bf16_f32 v187, v90, v91
  buffer_store_dwordx4 v[184:187], v14, s[52:55], s60 offen offset:1024 sc1
  v_mul_f32 v96, v96, v16
  v_mul_f32 v97, v97, v16
  v_mul_f32 v98, v98, v16
  v_mul_f32 v99, v99, v16
  v_cvt_pk_bf16_f32 v188, v96, v97
  v_cvt_pk_bf16_f32 v189, v98, v99
  v_mul_f32 v104, v104, v16
  v_mul_f32 v105, v105, v16
  v_mul_f32 v106, v106, v16
  v_mul_f32 v107, v107, v16
  v_cvt_pk_bf16_f32 v190, v104, v105
  v_cvt_pk_bf16_f32 v191, v106, v107
  buffer_store_dwordx4 v[188:191], v14, s[52:55], s60 offen offset:2048 sc1
  v_mul_f32 v112, v112, v16
  v_mul_f32 v113, v113, v16
  v_mul_f32 v114, v114, v16
  v_mul_f32 v115, v115, v16
  v_cvt_pk_bf16_f32 v192, v112, v113
  v_cvt_pk_bf16_f32 v193, v114, v115
  v_mul_f32 v120, v120, v16
  v_mul_f32 v121, v121, v16
  v_mul_f32 v122, v122, v16
  v_mul_f32 v123, v123, v16
  v_cvt_pk_bf16_f32 v194, v120, v121
  v_cvt_pk_bf16_f32 v195, v122, v123
  buffer_store_dwordx4 v[192:195], v14, s[52:55], s60 offen offset:3072 sc1
  v_rcp_f32 v16, v132
  v_rcp_f32 v17, v132
  s_lshl_b32 s60, s76, 13
  s_lshl_b32 s61, s57, 12
  s_add_u32 s60, s60, s61
  s_mov_b32 s61, 131072
  s_add_u32 s60, s60, s61
  v_mul_f32 v68, v68, v16
  v_mul_f32 v69, v69, v16
  v_mul_f32 v70, v70, v16
  v_mul_f32 v71, v71, v16
  v_cvt_pk_bf16_f32 v196, v68, v69
  v_cvt_pk_bf16_f32 v197, v70, v71
  v_mul_f32 v76, v76, v16
  v_mul_f32 v77, v77, v16
  v_mul_f32 v78, v78, v16
  v_mul_f32 v79, v79, v16
  v_cvt_pk_bf16_f32 v198, v76, v77
  v_cvt_pk_bf16_f32 v199, v78, v79
  buffer_store_dwordx4 v[196:199], v14, s[52:55], s60 offen offset:0 sc1
  v_mul_f32 v84, v84, v16
  v_mul_f32 v85, v85, v16
  v_mul_f32 v86, v86, v16
  v_mul_f32 v87, v87, v16
  v_cvt_pk_bf16_f32 v200, v84, v85
  v_cvt_pk_bf16_f32 v201, v86, v87
  v_mul_f32 v92, v92, v16
  v_mul_f32 v93, v93, v16
  v_mul_f32 v94, v94, v16
  v_mul_f32 v95, v95, v16
  v_cvt_pk_bf16_f32 v202, v92, v93
  v_cvt_pk_bf16_f32 v203, v94, v95
  buffer_store_dwordx4 v[200:203], v14, s[52:55], s60 offen offset:1024 sc1
  v_mul_f32 v100, v100, v16
  v_mul_f32 v101, v101, v16
  v_mul_f32 v102, v102, v16
  v_mul_f32 v103, v103, v16
  v_cvt_pk_bf16_f32 v204, v100, v101
  v_cvt_pk_bf16_f32 v205, v102, v103
  v_mul_f32 v108, v108, v16
  v_mul_f32 v109, v109, v16
  v_mul_f32 v110, v110, v16
  v_mul_f32 v111, v111, v16
  v_cvt_pk_bf16_f32 v206, v108, v109
  v_cvt_pk_bf16_f32 v207, v110, v111
  buffer_store_dwordx4 v[204:207], v14, s[52:55], s60 offen offset:2048 sc1
  v_mul_f32 v116, v116, v16
  v_mul_f32 v117, v117, v16
  v_mul_f32 v118, v118, v16
  v_mul_f32 v119, v119, v16
  v_cvt_pk_bf16_f32 v208, v116, v117
  v_cvt_pk_bf16_f32 v209, v118, v119
  v_mul_f32 v124, v124, v16
  v_mul_f32 v125, v125, v16
  v_mul_f32 v126, v126, v16
  v_mul_f32 v127, v127, v16
  v_cvt_pk_bf16_f32 v210, v124, v125
  v_cvt_pk_bf16_f32 v211, v126, v127
  buffer_store_dwordx4 v[208:211], v14, s[52:55], s60 offen offset:3072 sc1
  s_cmp_eq_u32 s58, 7
  s_cbranch_scc1 LF_armed
  s_cmp_eq_u32 s59, s6
  s_cbranch_scc1 LF_armed
  s_add_u32 s44, s30, 0x3900000
  s_addc_u32 s45, s31, 0
  s_mov_b32 s46, 0x800000
  s_mov_b32 s47, 0x20000
  s_lshl_b32 s60, s9, 2
  s_add_u32 s60, s60, s6
  s_lshl_b32 s60, s60, 2
  s_add_u32 s60, s60, s59
  s_lshl_b32 s60, s60, 13
  s_add_u32 s61, s60, 4096
  v_mov_b32 v244, -1
  v_mov_b32 v245, -1
  v_mov_b32 v246, -1
  v_mov_b32 v247, -1
  buffer_store_dwordx4 v[244:247], v14, s[44:47], s60 offen offset:0 sc1
  buffer_store_dwordx4 v[244:247], v14, s[44:47], s60 offen offset:1024 sc1
  buffer_store_dwordx4 v[244:247], v14, s[44:47], s60 offen offset:2048 sc1
  buffer_store_dwordx4 v[244:247], v14, s[44:47], s60 offen offset:3072 sc1
  buffer_store_dwordx4 v[244:247], v14, s[44:47], s61 offen offset:0 sc1
  buffer_store_dwordx4 v[244:247], v14, s[44:47], s61 offen offset:1024 sc1
  buffer_store_dwordx4 v[244:247], v14, s[44:47], s61 offen offset:2048 sc1
  buffer_store_dwordx4 v[244:247], v14, s[44:47], s61 offen offset:3072 sc1
  s_add_u32 s44, s30, 0x4900000
  s_addc_u32 s45, s31, 0
  s_mov_b32 s46, 0x800000
  s_mov_b32 s47, 0x20000
  buffer_store_dwordx4 v[244:247], v14, s[44:47], s60 offen offset:0 sc1
  buffer_store_dwordx4 v[244:247], v14, s[44:47], s60 offen offset:1024 sc1
  buffer_store_dwordx4 v[244:247], v14, s[44:47], s60 offen offset:2048 sc1
  buffer_store_dwordx4 v[244:247], v14, s[44:47], s60 offen offset:3072 sc1
  buffer_store_dwordx4 v[244:247], v14, s[44:47], s61 offen offset:0 sc1
  buffer_store_dwordx4 v[244:247], v14, s[44:47], s61 offen offset:1024 sc1
  buffer_store_dwordx4 v[244:247], v14, s[44:47], s61 offen offset:2048 sc1
  buffer_store_dwordx4 v[244:247], v14, s[44:47], s61 offen offset:3072 sc1
LF_armed:
  s_cmp_ge_u32 s58, 4
  s_cbranch_scc1 LF_nowarm2
  s_lshl_b32 s62, s2, 2
  s_add_u32 s62, s62, s59
  v_lshlrev_b32 v16, 7, v1
  s_lshl_b32 s63, s62, 13
  buffer_load_dword v31, v16, s[36:39], s63 offen
  v_min_u32 v16, 3456, v16
  s_mul_i32 s63, s62, 3584
  buffer_load_dword v31, v16, s[32:35], s63 offen
LF_nowarm2:
  s_lshl_b32 s62, s7, 2
  s_add_u32 s62, s62, s59
  s_mul_i32 s62, s62, 114688
  s_mul_i32 s63, s6, 14336
  s_add_u32 s62, s62, s63
  v_add_u32 v9, s62, v14
  s_mov_b32 s19, 57344
  s_mov_b32 s79, 0
  s_mov_b32 s75, 8
  s_mov_b32 s77, 0
LF3_A_skip:
  s_cmp_gt_u32 s71, 8
  s_cbranch_scc1 LF3_A_hdone
  s_cmp_lg_u32 s79, 0
  s_cbranch_scc1 LF3_A_hnext
  s_waitcnt vmcnt(16)
  v_cmp_gt_u32 vcc, 1, v11
  s_nop 0
  s_cbranch_vccz L_poll4_ok
  s_mov_b32 s3, 0x10000
  s_mov_b32 s75, 0
  s_mov_b32 s74, 0
L_poll4:
  s_sleep 2
  buffer_load_dword v11, v12, s[88:91], 0 offen sc1
  s_waitcnt vmcnt(0)
  v_cmp_gt_u32 vcc, 1, v11
  s_sub_u32 s3, s3, 1
  s_cbranch_scc1 L_poll4_ok
  s_cbranch_vccnz L_poll4
L_poll4_ok:
  s_and_b32 s62, s59, 1
  s_lshl_b32 s63, s62, 2
  v_lshrrev_b32 v17, 4, v1
  v_or_b32 v18, s63, v17
  v_lshlrev_b32 v18, 1, v18
  v_and_b32 v16, 15, v1
  v_xor_b32 v16, v16, v18
  v_lshlrev_b32 v16, 4, v16
  v_lshl_add_u32 v16, v17, 10, v16
  s_lshr_b32 s63, s59, 1
  s_lshl_b32 s63, s63, 3
  s_add_u32 s62, s62, s63
  s_lshl_b32 s63, s62, 12
  s_mul_i32 s61, s6, 458752
  s_add_u32 s63, s63, s61
  s_lshl_b32 s61, s8, 8
  s_add_u32 s63, s63, s61
  s_add_u32 s63, s63, 393216
  s_lshl_b32 s62, s62, 10
  s_add_u32 m0, s62, 147456
  s_nop 0
  buffer_load_dwordx4 v16, s[32:35], s63 offen lds
  s_add_u32 s63, s63, 8192
  s_add_u32 m0, s62, 149504
  s_nop 0
  buffer_load_dwordx4 v16, s[32:35], s63 offen lds
  s_add_u32 s63, s63, 8192
  s_add_u32 m0, s62, 151552
  s_nop 0
  buffer_load_dwordx4 v16, s[32:35], s63 offen lds
  s_add_u32 s63, s63, 8192
  s_add_u32 m0, s62, 153600
  s_nop 0
  buffer_load_dwordx4 v16, s[32:35], s63 offen lds
  s_add_u32 s63, s63, 8192
  s_mov_b32 s79, 1
LF3_A_hnext:
  s_cmp_eq_u32 s79, 1
  s_cbranch_scc1 LF3_A_h0
  s_cmp_eq_u32 s79, 2
  s_cbranch_scc1 LF3_A_h1
  s_cmp_eq_u32 s79, 3
  s_cbranch_scc1 LF3_A_h2
  s_cmp_eq_u32 s79, 4
  s_cbranch_scc1 LF3_A_h3
  s_cmp_eq_u32 s79, 5
  s_cbranch_scc1 LF3_A_h4
  s_cmp_eq_u32 s79, 6
  s_cbranch_scc1 LF3_A_h5
  s_cmp_eq_u32 s79, 7
  s_cbranch_scc1 LF3_A_h6
  s_branch LF3_A_hdone
LF3_A_h0:
  buffer_load_dwordx4 v[64:67], v9, s[40:43], 0 offen offset:0 sc1
  buffer_load_dwordx4 v[68:71], v9, s[40:43], s19 offen offset:0 sc1
  buffer_load_dwordx4 v[72:75], v9, s[40:43], 0 offen offset:1024 sc1
  buffer_load_dwordx4 v[76:79], v9, s[40:43], s19 offen offset:1024 sc1
  v_add_u32 v9, 2048, v9
  s_mov_b32 s79, 2
  s_add_u32 s75, s75, 4
  s_cmp_gt_u32 s71, 6
  s_cbranch_scc1 LF3_A_hdone
LF3_A_h1:
  buffer_load_dwordx4 v[80:83], v9, s[40:43], 0 offen offset:0 sc1
  buffer_load_dwordx4 v[84:87], v9, s[40:43], s19 offen offset:0 sc1
  buffer_load_dwordx4 v[88:91], v9, s[40:43], 0 offen offset:1024 sc1
  buffer_load_dwordx4 v[92:95], v9, s[40:43], s19 offen offset:1024 sc1
  v_add_u32 v9, 2048, v9
  s_mov_b32 s79, 3
  s_add_u32 s75, s75, 4
  s_cmp_gt_u32 s71, 5
  s_cbranch_scc1 LF3_A_hdone
LF3_A_h2:
  buffer_load_dwordx4 v[96:99], v9, s[40:43], 0 offen offset:0 sc1
  buffer_load_dwordx4 v[100:103], v9, s[40:43], s19 offen offset:0 sc1
  buffer_load_dwordx4 v[104:107], v9, s[40:43], 0 offen offset:1024 sc1
  buffer_load_dwordx4 v[108:111], v9, s[40:43], s19 offen offset:1024 sc1
  v_add_u32 v9, 2048, v9
  s_mov_b32 s79, 4
  s_add_u32 s75, s75, 4
  s_cmp_gt_u32 s71, 4
  s_cbranch_scc1 LF3_A_hdone
LF3_A_h3:
  buffer_load_dwordx4 v[112:115], v9, s[40:43], 0 offen offset:0 sc1
  buffer_load_dwordx4 v[116:119], v9, s[40:43], s19 offen offset:0 sc1
  buffer_load_dwordx4 v[120:123], v9, s[40:43], 0 offen offset:1024 sc1
  buffer_load_dwordx4 v[124:127], v9, s[40:43], s19 offen offset:1024 sc1
  v_add_u32 v9, 2048, v9
  s_mov_b32 s79, 5
  s_add_u32 s75, s75, 4
  s_cmp_gt_u32 s71, 3
  s_cbranch_scc1 LF3_A_hdone
LF3_A_h4:
  buffer_load_dwordx4 v[128:131], v9, s[40:43], 0 offen offset:0 sc1
  buffer_load_dwordx4 v[132:135], v9, s[40:43], s19 offen offset:0 sc1
  buffer_load_dwordx4 v[136:139], v9, s[40:43], 0 offen offset:1024 sc1
  buffer_load_dwordx4 v[140:143], v9, s[40:43], s19 offen offset:1024 sc1
  v_add_u32 v9, 2048, v9
  s_mov_b32 s79, 6
  s_add_u32 s75, s75, 4
  s_cmp_gt_u32 s71, 2
  s_cbranch_scc1 LF3_A_hdone
LF3_A_h5:
  buffer_load_dwordx4 v[144:147], v9, s[40:43], 0 offen offset:0 sc1
  buffer_load_dwordx4 v[148:151], v9, s[40:43], s19 offen offset:0 sc1
  buffer_load_dwordx4 v[152:155], v9, s[40:43], 0 offen offset:1024 sc1
  buffer_load_dwordx4 v[156:159], v9, s[40:43], s19 offen offset:1024 sc1
  v_add_u32 v9, 2048, v9
  s_mov_b32 s79, 7
  s_add_u32 s75, s75, 4
  s_cmp_gt_u32 s71, 1
  s_cbranch_scc1 LF3_A_hdone
LF3_A_h6:
  buffer_load_dwordx4 v[160:163], v9, s[40:43], 0 offen offset:0 sc1
  buffer_load_dwordx4 v[164:167], v9, s[40:43], s19 offen offset:0 sc1
  buffer_load_dwordx4 v[168:171], v9, s[40:43], 0 offen offset:1024 sc1
  buffer_load_dwordx4 v[172:175], v9, s[40:43], s19 offen offset:1024 sc1
  v_add_u32 v9, 2048, v9
  s_mov_b32 s79, 8
  s_add_u32 s75, s75, 4
LF3_A_hdone:
  s_sub_u32 s71, s71, 1
  s_cmp_lg_u32 s71, 0
  s_cbranch_scc1 LF3_A_ld
  s_mov_b32 s74, 1
  s_cmp_ge_u32 s75, 20
  s_cbranch_scc1 LF3_A_j20
  s_cmp_ge_u32 s75, 16
  s_cbranch_scc1 LF3_A_j16
  s_mov_b32 s74, 0
LF3_A_j16:
  s_waitcnt vmcnt(12)
LF3_A_j20:
  s_waitcnt vmcnt(20)
  s_branch LF3_join
LF3_A_s_go:
  s_cmp_lg_u32 s69, 98304
  s_cbranch_scc1 LF3_A_s_a
  v_mov_b32 v16, 1
  s_lshl_b32 s60, s2, 10
  s_cmp_eq_u32 s56, 0
  s_cselect_b32 s60, s60, 0x40000
  buffer_store_dword v16, off, s[88:91], s60 offset:128 sc1
  buffer_store_dword v16, off, s[88:91], s60 offset:0 sc1
LF3_A_s_a:
  s_and_b32 s60, s2, 31
  s_lshl_b32 s60, s60, 10
  s_cmp_lg_u32 s69, 229376
  s_cbranch_scc1 LF3_A_s_b
  v_and_b32 v23, 7, v1
  v_lshlrev_b32 v23, 15, v23
  buffer_load_dword v22, v23, s[88:91], s60 offen sc1
LF3_A_s_b:
  s_cmp_lg_u32 s69, 262144
  s_cbranch_scc1 LF3_A_s_c
  s_waitcnt vmcnt(8)
  v_cmp_gt_u32 vcc, 1, v22
  s_nop 0
  s_cbranch_vccz L_poll5_ok
  s_mov_b32 s3, 0x10000
L_poll5:
  s_sleep 2
  buffer_load_dword v22, v23, s[88:91], s60 offen sc1
  s_waitcnt vmcnt(0)
  v_cmp_gt_u32 vcc, 1, v22
  s_sub_u32 s3, s3, 1
  s_cbranch_scc1 L_poll5_ok
  s_cbranch_vccnz L_poll5
L_poll5_ok:
LF3_A_s_c:
  s_branch LF3_A_s_ret
LF3_A_d1_s_go:
  s_cmp_lg_u32 s69, 98304
  s_cbranch_scc1 LF3_A_d1_s_a
  v_mov_b32 v16, 1
  s_lshl_b32 s60, s2, 10
  s_cmp_eq_u32 s56, 0
  s_cselect_b32 s60, s60, 0x40000
  buffer_store_dword v16, off, s[88:91], s60 offset:128 sc1
  buffer_store_dword v16, off, s[88:91], s60 offset:0 sc1
LF3_A_d1_s_a:
  s_and_b32 s60, s2, 31
  s_lshl_b32 s60, s60, 10
  s_cmp_lg_u32 s69, 229376
  s_cbranch_scc1 LF3_A_d1_s_b
  v_and_b32 v23, 7, v1
  v_lshlrev_b32 v23, 15, v23
  buffer_load_dword v22, v23, s[88:91], s60 offen sc1
LF3_A_d1_s_b:
  s_cmp_lg_u32 s69, 262144
  s_cbranch_scc1 LF3_A_d1_s_c
  s_waitcnt vmcnt(8)
  v_cmp_gt_u32 vcc, 1, v22
  s_nop 0
  s_cbranch_vccz L_poll6_ok
  s_mov_b32 s3, 0x10000
L_poll6:
  s_sleep 2
  buffer_load_dword v22, v23, s[88:91], s60 offen sc1
  s_waitcnt vmcnt(0)
  v_cmp_gt_u32 vcc, 1, v22
  s_sub_u32 s3, s3, 1
  s_cbranch_scc1 L_poll6_ok
  s_cbranch_vccnz L_poll6
L_poll6_ok:
LF3_A_d1_s_c:
  s_branch LF3_A_d1_s_ret
LF3_A_lds_go:
  s_cmp_lg_u32 s69, 98304
  s_cbranch_scc1 LF3_A_lds_a
  v_mov_b32 v16, 1
  s_lshl_b32 s60, s2, 10
  s_cmp_eq_u32 s56, 0
  s_cselect_b32 s60, s60, 0x40000
  buffer_store_dword v16, off, s[88:91], s60 offset:128 sc1
  buffer_store_dword v16, off, s[88:91], s60 offset:0 sc1
LF3_A_lds_a:
  s_and_b32 s60, s2, 31
  s_lshl_b32 s60, s60, 10
  s_cmp_lg_u32 s69, 229376
  s_cbranch_scc1 LF3_A_lds_b
  v_and_b32 v23, 7, v1
  v_lshlrev_b32 v23, 15, v23
  buffer_load_dword v22, v23, s[88:91], s60 offen sc1
LF3_A_lds_b:
  s_cmp_lg_u32 s69, 262144
  s_cbranch_scc1 LF3_A_lds_c
  s_waitcnt vmcnt(8)
  v_cmp_gt_u32 vcc, 1, v22
  s_nop 0
  s_cbranch_vccz L_poll7_ok
  s_mov_b32 s3, 0x10000
L_poll7:
  s_sleep 2
  buffer_load_dword v22, v23, s[88:91], s60 offen sc1
  s_waitcnt vmcnt(0)
  v_cmp_gt_u32 vcc, 1, v22
  s_sub_u32 s3, s3, 1
  s_cbranch_scc1 L_poll7_ok
  s_cbranch_vccnz L_poll7
L_poll7_ok:
LF3_A_lds_c:
  s_branch LF3_A_lds_ret
LF3_B:
  s_setprio 1
  s_cmp_eq_u32 s60, 1
  s_cbranch_scc1 LF3_B_drain0
  s_sub_u32 s65, s65, 1
  s_cbranch_scc1 LF3_B_diag1
  .p2align 3
LF3_B_loop:
  v_mfma_f32_16x16x32_bf16 v[136:139], v[180:183], v[32:35], v[168:171]
  ds_read_b128 v[212:215], v3 offset:16384
  v_mfma_f32_16x16x32_bf16 v[136:139], v[184:187], v[36:39], v[136:139]
  v_exp_f32 v149, v149
  v_mfma_f32_16x16x32_bf16 v[136:139], v[188:191], v[40:43], v[136:139]
  ds_read_b128 v[216:219], v3 offset:20480
  v_cvt_pk_bf16_f32 v158, v148, v149
  v_mfma_f32_16x16x32_bf16 v[136:139], v[192:195], v[44:47], v[136:139]
  v_exp_f32 v150, v150
  v_mfma_f32_16x16x32_bf16 v[140:143], v[180:183], v[48:51], v[172:175]
  ds_read_b128 v[220:223], v3 offset:17408
  s_waitcnt lgkmcnt(3)
  v_mfma_f32_16x16x32_bf16 v[140:143], v[184:187], v[52:55], v[140:143]
  v_exp_f32 v151, v151
  v_mfma_f32_16x16x32_bf16 v[140:143], v[188:191], v[56:59], v[140:143]
  ds_read_b128 v[224:227], v3 offset:21504
  v_cvt_pk_bf16_f32 v159, v150, v151
  v_mfma_f32_16x16x32_bf16 v[140:143], v[192:195], v[60:63], v[140:143]
  v_exp_f32 v136, v136
  v_mfma_f32_16x16x32_bf16 v[144:147], v[196:199], v[32:35], v[168:171]
  ds_read_b128 v[228:231], v3 offset:18432
  v_xor_b32 v2, s66, v2
  v_mfma_f32_16x16x32_bf16 v[144:147], v[200:203], v[36:39], v[144:147]
  v_exp_f32 v137, v137
  v_mfma_f32_16x16x32_bf16 v[144:147], v[204:207], v[40:43], v[144:147]
  ds_read_b128 v[232:235], v3 offset:22528
  v_cvt_pk_bf16_f32 v160, v136, v137
  v_mfma_f32_16x16x32_bf16 v[144:147], v[208:211], v[44:47], v[144:147]
  v_exp_f32 v138, v138
  v_mfma_f32_16x16x32_bf16 v[148:151], v[196:199], v[48:51], v[172:175]
  ds_read_b128 v[236:239], v3 offset:19456
  s_xor_b32 s66, s66, 0x18000
  v_mfma_f32_16x16x32_bf16 v[148:151], v[200:203], v[52:55], v[148:151]
  v_exp_f32 v139, v139
  v_mfma_f32_16x16x32_bf16 v[148:151], v[204:207], v[56:59], v[148:151]
  ds_read_b128 v[240:243], v3 offset:23552
  v_cvt_pk_bf16_f32 v161, v138, v139
  v_mfma_f32_16x16x32_bf16 v[148:151], v[208:211], v[60:63], v[148:151]
  v_exp_f32 v140, v140
  v_mfma_f32_16x16x32_bf16 v[128:131], v[176:179], v[152:155], v[128:131]
  s_waitcnt vmcnt(0) lgkmcnt(2)
  s_barrier
  v_mfma_f32_16x16x32_bf16 v[132:135], v[176:179], v[156:159], v[132:135]
  v_exp_f32 v141, v141
  v_mfma_f32_16x16x32_bf16 v[64:67], v[212:215], v[152:155], v[64:67]
  ds_read_b128 v[180:183], v2 offset:0
  v_cvt_pk_bf16_f32 v164, v140, v141
  v_mfma_f32_16x16x32_bf16 v[68:71], v[212:215], v[156:159], v[68:71]
  v_exp_f32 v142, v142
  v_mfma_f32_16x16x32_bf16 v[76:79], v[216:219], v[156:159], v[76:79]
  ds_read_b128 v[184:187], v2 offset:1024
  v_mfma_f32_16x16x32_bf16 v[72:75], v[216:219], v[152:155], v[72:75]
  v_exp_f32 v143, v143
  v_mfma_f32_16x16x32_bf16 v[80:83], v[220:223], v[152:155], v[80:83]
  ds_read_b128 v[188:191], v2 offset:2048
  v_cvt_pk_bf16_f32 v165, v142, v143
  v_mfma_f32_16x16x32_bf16 v[84:87], v[220:223], v[156:159], v[84:87]
  v_exp_f32 v144, v144
  v_mfma_f32_16x16x32_bf16 v[92:95], v[224:227], v[156:159], v[92:95]
  ds_read_b128 v[192:195], v2 offset:3072
  s_waitcnt lgkmcnt(4)
  v_mfma_f32_16x16x32_bf16 v[88:91], v[224:227], v[152:155], v[88:91]
  v_exp_f32 v145, v145
  v_mfma_f32_16x16x32_bf16 v[96:99], v[228:231], v[152:155], v[96:99]
  ds_read_b128 v[196:199], v2 offset:4096
  v_cvt_pk_bf16_f32 v162, v144, v145
  v_mfma_f32_16x16x32_bf16 v[100:103], v[228:231], v[156:159], v[100:103]
  v_exp_f32 v146, v146
  v_mfma_f32_16x16x32_bf16 v[108:111], v[232:235], v[156:159], v[108:111]
  ds_read_b128 v[200:203], v2 offset:5120
  s_sub_u32 s65, s65, 1
  v_mfma_f32_16x16x32_bf16 v[104:107], v[232:235], v[152:155], v[104:107]
  v_exp_f32 v147, v147
  v_mfma_f32_16x16x32_bf16 v[112:115], v[236:239], v[152:155], v[112:115]
  ds_read_b128 v[204:207], v2 offset:6144
  v_cvt_pk_bf16_f32 v163, v146, v147
  v_mfma_f32_16x16x32_bf16 v[116:119], v[236:239], v[156:159], v[116:119]
  v_exp_f32 v148, v148
  v_mfma_f32_16x16x32_bf16 v[124:127], v[240:243], v[156:159], v[124:127]
  ds_read_b128 v[208:211], v2 offset:7168
  v_mfma_f32_16x16x32_bf16 v[120:123], v[240:243], v[152:155], v[120:123]
  s_waitcnt lgkmcnt(4)
  s_cbranch_scc1 LF3_B_diag0
  v_mfma_f32_16x16x32_bf16 v[136:139], v[180:183], v[32:35], v[168:171]
  ds_read_b128 v[212:215], v3 offset:24576
  v_mfma_f32_16x16x32_bf16 v[136:139], v[184:187], v[36:39], v[136:139]
  v_exp_f32 v149, v149
  v_mfma_f32_16x16x32_bf16 v[136:139], v[188:191], v[40:43], v[136:139]
  ds_read_b128 v[216:219], v3 offset:28672
  v_cvt_pk_bf16_f32 v166, v148, v149
  v_mfma_f32_16x16x32_bf16 v[136:139], v[192:195], v[44:47], v[136:139]
  v_exp_f32 v150, v150
  v_mfma_f32_16x16x32_bf16 v[140:143], v[180:183], v[48:51], v[172:175]
  ds_read_b128 v[220:223], v3 offset:25600
  s_waitcnt lgkmcnt(3)
  v_mfma_f32_16x16x32_bf16 v[140:143], v[184:187], v[52:55], v[140:143]
  v_exp_f32 v151, v151
  v_mfma_f32_16x16x32_bf16 v[140:143], v[188:191], v[56:59], v[140:143]
  ds_read_b128 v[224:227], v3 offset:29696
  v_cvt_pk_bf16_f32 v167, v150, v151
  v_mfma_f32_16x16x32_bf16 v[140:143], v[192:195], v[60:63], v[140:143]
  v_exp_f32 v136, v136
  v_mfma_f32_16x16x32_bf16 v[144:147], v[196:199], v[32:35], v[168:171]
  ds_read_b128 v[228:231], v3 offset:26624
  v_mfma_f32_16x16x32_bf16 v[144:147], v[200:203], v[36:39], v[144:147]
  v_exp_f32 v137, v137
  v_mfma_f32_16x16x32_bf16 v[144:147], v[204:207], v[40:43], v[144:147]
  ds_read_b128 v[232:235], v3 offset:30720
  v_cvt_pk_bf16_f32 v152, v136, v137
  v_mfma_f32_16x16x32_bf16 v[144:147], v[208:211], v[44:47], v[144:147]
  v_exp_f32 v138, v138
  v_mfma_f32_16x16x32_bf16 v[148:151], v[196:199], v[48:51], v[172:175]
  ds_read_b128 v[236:239], v3 offset:27648
  v_mfma_f32_16x16x32_bf16 v[148:151], v[200:203], v[52:55], v[148:151]
  v_exp_f32 v139, v139
  v_mfma_f32_16x16x32_bf16 v[148:151], v[204:207], v[56:59], v[148:151]
  ds_read_b128 v[240:243], v3 offset:31744
  v_cvt_pk_bf16_f32 v153, v138, v139
  v_mfma_f32_16x16x32_bf16 v[148:151], v[208:211], v[60:63], v[148:151]
  v_exp_f32 v140, v140
  v_mfma_f32_16x16x32_bf16 v[128:131], v[176:179], v[160:163], v[128:131]
  s_waitcnt lgkmcnt(2)
  v_mfma_f32_16x16x32_bf16 v[132:135], v[176:179], v[164:167], v[132:135]
  v_exp_f32 v141, v141
  v_mfma_f32_16x16x32_bf16 v[64:67], v[212:215], v[160:163], v[64:67]
  ds_read_b128 v[180:183], v2 offset:8192
  v_cvt_pk_bf16_f32 v156, v140, v141
  v_mfma_f32_16x16x32_bf16 v[68:71], v[212:215], v[164:167], v[68:71]
  v_exp_f32 v142, v142
  v_mfma_f32_16x16x32_bf16 v[76:79], v[216:219], v[164:167], v[76:79]
  ds_read_b128 v[184:187], v2 offset:9216
  v_mfma_f32_16x16x32_bf16 v[72:75], v[216:219], v[160:163], v[72:75]
  v_exp_f32 v143, v143
  v_mfma_f32_16x16x32_bf16 v[80:83], v[220:223], v[160:163], v[80:83]
  ds_read_b128 v[188:191], v2 offset:10240
  v_cvt_pk_bf16_f32 v157, v142, v143
  v_mfma_f32_16x16x32_bf16 v[84:87], v[220:223], v[164:167], v[84:87]
  v_exp_f32 v144, v144
  v_mfma_f32_16x16x32_bf16 v[92:95], v[224:227], v[164:167], v[92:95]
  ds_read_b128 v[192:195], v2 offset:11264
  s_waitcnt lgkmcnt(4)
  v_mfma_f32_16x16x32_bf16 v[88:91], v[224:227], v[160:163], v[88:91]
  v_exp_f32 v145, v145
  v_mfma_f32_16x16x32_bf16 v[96:99], v[228:231], v[160:163], v[96:99]
  ds_read_b128 v[196:199], v2 offset:12288
  v_cvt_pk_bf16_f32 v154, v144, v145
  v_mfma_f32_16x16x32_bf16 v[100:103], v[228:231], v[164:167], v[100:103]
  v_exp_f32 v146, v146
  v_mfma_f32_16x16x32_bf16 v[108:111], v[232:235], v[164:167], v[108:111]
  ds_read_b128 v[200:203], v2 offset:13312
  s_sub_u32 s65, s65, 1
  v_mfma_f32_16x16x32_bf16 v[104:107], v[232:235], v[160:163], v[104:107]
  v_exp_f32 v147, v147
  v_mfma_f32_16x16x32_bf16 v[112:115], v[236:239], v[160:163], v[112:115]
  ds_read_b128 v[204:207], v2 offset:14336
  v_cvt_pk_bf16_f32 v155, v146, v147
  v_mfma_f32_16x16x32_bf16 v[116:119], v[236:239], v[164:167], v[116:119]
  v_exp_f32 v148, v148
  v_mfma_f32_16x16x32_bf16 v[124:127], v[240:243], v[164:167], v[124:127]
  ds_read_b128 v[208:211], v2 offset:15360
  v_mov_b32 v3, v2
  v_mfma_f32_16x16x32_bf16 v[120:123], v[240:243], v[160:163], v[120:123]
  s_waitcnt lgkmcnt(4)
  s_cbranch_scc0 LF3_B_loop
LF3_B_diag1:
  v_mfma_f32_16x16x32_bf16 v[136:139], v[180:183], v[32:35], v[168:171]
  ds_read_b128 v[212:215], v3 offset:16384
  v_mfma_f32_16x16x32_bf16 v[136:139], v[184:187], v[36:39], v[136:139]
  ds_read_b128 v[216:219], v3 offset:20480
  v_exp_f32 v149, v149
  v_mfma_f32_16x16x32_bf16 v[136:139], v[188:191], v[40:43], v[136:139]
  ds_read_b128 v[220:223], v3 offset:17408
  v_cvt_pk_bf16_f32 v158, v148, v149
  v_mfma_f32_16x16x32_bf16 v[136:139], v[192:195], v[44:47], v[136:139]
  ds_read_b128 v[224:227], v3 offset:21504
  v_exp_f32 v150, v150
  v_mfma_f32_16x16x32_bf16 v[140:143], v[180:183], v[48:51], v[172:175]
  ds_read_b128 v[228:231], v3 offset:18432
  s_waitcnt lgkmcnt(5)
  v_mfma_f32_16x16x32_bf16 v[140:143], v[184:187], v[52:55], v[140:143]
  ds_read_b128 v[232:235], v3 offset:22528
  v_exp_f32 v151, v151
  v_mfma_f32_16x16x32_bf16 v[140:143], v[188:191], v[56:59], v[140:143]
  ds_read_b128 v[236:239], v3 offset:19456
  v_cvt_pk_bf16_f32 v159, v150, v151
  v_mfma_f32_16x16x32_bf16 v[140:143], v[192:195], v[60:63], v[140:143]
  ds_read_b128 v[240:243], v3 offset:23552
  v_cndmask_b32 v136, v136, v7, s[80:81]
  v_cndmask_b32 v137, v137, v7, s[82:83]
  v_cndmask_b32 v138, v138, v7, s[84:85]
  v_cndmask_b32 v139, v139, v7, s[86:87]
  v_mfma_f32_16x16x32_bf16 v[148:151], v[196:199], v[48:51], v[172:175]
  v_exp_f32 v136, v136
  v_mfma_f32_16x16x32_bf16 v[148:151], v[200:203], v[52:55], v[148:151]
  v_exp_f32 v137, v137
  v_mfma_f32_16x16x32_bf16 v[148:151], v[204:207], v[56:59], v[148:151]
  v_cvt_pk_bf16_f32 v160, v136, v137
  v_mfma_f32_16x16x32_bf16 v[148:151], v[208:211], v[60:63], v[148:151]
  v_exp_f32 v138, v138
  v_mfma_f32_16x16x32_bf16 v[128:131], v[176:179], v[152:155], v[128:131]
  s_waitcnt vmcnt(0) lgkmcnt(2)
  s_cmp_eq_u32 s59, 3
  s_cbranch_scc1 LF3_B_d1_nobar
  s_barrier
LF3_B_d1_nobar:
  v_mfma_f32_16x16x32_bf16 v[132:135], v[176:179], v[156:159], v[132:135]
  v_exp_f32 v139, v139
  v_mfma_f32_16x16x32_bf16 v[64:67], v[212:215], v[152:155], v[64:67]
  v_cvt_pk_bf16_f32 v161, v138, v139
  v_mfma_f32_16x16x32_bf16 v[68:71], v[212:215], v[156:159], v[68:71]
  v_exp_f32 v140, v140
  v_mfma_f32_16x16x32_bf16 v[76:79], v[216:219], v[156:159], v[76:79]
  v_mfma_f32_16x16x32_bf16 v[72:75], v[216:219], v[152:155], v[72:75]
  v_exp_f32 v141, v141
  v_mfma_f32_16x16x32_bf16 v[80:83], v[220:223], v[152:155], v[80:83]
  v_cvt_pk_bf16_f32 v164, v140, v141
  v_mfma_f32_16x16x32_bf16 v[84:87], v[220:223], v[156:159], v[84:87]
  v_exp_f32 v142, v142
  v_mfma_f32_16x16x32_bf16 v[92:95], v[224:227], v[156:159], v[92:95]
  s_waitcnt lgkmcnt(0)
  v_mfma_f32_16x16x32_bf16 v[88:91], v[224:227], v[152:155], v[88:91]
  v_exp_f32 v143, v143
  v_mfma_f32_16x16x32_bf16 v[96:99], v[228:231], v[152:155], v[96:99]
  v_cvt_pk_bf16_f32 v165, v142, v143
  v_mfma_f32_16x16x32_bf16 v[100:103], v[228:231], v[156:159], v[100:103]
  v_mov_b32 v162, 0
  v_mfma_f32_16x16x32_bf16 v[108:111], v[232:235], v[156:159], v[108:111]
  v_mov_b32 v163, 0
  v_mfma_f32_16x16x32_bf16 v[104:107], v[232:235], v[152:155], v[104:107]
  v_mfma_f32_16x16x32_bf16 v[112:115], v[236:239], v[152:155], v[112:115]
  v_cndmask_b32 v148, v148, v7, s[80:81]
  v_cndmask_b32 v149, v149, v7, s[82:83]
  v_cndmask_b32 v150, v150, v7, s[84:85]
  v_cndmask_b32 v151, v151, v7, s[86:87]
  v_mfma_f32_16x16x32_bf16 v[116:119], v[236:239], v[156:159], v[116:119]
  v_exp_f32 v148, v148
  v_mfma_f32_16x16x32_bf16 v[124:127], v[240:243], v[156:159], v[124:127]
  v_mfma_f32_16x16x32_bf16 v[120:123], v[240:243], v[152:155], v[120:123]
  ds_read_b128 v[212:215], v3 offset:24576
  ds_read_b128 v[216:219], v3 offset:28672
  ds_read_b128 v[220:223], v3 offset:25600
  ds_read_b128 v[224:227], v3 offset:29696
  ds_read_b128 v[228:231], v3 offset:26624
  ds_read_b128 v[232:235], v3 offset:30720
  ds_read_b128 v[236:239], v3 offset:27648
  ds_read_b128 v[240:243], v3 offset:31744
  v_exp_f32 v149, v149
  s_nop 0
  v_cvt_pk_bf16_f32 v166, v148, v149
  v_exp_f32 v150, v150
  v_exp_f32 v151, v151
  s_nop 0
  v_cvt_pk_bf16_f32 v167, v150, v151
  v_mfma_f32_16x16x32_bf16 v[128:131], v[176:179], v[160:163], v[128:131]
  s_nop 0
  v_mfma_f32_16x16x32_bf16 v[132:135], v[176:179], v[164:167], v[132:135]
  s_waitcnt lgkmcnt(7)
  v_mfma_f32_16x16x32_bf16 v[64:67], v[212:215], v[160:163], v[64:67]
  v_mfma_f32_16x16x32_bf16 v[68:71], v[212:215], v[164:167], v[68:71]
  s_waitcnt lgkmcnt(6)
  v_mfma_f32_16x16x32_bf16 v[76:79], v[216:219], v[164:167], v[76:79]
  v_mfma_f32_16x16x32_bf16 v[72:75], v[216:219], v[160:163], v[72:75]
  s_waitcnt lgkmcnt(5)
  v_mfma_f32_16x16x32_bf16 v[80:83], v[220:223], v[160:163], v[80:83]
  v_mfma_f32_16x16x32_bf16 v[84:87], v[220:223], v[164:167], v[84:87]
  s_waitcnt lgkmcnt(4)
  v_mfma_f32_16x16x32_bf16 v[92:95], v[224:227], v[164:167], v[92:95]
  v_mfma_f32_16x16x32_bf16 v[88:91], v[224:227], v[160:163], v[88:91]
  s_waitcnt lgkmcnt(3)
  v_mfma_f32_16x16x32_bf16 v[96:99], v[228:231], v[160:163], v[96:99]
  v_mfma_f32_16x16x32_bf16 v[100:103], v[228:231], v[164:167], v[100:103]
  s_waitcnt lgkmcnt(2)
  v_mfma_f32_16x16x32_bf16 v[108:111], v[232:235], v[164:167], v[108:111]
  v_mfma_f32_16x16x32_bf16 v[104:107], v[232:235], v[160:163], v[104:107]
  s_waitcnt lgkmcnt(1)
  v_mfma_f32_16x16x32_bf16 v[112:115], v[236:239], v[160:163], v[112:115]
  v_mfma_f32_16x16x32_bf16 v[116:119], v[236:239], v[164:167], v[116:119]
  s_waitcnt lgkmcnt(0)
  v_mfma_f32_16x16x32_bf16 v[124:127], v[240:243], v[164:167], v[124:127]
  v_mfma_f32_16x16x32_bf16 v[120:123], v[240:243], v[160:163], v[120:123]
  s_branch LF3_B_fin
LF3_B_diag0:
  v_mfma_f32_16x16x32_bf16 v[136:139], v[180:183], v[32:35], v[168:171]
  ds_read_b128 v[212:215], v3 offset:24576
  v_mfma_f32_16x16x32_bf16 v[136:139], v[184:187], v[36:39], v[136:139]
  ds_read_b128 v[216:219], v3 offset:28672
  v_exp_f32 v149, v149
  v_mfma_f32_16x16x32_bf16 v[136:139], v[188:191], v[40:43], v[136:139]
  ds_read_b128 v[220:223], v3 offset:25600
  v_cvt_pk_bf16_f32 v166, v148, v149
  v_mfma_f32_16x16x32_bf16 v[136:139], v[192:195], v[44:47], v[136:139]
  ds_read_b128 v[224:227], v3 offset:29696
  v_exp_f32 v150, v150
  v_mfma_f32_16x16x32_bf16 v[140:143], v[180:183], v[48:51], v[172:175]
  ds_read_b128 v[228:231], v3 offset:26624
  s_waitcnt lgkmcnt(5)
  v_mfma_f32_16x16x32_bf16 v[140:143], v[184:187], v[52:55], v[140:143]
  ds_read_b128 v[232:235], v3 offset:30720
  v_exp_f32 v151, v151
  v_mfma_f32_16x16x32_bf16 v[140:143], v[188:191], v[56:59], v[140:143]
  ds_read_b128 v[236:239], v3 offset:27648
  v_cvt_pk_bf16_f32 v167, v150, v151
  v_mfma_f32_16x16x32_bf16 v[140:143], v[192:195], v[60:63], v[140:143]
  ds_read_b128 v[240:243], v3 offset:31744
  v_cndmask_b32 v136, v136, v7, s[80:81]
  v_cndmask_b32 v137, v137, v7, s[82:83]
  v_cndmask_b32 v138, v138, v7, s[84:85]
  v_cndmask_b32 v139, v139, v7, s[86:87]
  v_mfma_f32_16x16x32_bf16 v[148:151], v[196:199], v[48:51], v[172:175]
  v_exp_f32 v136, v136
  v_mfma_f32_16x16x32_bf16 v[148:151], v[200:203], v[52:55], v[148:151]
  v_exp_f32 v137, v137
  v_mfma_f32_16x16x32_bf16 v[148:151], v[204:207], v[56:59], v[148:151]
  v_cvt_pk_bf16_f32 v152, v136, v137
  v_mfma_f32_16x16x32_bf16 v[148:151], v[208:211], v[60:63], v[148:151]
  v_exp_f32 v138, v138
  v_mfma_f32_16x16x32_bf16 v[128:131], v[176:179], v[160:163], v[128:131]
  s_waitcnt lgkmcnt(2)
  v_mfma_f32_16x16x32_bf16 v[132:135], v[176:179], v[164:167], v[132:135]
  v_exp_f32 v139, v139
  v_mfma_f32_16x16x32_bf16 v[64:67], v[212:215], v[160:163], v[64:67]
  v_cvt_pk_bf16_f32 v153, v138, v139
  v_mfma_f32_16x16x32_bf16 v[68:71], v[212:215], v[164:167], v[68:71]
  v_exp_f32 v140, v140
  v_mfma_f32_16x16x32_bf16 v[76:79], v[216:219], v[164:167], v[76:79]
  v_mfma_f32_16x16x32_bf16 v[72:75], v[216:219], v[160:163], v[72:75]
  v_exp_f32 v141, v141
  v_mfma_f32_16x16x32_bf16 v[80:83], v[220:223], v[160:163], v[80:83]
  v_cvt_pk_bf16_f32 v156, v140, v141
  v_mfma_f32_16x16x32_bf16 v[84:87], v[220:223], v[164:167], v[84:87]
  v_exp_f32 v142, v142
  v_mfma_f32_16x16x32_bf16 v[92:95], v[224:227], v[164:167], v[92:95]
  s_waitcnt lgkmcnt(0)
  v_mfma_f32_16x16x32_bf16 v[88:91], v[224:227], v[160:163], v[88:91]
  v_exp_f32 v143, v143
  v_mfma_f32_16x16x32_bf16 v[96:99], v[228:231], v[160:163], v[96:99]
  v_cvt_pk_bf16_f32 v157, v142, v143
  v_mfma_f32_16x16x32_bf16 v[100:103], v[228:231], v[164:167], v[100:103]
  v_mov_b32 v154, 0
  v_mfma_f32_16x16x32_bf16 v[108:111], v[232:235], v[164:167], v[108:111]
  v_mov_b32 v155, 0
  v_mfma_f32_16x16x32_bf16 v[104:107], v[232:235], v[160:163], v[104:107]
  v_mfma_f32_16x16x32_bf16 v[112:115], v[236:239], v[160:163], v[112:115]
  v_cndmask_b32 v148, v148, v7, s[80:81]
  v_cndmask_b32 v149, v149, v7, s[82:83]
  v_cndmask_b32 v150, v150, v7, s[84:85]
  v_cndmask_b32 v151, v151, v7, s[86:87]
  v_mfma_f32_16x16x32_bf16 v[116:119], v[236:239], v[164:167], v[116:119]
  v_exp_f32 v148, v148
  v_mfma_f32_16x16x32_bf16 v[124:127], v[240:243], v[164:167], v[124:127]
  v_mov_b32 v3, v2
  v_mfma_f32_16x16x32_bf16 v[120:123], v[240:243], v[160:163], v[120:123]
LF3_B_drain0:
  ds_read_b128 v[212:215], v3 offset:16384
  ds_read_b128 v[216:219], v3 offset:20480
  ds_read_b128 v[220:223], v3 offset:17408
  ds_read_b128 v[224:227], v3 offset:21504
  ds_read_b128 v[228:231], v3 offset:18432
  ds_read_b128 v[232:235], v3 offset:22528
  ds_read_b128 v[236:239], v3 offset:19456
  ds_read_b128 v[240:243], v3 offset:23552
  v_exp_f32 v149, v149
  s_nop 0
  v_cvt_pk_bf16_f32 v158, v148, v149
  v_exp_f32 v150, v150
  v_exp_f32 v151, v151
  s_nop 0
  v_cvt_pk_bf16_f32 v159, v150, v151
  v_mfma_f32_16x16x32_bf16 v[128:131], v[176:179], v[152:155], v[128:131]
  s_nop 0
  v_mfma_f32_16x16x32_bf16 v[132:135], v[176:179], v[156:159], v[132:135]
  s_waitcnt lgkmcnt(7)
  v_mfma_f32_16x16x32_bf16 v[64:67], v[212:215], v[152:155], v[64:67]
  v_mfma_f32_16x16x32_bf16 v[68:71], v[212:215], v[156:159], v[68:71]
  s_waitcnt lgkmcnt(6)
  v_mfma_f32_16x16x32_bf16 v[76:79], v[216:219], v[156:159], v[76:79]
  v_mfma_f32_16x16x32_bf16 v[72:75], v[216:219], v[152:155], v[72:75]
  s_waitcnt lgkmcnt(5)
  v_mfma_f32_16x16x32_bf16 v[80:83], v[220:223], v[152:155], v[80:83]
  v_mfma_f32_16x16x32_bf16 v[84:87], v[220:223], v[156:159], v[84:87]
  s_waitcnt lgkmcnt(4)
  v_mfma_f32_16x16x32_bf16 v[92:95], v[224:227], v[156:159], v[92:95]
  v_mfma_f32_16x16x32_bf16 v[88:91], v[224:227], v[152:155], v[88:91]
  s_waitcnt lgkmcnt(3)
  v_mfma_f32_16x16x32_bf16 v[96:99], v[228:231], v[152:155], v[96:99]
  v_mfma_f32_16x16x32_bf16 v[100:103], v[228:231], v[156:159], v[100:103]
  s_waitcnt lgkmcnt(2)
  v_mfma_f32_16x16x32_bf16 v[108:111], v[232:235], v[156:159], v[108:111]
  v_mfma_f32_16x16x32_bf16 v[104:107], v[232:235], v[152:155], v[104:107]
  s_waitcnt lgkmcnt(1)
  v_mfma_f32_16x16x32_bf16 v[112:115], v[236:239], v[152:155], v[112:115]
  v_mfma_f32_16x16x32_bf16 v[116:119], v[236:239], v[156:159], v[116:119]
  s_waitcnt lgkmcnt(0)
  v_mfma_f32_16x16x32_bf16 v[124:127], v[240:243], v[156:159], v[124:127]
  v_mfma_f32_16x16x32_bf16 v[120:123], v[240:243], v[152:155], v[120:123]
LF3_B_fin:
  s_waitcnt vmcnt(0) lgkmcnt(0)
  s_cmp_eq_u32 s71, 0
  s_cbranch_scc1 LF3_B_nob
  s_barrier
LF3_B_nob:
  s_nop 7
  v_add_f32 v17, v128, v132
  v_mov_b32 v18, 0x5f800000
  v_cmp_nlt_f32 vcc, v17, v18
  v_mov_b32 v19, 131072
  v_mov_b32 v20, 1
  s_and_saveexec_b64 s[62:63], vcc
  ds_write_b32 v19, v20
  s_mov_b64 exec, s[62:63]
  v_rcp_f32 v16, v128
  v_rcp_f32 v17, v128
  s_lshl_b32 s60, s76, 13
  s_lshl_b32 s61, s57, 12
  s_add_u32 s60, s60, s61
  v_pk_mul_f32 v[64:65], v[64:65], v[16:17]
  v_pk_mul_f32 v[66:67], v[66:67], v[16:17]
  v_cvt_pk_bf16_f32 v180, v64, v65
  v_cvt_pk_bf16_f32 v181, v66, v67
  v_pk_mul_f32 v[72:73], v[72:73], v[16:17]
  v_pk_mul_f32 v[74:75], v[74:75], v[16:17]
  v_cvt_pk_bf16_f32 v182, v72, v73
  v_cvt_pk_bf16_f32 v183, v74, v75
  buffer_store_dwordx4 v[180:183], v14, s[52:55], s60 offen offset:0 sc1
  v_pk_mul_f32 v[80:81], v[80:81], v[16:17]
  v_pk_mul_f32 v[82:83], v[82:83], v[16:17]
  v_cvt_pk_bf16_f32 v184, v80, v81
  v_cvt_pk_bf16_f32 v185, v82, v83
  v_pk_mul_f32 v[88:89], v[88:89], v[16:17]
  v_pk_mul_f32 v[90:91], v[90:91], v[16:17]
  v_cvt_pk_bf16_f32 v186, v88, v89
  v_cvt_pk_bf16_f32 v187, v90, v91
  buffer_store_dwordx4 v[184:187], v14, s[52:55], s60 offen offset:1024 sc1
  v_pk_mul_f32 v[96:97], v[96:97], v[16:17]
  v_pk_mul_f32 v[98:99], v[98:99], v[16:17]
  v_cvt_pk_bf16_f32 v188, v96, v97
  v_cvt_pk_bf16_f32 v189, v98, v99
  v_pk_mul_f32 v[104:105], v[104:105], v[16:17]
  v_pk_mul_f32 v[106:107], v[106:107], v[16:17]
  v_cvt_pk_bf16_f32 v190, v104, v105
  v_cvt_pk_bf16_f32 v191, v106, v107
  buffer_store_dwordx4 v[188:191], v14, s[52:55], s60 offen offset:2048 sc1
  v_pk_mul_f32 v[112:113], v[112:113], v[16:17]
  v_pk_mul_f32 v[114:115], v[114:115], v[16:17]
  v_cvt_pk_bf16_f32 v192, v112, v113
  v_cvt_pk_bf16_f32 v193, v114, v115
  v_pk_mul_f32 v[120:121], v[120:121], v[16:17]
  v_pk_mul_f32 v[122:123], v[122:123], v[16:17]
  v_cvt_pk_bf16_f32 v194, v120, v121
  v_cvt_pk_bf16_f32 v195, v122, v123
  buffer_store_dwordx4 v[192:195], v14, s[52:55], s60 offen offset:3072 sc1
  v_rcp_f32 v16, v132
  v_rcp_f32 v17, v132
  s_lshl_b32 s60, s76, 13
  s_lshl_b32 s61, s57, 12
  s_add_u32 s60, s60, s61
  s_mov_b32 s61, 131072
  s_add_u32 s60, s60, s61
  v_pk_mul_f32 v[68:69], v[68:69], v[16:17]
  v_pk_mul_f32 v[70:71], v[70:71], v[16:17]
  v_cvt_pk_bf16_f32 v196, v68, v69
  v_cvt_pk_bf16_f32 v197, v70, v71
  v_pk_mul_f32 v[76:77], v[76:77], v[16:17]
  v_pk_mul_f32 v[78:79], v[78:79], v[16:17]
  v_cvt_pk_bf16_f32 v198, v76, v77
  v_cvt_pk_bf16_f32 v199, v78, v79
  buffer_store_dwordx4 v[196:199], v14, s[52:55], s60 offen offset:0 sc1
  v_pk_mul_f32 v[84:85], v[84:85], v[16:17]
  v_pk_mul_f32 v[86:87], v[86:87], v[16:17]
  v_cvt_pk_bf16_f32 v200, v84, v85
  v_cvt_pk_bf16_f32 v201, v86, v87
  v_pk_mul_f32 v[92:93], v[92:93], v[16:17]
  v_pk_mul_f32 v[94:95], v[94:95], v[16:17]
  v_cvt_pk_bf16_f32 v202, v92, v93
  v_cvt_pk_bf16_f32 v203, v94, v95
  buffer_store_dwordx4 v[200:203], v14, s[52:55], s60 offen offset:1024 sc1
  v_pk_mul_f32 v[100:101], v[100:101], v[16:17]
  v_pk_mul_f32 v[102:103], v[102:103], v[16:17]
  v_cvt_pk_bf16_f32 v204, v100, v101
  v_cvt_pk_bf16_f32 v205, v102, v103
  v_pk_mul_f32 v[108:109], v[108:109], v[16:17]
  v_pk_mul_f32 v[110:111], v[110:111], v[16:17]
  v_cvt_pk_bf16_f32 v206, v108, v109
  v_cvt_pk_bf16_f32 v207, v110, v111
  buffer_store_dwordx4 v[204:207], v14, s[52:55], s60 offen offset:2048 sc1
  v_pk_mul_f32 v[116:117], v[116:117], v[16:17]
  v_pk_mul_f32 v[118:119], v[118:119], v[16:17]
  v_cvt_pk_bf16_f32 v208, v116, v117
  v_cvt_pk_bf16_f32 v209, v118, v119
  v_pk_mul_f32 v[124:125], v[124:125], v[16:17]
  v_pk_mul_f32 v[126:127], v[126:127], v[16:17]
  v_cvt_pk_bf16_f32 v210, v124, v125
  v_cvt_pk_bf16_f32 v211, v126, v127
  buffer_store_dwordx4 v[208:211], v14, s[52:55], s60 offen offset:3072 sc1
LF3_join:
  s_waitcnt lgkmcnt(0)
  s_barrier
  v_mov_b32 v16, 131072
  ds_read_b32 v17, v16
  s_waitcnt lgkmcnt(0)
  v_readfirstlane_b32 s60, v17
  s_nop 3
  s_andn2_b32 s60, s60, s70
  s_cmp_eq_u32 s60, 0
  s_cbranch_scc1 LF3_done
  s_waitcnt vmcnt(0)
  s_barrier
  s_mov_b32 s70, 1
  v_mov_b32 v5, v7
  v_mov_b32 v6, v7
  v_and_b32 v19, 15, v1
  v_lshrrev_b32 v20, 4, v1
  v_lshlrev_b32 v20, 2, v20
  v_sub_u32 v19, v19, v20
  v_add_u32 v19, s76, v19
  s_mov_b32 s62, 16
  v_add_u32 v20, s62, v19
  s_or_b32 s74, s72, 3
  s_mov_b32 s61, 0
LF3_mx:
  s_lshr_b32 s62, s61, 1
  s_lshl_b32 s62, s62, 15
  s_and_b32 s63, s61, 1
  s_lshl_b32 s63, s63, 13
  s_add_u32 s62, s62, s63
  s_add_u32 s63, s62, 4096
  buffer_load_dwordx4 v[180:183], v14, s[48:51], s62 offen offset:0
  buffer_load_dwordx4 v[184:187], v14, s[48:51], s62 offen offset:1024
  buffer_load_dwordx4 v[188:191], v14, s[48:51], s62 offen offset:2048
  buffer_load_dwordx4 v[192:195], v14, s[48:51], s62 offen offset:3072
  buffer_load_dwordx4 v[196:199], v14, s[48:51], s63 offen offset:0
  buffer_load_dwordx4 v[200:203], v14, s[48:51], s63 offen offset:1024
  buffer_load_dwordx4 v[204:207], v14, s[48:51], s63 offen offset:2048
  buffer_load_dwordx4 v[208:211], v14, s[48:51], s63 offen offset:3072
  s_waitcnt vmcnt(7)
  v_mfma_f32_16x16x32_bf16 v[136:139], v[180:183], v[32:35], 0
  s_waitcnt vmcnt(6)
  v_mfma_f32_16x16x32_bf16 v[136:139], v[184:187], v[36:39], v[136:139]
  s_waitcnt vmcnt(5)
  v_mfma_f32_16x16x32_bf16 v[136:139], v[188:191], v[40:43], v[136:139]
  s_waitcnt vmcnt(4)
  v_mfma_f32_16x16x32_bf16 v[136:139], v[192:195], v[44:47], v[136:139]
  v_mfma_f32_16x16x32_bf16 v[140:143], v[180:183], v[48:51], 0
  v_mfma_f32_16x16x32_bf16 v[140:143], v[184:187], v[52:55], v[140:143]
  v_mfma_f32_16x16x32_bf16 v[140:143], v[188:191], v[56:59], v[140:143]
  v_mfma_f32_16x16x32_bf16 v[140:143], v[192:195], v[60:63], v[140:143]
  s_waitcnt vmcnt(3)
  v_mfma_f32_16x16x32_bf16 v[144:147], v[196:199], v[32:35], 0
  s_waitcnt vmcnt(2)
  v_mfma_f32_16x16x32_bf16 v[144:147], v[200:203], v[36:39], v[144:147]
  s_waitcnt vmcnt(1)
  v_mfma_f32_16x16x32_bf16 v[144:147], v[204:207], v[40:43], v[144:147]
  s_waitcnt vmcnt(0)
  v_mfma_f32_16x16x32_bf16 v[144:147], v[208:211], v[44:47], v[144:147]
  v_mfma_f32_16x16x32_bf16 v[148:151], v[196:199], v[48:51], 0
  v_mfma_f32_16x16x32_bf16 v[148:151], v[200:203], v[52:55], v[148:151]
  v_mfma_f32_16x16x32_bf16 v[148:151], v[204:207], v[56:59], v[148:151]
  v_mfma_f32_16x16x32_bf16 v[148:151], v[208:211], v[60:63], v[148:151]
  s_nop 7
  s_lshl_b32 s62, s61, 5
  s_add_u32 s62, s62, 0
  v_cmp_gt_i32 vcc, s62, v19
  s_nop 1
  v_cndmask_b32 v136, v136, v7, vcc
  v_cmp_gt_i32 vcc, s62, v20
  s_nop 1
  v_cndmask_b32 v140, v140, v7, vcc
  s_lshl_b32 s62, s61, 5
  s_add_u32 s62, s62, 1
  v_cmp_gt_i32 vcc, s62, v19
  s_nop 1
  v_cndmask_b32 v137, v137, v7, vcc
  v_cmp_gt_i32 vcc, s62, v20
  s_nop 1
  v_cndmask_b32 v141, v141, v7, vcc
  s_lshl_b32 s62, s61, 5
  s_add_u32 s62, s62, 2
  v_cmp_gt_i32 vcc, s62, v19
  s_nop 1
  v_cndmask_b32 v138, v138, v7, vcc
  v_cmp_gt_i32 vcc, s62, v20
  s_nop 1
  v_cndmask_b32 v142, v142, v7, vcc
  s_lshl_b32 s62, s61, 5
  s_add_u32 s62, s62, 3
  v_cmp_gt_i32 vcc, s62, v19
  s_nop 1
  v_cndmask_b32 v139, v139, v7, vcc
  v_cmp_gt_i32 vcc, s62, v20
  s_nop 1
  v_cndmask_b32 v143, v143, v7, vcc
  s_lshl_b32 s62, s61, 5
  s_add_u32 s62, s62, 16
  v_cmp_gt_i32 vcc, s62, v19
  s_nop 1
  v_cndmask_b32 v144, v144, v7, vcc
  v_cmp_gt_i32 vcc, s62, v20
  s_nop 1
  v_cndmask_b32 v148, v148, v7, vcc
  s_lshl_b32 s62, s61, 5
  s_add_u32 s62, s62, 17
  v_cmp_gt_i32 vcc, s62, v19
  s_nop 1
  v_cndmask_b32 v145, v145, v7, vcc
  v_cmp_gt_i32 vcc, s62, v20
  s_nop 1
  v_cndmask_b32 v149, v149, v7, vcc
  s_lshl_b32 s62, s61, 5
  s_add_u32 s62, s62, 18
  v_cmp_gt_i32 vcc, s62, v19
  s_nop 1
  v_cndmask_b32 v146, v146, v7, vcc
  v_cmp_gt_i32 vcc, s62, v20
  s_nop 1
  v_cndmask_b32 v150, v150, v7, vcc
  s_lshl_b32 s62, s61, 5
  s_add_u32 s62, s62, 19
  v_cmp_gt_i32 vcc, s62, v19
  s_nop 1
  v_cndmask_b32 v147, v147, v7, vcc
  v_cmp_gt_i32 vcc, s62, v20
  s_nop 1
  v_cndmask_b32 v151, v151, v7, vcc
  v_max3_f32 v5, v5, v136, v137
  v_max3_f32 v5, v5, v138, v139
  v_max3_f32 v5, v5, v144, v145
  v_max3_f32 v5, v5, v146, v147
  v_max3_f32 v6, v6, v140, v141
  v_max3_f32 v6, v6, v142, v143
  v_max3_f32 v6, v6, v148, v149
  v_max3_f32 v6, v6, v150, v151
  s_add_u32 s61, s61, 1
  s_cmp_le_u32 s61, s74
  s_cbranch_scc1 LF3_mx
  v_mov_b32 v18, v5
  s_nop 1
  v_permlane16_swap_b32 v5, v18
  v_max_f32 v5, v5, v18
  v_mov_b32 v18, v5
  s_nop 1
  v_permlane32_swap_b32 v5, v18
  v_max_f32 v5, v5, v18
  v_sub_f32 v5, 0, v5
  v_mov_b32 v18, v6
  s_nop 1
  v_permlane16_swap_b32 v6, v18
  v_max_f32 v6, v6, v18
  v_mov_b32 v18, v6
  s_nop 1
  v_permlane32_swap_b32 v6, v18
  v_max_f32 v6, v6, v18
  v_sub_f32 v6, 0, v6
  v_and_b32 v16, 3, v1
  v_cmp_eq_u32 vcc, 0, v16
  v_mov_b32 v17, 0x3f803f80
  s_nop 0
  v_cndmask_b32 v176, 0, v17, vcc
  v_mov_b32 v177, v176
  v_mov_b32 v178, v176
  v_mov_b32 v179, v176
  v_mov_b32 v64, 0
  v_mov_b32 v65, 0
  v_mov_b32 v66, 0
  v_mov_b32 v67, 0
  v_mov_b32 v68, 0
  v_mov_b32 v69, 0
  v_mov_b32 v70, 0
  v_mov_b32 v71, 0
  v_mov_b32 v72, 0
  v_mov_b32 v73, 0
  v_mov_b32 v74, 0
  v_mov_b32 v75, 0
  v_mov_b32 v76, 0
  v_mov_b32 v77, 0
  v_mov_b32 v78, 0
  v_mov_b32 v79, 0
  v_mov_b32 v80, 0
  v_mov_b32 v81, 0
  v_mov_b32 v82, 0
  v_mov_b32 v83, 0
  v_mov_b32 v84, 0
  v_mov_b32 v85, 0
  v_mov_b32 v86, 0
  v_mov_b32 v87, 0
  v_mov_b32 v88, 0
  v_mov_b32 v89, 0
  v_mov_b32 v90, 0
  v_mov_b32 v91, 0
  v_mov_b32 v92, 0
  v_mov_b32 v93, 0
  v_mov_b32 v94, 0
  v_mov_b32 v95, 0
  v_mov_b32 v96, 0
  v_mov_b32 v97, 0
  v_mov_b32 v98, 0
  v_mov_b32 v99, 0
  v_mov_b32 v100, 0
  v_mov_b32 v101, 0
  v_mov_b32 v102, 0
  v_mov_b32 v103, 0
  v_mov_b32 v104, 0
  v_mov_b32 v105, 0
  v_mov_b32 v106, 0
  v_mov_b32 v107, 0
  v_mov_b32 v108, 0
  v_mov_b32 v109, 0
  v_mov_b32 v110, 0
  v_mov_b32 v111, 0
  v_mov_b32 v112, 0
  v_mov_b32 v113, 0
  v_mov_b32 v114, 0
  v_mov_b32 v115, 0
  v_mov_b32 v116, 0
  v_mov_b32 v117, 0
  v_mov_b32 v118, 0
  v_mov_b32 v119, 0
  v_mov_b32 v120, 0
  v_mov_b32 v121, 0
  v_mov_b32 v122, 0
  v_mov_b32 v123, 0
  v_mov_b32 v124, 0
  v_mov_b32 v125, 0
  v_mov_b32 v126, 0
  v_mov_b32 v127, 0
  v_mov_b32 v128, 0
  v_mov_b32 v129, 0
  v_mov_b32 v130, 0
  v_mov_b32 v131, 0
  v_mov_b32 v132, 0
  v_mov_b32 v133, 0
  v_mov_b32 v134, 0
  v_mov_b32 v135, 0
  s_lshl_b32 s67, s59, 13
  s_add_u32 s67, s67, 0x8000
  s_mov_b32 s68, 0x10000
  s_mov_b32 s69, 0
  s_cmp_ge_u32 s56, 4
  s_cbranch_scc1 LF3_redo_nodma
  s_mov_b32 m0, s67
  s_nop 0
  buffer_load_dwordx4 v4, s[48:51], s69 offen offset:0 sc1 lds
  buffer_load_dwordx4 v4, s[48:51], s69 offen offset:1024 sc1 lds
  buffer_load_dwordx4 v4, s[48:51], s69 offen offset:2048 sc1 lds
  buffer_load_dwordx4 v4, s[48:51], s69 offen offset:3072 sc1 lds
  s_add_u32 s69, s69, 4096
  s_add_u32 m0, s67, 4096
  s_nop 0
  buffer_load_dwordx4 v4, s[48:51], s69 offen offset:0 sc1 lds
  buffer_load_dwordx4 v4, s[48:51], s69 offen offset:1024 sc1 lds
  buffer_load_dwordx4 v4, s[48:51], s69 offen offset:2048 sc1 lds
  buffer_load_dwordx4 v4, s[48:51], s69 offen offset:3072 sc1 lds
  s_add_u32 s69, s69, 28672
  s_xor_b32 s67, s67, s68
  s_xor_b32 s68, s68, 0x18000
  s_mov_b32 m0, s67
  s_nop 0
  buffer_load_dwordx4 v4, s[48:51], s69 offen offset:0 sc1 lds
  buffer_load_dwordx4 v4, s[48:51], s69 offen offset:1024 sc1 lds
  buffer_load_dwordx4 v4, s[48:51], s69 offen offset:2048 sc1 lds
  buffer_load_dwordx4 v4, s[48:51], s69 offen offset:3072 sc1 lds
  s_add_u32 s69, s69, 4096
  s_add_u32 m0, s67, 4096
  s_nop 0
  buffer_load_dwordx4 v4, s[48:51], s69 offen offset:0 sc1 lds
  buffer_load_dwordx4 v4, s[48:51], s69 offen offset:1024 sc1 lds
  buffer_load_dwordx4 v4, s[48:51], s69 offen offset:2048 sc1 lds
  buffer_load_dwordx4 v4, s[48:51], s69 offen offset:3072 sc1 lds
  s_add_u32 s69, s69, 28672
  s_xor_b32 s67, s67, s68
  s_xor_b32 s68, s68, 0x18000
LF3_redo_nodma:
  s_waitcnt vmcnt(8)
  s_branch LF3_start
LF3_done:
  s_cmp_lt_u32 s56, 4
  s_cbranch_scc1 LF_comp
  s_cmp_ge_u32 s56, 6
  s_cbranch_scc1 LF_tail
  s_mov_b32 s10, 8192
  s_mov_b32 s11, 16384
  s_mov_b32 s12, 24576
  s_mov_b32 s13, 32768
  s_mov_b32 s16, 40960
  s_mov_b32 s17, 49152
  s_mov_b32 s78, 57344
  s_lshl_b32 s63, s6, 3
  v_min_u32 v16, 7, v1
  v_add_u32 v16, s63, v16
  v_lshrrev_b32 v17, 2, v16
  v_and_b32 v16, 3, v16
  v_lshl_add_u32 v16, v16, 3, v17
  s_lshl_b32 s62, s20, 5
  v_add_u32 v16, s62, v16
  v_lshlrev_b32 v16, 10, v16
  v_add_u32 v12, 256, v16
  s_cmp_lt_u32 s7, 8
  s_cselect_b32 s62, 128, 0
  v_add_u32 v12, s62, v12
  buffer_load_dword v11, v12, s[88:91], 0 offen sc1
  s_and_b32 s18, s64, 2
  s_cmp_eq_u32 s18, 0
  s_mov_b32 s61, 0x10000
  s_cselect_b32 s18, 0x8000, s61
  s_xor_b32 s18, s18, 0x8000
  s_lshl_b32 s63, s59, 2
  v_lshrrev_b32 v17, 4, v1
  v_or_b32 v18, s63, v17
  v_lshlrev_b32 v18, 1, v18
  v_and_b32 v16, 15, v1
  v_xor_b32 v16, v16, v18
  v_lshlrev_b32 v16, 4, v16
  v_lshl_add_u32 v16, v17, 10, v16
  s_lshl_b32 s63, s8, 8
  s_lshl_b32 s61, s6, 20
  s_add_u32 s63, s63, s61
  s_lshl_b32 s61, s59, 12
  s_add_u32 s63, s63, s61
  v_add_u32 v8, s63, v16
  s_lshl_b32 s63, s59, 13
  s_add_u32 s19, s18, s63
  s_add_u32 s19, s19, 16384
  s_lshl_b32 s63, s59, 10
  s_add_u32 s18, s18, s63
  s_and_b32 s63, s7, 7
  s_lshl_b32 s63, s63, 13
  s_xor_b32 s66, s63, 0
  s_xor_b32 s10, s63, 8192
  s_xor_b32 s11, s63, 16384
  s_xor_b32 s12, s63, 24576
  s_xor_b32 s13, s63, 32768
  s_xor_b32 s16, s63, 40960
  s_xor_b32 s17, s63, 49152
  s_xor_b32 s78, s63, 57344
  s_lshr_b32 m0, s66, 2
  s_add_u32 m0, m0, s18
  s_nop 0
  buffer_load_dwordx4 v8, s[36:39], s66 offen lds
  s_lshr_b32 m0, s10, 2
  s_add_u32 m0, m0, s18
  s_nop 0
  buffer_load_dwordx4 v8, s[36:39], s10 offen lds
  s_lshr_b32 m0, s11, 2
  s_add_u32 m0, m0, s18
  s_nop 0
  buffer_load_dwordx4 v8, s[36:39], s11 offen lds
  s_lshr_b32 m0, s12, 2
  s_add_u32 m0, m0, s18
  s_nop 0
  buffer_load_dwordx4 v8, s[36:39], s12 offen lds
  s_lshr_b32 m0, s13, 2
  s_add_u32 m0, m0, s18
  s_nop 0
  buffer_load_dwordx4 v8, s[36:39], s13 offen lds
  s_lshr_b32 m0, s16, 2
  s_add_u32 m0, m0, s18
  s_nop 0
  buffer_load_dwordx4 v8, s[36:39], s16 offen lds
  s_lshr_b32 m0, s17, 2
  s_add_u32 m0, m0, s18
  s_nop 0
  buffer_load_dwordx4 v8, s[36:39], s17 offen lds
  s_lshr_b32 m0, s78, 2
  s_add_u32 m0, m0, s18
  s_nop 0
  buffer_load_dwordx4 v8, s[36:39], s78 offen lds
  v_add_u32 v8, 0x10000, v8
  s_xor_b32 s18, s18, 0x8000
  s_barrier
  s_waitcnt vmcnt(8)
  v_cmp_gt_u32 vcc, 1, v11
  s_nop 0
  s_cbranch_vccnz LF_late
  s_lshl_b32 s63, s7, 3
  s_lshl_b32 s62, s59, 2
  s_add_u32 s63, s63, s62
  s_lshl_b32 s63, s63, 17
  s_lshl_b32 s62, s6, 15
  s_add_u32 s63, s63, s62
  v_add_u32 v10, s63, v14
  s_lshl_b32 s63, s8, 17
  s_xor_b32 s67, s63, 0x0
  s_xor_b32 s79, s63, 0x20000
  s_xor_b32 s64, s63, 0x40000
  s_xor_b32 s65, s63, 0x60000
  s_lshr_b32 m0, s67, 6
  s_add_u32 m0, m0, s19
  s_nop 0
  buffer_load_dwordx4 v10, s[52:55], s67 offen offset:0 sc1 lds
  buffer_load_dwordx4 v10, s[52:55], s67 offen offset:1024 sc1 lds
  s_lshr_b32 m0, s79, 6
  s_add_u32 m0, m0, s19
  s_nop 0
  buffer_load_dwordx4 v10, s[52:55], s79 offen offset:0 sc1 lds
  buffer_load_dwordx4 v10, s[52:55], s79 offen offset:1024 sc1 lds
  s_lshr_b32 m0, s64, 6
  s_add_u32 m0, m0, s19
  s_nop 0
  buffer_load_dwordx4 v10, s[52:55], s64 offen offset:0 sc1 lds
  buffer_load_dwordx4 v10, s[52:55], s64 offen offset:1024 sc1 lds
  s_lshr_b32 m0, s65, 6
  s_add_u32 m0, m0, s19
  s_nop 0
  buffer_load_dwordx4 v10, s[52:55], s65 offen offset:0 sc1 lds
  buffer_load_dwordx4 v10, s[52:55], s65 offen offset:1024 sc1 lds
  v_add_u32 v10, 2048, v10
  s_xor_b32 s19, s19, 0x8000
  s_barrier
  v_mov_b32 v16, 1
  s_lshl_b32 s60, s2, 10
  s_cmp_eq_u32 s56, 4
  s_cselect_b32 s60, s60, 0x40000
  buffer_store_dword v16, off, s[88:91], s60 offset:256 sc1
  buffer_store_dword v16, off, s[88:91], s60 offset:384 sc1
  s_lshr_b32 m0, s66, 2
  s_add_u32 m0, m0, s18
  s_nop 0
  buffer_load_dwordx4 v8, s[36:39], s66 offen lds
  s_lshr_b32 m0, s10, 2
  s_add_u32 m0, m0, s18
  s_nop 0
  buffer_load_dwordx4 v8, s[36:39], s10 offen lds
  s_lshr_b32 m0, s11, 2
  s_add_u32 m0, m0, s18
  s_nop 0
  buffer_load_dwordx4 v8, s[36:39], s11 offen lds
  s_lshr_b32 m0, s12, 2
  s_add_u32 m0, m0, s18
  s_nop 0
  buffer_load_dwordx4 v8, s[36:39], s12 offen lds
  s_lshr_b32 m0, s13, 2
  s_add_u32 m0, m0, s18
  s_nop 0
  buffer_load_dwordx4 v8, s[36:39], s13 offen lds
  s_lshr_b32 m0, s16, 2
  s_add_u32 m0, m0, s18
  s_nop 0
  buffer_load_dwordx4 v8, s[36:39], s16 offen lds
  s_lshr_b32 m0, s17, 2
  s_add_u32 m0, m0, s18
  s_nop 0
  buffer_load_dwordx4 v8, s[36:39], s17 offen lds
  s_lshr_b32 m0, s78, 2
  s_add_u32 m0, m0, s18
  s_nop 0
  buffer_load_dwordx4 v8, s[36:39], s78 offen lds
  v_add_u32 v8, 0x10000, v8
  s_xor_b32 s18, s18, 0x10000
  s_lshr_b32 m0, s67, 6
  s_add_u32 m0, m0, s19
  s_nop 0
  buffer_load_dwordx4 v10, s[52:55], s67 offen offset:0 sc1 lds
  buffer_load_dwordx4 v10, s[52:55], s67 offen offset:1024 sc1 lds
  s_lshr_b32 m0, s79, 6
  s_add_u32 m0, m0, s19
  s_nop 0
  buffer_load_dwordx4 v10, s[52:55], s79 offen offset:0 sc1 lds
  buffer_load_dwordx4 v10, s[52:55], s79 offen offset:1024 sc1 lds
  s_lshr_b32 m0, s64, 6
  s_add_u32 m0, m0, s19
  s_nop 0
  buffer_load_dwordx4 v10, s[52:55], s64 offen offset:0 sc1 lds
  buffer_load_dwordx4 v10, s[52:55], s64 offen offset:1024 sc1 lds
  s_lshr_b32 m0, s65, 6
  s_add_u32 m0, m0, s19
  s_nop 0
  buffer_load_dwordx4 v10, s[52:55], s65 offen offset:0 sc1 lds
  buffer_load_dwordx4 v10, s[52:55], s65 offen offset:1024 sc1 lds
  v_add_u32 v10, 2048, v10
  s_xor_b32 s19, s19, 0x10000
  s_barrier
  s_lshr_b32 m0, s66, 2
  s_add_u32 m0, m0, s18
  s_nop 0
  buffer_load_dwordx4 v8, s[36:39], s66 offen lds
  s_lshr_b32 m0, s10, 2
  s_add_u32 m0, m0, s18
  s_nop 0
  buffer_load_dwordx4 v8, s[36:39], s10 offen lds
  s_lshr_b32 m0, s11, 2
  s_add_u32 m0, m0, s18
  s_nop 0
  buffer_load_dwordx4 v8, s[36:39], s11 offen lds
  s_lshr_b32 m0, s12, 2
  s_add_u32 m0, m0, s18
  s_nop 0
  buffer_load_dwordx4 v8, s[36:39], s12 offen lds
  s_lshr_b32 m0, s13, 2
  s_add_u32 m0, m0, s18
  s_nop 0
  buffer_load_dwordx4 v8, s[36:39], s13 offen lds
  s_lshr_b32 m0, s16, 2
  s_add_u32 m0, m0, s18
  s_nop 0
  buffer_load_dwordx4 v8, s[36:39], s16 offen lds
  s_lshr_b32 m0, s17, 2
  s_add_u32 m0, m0, s18
  s_nop 0
  buffer_load_dwordx4 v8, s[36:39], s17 offen lds
  s_lshr_b32 m0, s78, 2
  s_add_u32 m0, m0, s18
  s_nop 0
  buffer_load_dwordx4 v8, s[36:39], s78 offen lds
  v_add_u32 v8, 0x10000, v8
  s_xor_b32 s18, s18, 0x8000
  s_lshr_b32 m0, s67, 6
  s_add_u32 m0, m0, s19
  s_nop 0
  buffer_load_dwordx4 v10, s[52:55], s67 offen offset:0 sc1 lds
  buffer_load_dwordx4 v10, s[52:55], s67 offen offset:1024 sc1 lds
  s_lshr_b32 m0, s79, 6
  s_add_u32 m0, m0, s19
  s_nop 0
  buffer_load_dwordx4 v10, s[52:55], s79 offen offset:0 sc1 lds
  buffer_load_dwordx4 v10, s[52:55], s79 offen offset:1024 sc1 lds
  s_lshr_b32 m0, s64, 6
  s_add_u32 m0, m0, s19
  s_nop 0
  buffer_load_dwordx4 v10, s[52:55], s64 offen offset:0 sc1 lds
  buffer_load_dwordx4 v10, s[52:55], s64 offen offset:1024 sc1 lds
  s_lshr_b32 m0, s65, 6
  s_add_u32 m0, m0, s19
  s_nop 0
  buffer_load_dwordx4 v10, s[52:55], s65 offen offset:0 sc1 lds
  buffer_load_dwordx4 v10, s[52:55], s65 offen offset:1024 sc1 lds
  v_add_u32 v10, 2048, v10
  s_xor_b32 s19, s19, 0x8000
  s_branch LF_ctxgo
LF_late:
  s_barrier
  v_mov_b32 v16, 1
  s_lshl_b32 s60, s2, 10
  s_cmp_eq_u32 s56, 4
  s_cselect_b32 s60, s60, 0x40000
  buffer_store_dword v16, off, s[88:91], s60 offset:256 sc1
  buffer_store_dword v16, off, s[88:91], s60 offset:384 sc1
  s_lshr_b32 m0, s66, 2
  s_add_u32 m0, m0, s18
  s_nop 0
  buffer_load_dwordx4 v8, s[36:39], s66 offen lds
  s_lshr_b32 m0, s10, 2
  s_add_u32 m0, m0, s18
  s_nop 0
  buffer_load_dwordx4 v8, s[36:39], s10 offen lds
  s_lshr_b32 m0, s11, 2
  s_add_u32 m0, m0, s18
  s_nop 0
  buffer_load_dwordx4 v8, s[36:39], s11 offen lds
  s_lshr_b32 m0, s12, 2
  s_add_u32 m0, m0, s18
  s_nop 0
  buffer_load_dwordx4 v8, s[36:39], s12 offen lds
  s_lshr_b32 m0, s13, 2
  s_add_u32 m0, m0, s18
  s_nop 0
  buffer_load_dwordx4 v8, s[36:39], s13 offen lds
  s_lshr_b32 m0, s16, 2
  s_add_u32 m0, m0, s18
  s_nop 0
  buffer_load_dwordx4 v8, s[36:39], s16 offen lds
  s_lshr_b32 m0, s17, 2
  s_add_u32 m0, m0, s18
  s_nop 0
  buffer_load_dwordx4 v8, s[36:39], s17 offen lds
  s_lshr_b32 m0, s78, 2
  s_add_u32 m0, m0, s18
  s_nop 0
  buffer_load_dwordx4 v8, s[36:39], s78 offen lds
  v_add_u32 v8, 0x10000, v8
  s_xor_b32 s18, s18, 0x10000
  buffer_load_dword v11, v12, s[88:91], 0 offen sc1
  s_barrier
  s_lshr_b32 m0, s66, 2
  s_add_u32 m0, m0, s18
  s_nop 0
  buffer_load_dwordx4 v8, s[36:39], s66 offen lds
  s_lshr_b32 m0, s10, 2
  s_add_u32 m0, m0, s18
  s_nop 0
  buffer_load_dwordx4 v8, s[36:39], s10 offen lds
  s_lshr_b32 m0, s11, 2
  s_add_u32 m0, m0, s18
  s_nop 0
  buffer_load_dwordx4 v8, s[36:39], s11 offen lds
  s_lshr_b32 m0, s12, 2
  s_add_u32 m0, m0, s18
  s_nop 0
  buffer_load_dwordx4 v8, s[36:39], s12 offen lds
  s_lshr_b32 m0, s13, 2
  s_add_u32 m0, m0, s18
  s_nop 0
  buffer_load_dwordx4 v8, s[36:39], s13 offen lds
  s_lshr_b32 m0, s16, 2
  s_add_u32 m0, m0, s18
  s_nop 0
  buffer_load_dwordx4 v8, s[36:39], s16 offen lds
  s_lshr_b32 m0, s17, 2
  s_add_u32 m0, m0, s18
  s_nop 0
  buffer_load_dwordx4 v8, s[36:39], s17 offen lds
  s_lshr_b32 m0, s78, 2
  s_add_u32 m0, m0, s18
  s_nop 0
  buffer_load_dwordx4 v8, s[36:39], s78 offen lds
  v_add_u32 v8, 0x10000, v8
  s_xor_b32 s18, s18, 0x8000
  s_waitcnt vmcnt(8)
  v_cmp_gt_u32 vcc, 1, v11
  s_nop 0
  s_cbranch_vccz L_poll8_ok
  s_mov_b32 s3, 0x10000
L_poll8:
  buffer_load_dword v11, v12, s[88:91], 0 offen sc1
  s_waitcnt vmcnt(0)
  v_cmp_gt_u32 vcc, 1, v11
  s_sub_u32 s3, s3, 1
  s_cbranch_scc1 L_poll8_ok
  s_cbranch_vccnz L_poll8
L_poll8_ok:
  s_lshl_b32 s63, s7, 3
  s_lshl_b32 s62, s59, 2
  s_add_u32 s63, s63, s62
  s_lshl_b32 s63, s63, 17
  s_lshl_b32 s62, s6, 15
  s_add_u32 s63, s63, s62
  v_add_u32 v10, s63, v14
  s_lshl_b32 s63, s8, 17
  s_xor_b32 s67, s63, 0x0
  s_xor_b32 s79, s63, 0x20000
  s_xor_b32 s64, s63, 0x40000
  s_xor_b32 s65, s63, 0x60000
  s_lshr_b32 m0, s67, 6
  s_add_u32 m0, m0, s19
  s_nop 0
  buffer_load_dwordx4 v10, s[52:55], s67 offen offset:0 sc1 lds
  buffer_load_dwordx4 v10, s[52:55], s67 offen offset:1024 sc1 lds
  s_lshr_b32 m0, s79, 6
  s_add_u32 m0, m0, s19
  s_nop 0
  buffer_load_dwordx4 v10, s[52:55], s79 offen offset:0 sc1 lds
  buffer_load_dwordx4 v10, s[52:55], s79 offen offset:1024 sc1 lds
  s_lshr_b32 m0, s64, 6
  s_add_u32 m0, m0, s19
  s_nop 0
  buffer_load_dwordx4 v10, s[52:55], s64 offen offset:0 sc1 lds
  buffer_load_dwordx4 v10, s[52:55], s64 offen offset:1024 sc1 lds
  s_lshr_b32 m0, s65, 6
  s_add_u32 m0, m0, s19
  s_nop 0
  buffer_load_dwordx4 v10, s[52:55], s65 offen offset:0 sc1 lds
  buffer_load_dwordx4 v10, s[52:55], s65 offen offset:1024 sc1 lds
  v_add_u32 v10, 2048, v10
  s_xor_b32 s19, s19, 0x8000
  s_lshr_b32 m0, s67, 6
  s_add_u32 m0, m0, s19
  s_nop 0
  buffer_load_dwordx4 v10, s[52:55], s67 offen offset:0 sc1 lds
  buffer_load_dwordx4 v10, s[52:55], s67 offen offset:1024 sc1 lds
  s_lshr_b32 m0, s79, 6
  s_add_u32 m0, m0, s19
  s_nop 0
  buffer_load_dwordx4 v10, s[52:55], s79 offen offset:0 sc1 lds
  buffer_load_dwordx4 v10, s[52:55], s79 offen offset:1024 sc1 lds
  s_lshr_b32 m0, s64, 6
  s_add_u32 m0, m0, s19
  s_nop 0
  buffer_load_dwordx4 v10, s[52:55], s64 offen offset:0 sc1 lds
  buffer_load_dwordx4 v10, s[52:55], s64 offen offset:1024 sc1 lds
  s_lshr_b32 m0, s65, 6
  s_add_u32 m0, m0, s19
  s_nop 0
  buffer_load_dwordx4 v10, s[52:55], s65 offen offset:0 sc1 lds
  buffer_load_dwordx4 v10, s[52:55], s65 offen offset:1024 sc1 lds
  v_add_u32 v10, 2048, v10
  s_xor_b32 s19, s19, 0x10000
  s_lshr_b32 m0, s67, 6
  s_add_u32 m0, m0, s19
  s_nop 0
  buffer_load_dwordx4 v10, s[52:55], s67 offen offset:0 sc1 lds
  buffer_load_dwordx4 v10, s[52:55], s67 offen offset:1024 sc1 lds
  s_lshr_b32 m0, s79, 6
  s_add_u32 m0, m0, s19
  s_nop 0
  buffer_load_dwordx4 v10, s[52:55], s79 offen offset:0 sc1 lds
  buffer_load_dwordx4 v10, s[52:55], s79 offen offset:1024 sc1 lds
  s_lshr_b32 m0, s64, 6
  s_add_u32 m0, m0, s19
  s_nop 0
  buffer_load_dwordx4 v10, s[52:55], s64 offen offset:0 sc1 lds
  buffer_load_dwordx4 v10, s[52:55], s64 offen offset:1024 sc1 lds
  s_lshr_b32 m0, s65, 6
  s_add_u32 m0, m0, s19
  s_nop 0
  buffer_load_dwordx4 v10, s[52:55], s65 offen offset:0 sc1 lds
  buffer_load_dwordx4 v10, s[52:55], s65 offen offset:1024 sc1 lds
  v_add_u32 v10, 2048, v10
  s_xor_b32 s19, s19, 0x8000
LF_ctxgo:
  s_waitcnt vmcnt(16)
  s_barrier
  s_lshr_b32 m0, s66, 2
  s_add_u32 m0, m0, s18
  s_nop 0
  buffer_load_dwordx4 v8, s[36:39], s66 offen lds
  s_lshr_b32 m0, s10, 2
  s_add_u32 m0, m0, s18
  s_nop 0
  buffer_load_dwordx4 v8, s[36:39], s10 offen lds
  s_lshr_b32 m0, s11, 2
  s_add_u32 m0, m0, s18
  s_nop 0
  buffer_load_dwordx4 v8, s[36:39], s11 offen lds
  s_lshr_b32 m0, s12, 2
  s_add_u32 m0, m0, s18
  s_nop 0
  buffer_load_dwordx4 v8, s[36:39], s12 offen lds
  s_lshr_b32 m0, s13, 2
  s_add_u32 m0, m0, s18
  s_nop 0
  buffer_load_dwordx4 v8, s[36:39], s13 offen lds
  s_lshr_b32 m0, s16, 2
  s_add_u32 m0, m0, s18
  s_nop 0
  buffer_load_dwordx4 v8, s[36:39], s16 offen lds
  s_lshr_b32 m0, s17, 2
  s_add_u32 m0, m0, s18
  s_nop 0
  buffer_load_dwordx4 v8, s[36:39], s17 offen lds
  s_lshr_b32 m0, s78, 2
  s_add_u32 m0, m0, s18
  s_nop 0
  buffer_load_dwordx4 v8, s[36:39], s78 offen lds
  v_add_u32 v8, 0x10000, v8
  s_xor_b32 s18, s18, 0x10000
  s_lshr_b32 m0, s67, 6
  s_add_u32 m0, m0, s19
  s_nop 0
  buffer_load_dwordx4 v10, s[52:55], s67 offen offset:0 sc1 lds
  buffer_load_dwordx4 v10, s[52:55], s67 offen offset:1024 sc1 lds
  s_lshr_b32 m0, s79, 6
  s_add_u32 m0, m0, s19
  s_nop 0
  buffer_load_dwordx4 v10, s[52:55], s79 offen offset:0 sc1 lds
  buffer_load_dwordx4 v10, s[52:55], s79 offen offset:1024 sc1 lds
  s_lshr_b32 m0, s64, 6
  s_add_u32 m0, m0, s19
  s_nop 0
  buffer_load_dwordx4 v10, s[52:55], s64 offen offset:0 sc1 lds
  buffer_load_dwordx4 v10, s[52:55], s64 offen offset:1024 sc1 lds
  s_lshr_b32 m0, s65, 6
  s_add_u32 m0, m0, s19
  s_nop 0
  buffer_load_dwordx4 v10, s[52:55], s65 offen offset:0 sc1 lds
  buffer_load_dwordx4 v10, s[52:55], s65 offen offset:1024 sc1 lds
  v_add_u32 v10, 2048, v10
  s_xor_b32 s19, s19, 0x10000
  s_waitcnt vmcnt(24)
  s_barrier
  s_lshr_b32 m0, s66, 2
  s_add_u32 m0, m0, s18
  s_nop 0
  buffer_load_dwordx4 v8, s[36:39], s66 offen lds
  s_lshr_b32 m0, s10, 2
  s_add_u32 m0, m0, s18
  s_nop 0
  buffer_load_dwordx4 v8, s[36:39], s10 offen lds
  s_lshr_b32 m0, s11, 2
  s_add_u32 m0, m0, s18
  s_nop 0
  buffer_load_dwordx4 v8, s[36:39], s11 offen lds
  s_lshr_b32 m0, s12, 2
  s_add_u32 m0, m0, s18
  s_nop 0
  buffer_load_dwordx4 v8, s[36:39], s12 offen lds
  s_lshr_b32 m0, s13, 2
  s_add_u32 m0, m0, s18
  s_nop 0
  buffer_load_dwordx4 v8, s[36:39], s13 offen lds
  s_lshr_b32 m0, s16, 2
  s_add_u32 m0, m0, s18
  s_nop 0
  buffer_load_dwordx4 v8, s[36:39], s16 offen lds
  s_lshr_b32 m0, s17, 2
  s_add_u32 m0, m0, s18
  s_nop 0
  buffer_load_dwordx4 v8, s[36:39], s17 offen lds
  s_lshr_b32 m0, s78, 2
  s_add_u32 m0, m0, s18
  s_nop 0
  buffer_load_dwordx4 v8, s[36:39], s78 offen lds
  v_add_u32 v8, 0x10000, v8
  s_xor_b32 s18, s18, 0x8000
  s_lshr_b32 m0, s67, 6
  s_add_u32 m0, m0, s19
  s_nop 0
  buffer_load_dwordx4 v10, s[52:55], s67 offen offset:0 sc1 lds
  buffer_load_dwordx4 v10, s[52:55], s67 offen offset:1024 sc1 lds
  s_lshr_b32 m0, s79, 6
  s_add_u32 m0, m0, s19
  s_nop 0
  buffer_load_dwordx4 v10, s[52:55], s79 offen offset:0 sc1 lds
  buffer_load_dwordx4 v10, s[52:55], s79 offen offset:1024 sc1 lds
  s_lshr_b32 m0, s64, 6
  s_add_u32 m0, m0, s19
  s_nop 0
  buffer_load_dwordx4 v10, s[52:55], s64 offen offset:0 sc1 lds
  buffer_load_dwordx4 v10, s[52:55], s64 offen offset:1024 sc1 lds
  s_lshr_b32 m0, s65, 6
  s_add_u32 m0, m0, s19
  s_nop 0
  buffer_load_dwordx4 v10, s[52:55], s65 offen offset:0 sc1 lds
  buffer_load_dwordx4 v10, s[52:55], s65 offen offset:1024 sc1 lds
  v_add_u32 v10, 2048, v10
  s_xor_b32 s19, s19, 0x8000
  s_waitcnt vmcnt(32)
  s_barrier
  s_lshr_b32 m0, s66, 2
  s_add_u32 m0, m0, s18
  s_nop 0
  buffer_load_dwordx4 v8, s[36:39], s66 offen lds
  s_lshr_b32 m0, s10, 2
  s_add_u32 m0, m0, s18
  s_nop 0
  buffer_load_dwordx4 v8, s[36:39], s10 offen lds
  s_lshr_b32 m0, s11, 2
  s_add_u32 m0, m0, s18
  s_nop 0
  buffer_load_dwordx4 v8, s[36:39], s11 offen lds
  s_lshr_b32 m0, s12, 2
  s_add_u32 m0, m0, s18
  s_nop 0
  buffer_load_dwordx4 v8, s[36:39], s12 offen lds
  s_lshr_b32 m0, s13, 2
  s_add_u32 m0, m0, s18
  s_nop 0
  buffer_load_dwordx4 v8, s[36:39], s13 offen lds
  s_lshr_b32 m0, s16, 2
  s_add_u32 m0, m0, s18
  s_nop 0
  buffer_load_dwordx4 v8, s[36:39], s16 offen lds
  s_lshr_b32 m0, s17, 2
  s_add_u32 m0, m0, s18
  s_nop 0
  buffer_load_dwordx4 v8, s[36:39], s17 offen lds
  s_lshr_b32 m0, s78, 2
  s_add_u32 m0, m0, s18
  s_nop 0
  buffer_load_dwordx4 v8, s[36:39], s78 offen lds
  v_add_u32 v8, 0x10000, v8
  s_xor_b32 s18, s18, 0x10000
  s_lshr_b32 m0, s67, 6
  s_add_u32 m0, m0, s19
  s_nop 0
  buffer_load_dwordx4 v10, s[52:55], s67 offen offset:0 sc1 lds
  buffer_load_dwordx4 v10, s[52:55], s67 offen offset:1024 sc1 lds
  s_lshr_b32 m0, s79, 6
  s_add_u32 m0, m0, s19
  s_nop 0
  buffer_load_dwordx4 v10, s[52:55], s79 offen offset:0 sc1 lds
  buffer_load_dwordx4 v10, s[52:55], s79 offen offset:1024 sc1 lds
  s_lshr_b32 m0, s64, 6
  s_add_u32 m0, m0, s19
  s_nop 0
  buffer_load_dwordx4 v10, s[52:55], s64 offen offset:0 sc1 lds
  buffer_load_dwordx4 v10, s[52:55], s64 offen offset:1024 sc1 lds
  s_lshr_b32 m0, s65, 6
  s_add_u32 m0, m0, s19
  s_nop 0
  buffer_load_dwordx4 v10, s[52:55], s65 offen offset:0 sc1 lds
  buffer_load_dwordx4 v10, s[52:55], s65 offen offset:1024 sc1 lds
  v_add_u32 v10, 2048, v10
  s_xor_b32 s19, s19, 0x10000
  s_waitcnt vmcnt(32)
  s_barrier
  s_lshr_b32 m0, s66, 2
  s_add_u32 m0, m0, s18
  s_nop 0
  buffer_load_dwordx4 v8, s[36:39], s66 offen lds
  s_lshr_b32 m0, s10, 2
  s_add_u32 m0, m0, s18
  s_nop 0
  buffer_load_dwordx4 v8, s[36:39], s10 offen lds
  s_lshr_b32 m0, s11, 2
  s_add_u32 m0, m0, s18
  s_nop 0
  buffer_load_dwordx4 v8, s[36:39], s11 offen lds
  s_lshr_b32 m0, s12, 2
  s_add_u32 m0, m0, s18
  s_nop 0
  buffer_load_dwordx4 v8, s[36:39], s12 offen lds
  s_lshr_b32 m0, s13, 2
  s_add_u32 m0, m0, s18
  s_nop 0
  buffer_load_dwordx4 v8, s[36:39], s13 offen lds
  s_lshr_b32 m0, s16, 2
  s_add_u32 m0, m0, s18
  s_nop 0
  buffer_load_dwordx4 v8, s[36:39], s16 offen lds
  s_lshr_b32 m0, s17, 2
  s_add_u32 m0, m0, s18
  s_nop 0
  buffer_load_dwordx4 v8, s[36:39], s17 offen lds
  s_lshr_b32 m0, s78, 2
  s_add_u32 m0, m0, s18
  s_nop 0
  buffer_load_dwordx4 v8, s[36:39], s78 offen lds
  v_add_u32 v8, 0x10000, v8
  s_xor_b32 s18, s18, 0x8000
  s_lshr_b32 m0, s67, 6
  s_add_u32 m0, m0, s19
  s_nop 0
  buffer_load_dwordx4 v10, s[52:55], s67 offen offset:0 sc1 lds
  buffer_load_dwordx4 v10, s[52:55], s67 offen offset:1024 sc1 lds
  s_lshr_b32 m0, s79, 6
  s_add_u32 m0, m0, s19
  s_nop 0
  buffer_load_dwordx4 v10, s[52:55], s79 offen offset:0 sc1 lds
  buffer_load_dwordx4 v10, s[52:55], s79 offen offset:1024 sc1 lds
  s_lshr_b32 m0, s64, 6
  s_add_u32 m0, m0, s19
  s_nop 0
  buffer_load_dwordx4 v10, s[52:55], s64 offen offset:0 sc1 lds
  buffer_load_dwordx4 v10, s[52:55], s64 offen offset:1024 sc1 lds
  s_lshr_b32 m0, s65, 6
  s_add_u32 m0, m0, s19
  s_nop 0
  buffer_load_dwordx4 v10, s[52:55], s65 offen offset:0 sc1 lds
  buffer_load_dwordx4 v10, s[52:55], s65 offen offset:1024 sc1 lds
  v_add_u32 v10, 2048, v10
  s_xor_b32 s19, s19, 0x8000
  s_waitcnt vmcnt(32)
  s_barrier
  s_lshr_b32 m0, s66, 2
  s_add_u32 m0, m0, s18
  s_nop 0
  buffer_load_dwordx4 v8, s[36:39], s66 offen lds
  s_lshr_b32 m0, s10, 2
  s_add_u32 m0, m0, s18
  s_nop 0
  buffer_load_dwordx4 v8, s[36:39], s10 offen lds
  s_lshr_b32 m0, s11, 2
  s_add_u32 m0, m0, s18
  s_nop 0
  buffer_load_dwordx4 v8, s[36:39], s11 offen lds
  s_lshr_b32 m0, s12, 2
  s_add_u32 m0, m0, s18
  s_nop 0
  buffer_load_dwordx4 v8, s[36:39], s12 offen lds
  s_lshr_b32 m0, s13, 2
  s_add_u32 m0, m0, s18
  s_nop 0
  buffer_load_dwordx4 v8, s[36:39], s13 offen lds
  s_lshr_b32 m0, s16, 2
  s_add_u32 m0, m0, s18
  s_nop 0
  buffer_load_dwordx4 v8, s[36:39], s16 offen lds
  s_lshr_b32 m0, s17, 2
  s_add_u32 m0, m0, s18
  s_nop 0
  buffer_load_dwordx4 v8, s[36:39], s17 offen lds
  s_lshr_b32 m0, s78, 2
  s_add_u32 m0, m0, s18
  s_nop 0
  buffer_load_dwordx4 v8, s[36:39], s78 offen lds
  v_add_u32 v8, 0x10000, v8
  s_xor_b32 s18, s18, 0x10000
  s_lshr_b32 m0, s67, 6
  s_add_u32 m0, m0, s19
  s_nop 0
  buffer_load_dwordx4 v10, s[52:55], s67 offen offset:0 sc1 lds
  buffer_load_dwordx4 v10, s[52:55], s67 offen offset:1024 sc1 lds
  s_lshr_b32 m0, s79, 6
  s_add_u32 m0, m0, s19
  s_nop 0
  buffer_load_dwordx4 v10, s[52:55], s79 offen offset:0 sc1 lds
  buffer_load_dwordx4 v10, s[52:55], s79 offen offset:1024 sc1 lds
  s_lshr_b32 m0, s64, 6
  s_add_u32 m0, m0, s19
  s_nop 0
  buffer_load_dwordx4 v10, s[52:55], s64 offen offset:0 sc1 lds
  buffer_load_dwordx4 v10, s[52:55], s64 offen offset:1024 sc1 lds
  s_lshr_b32 m0, s65, 6
  s_add_u32 m0, m0, s19
  s_nop 0
  buffer_load_dwordx4 v10, s[52:55], s65 offen offset:0 sc1 lds
  buffer_load_dwordx4 v10, s[52:55], s65 offen offset:1024 sc1 lds
  v_add_u32 v10, 2048, v10
  s_xor_b32 s19, s19, 0x10000
  s_waitcnt vmcnt(32)
  s_barrier
  s_lshr_b32 m0, s66, 2
  s_add_u32 m0, m0, s18
  s_nop 0
  buffer_load_dwordx4 v8, s[36:39], s66 offen lds
  s_lshr_b32 m0, s10, 2
  s_add_u32 m0, m0, s18
  s_nop 0
  buffer_load_dwordx4 v8, s[36:39], s10 offen lds
  s_lshr_b32 m0, s11, 2
  s_add_u32 m0, m0, s18
  s_nop 0
  buffer_load_dwordx4 v8, s[36:39], s11 offen lds
  s_lshr_b32 m0, s12, 2
  s_add_u32 m0, m0, s18
  s_nop 0
  buffer_load_dwordx4 v8, s[36:39], s12 offen lds
  s_lshr_b32 m0, s13, 2
  s_add_u32 m0, m0, s18
  s_nop 0
  buffer_load_dwordx4 v8, s[36:39], s13 offen lds
  s_lshr_b32 m0, s16, 2
  s_add_u32 m0, m0, s18
  s_nop 0
  buffer_load_dwordx4 v8, s[36:39], s16 offen lds
  s_lshr_b32 m0, s17, 2
  s_add_u32 m0, m0, s18
  s_nop 0
  buffer_load_dwordx4 v8, s[36:39], s17 offen lds
  s_lshr_b32 m0, s78, 2
  s_add_u32 m0, m0, s18
  s_nop 0
  buffer_load_dwordx4 v8, s[36:39], s78 offen lds
  v_add_u32 v8, 0x10000, v8
  s_xor_b32 s18, s18, 0x8000
  s_lshr_b32 m0, s67, 6
  s_add_u32 m0, m0, s19
  s_nop 0
  buffer_load_dwordx4 v10, s[52:55], s67 offen offset:0 sc1 lds
  buffer_load_dwordx4 v10, s[52:55], s67 offen offset:1024 sc1 lds
  s_lshr_b32 m0, s79, 6
  s_add_u32 m0, m0, s19
  s_nop 0
  buffer_load_dwordx4 v10, s[52:55], s79 offen offset:0 sc1 lds
  buffer_load_dwordx4 v10, s[52:55], s79 offen offset:1024 sc1 lds
  s_lshr_b32 m0, s64, 6
  s_add_u32 m0, m0, s19
  s_nop 0
  buffer_load_dwordx4 v10, s[52:55], s64 offen offset:0 sc1 lds
  buffer_load_dwordx4 v10, s[52:55], s64 offen offset:1024 sc1 lds
  s_lshr_b32 m0, s65, 6
  s_add_u32 m0, m0, s19
  s_nop 0
  buffer_load_dwordx4 v10, s[52:55], s65 offen offset:0 sc1 lds
  buffer_load_dwordx4 v10, s[52:55], s65 offen offset:1024 sc1 lds
  v_add_u32 v10, 2048, v10
  s_xor_b32 s19, s19, 0x8000
  s_waitcnt vmcnt(32)
  s_barrier
  s_lshr_b32 m0, s66, 2
  s_add_u32 m0, m0, s18
  s_nop 0
  buffer_load_dwordx4 v8, s[36:39], s66 offen lds
  s_lshr_b32 m0, s10, 2
  s_add_u32 m0, m0, s18
  s_nop 0
  buffer_load_dwordx4 v8, s[36:39], s10 offen lds
  s_lshr_b32 m0, s11, 2
  s_add_u32 m0, m0, s18
  s_nop 0
  buffer_load_dwordx4 v8, s[36:39], s11 offen lds
  s_lshr_b32 m0, s12, 2
  s_add_u32 m0, m0, s18
  s_nop 0
  buffer_load_dwordx4 v8, s[36:39], s12 offen lds
  s_lshr_b32 m0, s13, 2
  s_add_u32 m0, m0, s18
  s_nop 0
  buffer_load_dwordx4 v8, s[36:39], s13 offen lds
  s_lshr_b32 m0, s16, 2
  s_add_u32 m0, m0, s18
  s_nop 0
  buffer_load_dwordx4 v8, s[36:39], s16 offen lds
  s_lshr_b32 m0, s17, 2
  s_add_u32 m0, m0, s18
  s_nop 0
  buffer_load_dwordx4 v8, s[36:39], s17 offen lds
  s_lshr_b32 m0, s78, 2
  s_add_u32 m0, m0, s18
  s_nop 0
  buffer_load_dwordx4 v8, s[36:39], s78 offen lds
  v_add_u32 v8, 0x10000, v8
  s_xor_b32 s18, s18, 0x10000
  s_lshr_b32 m0, s67, 6
  s_add_u32 m0, m0, s19
  s_nop 0
  buffer_load_dwordx4 v10, s[52:55], s67 offen offset:0 sc1 lds
  buffer_load_dwordx4 v10, s[52:55], s67 offen offset:1024 sc1 lds
  s_lshr_b32 m0, s79, 6
  s_add_u32 m0, m0, s19
  s_nop 0
  buffer_load_dwordx4 v10, s[52:55], s79 offen offset:0 sc1 lds
  buffer_load_dwordx4 v10, s[52:55], s79 offen offset:1024 sc1 lds
  s_lshr_b32 m0, s64, 6
  s_add_u32 m0, m0, s19
  s_nop 0
  buffer_load_dwordx4 v10, s[52:55], s64 offen offset:0 sc1 lds
  buffer_load_dwordx4 v10, s[52:55], s64 offen offset:1024 sc1 lds
  s_lshr_b32 m0, s65, 6
  s_add_u32 m0, m0, s19
  s_nop 0
  buffer_load_dwordx4 v10, s[52:55], s65 offen offset:0 sc1 lds
  buffer_load_dwordx4 v10, s[52:55], s65 offen offset:1024 sc1 lds
  v_add_u32 v10, 2048, v10
  s_xor_b32 s19, s19, 0x10000
  s_waitcnt vmcnt(32)
  s_barrier
  s_lshr_b32 m0, s66, 2
  s_add_u32 m0, m0, s18
  s_nop 0
  buffer_load_dwordx4 v8, s[36:39], s66 offen lds
  s_lshr_b32 m0, s10, 2
  s_add_u32 m0, m0, s18
  s_nop 0
  buffer_load_dwordx4 v8, s[36:39], s10 offen lds
  s_lshr_b32 m0, s11, 2
  s_add_u32 m0, m0, s18
  s_nop 0
  buffer_load_dwordx4 v8, s[36:39], s11 offen lds
  s_lshr_b32 m0, s12, 2
  s_add_u32 m0, m0, s18
  s_nop 0
  buffer_load_dwordx4 v8, s[36:39], s12 offen lds
  s_lshr_b32 m0, s13, 2
  s_add_u32 m0, m0, s18
  s_nop 0
  buffer_load_dwordx4 v8, s[36:39], s13 offen lds
  s_lshr_b32 m0, s16, 2
  s_add_u32 m0, m0, s18
  s_nop 0
  buffer_load_dwordx4 v8, s[36:39], s16 offen lds
  s_lshr_b32 m0, s17, 2
  s_add_u32 m0, m0, s18
  s_nop 0
  buffer_load_dwordx4 v8, s[36:39], s17 offen lds
  s_lshr_b32 m0, s78, 2
  s_add_u32 m0, m0, s18
  s_nop 0
  buffer_load_dwordx4 v8, s[36:39], s78 offen lds
  v_add_u32 v8, 0x10000, v8
  s_xor_b32 s18, s18, 0x8000
  s_lshr_b32 m0, s67, 6
  s_add_u32 m0, m0, s19
  s_nop 0
  buffer_load_dwordx4 v10, s[52:55], s67 offen offset:0 sc1 lds
  buffer_load_dwordx4 v10, s[52:55], s67 offen offset:1024 sc1 lds
  s_lshr_b32 m0, s79, 6
  s_add_u32 m0, m0, s19
  s_nop 0
  buffer_load_dwordx4 v10, s[52:55], s79 offen offset:0 sc1 lds
  buffer_load_dwordx4 v10, s[52:55], s79 offen offset:1024 sc1 lds
  s_lshr_b32 m0, s64, 6
  s_add_u32 m0, m0, s19
  s_nop 0
  buffer_load_dwordx4 v10, s[52:55], s64 offen offset:0 sc1 lds
  buffer_load_dwordx4 v10, s[52:55], s64 offen offset:1024 sc1 lds
  s_lshr_b32 m0, s65, 6
  s_add_u32 m0, m0, s19
  s_nop 0
  buffer_load_dwordx4 v10, s[52:55], s65 offen offset:0 sc1 lds
  buffer_load_dwordx4 v10, s[52:55], s65 offen offset:1024 sc1 lds
  v_add_u32 v10, 2048, v10
  s_xor_b32 s19, s19, 0x8000
  s_waitcnt vmcnt(32)
  s_barrier
  s_lshr_b32 m0, s66, 2
  s_add_u32 m0, m0, s18
  s_nop 0
  buffer_load_dwordx4 v8, s[36:39], s66 offen lds
  s_lshr_b32 m0, s10, 2
  s_add_u32 m0, m0, s18
  s_nop 0
  buffer_load_dwordx4 v8, s[36:39], s10 offen lds
  s_lshr_b32 m0, s11, 2
  s_add_u32 m0, m0, s18
  s_nop 0
  buffer_load_dwordx4 v8, s[36:39], s11 offen lds
  s_lshr_b32 m0, s12, 2
  s_add_u32 m0, m0, s18
  s_nop 0
  buffer_load_dwordx4 v8, s[36:39], s12 offen lds
  s_lshr_b32 m0, s13, 2
  s_add_u32 m0, m0, s18
  s_nop 0
  buffer_load_dwordx4 v8, s[36:39], s13 offen lds
  s_lshr_b32 m0, s16, 2
  s_add_u32 m0, m0, s18
  s_nop 0
  buffer_load_dwordx4 v8, s[36:39], s16 offen lds
  s_lshr_b32 m0, s17, 2
  s_add_u32 m0, m0, s18
  s_nop 0
  buffer_load_dwordx4 v8, s[36:39], s17 offen lds
  s_lshr_b32 m0, s78, 2
  s_add_u32 m0, m0, s18
  s_nop 0
  buffer_load_dwordx4 v8, s[36:39], s78 offen lds
  v_add_u32 v8, 0x10000, v8
  s_xor_b32 s18, s18, 0x10000
  s_lshr_b32 m0, s67, 6
  s_add_u32 m0, m0, s19
  s_nop 0
  buffer_load_dwordx4 v10, s[52:55], s67 offen offset:0 sc1 lds
  buffer_load_dwordx4 v10, s[52:55], s67 offen offset:1024 sc1 lds
  s_lshr_b32 m0, s79, 6
  s_add_u32 m0, m0, s19
  s_nop 0
  buffer_load_dwordx4 v10, s[52:55], s79 offen offset:0 sc1 lds
  buffer_load_dwordx4 v10, s[52:55], s79 offen offset:1024 sc1 lds
  s_lshr_b32 m0, s64, 6
  s_add_u32 m0, m0, s19
  s_nop 0
  buffer_load_dwordx4 v10, s[52:55], s64 offen offset:0 sc1 lds
  buffer_load_dwordx4 v10, s[52:55], s64 offen offset:1024 sc1 lds
  s_lshr_b32 m0, s65, 6
  s_add_u32 m0, m0, s19
  s_nop 0
  buffer_load_dwordx4 v10, s[52:55], s65 offen offset:0 sc1 lds
  buffer_load_dwordx4 v10, s[52:55], s65 offen offset:1024 sc1 lds
  v_add_u32 v10, 2048, v10
  s_xor_b32 s19, s19, 0x10000
  s_waitcnt vmcnt(32)
  s_barrier
  s_lshr_b32 m0, s66, 2
  s_add_u32 m0, m0, s18
  s_nop 0
  buffer_load_dwordx4 v8, s[36:39], s66 offen lds
  s_lshr_b32 m0, s10, 2
  s_add_u32 m0, m0, s18
  s_nop 0
  buffer_load_dwordx4 v8, s[36:39], s10 offen lds
  s_lshr_b32 m0, s11, 2
  s_add_u32 m0, m0, s18
  s_nop 0
  buffer_load_dwordx4 v8, s[36:39], s11 offen lds
  s_lshr_b32 m0, s12, 2
  s_add_u32 m0, m0, s18
  s_nop 0
  buffer_load_dwordx4 v8, s[36:39], s12 offen lds
  s_lshr_b32 m0, s13, 2
  s_add_u32 m0, m0, s18
  s_nop 0
  buffer_load_dwordx4 v8, s[36:39], s13 offen lds
  s_lshr_b32 m0, s16, 2
  s_add_u32 m0, m0, s18
  s_nop 0
  buffer_load_dwordx4 v8, s[36:39], s16 offen lds
  s_lshr_b32 m0, s17, 2
  s_add_u32 m0, m0, s18
  s_nop 0
  buffer_load_dwordx4 v8, s[36:39], s17 offen lds
  s_lshr_b32 m0, s78, 2
  s_add_u32 m0, m0, s18
  s_nop 0
  buffer_load_dwordx4 v8, s[36:39], s78 offen lds
  v_add_u32 v8, 0x10000, v8
  s_xor_b32 s18, s18, 0x8000
  s_lshr_b32 m0, s67, 6
  s_add_u32 m0, m0, s19
  s_nop 0
  buffer_load_dwordx4 v10, s[52:55], s67 offen offset:0 sc1 lds
  buffer_load_dwordx4 v10, s[52:55], s67 offen offset:1024 sc1 lds
  s_lshr_b32 m0, s79, 6
  s_add_u32 m0, m0, s19
  s_nop 0
  buffer_load_dwordx4 v10, s[52:55], s79 offen offset:0 sc1 lds
  buffer_load_dwordx4 v10, s[52:55], s79 offen offset:1024 sc1 lds
  s_lshr_b32 m0, s64, 6
  s_add_u32 m0, m0, s19
  s_nop 0
  buffer_load_dwordx4 v10, s[52:55], s64 offen offset:0 sc1 lds
  buffer_load_dwordx4 v10, s[52:55], s64 offen offset:1024 sc1 lds
  s_lshr_b32 m0, s65, 6
  s_add_u32 m0, m0, s19
  s_nop 0
  buffer_load_dwordx4 v10, s[52:55], s65 offen offset:0 sc1 lds
  buffer_load_dwordx4 v10, s[52:55], s65 offen offset:1024 sc1 lds
  v_add_u32 v10, 2048, v10
  s_xor_b32 s19, s19, 0x8000
  s_waitcnt vmcnt(32)
  s_barrier
  s_lshr_b32 m0, s66, 2
  s_add_u32 m0, m0, s18
  s_nop 0
  buffer_load_dwordx4 v8, s[36:39], s66 offen lds
  s_lshr_b32 m0, s10, 2
  s_add_u32 m0, m0, s18
  s_nop 0
  buffer_load_dwordx4 v8, s[36:39], s10 offen lds
  s_lshr_b32 m0, s11, 2
  s_add_u32 m0, m0, s18
  s_nop 0
  buffer_load_dwordx4 v8, s[36:39], s11 offen lds
  s_lshr_b32 m0, s12, 2
  s_add_u32 m0, m0, s18
  s_nop 0
  buffer_load_dwordx4 v8, s[36:39], s12 offen lds
  s_lshr_b32 m0, s13, 2
  s_add_u32 m0, m0, s18
  s_nop 0
  buffer_load_dwordx4 v8, s[36:39], s13 offen lds
  s_lshr_b32 m0, s16, 2
  s_add_u32 m0, m0, s18
  s_nop 0
  buffer_load_dwordx4 v8, s[36:39], s16 offen lds
  s_lshr_b32 m0, s17, 2
  s_add_u32 m0, m0, s18
  s_nop 0
  buffer_load_dwordx4 v8, s[36:39], s17 offen lds
  s_lshr_b32 m0, s78, 2
  s_add_u32 m0, m0, s18
  s_nop 0
  buffer_load_dwordx4 v8, s[36:39], s78 offen lds
  v_add_u32 v8, 0x10000, v8
  s_xor_b32 s18, s18, 0x10000
  s_lshr_b32 m0, s67, 6
  s_add_u32 m0, m0, s19
  s_nop 0
  buffer_load_dwordx4 v10, s[52:55], s67 offen offset:0 sc1 lds
  buffer_load_dwordx4 v10, s[52:55], s67 offen offset:1024 sc1 lds
  s_lshr_b32 m0, s79, 6
  s_add_u32 m0, m0, s19
  s_nop 0
  buffer_load_dwordx4 v10, s[52:55], s79 offen offset:0 sc1 lds
  buffer_load_dwordx4 v10, s[52:55], s79 offen offset:1024 sc1 lds
  s_lshr_b32 m0, s64, 6
  s_add_u32 m0, m0, s19
  s_nop 0
  buffer_load_dwordx4 v10, s[52:55], s64 offen offset:0 sc1 lds
  buffer_load_dwordx4 v10, s[52:55], s64 offen offset:1024 sc1 lds
  s_lshr_b32 m0, s65, 6
  s_add_u32 m0, m0, s19
  s_nop 0
  buffer_load_dwordx4 v10, s[52:55], s65 offen offset:0 sc1 lds
  buffer_load_dwordx4 v10, s[52:55], s65 offen offset:1024 sc1 lds
  v_add_u32 v10, 2048, v10
  s_xor_b32 s19, s19, 0x10000
  s_waitcnt vmcnt(32)
  s_barrier
  s_lshr_b32 m0, s66, 2
  s_add_u32 m0, m0, s18
  s_nop 0
  buffer_load_dwordx4 v8, s[36:39], s66 offen lds
  s_lshr_b32 m0, s10, 2
  s_add_u32 m0, m0, s18
  s_nop 0
  buffer_load_dwordx4 v8, s[36:39], s10 offen lds
  s_lshr_b32 m0, s11, 2
  s_add_u32 m0, m0, s18
  s_nop 0
  buffer_load_dwordx4 v8, s[36:39], s11 offen lds
  s_lshr_b32 m0, s12, 2
  s_add_u32 m0, m0, s18
  s_nop 0
  buffer_load_dwordx4 v8, s[36:39], s12 offen lds
  s_lshr_b32 m0, s13, 2
  s_add_u32 m0, m0, s18
  s_nop 0
  buffer_load_dwordx4 v8, s[36:39], s13 offen lds
  s_lshr_b32 m0, s16, 2
  s_add_u32 m0, m0, s18
  s_nop 0
  buffer_load_dwordx4 v8, s[36:39], s16 offen lds
  s_lshr_b32 m0, s17, 2
  s_add_u32 m0, m0, s18
  s_nop 0
  buffer_load_dwordx4 v8, s[36:39], s17 offen lds
  s_lshr_b32 m0, s78, 2
  s_add_u32 m0, m0, s18
  s_nop 0
  buffer_load_dwordx4 v8, s[36:39], s78 offen lds
  v_add_u32 v8, 0x10000, v8
  s_xor_b32 s18, s18, 0x8000
  s_lshr_b32 m0, s67, 6
  s_add_u32 m0, m0, s19
  s_nop 0
  buffer_load_dwordx4 v10, s[52:55], s67 offen offset:0 sc1 lds
  buffer_load_dwordx4 v10, s[52:55], s67 offen offset:1024 sc1 lds
  s_lshr_b32 m0, s79, 6
  s_add_u32 m0, m0, s19
  s_nop 0
  buffer_load_dwordx4 v10, s[52:55], s79 offen offset:0 sc1 lds
  buffer_load_dwordx4 v10, s[52:55], s79 offen offset:1024 sc1 lds
  s_lshr_b32 m0, s64, 6
  s_add_u32 m0, m0, s19
  s_nop 0
  buffer_load_dwordx4 v10, s[52:55], s64 offen offset:0 sc1 lds
  buffer_load_dwordx4 v10, s[52:55], s64 offen offset:1024 sc1 lds
  s_lshr_b32 m0, s65, 6
  s_add_u32 m0, m0, s19
  s_nop 0
  buffer_load_dwordx4 v10, s[52:55], s65 offen offset:0 sc1 lds
  buffer_load_dwordx4 v10, s[52:55], s65 offen offset:1024 sc1 lds
  v_add_u32 v10, 2048, v10
  s_xor_b32 s19, s19, 0x8000
  s_waitcnt vmcnt(32)
  s_barrier
  s_lshr_b32 m0, s66, 2
  s_add_u32 m0, m0, s18
  s_nop 0
  buffer_load_dwordx4 v8, s[36:39], s66 offen lds
  s_lshr_b32 m0, s10, 2
  s_add_u32 m0, m0, s18
  s_nop 0
  buffer_load_dwordx4 v8, s[36:39], s10 offen lds
  s_lshr_b32 m0, s11, 2
  s_add_u32 m0, m0, s18
  s_nop 0
  buffer_load_dwordx4 v8, s[36:39], s11 offen lds
  s_lshr_b32 m0, s12, 2
  s_add_u32 m0, m0, s18
  s_nop 0
  buffer_load_dwordx4 v8, s[36:39], s12 offen lds
  s_lshr_b32 m0, s13, 2
  s_add_u32 m0, m0, s18
  s_nop 0
  buffer_load_dwordx4 v8, s[36:39], s13 offen lds
  s_lshr_b32 m0, s16, 2
  s_add_u32 m0, m0, s18
  s_nop 0
  buffer_load_dwordx4 v8, s[36:39], s16 offen lds
  s_lshr_b32 m0, s17, 2
  s_add_u32 m0, m0, s18
  s_nop 0
  buffer_load_dwordx4 v8, s[36:39], s17 offen lds
  s_lshr_b32 m0, s78, 2
  s_add_u32 m0, m0, s18
  s_nop 0
  buffer_load_dwordx4 v8, s[36:39], s78 offen lds
  v_add_u32 v8, 0x10000, v8
  s_xor_b32 s18, s18, 0x10000
  s_lshr_b32 m0, s67, 6
  s_add_u32 m0, m0, s19
  s_nop 0
  buffer_load_dwordx4 v10, s[52:55], s67 offen offset:0 sc1 lds
  buffer_load_dwordx4 v10, s[52:55], s67 offen offset:1024 sc1 lds
  s_lshr_b32 m0, s79, 6
  s_add_u32 m0, m0, s19
  s_nop 0
  buffer_load_dwordx4 v10, s[52:55], s79 offen offset:0 sc1 lds
  buffer_load_dwordx4 v10, s[52:55], s79 offen offset:1024 sc1 lds
  s_lshr_b32 m0, s64, 6
  s_add_u32 m0, m0, s19
  s_nop 0
  buffer_load_dwordx4 v10, s[52:55], s64 offen offset:0 sc1 lds
  buffer_load_dwordx4 v10, s[52:55], s64 offen offset:1024 sc1 lds
  s_lshr_b32 m0, s65, 6
  s_add_u32 m0, m0, s19
  s_nop 0
  buffer_load_dwordx4 v10, s[52:55], s65 offen offset:0 sc1 lds
  buffer_load_dwordx4 v10, s[52:55], s65 offen offset:1024 sc1 lds
  v_add_u32 v10, 2048, v10
  s_xor_b32 s19, s19, 0x10000
  s_waitcnt vmcnt(32)
  s_barrier
  s_waitcnt vmcnt(16)
  s_barrier
  s_waitcnt vmcnt(0)
  s_barrier
  s_barrier
  s_endpgm
LF_tail:
  s_setprio 0
  s_barrier
  s_waitcnt vmcnt(0)
  s_barrier
  v_lshrrev_b32 v17, 1, v1
  v_and_b32 v18, 1, v1
  v_lshlrev_b32 v18, 7, v18
  v_lshl_add_u32 v17, v17, 10, v18
  s_and_b32 s60, s7, 7
  s_lshl_b32 s60, s60, 1
  s_and_b32 s61, s59, 1
  s_add_u32 s60, s60, s61
  s_lshl_b32 s60, s60, 16
  s_lshl_b32 s61, s6, 20
  s_add_u32 s60, s60, s61
  s_lshl_b32 s61, s8, 8
  s_add_u32 s60, s60, s61
  buffer_load_dword v31, v17, s[36:39], s60 offen
  s_add_u32 s60, s60, 0x8000
  s_barrier
  buffer_load_dword v31, v17, s[36:39], s60 offen
  v_and_b32 v16, 3, v1
  s_andn2_b32 s62, s2, 3
  v_add_u32 v16, s62, v16
  v_lshlrev_b32 v16, 10, v16
  v_add_u32 v12, 256, v16
  s_mov_b32 s44, s24
  s_mov_b32 s45, s25
  s_mov_b32 s46, 0x400
  s_mov_b32 s47, 0x20000
  s_and_b32 s62, s6, 1
  s_lshl_b32 s62, s62, 7
  s_lshl_b32 s61, s8, 8
  s_add_u32 s62, s62, s61
  v_lshrrev_b32 v17, 4, v1
  v_lshlrev_b32 v17, 3, v17
  buffer_load_dwordx2 v[248:249], v17, s[44:47], s62 offen offset:0
  buffer_load_dwordx2 v[250:251], v17, s[44:47], s62 offen offset:32
  buffer_load_dwordx2 v[252:253], v17, s[44:47], s62 offen offset:64
  buffer_load_dwordx2 v[254:255], v17, s[44:47], s62 offen offset:96
  s_add_u32 s48, s30, 0x3900000
  s_addc_u32 s49, s31, 0
  s_mov_b32 s50, 0x800000
  s_mov_b32 s51, 0x20000
  s_and_b32 s63, s59, 1
  s_lshl_b32 s62, s63, 13
  s_add_u32 s62, s62, 131072
  v_add_u32 v18, s62, v14
  s_lshl_b32 s63, s63, 1
  s_add_u32 s60, s6, 1
  s_and_b32 s60, s60, 3
  s_lshl_b32 s61, s9, 2
  s_add_u32 s60, s60, s61
  s_lshl_b32 s60, s60, 2
  s_add_u32 s60, s60, s6
  s_lshl_b32 s60, s60, 2
  s_add_u32 s60, s60, s63
  s_lshl_b32 s65, s60, 11
  s_add_u32 s60, s6, 2
  s_and_b32 s60, s60, 3
  s_lshl_b32 s61, s9, 2
  s_add_u32 s60, s60, s61
  s_lshl_b32 s60, s60, 2
  s_add_u32 s60, s60, s6
  s_lshl_b32 s60, s60, 2
  s_add_u32 s60, s60, s63
  s_lshl_b32 s66, s60, 11
  s_add_u32 s60, s6, 3
  s_and_b32 s60, s60, 3
  s_lshl_b32 s61, s9, 2
  s_add_u32 s60, s60, s61
  s_lshl_b32 s60, s60, 2
  s_add_u32 s60, s60, s6
  s_lshl_b32 s60, s60, 2
  s_add_u32 s60, s60, s63
  s_lshl_b32 s67, s60, 11
  s_barrier
  ds_read_b128 v[64:67], v18 offset:0
  ds_read_b128 v[68:71], v18 offset:1024
  ds_read_b128 v[72:75], v18 offset:2048
  ds_read_b128 v[76:79], v18 offset:3072
  ds_read_b128 v[80:83], v18 offset:4096
  ds_read_b128 v[84:87], v18 offset:5120
  ds_read_b128 v[88:91], v18 offset:6144
  ds_read_b128 v[92:95], v18 offset:7168
  buffer_load_dword v11, v12, s[88:91], 0 offen sc1
  s_barrier
  s_barrier
  s_waitcnt vmcnt(0)
  v_cmp_gt_u32 vcc, 1, v11
  s_nop 0
  s_cbranch_vccz L_poll9_ok
  s_mov_b32 s3, 0x10000
L_poll9:
  s_sleep 2
  buffer_load_dword v11, v12, s[88:91], 0 offen sc1
  s_waitcnt vmcnt(0)
  v_cmp_gt_u32 vcc, 1, v11
  s_sub_u32 s3, s3, 1
  s_cbranch_scc1 L_poll9_ok
  s_cbranch_vccnz L_poll9
L_poll9_ok:
  buffer_load_dwordx4 v[128:131], v14, s[48:51], s65 offen offset:0 sc1
  buffer_load_dwordx4 v[132:135], v14, s[48:51], s65 offen offset:1024 sc1
  buffer_load_dwordx4 v[136:139], v14, s[48:51], s66 offen offset:0 sc1
  buffer_load_dwordx4 v[140:143], v14, s[48:51], s66 offen offset:1024 sc1
  buffer_load_dwordx4 v[144:147], v14, s[48:51], s67 offen offset:0 sc1
  buffer_load_dwordx4 v[148:151], v14, s[48:51], s67 offen offset:1024 sc1
  buffer_load_dwordx4 v[160:163], v14, s[48:51], s65 offen offset:2048 sc1
  buffer_load_dwordx4 v[164:167], v14, s[48:51], s65 offen offset:3072 sc1
  buffer_load_dwordx4 v[168:171], v14, s[48:51], s66 offen offset:2048 sc1
  buffer_load_dwordx4 v[172:175], v14, s[48:51], s66 offen offset:3072 sc1
  buffer_load_dwordx4 v[176:179], v14, s[48:51], s67 offen offset:2048 sc1
  buffer_load_dwordx4 v[180:183], v14, s[48:51], s67 offen offset:3072 sc1
  s_barrier
  s_barrier
  s_mov_b32 s3, 0x10000
LF_gchk0:
  s_waitcnt vmcnt(0)
LF_gchk0_t:
  v_max3_u32 v16, v128, v129, v130
  v_max3_u32 v17, v131, v132, v133
  v_max3_u32 v16, v16, v134, v135
  v_max3_u32 v17, v17, v136, v137
  v_max3_u32 v16, v16, v138, v139
  v_max3_u32 v17, v17, v140, v141
  v_max3_u32 v16, v16, v142, v143
  v_max3_u32 v17, v17, v144, v145
  v_max3_u32 v16, v16, v146, v147
  v_max3_u32 v17, v17, v148, v149
  v_max3_u32 v16, v16, v150, v151
  v_max_u32 v16, v16, v17
  v_cmp_eq_u32 vcc, -1, v16
  s_sub_u32 s3, s3, 1
  s_cbranch_scc1 LF_gchk0_ok
  s_cbranch_vccz LF_gchk0_ok
  buffer_load_dwordx4 v[128:131], v14, s[48:51], s65 offen offset:0 sc1
  buffer_load_dwordx4 v[132:135], v14, s[48:51], s65 offen offset:1024 sc1
  buffer_load_dwordx4 v[136:139], v14, s[48:51], s66 offen offset:0 sc1
  buffer_load_dwordx4 v[140:143], v14, s[48:51], s66 offen offset:1024 sc1
  buffer_load_dwordx4 v[144:147], v14, s[48:51], s67 offen offset:0 sc1
  buffer_load_dwordx4 v[148:151], v14, s[48:51], s67 offen offset:1024 sc1
  s_branch LF_gchk0
LF_gchk0_ok:
  s_mov_b32 s3, 0x10000
LF_gchk1:
  s_waitcnt vmcnt(0)
LF_gchk1_t:
  v_max3_u32 v16, v160, v161, v162
  v_max3_u32 v17, v163, v164, v165
  v_max3_u32 v16, v16, v166, v167
  v_max3_u32 v17, v17, v168, v169
  v_max3_u32 v16, v16, v170, v171
  v_max3_u32 v17, v17, v172, v173
  v_max3_u32 v16, v16, v174, v175
  v_max3_u32 v17, v17, v176, v177
  v_max3_u32 v16, v16, v178, v179
  v_max3_u32 v17, v17, v180, v181
  v_max3_u32 v16, v16, v182, v183
  v_max_u32 v16, v16, v17
  v_cmp_eq_u32 vcc, -1, v16
  s_sub_u32 s3, s3, 1
  s_cbranch_scc1 LF_gchk1_ok
  s_cbranch_vccz LF_gchk1_ok
  buffer_load_dwordx4 v[160:163], v14, s[48:51], s65 offen offset:2048 sc1
  buffer_load_dwordx4 v[164:167], v14, s[48:51], s65 offen offset:3072 sc1
  buffer_load_dwordx4 v[168:171], v14, s[48:51], s66 offen offset:2048 sc1
  buffer_load_dwordx4 v[172:175], v14, s[48:51], s66 offen offset:3072 sc1
  buffer_load_dwordx4 v[176:179], v14, s[48:51], s67 offen offset:2048 sc1
  buffer_load_dwordx4 v[180:183], v14, s[48:51], s67 offen offset:3072 sc1
  s_branch LF_gchk1
LF_gchk1_ok:
  s_barrier
  v_lshlrev_b32 v96, 16, v128
  v_lshlrev_b32 v112, 16, v160
  v_and_b32 v97, 0xffff0000, v128
  v_and_b32 v113, 0xffff0000, v160
  v_lshlrev_b32 v98, 16, v129
  v_lshlrev_b32 v114, 16, v161
  v_and_b32 v99, 0xffff0000, v129
  v_and_b32 v115, 0xffff0000, v161
  v_lshlrev_b32 v100, 16, v130
  v_lshlrev_b32 v116, 16, v162
  v_and_b32 v101, 0xffff0000, v130
  v_and_b32 v117, 0xffff0000, v162
  v_lshlrev_b32 v102, 16, v131
  v_lshlrev_b32 v118, 16, v163
  v_and_b32 v103, 0xffff0000, v131
  v_and_b32 v119, 0xffff0000, v163
  v_lshlrev_b32 v104, 16, v132
  v_lshlrev_b32 v120, 16, v164
  v_and_b32 v105, 0xffff0000, v132
  v_and_b32 v121, 0xffff0000, v164
  v_lshlrev_b32 v106, 16, v133
  v_lshlrev_b32 v122, 16, v165
  v_and_b32 v107, 0xffff0000, v133
  v_and_b32 v123, 0xffff0000, v165
  v_lshlrev_b32 v108, 16, v134
  v_lshlrev_b32 v124, 16, v166
  v_and_b32 v109, 0xffff0000, v134
  v_and_b32 v125, 0xffff0000, v166
  v_lshlrev_b32 v110, 16, v135
  v_lshlrev_b32 v126, 16, v167
  v_and_b32 v111, 0xffff0000, v135
  v_and_b32 v127, 0xffff0000, v167
  s_waitcnt lgkmcnt(7)
  v_pk_add_f32 v[64:65], v[64:65], v[96:97]
  s_waitcnt lgkmcnt(3)
  v_pk_add_f32 v[80:81], v[80:81], v[112:113]
  v_pk_add_f32 v[66:67], v[66:67], v[98:99]
  v_pk_add_f32 v[82:83], v[82:83], v[114:115]
  v_pk_add_f32 v[68:69], v[68:69], v[100:101]
  s_barrier
  s_waitcnt lgkmcnt(2)
  v_pk_add_f32 v[84:85], v[84:85], v[116:117]
  v_pk_add_f32 v[70:71], v[70:71], v[102:103]
  v_pk_add_f32 v[86:87], v[86:87], v[118:119]
  v_pk_add_f32 v[72:73], v[72:73], v[104:105]
  s_waitcnt lgkmcnt(1)
  v_pk_add_f32 v[88:89], v[88:89], v[120:121]
  v_pk_add_f32 v[74:75], v[74:75], v[106:107]
  v_pk_add_f32 v[90:91], v[90:91], v[122:123]
  v_pk_add_f32 v[76:77], v[76:77], v[108:109]
  s_waitcnt lgkmcnt(0)
  v_pk_add_f32 v[92:93], v[92:93], v[124:125]
  v_pk_add_f32 v[78:79], v[78:79], v[110:111]
  v_pk_add_f32 v[94:95], v[94:95], v[126:127]
  v_lshlrev_b32 v96, 16, v136
  v_lshlrev_b32 v112, 16, v168
  v_and_b32 v97, 0xffff0000, v136
  v_and_b32 v113, 0xffff0000, v168
  v_lshlrev_b32 v98, 16, v137
  v_lshlrev_b32 v114, 16, v169
  v_and_b32 v99, 0xffff0000, v137
  v_and_b32 v115, 0xffff0000, v169
  v_lshlrev_b32 v100, 16, v138
  v_lshlrev_b32 v116, 16, v170
  v_and_b32 v101, 0xffff0000, v138
  v_and_b32 v117, 0xffff0000, v170
  v_lshlrev_b32 v102, 16, v139
  v_lshlrev_b32 v118, 16, v171
  v_and_b32 v103, 0xffff0000, v139
  v_and_b32 v119, 0xffff0000, v171
  v_lshlrev_b32 v104, 16, v140
  v_lshlrev_b32 v120, 16, v172
  v_and_b32 v105, 0xffff0000, v140
  v_and_b32 v121, 0xffff0000, v172
  v_lshlrev_b32 v106, 16, v141
  v_lshlrev_b32 v122, 16, v173
  v_and_b32 v107, 0xffff0000, v141
  v_and_b32 v123, 0xffff0000, v173
  v_lshlrev_b32 v108, 16, v142
  v_lshlrev_b32 v124, 16, v174
  v_and_b32 v109, 0xffff0000, v142
  s_barrier
  v_and_b32 v125, 0xffff0000, v174
  v_lshlrev_b32 v110, 16, v143
  v_lshlrev_b32 v126, 16, v175
  v_and_b32 v111, 0xffff0000, v143
  v_and_b32 v127, 0xffff0000, v175
  v_pk_add_f32 v[64:65], v[64:65], v[96:97]
  v_pk_add_f32 v[80:81], v[80:81], v[112:113]
  v_pk_add_f32 v[66:67], v[66:67], v[98:99]
  v_pk_add_f32 v[82:83], v[82:83], v[114:115]
  v_pk_add_f32 v[68:69], v[68:69], v[100:101]
  v_pk_add_f32 v[84:85], v[84:85], v[116:117]
  v_pk_add_f32 v[70:71], v[70:71], v[102:103]
  v_pk_add_f32 v[86:87], v[86:87], v[118:119]
  v_pk_add_f32 v[72:73], v[72:73], v[104:105]
  v_pk_add_f32 v[88:89], v[88:89], v[120:121]
  v_pk_add_f32 v[74:75], v[74:75], v[106:107]
  v_pk_add_f32 v[90:91], v[90:91], v[122:123]
  v_pk_add_f32 v[76:77], v[76:77], v[108:109]
  v_pk_add_f32 v[92:93], v[92:93], v[124:125]
  v_pk_add_f32 v[78:79], v[78:79], v[110:111]
  v_pk_add_f32 v[94:95], v[94:95], v[126:127]
  v_lshlrev_b32 v96, 16, v144
  v_lshlrev_b32 v112, 16, v176
  v_and_b32 v97, 0xffff0000, v144
  v_and_b32 v113, 0xffff0000, v176
  v_lshlrev_b32 v98, 16, v145
  v_lshlrev_b32 v114, 16, v177
  v_and_b32 v99, 0xffff0000, v145
  v_and_b32 v115, 0xffff0000, v177
  v_lshlrev_b32 v100, 16, v146
  v_lshlrev_b32 v116, 16, v178
  v_and_b32 v101, 0xffff0000, v146
  v_and_b32 v117, 0xffff0000, v178
  v_lshlrev_b32 v102, 16, v147
  v_lshlrev_b32 v118, 16, v179
  v_and_b32 v103, 0xffff0000, v147
  v_and_b32 v119, 0xffff0000, v179
  s_barrier
  v_lshlrev_b32 v104, 16, v148
  v_lshlrev_b32 v120, 16, v180
  v_and_b32 v105, 0xffff0000, v148
  v_and_b32 v121, 0xffff0000, v180
  v_lshlrev_b32 v106, 16, v149
  v_lshlrev_b32 v122, 16, v181
  v_and_b32 v107, 0xffff0000, v149
  v_and_b32 v123, 0xffff0000, v181
  v_lshlrev_b32 v108, 16, v150
  v_lshlrev_b32 v124, 16, v182
  v_and_b32 v109, 0xffff0000, v150
  v_and_b32 v125, 0xffff0000, v182
  v_lshlrev_b32 v110, 16, v151
  v_lshlrev_b32 v126, 16, v183
  v_and_b32 v111, 0xffff0000, v151
  v_and_b32 v127, 0xffff0000, v183
  v_pk_add_f32 v[64:65], v[64:65], v[96:97]
  v_pk_add_f32 v[80:81], v[80:81], v[112:113]
  v_pk_add_f32 v[66:67], v[66:67], v[98:99]
  v_pk_add_f32 v[82:83], v[82:83], v[114:115]
  v_pk_add_f32 v[68:69], v[68:69], v[100:101]
  v_pk_add_f32 v[84:85], v[84:85], v[116:117]
  v_pk_add_f32 v[70:71], v[70:71], v[102:103]
  v_pk_add_f32 v[86:87], v[86:87], v[118:119]
  v_pk_add_f32 v[72:73], v[72:73], v[104:105]
  v_pk_add_f32 v[88:89], v[88:89], v[120:121]
  v_pk_add_f32 v[74:75], v[74:75], v[106:107]
  v_pk_add_f32 v[90:91], v[90:91], v[122:123]
  v_pk_add_f32 v[76:77], v[76:77], v[108:109]
  v_pk_add_f32 v[92:93], v[92:93], v[124:125]
  v_pk_add_f32 v[78:79], v[78:79], v[110:111]
  v_pk_add_f32 v[94:95], v[94:95], v[126:127]
  v_lshlrev_b32 v96, 16, v248
  v_lshlrev_b32 v112, 16, v248
  v_and_b32 v97, 0xffff0000, v248
  v_and_b32 v113, 0xffff0000, v248
  v_lshlrev_b32 v98, 16, v249
  v_lshlrev_b32 v114, 16, v249
  s_barrier
  v_and_b32 v99, 0xffff0000, v249
  v_and_b32 v115, 0xffff0000, v249
  v_lshlrev_b32 v100, 16, v250
  v_lshlrev_b32 v116, 16, v250
  v_and_b32 v101, 0xffff0000, v250
  v_and_b32 v117, 0xffff0000, v250
  v_lshlrev_b32 v102, 16, v251
  v_lshlrev_b32 v118, 16, v251
  v_and_b32 v103, 0xffff0000, v251
  v_and_b32 v119, 0xffff0000, v251
  v_lshlrev_b32 v104, 16, v252
  v_lshlrev_b32 v120, 16, v252
  v_and_b32 v105, 0xffff0000, v252
  v_and_b32 v121, 0xffff0000, v252
  v_lshlrev_b32 v106, 16, v253
  v_lshlrev_b32 v122, 16, v253
  v_and_b32 v107, 0xffff0000, v253
  v_and_b32 v123, 0xffff0000, v253
  v_lshlrev_b32 v108, 16, v254
  v_lshlrev_b32 v124, 16, v254
  v_and_b32 v109, 0xffff0000, v254
  v_and_b32 v125, 0xffff0000, v254
  v_lshlrev_b32 v110, 16, v255
  v_lshlrev_b32 v126, 16, v255
  v_and_b32 v111, 0xffff0000, v255
  v_and_b32 v127, 0xffff0000, v255
  v_add_f32 v64, v64, v96
  v_add_f32 v80, v80, v112
  v_mul_f32 v96, 0xbfb8aa3b, v64
  v_mul_f32 v112, 0xbfb8aa3b, v80
  v_exp_f32 v96, v96
  v_exp_f32 v112, v112
  v_add_f32 v65, v65, v97
  v_add_f32 v81, v81, v113
  v_mul_f32 v97, 0xbfb8aa3b, v65
  v_mul_f32 v113, 0xbfb8aa3b, v81
  v_exp_f32 v97, v97
  v_exp_f32 v113, v113
  s_barrier
  v_add_f32 v66, v66, v98
  v_add_f32 v82, v82, v114
  v_mul_f32 v98, 0xbfb8aa3b, v66
  v_mul_f32 v114, 0xbfb8aa3b, v82
  v_exp_f32 v98, v98
  v_exp_f32 v114, v114
  v_add_f32 v67, v67, v99
  v_add_f32 v83, v83, v115
  v_mul_f32 v99, 0xbfb8aa3b, v67
  v_mul_f32 v115, 0xbfb8aa3b, v83
  v_exp_f32 v99, v99
  v_exp_f32 v115, v115
  v_add_f32 v68, v68, v100
  v_add_f32 v84, v84, v116
  v_mul_f32 v100, 0xbfb8aa3b, v68
  v_mul_f32 v116, 0xbfb8aa3b, v84
  v_exp_f32 v100, v100
  v_exp_f32 v116, v116
  v_add_f32 v69, v69, v101
  v_add_f32 v85, v85, v117
  v_mul_f32 v101, 0xbfb8aa3b, v69
  v_mul_f32 v117, 0xbfb8aa3b, v85
  v_exp_f32 v101, v101
  v_exp_f32 v117, v117
  v_add_f32 v70, v70, v102
  v_add_f32 v86, v86, v118
  v_mul_f32 v102, 0xbfb8aa3b, v70
  v_mul_f32 v118, 0xbfb8aa3b, v86
  v_exp_f32 v102, v102
  v_exp_f32 v118, v118
  v_add_f32 v71, v71, v103
  v_add_f32 v87, v87, v119
  v_mul_f32 v103, 0xbfb8aa3b, v71
  v_mul_f32 v119, 0xbfb8aa3b, v87
  v_exp_f32 v103, v103
  v_exp_f32 v119, v119
  v_add_f32 v72, v72, v104
  s_barrier
  v_add_f32 v88, v88, v120
  v_mul_f32 v104, 0xbfb8aa3b, v72
  v_mul_f32 v120, 0xbfb8aa3b, v88
  v_exp_f32 v104, v104
  v_exp_f32 v120, v120
  v_add_f32 v73, v73, v105
  v_add_f32 v89, v89, v121
  v_mul_f32 v105, 0xbfb8aa3b, v73
  v_mul_f32 v121, 0xbfb8aa3b, v89
  v_exp_f32 v105, v105
  v_exp_f32 v121, v121
  v_add_f32 v74, v74, v106
  v_add_f32 v90, v90, v122
  v_mul_f32 v106, 0xbfb8aa3b, v74
  v_mul_f32 v122, 0xbfb8aa3b, v90
  v_exp_f32 v106, v106
  v_exp_f32 v122, v122
  v_add_f32 v75, v75, v107
  v_add_f32 v91, v91, v123
  v_mul_f32 v107, 0xbfb8aa3b, v75
  v_mul_f32 v123, 0xbfb8aa3b, v91
  v_exp_f32 v107, v107
  v_exp_f32 v123, v123
  v_add_f32 v76, v76, v108
  v_add_f32 v92, v92, v124
  v_mul_f32 v108, 0xbfb8aa3b, v76
  v_mul_f32 v124, 0xbfb8aa3b, v92
  v_exp_f32 v108, v108
  v_exp_f32 v124, v124
  v_add_f32 v77, v77, v109
  v_add_f32 v93, v93, v125
  v_mul_f32 v109, 0xbfb8aa3b, v77
  v_mul_f32 v125, 0xbfb8aa3b, v93
  v_exp_f32 v109, v109
  v_exp_f32 v125, v125
  v_add_f32 v78, v78, v110
  v_add_f32 v94, v94, v126
  v_mul_f32 v110, 0xbfb8aa3b, v78
  s_barrier
  v_mul_f32 v126, 0xbfb8aa3b, v94
  v_exp_f32 v110, v110
  v_exp_f32 v126, v126
  v_add_f32 v79, v79, v111
  v_add_f32 v95, v95, v127
  v_mul_f32 v111, 0xbfb8aa3b, v79
  v_mul_f32 v127, 0xbfb8aa3b, v95
  v_exp_f32 v111, v111
  v_exp_f32 v127, v127
  v_add_f32 v96, 1.0, v96
  v_add_f32 v112, 1.0, v112
  v_rcp_f32 v96, v96
  v_rcp_f32 v112, v112
  v_add_f32 v97, 1.0, v97
  v_add_f32 v113, 1.0, v113
  v_rcp_f32 v97, v97
  v_rcp_f32 v113, v113
  v_add_f32 v98, 1.0, v98
  v_add_f32 v114, 1.0, v114
  v_rcp_f32 v98, v98
  v_rcp_f32 v114, v114
  v_add_f32 v99, 1.0, v99
  v_add_f32 v115, 1.0, v115
  v_rcp_f32 v99, v99
  v_rcp_f32 v115, v115
  v_add_f32 v100, 1.0, v100
  v_add_f32 v116, 1.0, v116
  v_rcp_f32 v100, v100
  v_rcp_f32 v116, v116
  v_add_f32 v101, 1.0, v101
  v_add_f32 v117, 1.0, v117
  v_rcp_f32 v101, v101
  v_rcp_f32 v117, v117
  v_add_f32 v102, 1.0, v102
  v_add_f32 v118, 1.0, v118
  v_rcp_f32 v102, v102
  v_rcp_f32 v118, v118
  s_barrier
  v_add_f32 v103, 1.0, v103
  v_add_f32 v119, 1.0, v119
  v_rcp_f32 v103, v103
  v_rcp_f32 v119, v119
  v_add_f32 v104, 1.0, v104
  v_add_f32 v120, 1.0, v120
  v_rcp_f32 v104, v104
  v_rcp_f32 v120, v120
  v_add_f32 v105, 1.0, v105
  v_add_f32 v121, 1.0, v121
  v_rcp_f32 v105, v105
  v_rcp_f32 v121, v121
  v_add_f32 v106, 1.0, v106
  v_add_f32 v122, 1.0, v122
  v_rcp_f32 v106, v106
  v_rcp_f32 v122, v122
  v_add_f32 v107, 1.0, v107
  v_add_f32 v123, 1.0, v123
  v_rcp_f32 v107, v107
  v_rcp_f32 v123, v123
  v_add_f32 v108, 1.0, v108
  v_add_f32 v124, 1.0, v124
  v_rcp_f32 v108, v108
  v_rcp_f32 v124, v124
  v_add_f32 v109, 1.0, v109
  v_add_f32 v125, 1.0, v125
  v_rcp_f32 v109, v109
  v_rcp_f32 v125, v125
  v_add_f32 v110, 1.0, v110
  v_add_f32 v126, 1.0, v126
  v_rcp_f32 v110, v110
  v_rcp_f32 v126, v126
  v_add_f32 v111, 1.0, v111
  v_add_f32 v127, 1.0, v127
  v_rcp_f32 v111, v111
  v_rcp_f32 v127, v127
  v_mul_f32 v64, v64, v96
  v_mul_f32 v80, v80, v112
  s_barrier
  v_mul_f32 v65, v65, v97
  v_mul_f32 v81, v81, v113
  v_mul_f32 v66, v66, v98
  v_mul_f32 v82, v82, v114
  v_mul_f32 v67, v67, v99
  v_mul_f32 v83, v83, v115
  v_mul_f32 v68, v68, v100
  v_mul_f32 v84, v84, v116
  v_mul_f32 v69, v69, v101
  v_mul_f32 v85, v85, v117
  v_mul_f32 v70, v70, v102
  v_mul_f32 v86, v86, v118
  v_mul_f32 v71, v71, v103
  v_mul_f32 v87, v87, v119
  v_mul_f32 v72, v72, v104
  v_mul_f32 v88, v88, v120
  v_mul_f32 v73, v73, v105
  v_mul_f32 v89, v89, v121
  v_mul_f32 v74, v74, v106
  v_mul_f32 v90, v90, v122
  v_mul_f32 v75, v75, v107
  v_mul_f32 v91, v91, v123
  v_mul_f32 v76, v76, v108
  v_mul_f32 v92, v92, v124
  v_mul_f32 v77, v77, v109
  v_mul_f32 v93, v93, v125
  v_mul_f32 v78, v78, v110
  v_mul_f32 v94, v94, v126
  v_mul_f32 v79, v79, v111
  v_mul_f32 v95, v95, v127
  ds_write_b128 v18, v[64:67] offset:0
  ds_write_b128 v18, v[80:83] offset:4096
  ds_write_b128 v18, v[68:71] offset:1024
  ds_write_b128 v18, v[84:87] offset:5120
  ds_write_b128 v18, v[72:75] offset:2048
  ds_write_b128 v18, v[88:91] offset:6144
  ds_write_b128 v18, v[76:79] offset:3072
  ds_write_b128 v18, v[92:95] offset:7168
  s_waitcnt lgkmcnt(0)
  s_barrier
  s_endpgm
LF_comp:
  ds_read_b64_tr_b16 v[32:33], v27 offset:0
  ds_read_b64_tr_b16 v[34:35], v27 offset:4096
  ds_read_b64_tr_b16 v[36:37], v28 offset:0
  ds_read_b64_tr_b16 v[38:39], v28 offset:4096
  ds_read_b64_tr_b16 v[40:41], v29 offset:0
  ds_read_b64_tr_b16 v[42:43], v29 offset:4096
  ds_read_b64_tr_b16 v[44:45], v30 offset:0
  ds_read_b64_tr_b16 v[46:47], v30 offset:4096
  ds_read_b64_tr_b16 v[48:49], v5 offset:0
  ds_read_b64_tr_b16 v[50:51], v5 offset:4096
  ds_read_b64_tr_b16 v[52:53], v6 offset:0
  ds_read_b64_tr_b16 v[54:55], v6 offset:4096
  ds_read_b64_tr_b16 v[56:57], v21 offset:0
  ds_read_b64_tr_b16 v[58:59], v21 offset:4096
  ds_read_b64_tr_b16 v[60:61], v2 offset:0
  ds_read_b64_tr_b16 v[62:63], v2 offset:4096
  s_waitcnt lgkmcnt(8)
  v_mfma_f32_16x16x32_bf16 v[176:179], v[32:35], v[64:67], 0
  s_add_u32 m0, s18, 0
  v_mfma_f32_16x16x32_bf16 v[208:211], v[32:35], v[68:71], 0
  ds_read_b64_tr_b16 v[32:33], v27 offset:8192
  buffer_load_dwordx4 v8, s[32:35], 0 offen lds
  v_mfma_f32_16x16x32_bf16 v[212:215], v[36:39], v[68:71], 0
  ds_read_b64_tr_b16 v[34:35], v27 offset:12288
  v_mfma_f32_16x16x32_bf16 v[180:183], v[36:39], v[64:67], 0
  ds_read_b64_tr_b16 v[36:37], v28 offset:8192
  s_add_u32 m0, s18, 2048
  v_mfma_f32_16x16x32_bf16 v[184:187], v[40:43], v[64:67], 0
  ds_read_b64_tr_b16 v[38:39], v28 offset:12288
  v_mfma_f32_16x16x32_bf16 v[216:219], v[40:43], v[68:71], 0
  ds_read_b64_tr_b16 v[40:41], v29 offset:8192
  buffer_load_dwordx4 v8, s[32:35], s10 offen lds
  v_mfma_f32_16x16x32_bf16 v[220:223], v[44:47], v[68:71], 0
  ds_read_b64_tr_b16 v[42:43], v29 offset:12288
  s_add_u32 m0, s18, 4096
  v_mfma_f32_16x16x32_bf16 v[188:191], v[44:47], v[64:67], 0
  ds_read_b64_tr_b16 v[44:45], v30 offset:8192
  s_waitcnt lgkmcnt(7)
  v_mfma_f32_16x16x32_bf16 v[192:195], v[48:51], v[64:67], 0
  ds_read_b64_tr_b16 v[46:47], v30 offset:12288
  buffer_load_dwordx4 v8, s[32:35], s11 offen lds
  v_mfma_f32_16x16x32_bf16 v[224:227], v[48:51], v[68:71], 0
  ds_read_b64_tr_b16 v[48:49], v5 offset:8192
  v_mfma_f32_16x16x32_bf16 v[228:231], v[52:55], v[68:71], 0
  ds_read_b64_tr_b16 v[50:51], v5 offset:12288
  s_add_u32 m0, s18, 6144
  v_mfma_f32_16x16x32_bf16 v[196:199], v[52:55], v[64:67], 0
  ds_read_b64_tr_b16 v[52:53], v6 offset:8192
  v_mfma_f32_16x16x32_bf16 v[200:203], v[56:59], v[64:67], 0
  ds_read_b64_tr_b16 v[54:55], v6 offset:12288
  buffer_load_dwordx4 v8, s[32:35], s12 offen lds
  v_mfma_f32_16x16x32_bf16 v[232:235], v[56:59], v[68:71], 0
  ds_read_b64_tr_b16 v[56:57], v21 offset:8192
  s_add_u32 m0, s18, 8192
  v_mfma_f32_16x16x32_bf16 v[236:239], v[60:63], v[68:71], 0
  ds_read_b64_tr_b16 v[58:59], v21 offset:12288
  v_mfma_f32_16x16x32_bf16 v[204:207], v[60:63], v[64:67], 0
  ds_read_b64_tr_b16 v[60:61], v2 offset:8192
  buffer_load_dwordx4 v8, s[32:35], s13 offen lds
  s_waitcnt lgkmcnt(7)
  v_mfma_f32_16x16x32_bf16 v[176:179], v[32:35], v[72:75], v[176:179]
  ds_read_b64_tr_b16 v[62:63], v2 offset:12288
  v_mfma_f32_16x16x32_bf16 v[208:211], v[32:35], v[76:79], v[208:211]
  ds_read_b64_tr_b16 v[32:33], v27 offset:16384
  s_add_u32 m0, s18, 10240
  v_mfma_f32_16x16x32_bf16 v[212:215], v[36:39], v[76:79], v[212:215]
  ds_read_b64_tr_b16 v[34:35], v27 offset:20480
  buffer_load_dwordx4 v8, s[32:35], s16 offen lds
  v_mfma_f32_16x16x32_bf16 v[180:183], v[36:39], v[72:75], v[180:183]
  ds_read_b64_tr_b16 v[36:37], v28 offset:16384
  v_mfma_f32_16x16x32_bf16 v[184:187], v[40:43], v[72:75], v[184:187]
  ds_read_b64_tr_b16 v[38:39], v28 offset:20480
  s_add_u32 m0, s18, 12288
  v_mfma_f32_16x16x32_bf16 v[216:219], v[40:43], v[76:79], v[216:219]
  ds_read_b64_tr_b16 v[40:41], v29 offset:16384
  v_mfma_f32_16x16x32_bf16 v[220:223], v[44:47], v[76:79], v[220:223]
  ds_read_b64_tr_b16 v[42:43], v29 offset:20480
  buffer_load_dwordx4 v8, s[32:35], s17 offen lds
  v_mfma_f32_16x16x32_bf16 v[188:191], v[44:47], v[72:75], v[188:191]
  ds_read_b64_tr_b16 v[44:45], v30 offset:16384
  s_waitcnt lgkmcnt(7)
  v_mfma_f32_16x16x32_bf16 v[192:195], v[48:51], v[72:75], v[192:195]
  ds_read_b64_tr_b16 v[46:47], v30 offset:20480
  s_add_u32 m0, s18, 14336
  v_mfma_f32_16x16x32_bf16 v[224:227], v[48:51], v[76:79], v[224:227]
  ds_read_b64_tr_b16 v[48:49], v5 offset:16384
  buffer_load_dwordx4 v8, s[32:35], s78 offen lds
  v_mfma_f32_16x16x32_bf16 v[228:231], v[52:55], v[76:79], v[228:231]
  ds_read_b64_tr_b16 v[50:51], v5 offset:20480
  v_mfma_f32_16x16x32_bf16 v[196:199], v[52:55], v[72:75], v[196:199]
  ds_read_b64_tr_b16 v[52:53], v6 offset:16384
  v_add_u32 v8, 0x20000, v8
  v_mfma_f32_16x16x32_bf16 v[200:203], v[56:59], v[72:75], v[200:203]
  ds_read_b64_tr_b16 v[54:55], v6 offset:20480
  v_mfma_f32_16x16x32_bf16 v[232:235], v[56:59], v[76:79], v[232:235]
  ds_read_b64_tr_b16 v[56:57], v21 offset:16384
  s_xor_b32 s18, s18, 0x10000
  v_mfma_f32_16x16x32_bf16 v[236:239], v[60:63], v[76:79], v[236:239]
  ds_read_b64_tr_b16 v[58:59], v21 offset:20480
  v_mfma_f32_16x16x32_bf16 v[204:207], v[60:63], v[72:75], v[204:207]
  ds_read_b64_tr_b16 v[60:61], v2 offset:16384
  s_waitcnt lgkmcnt(7)
  v_mfma_f32_16x16x32_bf16 v[176:179], v[32:35], v[80:83], v[176:179]
  ds_read_b64_tr_b16 v[62:63], v2 offset:20480
  v_mfma_f32_16x16x32_bf16 v[208:211], v[32:35], v[84:87], v[208:211]
  ds_read_b64_tr_b16 v[32:33], v27 offset:24576
  v_mfma_f32_16x16x32_bf16 v[212:215], v[36:39], v[84:87], v[212:215]
  ds_read_b64_tr_b16 v[34:35], v27 offset:28672
  v_xor_b32 v27, 0x10000, v27
  v_mfma_f32_16x16x32_bf16 v[180:183], v[36:39], v[80:83], v[180:183]
  ds_read_b64_tr_b16 v[36:37], v28 offset:24576
  v_mfma_f32_16x16x32_bf16 v[184:187], v[40:43], v[80:83], v[184:187]
  ds_read_b64_tr_b16 v[38:39], v28 offset:28672
  v_xor_b32 v28, 0x10000, v28
  v_mfma_f32_16x16x32_bf16 v[216:219], v[40:43], v[84:87], v[216:219]
  ds_read_b64_tr_b16 v[40:41], v29 offset:24576
  v_mfma_f32_16x16x32_bf16 v[220:223], v[44:47], v[84:87], v[220:223]
  ds_read_b64_tr_b16 v[42:43], v29 offset:28672
  v_xor_b32 v29, 0x10000, v29
  v_mfma_f32_16x16x32_bf16 v[188:191], v[44:47], v[80:83], v[188:191]
  ds_read_b64_tr_b16 v[44:45], v30 offset:24576
  s_waitcnt lgkmcnt(7)
  v_mfma_f32_16x16x32_bf16 v[192:195], v[48:51], v[80:83], v[192:195]
  ds_read_b64_tr_b16 v[46:47], v30 offset:28672
  v_xor_b32 v30, 0x10000, v30
  v_mfma_f32_16x16x32_bf16 v[224:227], v[48:51], v[84:87], v[224:227]
  ds_read_b64_tr_b16 v[48:49], v5 offset:24576
  v_mfma_f32_16x16x32_bf16 v[228:231], v[52:55], v[84:87], v[228:231]
  ds_read_b64_tr_b16 v[50:51], v5 offset:28672
  v_xor_b32 v5, 0x10000, v5
  v_mfma_f32_16x16x32_bf16 v[196:199], v[52:55], v[80:83], v[196:199]
  ds_read_b64_tr_b16 v[52:53], v6 offset:24576
  v_mfma_f32_16x16x32_bf16 v[200:203], v[56:59], v[80:83], v[200:203]
  ds_read_b64_tr_b16 v[54:55], v6 offset:28672
  v_xor_b32 v6, 0x10000, v6
  v_mfma_f32_16x16x32_bf16 v[232:235], v[56:59], v[84:87], v[232:235]
  ds_read_b64_tr_b16 v[56:57], v21 offset:24576
  v_mfma_f32_16x16x32_bf16 v[236:239], v[60:63], v[84:87], v[236:239]
  ds_read_b64_tr_b16 v[58:59], v21 offset:28672
  v_xor_b32 v21, 0x10000, v21
  v_mfma_f32_16x16x32_bf16 v[204:207], v[60:63], v[80:83], v[204:207]
  ds_read_b64_tr_b16 v[60:61], v2 offset:24576
  s_waitcnt lgkmcnt(7)
  v_mfma_f32_16x16x32_bf16 v[176:179], v[32:35], v[88:91], v[176:179]
  ds_read_b64_tr_b16 v[62:63], v2 offset:28672
  v_xor_b32 v2, 0x10000, v2
s_cmp_eq_u32 s74, 1
  s_cbranch_scc1 LF_w1
  s_waitcnt vmcnt(12)
LF_w1:
  s_barrier
  v_mfma_f32_16x16x32_bf16 v[208:211], v[32:35], v[92:95], v[208:211]
  ds_read_b64_tr_b16 v[32:33], v27 offset:0
  v_mfma_f32_16x16x32_bf16 v[212:215], v[36:39], v[92:95], v[212:215]
  ds_read_b64_tr_b16 v[34:35], v27 offset:4096
  v_mfma_f32_16x16x32_bf16 v[180:183], v[36:39], v[88:91], v[180:183]
  ds_read_b64_tr_b16 v[36:37], v28 offset:0
  v_mfma_f32_16x16x32_bf16 v[184:187], v[40:43], v[88:91], v[184:187]
  ds_read_b64_tr_b16 v[38:39], v28 offset:4096
  v_mfma_f32_16x16x32_bf16 v[216:219], v[40:43], v[92:95], v[216:219]
  ds_read_b64_tr_b16 v[40:41], v29 offset:0
  v_mfma_f32_16x16x32_bf16 v[220:223], v[44:47], v[92:95], v[220:223]
  ds_read_b64_tr_b16 v[42:43], v29 offset:4096
  v_mfma_f32_16x16x32_bf16 v[188:191], v[44:47], v[88:91], v[188:191]
  ds_read_b64_tr_b16 v[44:45], v30 offset:0
  s_waitcnt lgkmcnt(7)
  v_mfma_f32_16x16x32_bf16 v[192:195], v[48:51], v[88:91], v[192:195]
  ds_read_b64_tr_b16 v[46:47], v30 offset:4096
  v_mfma_f32_16x16x32_bf16 v[224:227], v[48:51], v[92:95], v[224:227]
  ds_read_b64_tr_b16 v[48:49], v5 offset:0
  v_mfma_f32_16x16x32_bf16 v[228:231], v[52:55], v[92:95], v[228:231]
  ds_read_b64_tr_b16 v[50:51], v5 offset:4096
  v_mfma_f32_16x16x32_bf16 v[196:199], v[52:55], v[88:91], v[196:199]
  ds_read_b64_tr_b16 v[52:53], v6 offset:0
  v_mfma_f32_16x16x32_bf16 v[200:203], v[56:59], v[88:91], v[200:203]
  ds_read_b64_tr_b16 v[54:55], v6 offset:4096
  v_mfma_f32_16x16x32_bf16 v[232:235], v[56:59], v[92:95], v[232:235]
  ds_read_b64_tr_b16 v[56:57], v21 offset:0
  v_mfma_f32_16x16x32_bf16 v[236:239], v[60:63], v[92:95], v[236:239]
  ds_read_b64_tr_b16 v[58:59], v21 offset:4096
  v_mfma_f32_16x16x32_bf16 v[204:207], v[60:63], v[88:91], v[204:207]
  ds_read_b64_tr_b16 v[62:63], v2 offset:4096
  ds_read_b64_tr_b16 v[60:61], v2 offset:0
  s_waitcnt vmcnt(20) lgkmcnt(8)
  v_mfma_f32_16x16x32_bf16 v[176:179], v[32:35], v[96:99], v[176:179]
  v_mfma_f32_16x16x32_bf16 v[208:211], v[32:35], v[100:103], v[208:211]
  ds_read_b64_tr_b16 v[32:33], v27 offset:8192
  v_mfma_f32_16x16x32_bf16 v[212:215], v[36:39], v[100:103], v[212:215]
  ds_read_b64_tr_b16 v[34:35], v27 offset:12288
  v_mfma_f32_16x16x32_bf16 v[180:183], v[36:39], v[96:99], v[180:183]
  ds_read_b64_tr_b16 v[36:37], v28 offset:8192
  v_mfma_f32_16x16x32_bf16 v[184:187], v[40:43], v[96:99], v[184:187]
  ds_read_b64_tr_b16 v[38:39], v28 offset:12288
  v_mfma_f32_16x16x32_bf16 v[216:219], v[40:43], v[100:103], v[216:219]
  ds_read_b64_tr_b16 v[40:41], v29 offset:8192
  v_mfma_f32_16x16x32_bf16 v[220:223], v[44:47], v[100:103], v[220:223]
  ds_read_b64_tr_b16 v[42:43], v29 offset:12288
  v_mfma_f32_16x16x32_bf16 v[188:191], v[44:47], v[96:99], v[188:191]
  ds_read_b64_tr_b16 v[44:45], v30 offset:8192
  s_waitcnt lgkmcnt(7)
  v_mfma_f32_16x16x32_bf16 v[192:195], v[48:51], v[96:99], v[192:195]
  ds_read_b64_tr_b16 v[46:47], v30 offset:12288
  v_mfma_f32_16x16x32_bf16 v[224:227], v[48:51], v[100:103], v[224:227]
  ds_read_b64_tr_b16 v[48:49], v5 offset:8192
  v_mfma_f32_16x16x32_bf16 v[228:231], v[52:55], v[100:103], v[228:231]
  ds_read_b64_tr_b16 v[50:51], v5 offset:12288
  v_mfma_f32_16x16x32_bf16 v[196:199], v[52:55], v[96:99], v[196:199]
  ds_read_b64_tr_b16 v[52:53], v6 offset:8192
  v_mfma_f32_16x16x32_bf16 v[200:203], v[56:59], v[96:99], v[200:203]
  ds_read_b64_tr_b16 v[54:55], v6 offset:12288
  v_mfma_f32_16x16x32_bf16 v[232:235], v[56:59], v[100:103], v[232:235]
  ds_read_b64_tr_b16 v[56:57], v21 offset:8192
  v_mfma_f32_16x16x32_bf16 v[236:239], v[60:63], v[100:103], v[236:239]
  ds_read_b64_tr_b16 v[58:59], v21 offset:12288
  v_mfma_f32_16x16x32_bf16 v[204:207], v[60:63], v[96:99], v[204:207]
  ds_read_b64_tr_b16 v[60:61], v2 offset:8192
  s_waitcnt lgkmcnt(7)
  v_mfma_f32_16x16x32_bf16 v[176:179], v[32:35], v[104:107], v[176:179]
  ds_read_b64_tr_b16 v[62:63], v2 offset:12288
  v_mfma_f32_16x16x32_bf16 v[208:211], v[32:35], v[108:111], v[208:211]
  ds_read_b64_tr_b16 v[32:33], v27 offset:16384
  v_mfma_f32_16x16x32_bf16 v[212:215], v[36:39], v[108:111], v[212:215]
  ds_read_b64_tr_b16 v[34:35], v27 offset:20480
  v_mfma_f32_16x16x32_bf16 v[180:183], v[36:39], v[104:107], v[180:183]
  ds_read_b64_tr_b16 v[36:37], v28 offset:16384
  v_mfma_f32_16x16x32_bf16 v[184:187], v[40:43], v[104:107], v[184:187]
  ds_read_b64_tr_b16 v[38:39], v28 offset:20480
  v_mfma_f32_16x16x32_bf16 v[216:219], v[40:43], v[108:111], v[216:219]
  ds_read_b64_tr_b16 v[40:41], v29 offset:16384
  v_mfma_f32_16x16x32_bf16 v[220:223], v[44:47], v[108:111], v[220:223]
  ds_read_b64_tr_b16 v[42:43], v29 offset:20480
  v_mfma_f32_16x16x32_bf16 v[188:191], v[44:47], v[104:107], v[188:191]
  ds_read_b64_tr_b16 v[44:45], v30 offset:16384
  s_waitcnt lgkmcnt(7)
  v_mfma_f32_16x16x32_bf16 v[192:195], v[48:51], v[104:107], v[192:195]
  ds_read_b64_tr_b16 v[46:47], v30 offset:20480
  v_mfma_f32_16x16x32_bf16 v[224:227], v[48:51], v[108:111], v[224:227]
  ds_read_b64_tr_b16 v[48:49], v5 offset:16384
  v_mfma_f32_16x16x32_bf16 v[228:231], v[52:55], v[108:111], v[228:231]
  ds_read_b64_tr_b16 v[50:51], v5 offset:20480
  v_mfma_f32_16x16x32_bf16 v[196:199], v[52:55], v[104:107], v[196:199]
  ds_read_b64_tr_b16 v[52:53], v6 offset:16384
  v_mfma_f32_16x16x32_bf16 v[200:203], v[56:59], v[104:107], v[200:203]
  ds_read_b64_tr_b16 v[54:55], v6 offset:20480
  v_mfma_f32_16x16x32_bf16 v[232:235], v[56:59], v[108:111], v[232:235]
  ds_read_b64_tr_b16 v[56:57], v21 offset:16384
  v_mfma_f32_16x16x32_bf16 v[236:239], v[60:63], v[108:111], v[236:239]
  ds_read_b64_tr_b16 v[58:59], v21 offset:20480
  v_mfma_f32_16x16x32_bf16 v[204:207], v[60:63], v[104:107], v[204:207]
  ds_read_b64_tr_b16 v[60:61], v2 offset:16384
  s_waitcnt lgkmcnt(7)
  v_mfma_f32_16x16x32_bf16 v[176:179], v[32:35], v[112:115], v[176:179]
  ds_read_b64_tr_b16 v[62:63], v2 offset:20480
  v_mfma_f32_16x16x32_bf16 v[208:211], v[32:35], v[116:119], v[208:211]
  ds_read_b64_tr_b16 v[32:33], v27 offset:24576
  v_mfma_f32_16x16x32_bf16 v[212:215], v[36:39], v[116:119], v[212:215]
  ds_read_b64_tr_b16 v[34:35], v27 offset:28672
  v_xor_b32 v27, 0x8000, v27
  v_mfma_f32_16x16x32_bf16 v[180:183], v[36:39], v[112:115], v[180:183]
  ds_read_b64_tr_b16 v[36:37], v28 offset:24576
  v_mfma_f32_16x16x32_bf16 v[184:187], v[40:43], v[112:115], v[184:187]
  ds_read_b64_tr_b16 v[38:39], v28 offset:28672
  v_xor_b32 v28, 0x8000, v28
  v_mfma_f32_16x16x32_bf16 v[216:219], v[40:43], v[116:119], v[216:219]
  ds_read_b64_tr_b16 v[40:41], v29 offset:24576
  v_mfma_f32_16x16x32_bf16 v[220:223], v[44:47], v[116:119], v[220:223]
  ds_read_b64_tr_b16 v[42:43], v29 offset:28672
  v_xor_b32 v29, 0x8000, v29
  v_mfma_f32_16x16x32_bf16 v[188:191], v[44:47], v[112:115], v[188:191]
  ds_read_b64_tr_b16 v[44:45], v30 offset:24576
  s_waitcnt lgkmcnt(7)
  v_mfma_f32_16x16x32_bf16 v[192:195], v[48:51], v[112:115], v[192:195]
  ds_read_b64_tr_b16 v[46:47], v30 offset:28672
  v_xor_b32 v30, 0x8000, v30
  v_mfma_f32_16x16x32_bf16 v[224:227], v[48:51], v[116:119], v[224:227]
  ds_read_b64_tr_b16 v[48:49], v5 offset:24576
  v_mfma_f32_16x16x32_bf16 v[228:231], v[52:55], v[116:119], v[228:231]
  ds_read_b64_tr_b16 v[50:51], v5 offset:28672
  v_xor_b32 v5, 0x8000, v5
  v_mfma_f32_16x16x32_bf16 v[196:199], v[52:55], v[112:115], v[196:199]
  ds_read_b64_tr_b16 v[52:53], v6 offset:24576
  v_mfma_f32_16x16x32_bf16 v[200:203], v[56:59], v[112:115], v[200:203]
  ds_read_b64_tr_b16 v[54:55], v6 offset:28672
  v_xor_b32 v6, 0x8000, v6
  v_mfma_f32_16x16x32_bf16 v[232:235], v[56:59], v[116:119], v[232:235]
  ds_read_b64_tr_b16 v[56:57], v21 offset:24576
  v_mfma_f32_16x16x32_bf16 v[236:239], v[60:63], v[116:119], v[236:239]
  ds_read_b64_tr_b16 v[58:59], v21 offset:28672
  v_xor_b32 v21, 0x8000, v21
  v_mfma_f32_16x16x32_bf16 v[204:207], v[60:63], v[112:115], v[204:207]
  ds_read_b64_tr_b16 v[60:61], v2 offset:24576
  s_waitcnt lgkmcnt(7)
  v_mfma_f32_16x16x32_bf16 v[176:179], v[32:35], v[120:123], v[176:179]
  ds_read_b64_tr_b16 v[62:63], v2 offset:28672
  v_xor_b32 v2, 0x8000, v2
  s_waitcnt vmcnt(0)
  s_barrier
  v_mfma_f32_16x16x32_bf16 v[208:211], v[32:35], v[124:127], v[208:211]
  ds_read_b64_tr_b16 v[32:33], v27 offset:0
  v_mfma_f32_16x16x32_bf16 v[212:215], v[36:39], v[124:127], v[212:215]
  ds_read_b64_tr_b16 v[34:35], v27 offset:4096
  v_mfma_f32_16x16x32_bf16 v[180:183], v[36:39], v[120:123], v[180:183]
  ds_read_b64_tr_b16 v[36:37], v28 offset:0
  v_mfma_f32_16x16x32_bf16 v[184:187], v[40:43], v[120:123], v[184:187]
  ds_read_b64_tr_b16 v[38:39], v28 offset:4096
  v_mfma_f32_16x16x32_bf16 v[216:219], v[40:43], v[124:127], v[216:219]
  ds_read_b64_tr_b16 v[40:41], v29 offset:0
  v_mfma_f32_16x16x32_bf16 v[220:223], v[44:47], v[124:127], v[220:223]
  ds_read_b64_tr_b16 v[42:43], v29 offset:4096
  v_mfma_f32_16x16x32_bf16 v[188:191], v[44:47], v[120:123], v[188:191]
  ds_read_b64_tr_b16 v[44:45], v30 offset:0
  s_waitcnt lgkmcnt(7)
  v_mfma_f32_16x16x32_bf16 v[192:195], v[48:51], v[120:123], v[192:195]
  ds_read_b64_tr_b16 v[46:47], v30 offset:4096
  v_mfma_f32_16x16x32_bf16 v[224:227], v[48:51], v[124:127], v[224:227]
  ds_read_b64_tr_b16 v[48:49], v5 offset:0
  v_mfma_f32_16x16x32_bf16 v[228:231], v[52:55], v[124:127], v[228:231]
  ds_read_b64_tr_b16 v[50:51], v5 offset:4096
  v_mfma_f32_16x16x32_bf16 v[196:199], v[52:55], v[120:123], v[196:199]
  ds_read_b64_tr_b16 v[52:53], v6 offset:0
  v_mfma_f32_16x16x32_bf16 v[200:203], v[56:59], v[120:123], v[200:203]
  ds_read_b64_tr_b16 v[54:55], v6 offset:4096
  v_mfma_f32_16x16x32_bf16 v[232:235], v[56:59], v[124:127], v[232:235]
  ds_read_b64_tr_b16 v[56:57], v21 offset:0
  v_mfma_f32_16x16x32_bf16 v[236:239], v[60:63], v[124:127], v[236:239]
  ds_read_b64_tr_b16 v[58:59], v21 offset:4096
  v_mfma_f32_16x16x32_bf16 v[204:207], v[60:63], v[120:123], v[204:207]
  ds_read_b64_tr_b16 v[62:63], v2 offset:4096
  ds_read_b64_tr_b16 v[60:61], v2 offset:0
  s_waitcnt lgkmcnt(8)
  v_mfma_f32_16x16x32_bf16 v[176:179], v[32:35], v[128:131], v[176:179]
  v_mfma_f32_16x16x32_bf16 v[208:211], v[32:35], v[132:135], v[208:211]
  ds_read_b64_tr_b16 v[32:33], v27 offset:8192
  v_mfma_f32_16x16x32_bf16 v[212:215], v[36:39], v[132:135], v[212:215]
  ds_read_b64_tr_b16 v[34:35], v27 offset:12288
  v_mfma_f32_16x16x32_bf16 v[180:183], v[36:39], v[128:131], v[180:183]
  ds_read_b64_tr_b16 v[36:37], v28 offset:8192
  v_mfma_f32_16x16x32_bf16 v[184:187], v[40:43], v[128:131], v[184:187]
  ds_read_b64_tr_b16 v[38:39], v28 offset:12288
  v_mfma_f32_16x16x32_bf16 v[216:219], v[40:43], v[132:135], v[216:219]
  ds_read_b64_tr_b16 v[40:41], v29 offset:8192
  v_mfma_f32_16x16x32_bf16 v[220:223], v[44:47], v[132:135], v[220:223]
  ds_read_b64_tr_b16 v[42:43], v29 offset:12288
  v_mfma_f32_16x16x32_bf16 v[188:191], v[44:47], v[128:131], v[188:191]
  ds_read_b64_tr_b16 v[44:45], v30 offset:8192
  s_waitcnt lgkmcnt(7)
  v_mfma_f32_16x16x32_bf16 v[192:195], v[48:51], v[128:131], v[192:195]
  ds_read_b64_tr_b16 v[46:47], v30 offset:12288
  v_mfma_f32_16x16x32_bf16 v[224:227], v[48:51], v[132:135], v[224:227]
  ds_read_b64_tr_b16 v[48:49], v5 offset:8192
  v_mfma_f32_16x16x32_bf16 v[228:231], v[52:55], v[132:135], v[228:231]
  ds_read_b64_tr_b16 v[50:51], v5 offset:12288
  v_mfma_f32_16x16x32_bf16 v[196:199], v[52:55], v[128:131], v[196:199]
  ds_read_b64_tr_b16 v[52:53], v6 offset:8192
  v_mfma_f32_16x16x32_bf16 v[200:203], v[56:59], v[128:131], v[200:203]
  ds_read_b64_tr_b16 v[54:55], v6 offset:12288
  v_mfma_f32_16x16x32_bf16 v[232:235], v[56:59], v[132:135], v[232:235]
  ds_read_b64_tr_b16 v[56:57], v21 offset:8192
  v_mfma_f32_16x16x32_bf16 v[236:239], v[60:63], v[132:135], v[236:239]
  ds_read_b64_tr_b16 v[58:59], v21 offset:12288
  v_mfma_f32_16x16x32_bf16 v[204:207], v[60:63], v[128:131], v[204:207]
  ds_read_b64_tr_b16 v[60:61], v2 offset:8192
  s_waitcnt lgkmcnt(7)
  v_mfma_f32_16x16x32_bf16 v[176:179], v[32:35], v[136:139], v[176:179]
  ds_read_b64_tr_b16 v[62:63], v2 offset:12288
  v_mfma_f32_16x16x32_bf16 v[208:211], v[32:35], v[140:143], v[208:211]
  ds_read_b64_tr_b16 v[32:33], v27 offset:16384
  v_mfma_f32_16x16x32_bf16 v[212:215], v[36:39], v[140:143], v[212:215]
  ds_read_b64_tr_b16 v[34:35], v27 offset:20480
  v_mfma_f32_16x16x32_bf16 v[180:183], v[36:39], v[136:139], v[180:183]
  ds_read_b64_tr_b16 v[36:37], v28 offset:16384
  v_mfma_f32_16x16x32_bf16 v[184:187], v[40:43], v[136:139], v[184:187]
  ds_read_b64_tr_b16 v[38:39], v28 offset:20480
  v_mfma_f32_16x16x32_bf16 v[216:219], v[40:43], v[140:143], v[216:219]
  ds_read_b64_tr_b16 v[40:41], v29 offset:16384
  v_mfma_f32_16x16x32_bf16 v[220:223], v[44:47], v[140:143], v[220:223]
  ds_read_b64_tr_b16 v[42:43], v29 offset:20480
  v_mfma_f32_16x16x32_bf16 v[188:191], v[44:47], v[136:139], v[188:191]
  ds_read_b64_tr_b16 v[44:45], v30 offset:16384
  s_waitcnt lgkmcnt(7)
  v_mfma_f32_16x16x32_bf16 v[192:195], v[48:51], v[136:139], v[192:195]
  ds_read_b64_tr_b16 v[46:47], v30 offset:20480
  v_mfma_f32_16x16x32_bf16 v[224:227], v[48:51], v[140:143], v[224:227]
  ds_read_b64_tr_b16 v[48:49], v5 offset:16384
  v_mfma_f32_16x16x32_bf16 v[228:231], v[52:55], v[140:143], v[228:231]
  ds_read_b64_tr_b16 v[50:51], v5 offset:20480
  v_mfma_f32_16x16x32_bf16 v[196:199], v[52:55], v[136:139], v[196:199]
  ds_read_b64_tr_b16 v[52:53], v6 offset:16384
  v_mfma_f32_16x16x32_bf16 v[200:203], v[56:59], v[136:139], v[200:203]
  ds_read_b64_tr_b16 v[54:55], v6 offset:20480
  v_mfma_f32_16x16x32_bf16 v[232:235], v[56:59], v[140:143], v[232:235]
  ds_read_b64_tr_b16 v[56:57], v21 offset:16384
  v_mfma_f32_16x16x32_bf16 v[236:239], v[60:63], v[140:143], v[236:239]
  ds_read_b64_tr_b16 v[58:59], v21 offset:20480
  v_mfma_f32_16x16x32_bf16 v[204:207], v[60:63], v[136:139], v[204:207]
  ds_read_b64_tr_b16 v[60:61], v2 offset:16384
  s_waitcnt lgkmcnt(7)
  v_mfma_f32_16x16x32_bf16 v[176:179], v[32:35], v[144:147], v[176:179]
  ds_read_b64_tr_b16 v[62:63], v2 offset:20480
  v_mfma_f32_16x16x32_bf16 v[208:211], v[32:35], v[148:151], v[208:211]
  ds_read_b64_tr_b16 v[32:33], v27 offset:24576
  v_mfma_f32_16x16x32_bf16 v[212:215], v[36:39], v[148:151], v[212:215]
  ds_read_b64_tr_b16 v[34:35], v27 offset:28672
  v_xor_b32 v27, s73, v27
  v_mfma_f32_16x16x32_bf16 v[180:183], v[36:39], v[144:147], v[180:183]
  ds_read_b64_tr_b16 v[36:37], v28 offset:24576
  v_mfma_f32_16x16x32_bf16 v[184:187], v[40:43], v[144:147], v[184:187]
  ds_read_b64_tr_b16 v[38:39], v28 offset:28672
  v_xor_b32 v28, s73, v28
  v_mfma_f32_16x16x32_bf16 v[216:219], v[40:43], v[148:151], v[216:219]
  ds_read_b64_tr_b16 v[40:41], v29 offset:24576
  v_mfma_f32_16x16x32_bf16 v[220:223], v[44:47], v[148:151], v[220:223]
  ds_read_b64_tr_b16 v[42:43], v29 offset:28672
  v_xor_b32 v29, s73, v29
  v_mfma_f32_16x16x32_bf16 v[188:191], v[44:47], v[144:147], v[188:191]
  ds_read_b64_tr_b16 v[44:45], v30 offset:24576
  s_waitcnt lgkmcnt(7)
  v_mfma_f32_16x16x32_bf16 v[192:195], v[48:51], v[144:147], v[192:195]
  ds_read_b64_tr_b16 v[46:47], v30 offset:28672
  v_xor_b32 v30, s73, v30
  v_mfma_f32_16x16x32_bf16 v[224:227], v[48:51], v[148:151], v[224:227]
  ds_read_b64_tr_b16 v[48:49], v5 offset:24576
  v_mfma_f32_16x16x32_bf16 v[228:231], v[52:55], v[148:151], v[228:231]
  ds_read_b64_tr_b16 v[50:51], v5 offset:28672
  v_xor_b32 v5, s73, v5
  v_mfma_f32_16x16x32_bf16 v[196:199], v[52:55], v[144:147], v[196:199]
  ds_read_b64_tr_b16 v[52:53], v6 offset:24576
  v_mfma_f32_16x16x32_bf16 v[200:203], v[56:59], v[144:147], v[200:203]
  ds_read_b64_tr_b16 v[54:55], v6 offset:28672
  v_xor_b32 v6, s73, v6
  v_mfma_f32_16x16x32_bf16 v[232:235], v[56:59], v[148:151], v[232:235]
  ds_read_b64_tr_b16 v[56:57], v21 offset:24576
  v_mfma_f32_16x16x32_bf16 v[236:239], v[60:63], v[148:151], v[236:239]
  ds_read_b64_tr_b16 v[58:59], v21 offset:28672
  v_xor_b32 v21, s73, v21
  v_mfma_f32_16x16x32_bf16 v[204:207], v[60:63], v[144:147], v[204:207]
  ds_read_b64_tr_b16 v[60:61], v2 offset:24576
  s_waitcnt lgkmcnt(7)
  v_mfma_f32_16x16x32_bf16 v[176:179], v[32:35], v[152:155], v[176:179]
  ds_read_b64_tr_b16 v[62:63], v2 offset:28672
  v_xor_b32 v2, s73, v2
  s_barrier
  v_mfma_f32_16x16x32_bf16 v[208:211], v[32:35], v[156:159], v[208:211]
  ds_read_b64_tr_b16 v[32:33], v27 offset:0
  v_mfma_f32_16x16x32_bf16 v[212:215], v[36:39], v[156:159], v[212:215]
  ds_read_b64_tr_b16 v[34:35], v27 offset:4096
  v_mfma_f32_16x16x32_bf16 v[180:183], v[36:39], v[152:155], v[180:183]
  ds_read_b64_tr_b16 v[36:37], v28 offset:0
  v_mfma_f32_16x16x32_bf16 v[184:187], v[40:43], v[152:155], v[184:187]
  ds_read_b64_tr_b16 v[38:39], v28 offset:4096
  v_mfma_f32_16x16x32_bf16 v[216:219], v[40:43], v[156:159], v[216:219]
  ds_read_b64_tr_b16 v[40:41], v29 offset:0
  v_mfma_f32_16x16x32_bf16 v[220:223], v[44:47], v[156:159], v[220:223]
  ds_read_b64_tr_b16 v[42:43], v29 offset:4096
  v_mfma_f32_16x16x32_bf16 v[188:191], v[44:47], v[152:155], v[188:191]
  ds_read_b64_tr_b16 v[44:45], v30 offset:0
  s_waitcnt lgkmcnt(7)
  v_mfma_f32_16x16x32_bf16 v[192:195], v[48:51], v[152:155], v[192:195]
  ds_read_b64_tr_b16 v[46:47], v30 offset:4096
  v_mfma_f32_16x16x32_bf16 v[224:227], v[48:51], v[156:159], v[224:227]
  ds_read_b64_tr_b16 v[48:49], v5 offset:0
  v_mfma_f32_16x16x32_bf16 v[228:231], v[52:55], v[156:159], v[228:231]
  ds_read_b64_tr_b16 v[50:51], v5 offset:4096
  v_mfma_f32_16x16x32_bf16 v[196:199], v[52:55], v[152:155], v[196:199]
  ds_read_b64_tr_b16 v[52:53], v6 offset:0
  v_mfma_f32_16x16x32_bf16 v[200:203], v[56:59], v[152:155], v[200:203]
  ds_read_b64_tr_b16 v[54:55], v6 offset:4096
  v_mfma_f32_16x16x32_bf16 v[232:235], v[56:59], v[156:159], v[232:235]
  ds_read_b64_tr_b16 v[56:57], v21 offset:0
  v_mfma_f32_16x16x32_bf16 v[236:239], v[60:63], v[156:159], v[236:239]
  ds_read_b64_tr_b16 v[58:59], v21 offset:4096
  v_mfma_f32_16x16x32_bf16 v[204:207], v[60:63], v[152:155], v[204:207]
  ds_read_b64_tr_b16 v[62:63], v2 offset:4096
  ds_read_b64_tr_b16 v[60:61], v2 offset:0
  s_waitcnt lgkmcnt(8)
  v_mfma_f32_16x16x32_bf16 v[176:179], v[32:35], v[160:163], v[176:179]
  v_mfma_f32_16x16x32_bf16 v[208:211], v[32:35], v[164:167], v[208:211]
  ds_read_b64_tr_b16 v[32:33], v27 offset:8192
  v_mfma_f32_16x16x32_bf16 v[212:215], v[36:39], v[164:167], v[212:215]
  ds_read_b64_tr_b16 v[34:35], v27 offset:12288
  v_mfma_f32_16x16x32_bf16 v[180:183], v[36:39], v[160:163], v[180:183]
  ds_read_b64_tr_b16 v[36:37], v28 offset:8192
  v_mfma_f32_16x16x32_bf16 v[184:187], v[40:43], v[160:163], v[184:187]
  ds_read_b64_tr_b16 v[38:39], v28 offset:12288
  v_mfma_f32_16x16x32_bf16 v[216:219], v[40:43], v[164:167], v[216:219]
  ds_read_b64_tr_b16 v[40:41], v29 offset:8192
  v_mfma_f32_16x16x32_bf16 v[220:223], v[44:47], v[164:167], v[220:223]
  ds_read_b64_tr_b16 v[42:43], v29 offset:12288
  v_mfma_f32_16x16x32_bf16 v[188:191], v[44:47], v[160:163], v[188:191]
  ds_read_b64_tr_b16 v[44:45], v30 offset:8192
  s_waitcnt lgkmcnt(7)
  v_mfma_f32_16x16x32_bf16 v[192:195], v[48:51], v[160:163], v[192:195]
  ds_read_b64_tr_b16 v[46:47], v30 offset:12288
  v_mfma_f32_16x16x32_bf16 v[224:227], v[48:51], v[164:167], v[224:227]
  ds_read_b64_tr_b16 v[48:49], v5 offset:8192
  v_mfma_f32_16x16x32_bf16 v[228:231], v[52:55], v[164:167], v[228:231]
  ds_read_b64_tr_b16 v[50:51], v5 offset:12288
  v_mfma_f32_16x16x32_bf16 v[196:199], v[52:55], v[160:163], v[196:199]
  ds_read_b64_tr_b16 v[52:53], v6 offset:8192
  v_mfma_f32_16x16x32_bf16 v[200:203], v[56:59], v[160:163], v[200:203]
  ds_read_b64_tr_b16 v[54:55], v6 offset:12288
  v_mfma_f32_16x16x32_bf16 v[232:235], v[56:59], v[164:167], v[232:235]
  ds_read_b64_tr_b16 v[56:57], v21 offset:8192
  v_mfma_f32_16x16x32_bf16 v[236:239], v[60:63], v[164:167], v[236:239]
  ds_read_b64_tr_b16 v[58:59], v21 offset:12288
  v_mfma_f32_16x16x32_bf16 v[204:207], v[60:63], v[160:163], v[204:207]
  ds_read_b64_tr_b16 v[60:61], v2 offset:8192
  s_waitcnt lgkmcnt(7)
  v_mfma_f32_16x16x32_bf16 v[176:179], v[32:35], v[168:171], v[176:179]
  ds_read_b64_tr_b16 v[62:63], v2 offset:12288
  v_mfma_f32_16x16x32_bf16 v[208:211], v[32:35], v[172:175], v[208:211]
  v_mfma_f32_16x16x32_bf16 v[212:215], v[36:39], v[172:175], v[212:215]
  v_mfma_f32_16x16x32_bf16 v[180:183], v[36:39], v[168:171], v[180:183]
  v_mfma_f32_16x16x32_bf16 v[184:187], v[40:43], v[168:171], v[184:187]
  v_mfma_f32_16x16x32_bf16 v[216:219], v[40:43], v[172:175], v[216:219]
  v_mfma_f32_16x16x32_bf16 v[220:223], v[44:47], v[172:175], v[220:223]
  v_mfma_f32_16x16x32_bf16 v[188:191], v[44:47], v[168:171], v[188:191]
  s_waitcnt lgkmcnt(0)
  v_mfma_f32_16x16x32_bf16 v[192:195], v[48:51], v[168:171], v[192:195]
  v_mfma_f32_16x16x32_bf16 v[224:227], v[48:51], v[172:175], v[224:227]
  v_mfma_f32_16x16x32_bf16 v[228:231], v[52:55], v[172:175], v[228:231]
  v_mfma_f32_16x16x32_bf16 v[196:199], v[52:55], v[168:171], v[196:199]
  v_mfma_f32_16x16x32_bf16 v[200:203], v[56:59], v[168:171], v[200:203]
  v_mfma_f32_16x16x32_bf16 v[232:235], v[56:59], v[172:175], v[232:235]
  v_mfma_f32_16x16x32_bf16 v[236:239], v[60:63], v[172:175], v[236:239]
  v_mfma_f32_16x16x32_bf16 v[204:207], v[60:63], v[168:171], v[204:207]
  s_add_u32 s48, s30, 0x3900000
  s_addc_u32 s49, s31, 0
  s_mov_b32 s50, 0x800000
  s_mov_b32 s51, 0x20000
  s_lshl_b32 s60, s9, 2
  s_add_u32 s60, s60, s6
  s_lshl_b32 s60, s60, 15
  s_and_b32 s61, s59, 2
  s_and_b32 s62, s59, 1
  s_lshl_b32 s63, s62, 12
  s_add_u32 s60, s60, s63
  s_lshl_b32 s62, s62, 13
  s_add_u32 s62, s62, 131072
  v_add_u32 v16, s62, v14
  s_add_u32 s62, s61, 0
  s_lshl_b32 s63, s62, 13
  s_add_u32 s63, s63, s60
  s_cmp_eq_u32 s62, s6
  s_cbranch_scc1 LF_gown0
  v_cvt_pk_bf16_f32 v64, v176, v177
  v_cvt_pk_bf16_f32 v65, v178, v179
  v_cvt_pk_bf16_f32 v66, v180, v181
  v_cvt_pk_bf16_f32 v67, v182, v183
  buffer_store_dwordx4 v[64:67], v14, s[48:51], s63 offen offset:0 sc1
  v_cvt_pk_bf16_f32 v68, v184, v185
  v_cvt_pk_bf16_f32 v69, v186, v187
  v_cvt_pk_bf16_f32 v70, v188, v189
  v_cvt_pk_bf16_f32 v71, v190, v191
  buffer_store_dwordx4 v[68:71], v14, s[48:51], s63 offen offset:1024 sc1
  v_cvt_pk_bf16_f32 v72, v208, v209
  v_cvt_pk_bf16_f32 v73, v210, v211
  v_cvt_pk_bf16_f32 v74, v212, v213
  v_cvt_pk_bf16_f32 v75, v214, v215
  buffer_store_dwordx4 v[72:75], v14, s[48:51], s63 offen offset:2048 sc1
  v_cvt_pk_bf16_f32 v76, v216, v217
  v_cvt_pk_bf16_f32 v77, v218, v219
  v_cvt_pk_bf16_f32 v78, v220, v221
  v_cvt_pk_bf16_f32 v79, v222, v223
  buffer_store_dwordx4 v[76:79], v14, s[48:51], s63 offen offset:3072 sc1
  s_branch LF_gsent0
LF_gown0:
  ds_write_b128 v16, v[176:179] offset:0
  ds_write_b128 v16, v[180:183] offset:1024
  ds_write_b128 v16, v[184:187] offset:2048
  ds_write_b128 v16, v[188:191] offset:3072
  ds_write_b128 v16, v[208:211] offset:4096
  ds_write_b128 v16, v[212:215] offset:5120
  ds_write_b128 v16, v[216:219] offset:6144
  ds_write_b128 v16, v[220:223] offset:7168
LF_gsent0:
  s_add_u32 s62, s61, 1
  s_lshl_b32 s63, s62, 13
  s_add_u32 s63, s63, s60
  s_cmp_eq_u32 s62, s6
  s_cbranch_scc1 LF_gown1
  v_cvt_pk_bf16_f32 v80, v192, v193
  v_cvt_pk_bf16_f32 v81, v194, v195
  v_cvt_pk_bf16_f32 v82, v196, v197
  v_cvt_pk_bf16_f32 v83, v198, v199
  buffer_store_dwordx4 v[80:83], v14, s[48:51], s63 offen offset:0 sc1
  v_cvt_pk_bf16_f32 v84, v200, v201
  v_cvt_pk_bf16_f32 v85, v202, v203
  v_cvt_pk_bf16_f32 v86, v204, v205
  v_cvt_pk_bf16_f32 v87, v206, v207
  buffer_store_dwordx4 v[84:87], v14, s[48:51], s63 offen offset:1024 sc1
  v_cvt_pk_bf16_f32 v88, v224, v225
  v_cvt_pk_bf16_f32 v89, v226, v227
  v_cvt_pk_bf16_f32 v90, v228, v229
  v_cvt_pk_bf16_f32 v91, v230, v231
  buffer_store_dwordx4 v[88:91], v14, s[48:51], s63 offen offset:2048 sc1
  v_cvt_pk_bf16_f32 v92, v232, v233
  v_cvt_pk_bf16_f32 v93, v234, v235
  v_cvt_pk_bf16_f32 v94, v236, v237
  v_cvt_pk_bf16_f32 v95, v238, v239
  buffer_store_dwordx4 v[92:95], v14, s[48:51], s63 offen offset:3072 sc1
  s_branch LF_gsent1
LF_gown1:
  ds_write_b128 v16, v[192:195] offset:0
  ds_write_b128 v16, v[196:199] offset:1024
  ds_write_b128 v16, v[200:203] offset:2048
  ds_write_b128 v16, v[204:207] offset:3072
  ds_write_b128 v16, v[224:227] offset:4096
  ds_write_b128 v16, v[228:231] offset:5120
  ds_write_b128 v16, v[232:235] offset:6144
  ds_write_b128 v16, v[236:239] offset:7168
LF_gsent1:
  s_add_u32 s44, s30, 0x4900000
  s_addc_u32 s45, s31, 0
  s_mov_b32 s46, 0x800000
  s_mov_b32 s47, 0x20000
  s_mov_b32 s48, s26
  s_mov_b32 s49, s27
  s_mov_b32 s50, 0x200000
  s_mov_b32 s51, 0x20000
  s_mov_b32 s63, s59
  s_add_u32 s60, s6, 1
  s_and_b32 s60, s60, 3
  s_lshl_b32 s61, s9, 2
  s_add_u32 s60, s60, s61
  s_lshl_b32 s60, s60, 2
  s_add_u32 s60, s60, s6
  s_lshl_b32 s60, s60, 2
  s_add_u32 s60, s60, s63
  s_lshl_b32 s65, s60, 11
  s_add_u32 s60, s6, 2
  s_and_b32 s60, s60, 3
  s_lshl_b32 s61, s9, 2
  s_add_u32 s60, s60, s61
  s_lshl_b32 s60, s60, 2
  s_add_u32 s60, s60, s6
  s_lshl_b32 s60, s60, 2
  s_add_u32 s60, s60, s63
  s_lshl_b32 s66, s60, 11
  s_add_u32 s60, s6, 3
  s_and_b32 s60, s60, 3
  s_lshl_b32 s61, s9, 2
  s_add_u32 s60, s60, s61
  s_lshl_b32 s60, s60, 2
  s_add_u32 s60, s60, s6
  s_lshl_b32 s60, s60, 2
  s_add_u32 s60, s60, s63
  s_lshl_b32 s67, s60, 11
  v_lshlrev_b32 v112, 16, v240
  v_and_b32 v113, 0xffff0000, v240
  v_lshlrev_b32 v114, 16, v241
  v_and_b32 v115, 0xffff0000, v241
  v_lshlrev_b32 v116, 16, v242
  v_and_b32 v117, 0xffff0000, v242
  v_lshlrev_b32 v118, 16, v243
  v_and_b32 v119, 0xffff0000, v243
  v_lshlrev_b32 v120, 16, v244
  v_and_b32 v121, 0xffff0000, v244
  v_lshlrev_b32 v122, 16, v245
  v_and_b32 v123, 0xffff0000, v245
  v_lshlrev_b32 v124, 16, v246
  v_and_b32 v125, 0xffff0000, v246
  v_lshlrev_b32 v126, 16, v247
  v_and_b32 v127, 0xffff0000, v247
  s_waitcnt lgkmcnt(0)
  s_barrier
  ds_read_b128 v[48:51], v26 offset:0
  ds_read_b128 v[52:55], v26 offset:2048
  ds_read_b128 v[56:59], v26 offset:4096
  ds_read_b128 v[60:63], v26 offset:6144
  ds_read_b64_tr_b16 v[32:33], v22 offset:0
  ds_read_b64_tr_b16 v[34:35], v22 offset:4096
  ds_read_b64_tr_b16 v[36:37], v23 offset:0
  ds_read_b64_tr_b16 v[38:39], v23 offset:4096
  ds_read_b64_tr_b16 v[40:41], v24 offset:0
  ds_read_b64_tr_b16 v[42:43], v24 offset:4096
  ds_read_b64_tr_b16 v[44:45], v25 offset:0
  ds_read_b64_tr_b16 v[46:47], v25 offset:4096
  s_waitcnt lgkmcnt(0)
  v_mfma_f32_16x16x32_bf16 v[128:131], v[32:35], v[48:51], 0
  ds_read_b128 v[80:83], v26 offset:1024
  ds_read_b128 v[84:87], v26 offset:3072
  v_mfma_f32_16x16x32_bf16 v[144:147], v[32:35], v[52:55], 0
  ds_read_b128 v[88:91], v26 offset:5120
  ds_read_b128 v[92:95], v26 offset:7168
  v_mfma_f32_16x16x32_bf16 v[160:163], v[32:35], v[56:59], 0
  ds_read_b64_tr_b16 v[64:65], v22 offset:8192
  v_mfma_f32_16x16x32_bf16 v[176:179], v[32:35], v[60:63], 0
  ds_read_b64_tr_b16 v[66:67], v22 offset:12288
  v_mfma_f32_16x16x32_bf16 v[180:183], v[36:39], v[60:63], 0
  ds_read_b64_tr_b16 v[68:69], v23 offset:8192
  v_mfma_f32_16x16x32_bf16 v[164:167], v[36:39], v[56:59], 0
  ds_read_b64_tr_b16 v[70:71], v23 offset:12288
  v_mfma_f32_16x16x32_bf16 v[148:151], v[36:39], v[52:55], 0
  ds_read_b64_tr_b16 v[72:73], v24 offset:8192
  v_mfma_f32_16x16x32_bf16 v[132:135], v[36:39], v[48:51], 0
  ds_read_b64_tr_b16 v[74:75], v24 offset:12288
  v_mfma_f32_16x16x32_bf16 v[136:139], v[40:43], v[48:51], 0
  ds_read_b64_tr_b16 v[76:77], v25 offset:8192
  v_mfma_f32_16x16x32_bf16 v[152:155], v[40:43], v[52:55], 0
  ds_read_b64_tr_b16 v[78:79], v25 offset:12288
  v_mfma_f32_16x16x32_bf16 v[168:171], v[40:43], v[56:59], 0
  v_xor_b32 v26, 0x8000, v26
  v_mfma_f32_16x16x32_bf16 v[184:187], v[40:43], v[60:63], 0
  v_xor_b32 v22, 0x8000, v22
  v_mfma_f32_16x16x32_bf16 v[188:191], v[44:47], v[60:63], 0
  v_xor_b32 v23, 0x8000, v23
  v_mfma_f32_16x16x32_bf16 v[172:175], v[44:47], v[56:59], 0
  v_xor_b32 v24, 0x8000, v24
  v_mfma_f32_16x16x32_bf16 v[156:159], v[44:47], v[52:55], 0
  v_xor_b32 v25, 0x8000, v25
  v_mfma_f32_16x16x32_bf16 v[140:143], v[44:47], v[48:51], 0
  s_waitcnt lgkmcnt(0)
  s_barrier
  v_mfma_f32_16x16x32_bf16 v[128:131], v[64:67], v[80:83], v[128:131]
  ds_read_b128 v[48:51], v26 offset:0
  ds_read_b128 v[52:55], v26 offset:2048
  v_mfma_f32_16x16x32_bf16 v[144:147], v[64:67], v[84:87], v[144:147]
  ds_read_b128 v[56:59], v26 offset:4096
  ds_read_b128 v[60:63], v26 offset:6144
  v_mfma_f32_16x16x32_bf16 v[160:163], v[64:67], v[88:91], v[160:163]
  ds_read_b64_tr_b16 v[32:33], v22 offset:0
  v_mfma_f32_16x16x32_bf16 v[176:179], v[64:67], v[92:95], v[176:179]
  ds_read_b64_tr_b16 v[34:35], v22 offset:4096
  v_mfma_f32_16x16x32_bf16 v[180:183], v[68:71], v[92:95], v[180:183]
  ds_read_b64_tr_b16 v[36:37], v23 offset:0
  v_mfma_f32_16x16x32_bf16 v[164:167], v[68:71], v[88:91], v[164:167]
  ds_read_b64_tr_b16 v[38:39], v23 offset:4096
  v_mfma_f32_16x16x32_bf16 v[148:151], v[68:71], v[84:87], v[148:151]
  ds_read_b64_tr_b16 v[40:41], v24 offset:0
  v_mfma_f32_16x16x32_bf16 v[132:135], v[68:71], v[80:83], v[132:135]
  ds_read_b64_tr_b16 v[42:43], v24 offset:4096
  v_mfma_f32_16x16x32_bf16 v[136:139], v[72:75], v[80:83], v[136:139]
  ds_read_b64_tr_b16 v[44:45], v25 offset:0
  v_mfma_f32_16x16x32_bf16 v[152:155], v[72:75], v[84:87], v[152:155]
  ds_read_b64_tr_b16 v[46:47], v25 offset:4096
  v_mfma_f32_16x16x32_bf16 v[168:171], v[72:75], v[88:91], v[168:171]
  v_mfma_f32_16x16x32_bf16 v[184:187], v[72:75], v[92:95], v[184:187]
  v_mfma_f32_16x16x32_bf16 v[188:191], v[76:79], v[92:95], v[188:191]
  v_mfma_f32_16x16x32_bf16 v[172:175], v[76:79], v[88:91], v[172:175]
  v_mfma_f32_16x16x32_bf16 v[156:159], v[76:79], v[84:87], v[156:159]
  v_mfma_f32_16x16x32_bf16 v[140:143], v[76:79], v[80:83], v[140:143]
  s_waitcnt lgkmcnt(0)
  v_mfma_f32_16x16x32_bf16 v[128:131], v[32:35], v[48:51], v[128:131]
  ds_read_b128 v[80:83], v26 offset:1024
  ds_read_b128 v[84:87], v26 offset:3072
  v_mfma_f32_16x16x32_bf16 v[144:147], v[32:35], v[52:55], v[144:147]
  ds_read_b128 v[88:91], v26 offset:5120
  ds_read_b128 v[92:95], v26 offset:7168
  v_mfma_f32_16x16x32_bf16 v[160:163], v[32:35], v[56:59], v[160:163]
  ds_read_b64_tr_b16 v[64:65], v22 offset:8192
  v_mfma_f32_16x16x32_bf16 v[176:179], v[32:35], v[60:63], v[176:179]
  ds_read_b64_tr_b16 v[66:67], v22 offset:12288
  v_mfma_f32_16x16x32_bf16 v[180:183], v[36:39], v[60:63], v[180:183]
  ds_read_b64_tr_b16 v[68:69], v23 offset:8192
  v_mfma_f32_16x16x32_bf16 v[164:167], v[36:39], v[56:59], v[164:167]
  ds_read_b64_tr_b16 v[70:71], v23 offset:12288
  v_mfma_f32_16x16x32_bf16 v[148:151], v[36:39], v[52:55], v[148:151]
  ds_read_b64_tr_b16 v[72:73], v24 offset:8192
  v_mfma_f32_16x16x32_bf16 v[132:135], v[36:39], v[48:51], v[132:135]
  ds_read_b64_tr_b16 v[74:75], v24 offset:12288
  v_mfma_f32_16x16x32_bf16 v[136:139], v[40:43], v[48:51], v[136:139]
  ds_read_b64_tr_b16 v[76:77], v25 offset:8192
  v_mfma_f32_16x16x32_bf16 v[152:155], v[40:43], v[52:55], v[152:155]
  ds_read_b64_tr_b16 v[78:79], v25 offset:12288
  v_mfma_f32_16x16x32_bf16 v[168:171], v[40:43], v[56:59], v[168:171]
  v_xor_b32 v26, 0x10000, v26
  v_mfma_f32_16x16x32_bf16 v[184:187], v[40:43], v[60:63], v[184:187]
  v_xor_b32 v22, 0x10000, v22
  v_mfma_f32_16x16x32_bf16 v[188:191], v[44:47], v[60:63], v[188:191]
  v_xor_b32 v23, 0x10000, v23
  v_mfma_f32_16x16x32_bf16 v[172:175], v[44:47], v[56:59], v[172:175]
  v_xor_b32 v24, 0x10000, v24
  v_mfma_f32_16x16x32_bf16 v[156:159], v[44:47], v[52:55], v[156:159]
  v_xor_b32 v25, 0x10000, v25
  v_mfma_f32_16x16x32_bf16 v[140:143], v[44:47], v[48:51], v[140:143]
  s_waitcnt lgkmcnt(0)
  s_barrier
  v_mfma_f32_16x16x32_bf16 v[128:131], v[64:67], v[80:83], v[128:131]
  ds_read_b128 v[48:51], v26 offset:0
  ds_read_b128 v[52:55], v26 offset:2048
  v_mfma_f32_16x16x32_bf16 v[144:147], v[64:67], v[84:87], v[144:147]
  ds_read_b128 v[56:59], v26 offset:4096
  ds_read_b128 v[60:63], v26 offset:6144
  v_mfma_f32_16x16x32_bf16 v[160:163], v[64:67], v[88:91], v[160:163]
  ds_read_b64_tr_b16 v[32:33], v22 offset:0
  v_mfma_f32_16x16x32_bf16 v[176:179], v[64:67], v[92:95], v[176:179]
  ds_read_b64_tr_b16 v[34:35], v22 offset:4096
  v_mfma_f32_16x16x32_bf16 v[180:183], v[68:71], v[92:95], v[180:183]
  ds_read_b64_tr_b16 v[36:37], v23 offset:0
  v_mfma_f32_16x16x32_bf16 v[164:167], v[68:71], v[88:91], v[164:167]
  ds_read_b64_tr_b16 v[38:39], v23 offset:4096
  v_mfma_f32_16x16x32_bf16 v[148:151], v[68:71], v[84:87], v[148:151]
  ds_read_b64_tr_b16 v[40:41], v24 offset:0
  v_mfma_f32_16x16x32_bf16 v[132:135], v[68:71], v[80:83], v[132:135]
  ds_read_b64_tr_b16 v[42:43], v24 offset:4096
  v_mfma_f32_16x16x32_bf16 v[136:139], v[72:75], v[80:83], v[136:139]
  ds_read_b64_tr_b16 v[44:45], v25 offset:0
  v_mfma_f32_16x16x32_bf16 v[152:155], v[72:75], v[84:87], v[152:155]
  ds_read_b64_tr_b16 v[46:47], v25 offset:4096
  v_mfma_f32_16x16x32_bf16 v[168:171], v[72:75], v[88:91], v[168:171]
  v_mfma_f32_16x16x32_bf16 v[184:187], v[72:75], v[92:95], v[184:187]
  v_mfma_f32_16x16x32_bf16 v[188:191], v[76:79], v[92:95], v[188:191]
  v_mfma_f32_16x16x32_bf16 v[172:175], v[76:79], v[88:91], v[172:175]
  v_mfma_f32_16x16x32_bf16 v[156:159], v[76:79], v[84:87], v[156:159]
  v_mfma_f32_16x16x32_bf16 v[140:143], v[76:79], v[80:83], v[140:143]
  s_waitcnt lgkmcnt(0)
  s_mov_b32 s75, 6
LF_loop:
  v_mfma_f32_16x16x32_bf16 v[128:131], v[32:35], v[48:51], v[128:131]
  ds_read_b128 v[80:83], v26 offset:1024
  ds_read_b128 v[84:87], v26 offset:3072
  v_mfma_f32_16x16x32_bf16 v[144:147], v[32:35], v[52:55], v[144:147]
  ds_read_b128 v[88:91], v26 offset:5120
  ds_read_b128 v[92:95], v26 offset:7168
  v_mfma_f32_16x16x32_bf16 v[160:163], v[32:35], v[56:59], v[160:163]
  ds_read_b64_tr_b16 v[64:65], v22 offset:8192
  v_mfma_f32_16x16x32_bf16 v[176:179], v[32:35], v[60:63], v[176:179]
  ds_read_b64_tr_b16 v[66:67], v22 offset:12288
  v_mfma_f32_16x16x32_bf16 v[180:183], v[36:39], v[60:63], v[180:183]
  ds_read_b64_tr_b16 v[68:69], v23 offset:8192
  v_mfma_f32_16x16x32_bf16 v[164:167], v[36:39], v[56:59], v[164:167]
  ds_read_b64_tr_b16 v[70:71], v23 offset:12288
  v_mfma_f32_16x16x32_bf16 v[148:151], v[36:39], v[52:55], v[148:151]
  ds_read_b64_tr_b16 v[72:73], v24 offset:8192
  v_mfma_f32_16x16x32_bf16 v[132:135], v[36:39], v[48:51], v[132:135]
  ds_read_b64_tr_b16 v[74:75], v24 offset:12288
  v_mfma_f32_16x16x32_bf16 v[136:139], v[40:43], v[48:51], v[136:139]
  ds_read_b64_tr_b16 v[76:77], v25 offset:8192
  v_mfma_f32_16x16x32_bf16 v[152:155], v[40:43], v[52:55], v[152:155]
  ds_read_b64_tr_b16 v[78:79], v25 offset:12288
  v_mfma_f32_16x16x32_bf16 v[168:171], v[40:43], v[56:59], v[168:171]
  v_xor_b32 v26, 0x8000, v26
  v_mfma_f32_16x16x32_bf16 v[184:187], v[40:43], v[60:63], v[184:187]
  v_xor_b32 v22, 0x8000, v22
  v_mfma_f32_16x16x32_bf16 v[188:191], v[44:47], v[60:63], v[188:191]
  v_xor_b32 v23, 0x8000, v23
  v_mfma_f32_16x16x32_bf16 v[172:175], v[44:47], v[56:59], v[172:175]
  v_xor_b32 v24, 0x8000, v24
  v_mfma_f32_16x16x32_bf16 v[156:159], v[44:47], v[52:55], v[156:159]
  v_xor_b32 v25, 0x8000, v25
  v_mfma_f32_16x16x32_bf16 v[140:143], v[44:47], v[48:51], v[140:143]
  s_waitcnt lgkmcnt(0)
  s_barrier
  v_mfma_f32_16x16x32_bf16 v[128:131], v[64:67], v[80:83], v[128:131]
  ds_read_b128 v[48:51], v26 offset:0
  ds_read_b128 v[52:55], v26 offset:2048
  v_mfma_f32_16x16x32_bf16 v[144:147], v[64:67], v[84:87], v[144:147]
  ds_read_b128 v[56:59], v26 offset:4096
  ds_read_b128 v[60:63], v26 offset:6144
  v_mfma_f32_16x16x32_bf16 v[160:163], v[64:67], v[88:91], v[160:163]
  ds_read_b64_tr_b16 v[32:33], v22 offset:0
  v_mfma_f32_16x16x32_bf16 v[176:179], v[64:67], v[92:95], v[176:179]
  ds_read_b64_tr_b16 v[34:35], v22 offset:4096
  v_mfma_f32_16x16x32_bf16 v[180:183], v[68:71], v[92:95], v[180:183]
  ds_read_b64_tr_b16 v[36:37], v23 offset:0
  v_mfma_f32_16x16x32_bf16 v[164:167], v[68:71], v[88:91], v[164:167]
  ds_read_b64_tr_b16 v[38:39], v23 offset:4096
  v_mfma_f32_16x16x32_bf16 v[148:151], v[68:71], v[84:87], v[148:151]
  ds_read_b64_tr_b16 v[40:41], v24 offset:0
  v_mfma_f32_16x16x32_bf16 v[132:135], v[68:71], v[80:83], v[132:135]
  ds_read_b64_tr_b16 v[42:43], v24 offset:4096
  v_mfma_f32_16x16x32_bf16 v[136:139], v[72:75], v[80:83], v[136:139]
  ds_read_b64_tr_b16 v[44:45], v25 offset:0
  v_mfma_f32_16x16x32_bf16 v[152:155], v[72:75], v[84:87], v[152:155]
  ds_read_b64_tr_b16 v[46:47], v25 offset:4096
  v_mfma_f32_16x16x32_bf16 v[168:171], v[72:75], v[88:91], v[168:171]
  v_mfma_f32_16x16x32_bf16 v[184:187], v[72:75], v[92:95], v[184:187]
  v_mfma_f32_16x16x32_bf16 v[188:191], v[76:79], v[92:95], v[188:191]
  v_mfma_f32_16x16x32_bf16 v[172:175], v[76:79], v[88:91], v[172:175]
  v_mfma_f32_16x16x32_bf16 v[156:159], v[76:79], v[84:87], v[156:159]
  v_mfma_f32_16x16x32_bf16 v[140:143], v[76:79], v[80:83], v[140:143]
  s_waitcnt lgkmcnt(0)
  v_mfma_f32_16x16x32_bf16 v[128:131], v[32:35], v[48:51], v[128:131]
  ds_read_b128 v[80:83], v26 offset:1024
  ds_read_b128 v[84:87], v26 offset:3072
  v_mfma_f32_16x16x32_bf16 v[144:147], v[32:35], v[52:55], v[144:147]
  ds_read_b128 v[88:91], v26 offset:5120
  ds_read_b128 v[92:95], v26 offset:7168
  v_mfma_f32_16x16x32_bf16 v[160:163], v[32:35], v[56:59], v[160:163]
  ds_read_b64_tr_b16 v[64:65], v22 offset:8192
  v_mfma_f32_16x16x32_bf16 v[176:179], v[32:35], v[60:63], v[176:179]
  ds_read_b64_tr_b16 v[66:67], v22 offset:12288
  v_mfma_f32_16x16x32_bf16 v[180:183], v[36:39], v[60:63], v[180:183]
  ds_read_b64_tr_b16 v[68:69], v23 offset:8192
  v_mfma_f32_16x16x32_bf16 v[164:167], v[36:39], v[56:59], v[164:167]
  ds_read_b64_tr_b16 v[70:71], v23 offset:12288
  v_mfma_f32_16x16x32_bf16 v[148:151], v[36:39], v[52:55], v[148:151]
  ds_read_b64_tr_b16 v[72:73], v24 offset:8192
  v_mfma_f32_16x16x32_bf16 v[132:135], v[36:39], v[48:51], v[132:135]
  ds_read_b64_tr_b16 v[74:75], v24 offset:12288
  v_mfma_f32_16x16x32_bf16 v[136:139], v[40:43], v[48:51], v[136:139]
  ds_read_b64_tr_b16 v[76:77], v25 offset:8192
  v_mfma_f32_16x16x32_bf16 v[152:155], v[40:43], v[52:55], v[152:155]
  ds_read_b64_tr_b16 v[78:79], v25 offset:12288
  v_mfma_f32_16x16x32_bf16 v[168:171], v[40:43], v[56:59], v[168:171]
  v_xor_b32 v26, 0x10000, v26
  v_mfma_f32_16x16x32_bf16 v[184:187], v[40:43], v[60:63], v[184:187]
  v_xor_b32 v22, 0x10000, v22
  v_mfma_f32_16x16x32_bf16 v[188:191], v[44:47], v[60:63], v[188:191]
  v_xor_b32 v23, 0x10000, v23
  v_mfma_f32_16x16x32_bf16 v[172:175], v[44:47], v[56:59], v[172:175]
  v_xor_b32 v24, 0x10000, v24
  v_mfma_f32_16x16x32_bf16 v[156:159], v[44:47], v[52:55], v[156:159]
  v_xor_b32 v25, 0x10000, v25
  v_mfma_f32_16x16x32_bf16 v[140:143], v[44:47], v[48:51], v[140:143]
  s_waitcnt lgkmcnt(0)
  s_barrier
  v_mfma_f32_16x16x32_bf16 v[128:131], v[64:67], v[80:83], v[128:131]
  ds_read_b128 v[48:51], v26 offset:0
  ds_read_b128 v[52:55], v26 offset:2048
  v_mfma_f32_16x16x32_bf16 v[144:147], v[64:67], v[84:87], v[144:147]
  ds_read_b128 v[56:59], v26 offset:4096
  ds_read_b128 v[60:63], v26 offset:6144
  v_mfma_f32_16x16x32_bf16 v[160:163], v[64:67], v[88:91], v[160:163]
  ds_read_b64_tr_b16 v[32:33], v22 offset:0
  v_mfma_f32_16x16x32_bf16 v[176:179], v[64:67], v[92:95], v[176:179]
  ds_read_b64_tr_b16 v[34:35], v22 offset:4096
  v_mfma_f32_16x16x32_bf16 v[180:183], v[68:71], v[92:95], v[180:183]
  ds_read_b64_tr_b16 v[36:37], v23 offset:0
  v_mfma_f32_16x16x32_bf16 v[164:167], v[68:71], v[88:91], v[164:167]
  ds_read_b64_tr_b16 v[38:39], v23 offset:4096
  v_mfma_f32_16x16x32_bf16 v[148:151], v[68:71], v[84:87], v[148:151]
  ds_read_b64_tr_b16 v[40:41], v24 offset:0
  v_mfma_f32_16x16x32_bf16 v[132:135], v[68:71], v[80:83], v[132:135]
  ds_read_b64_tr_b16 v[42:43], v24 offset:4096
  v_mfma_f32_16x16x32_bf16 v[136:139], v[72:75], v[80:83], v[136:139]
  ds_read_b64_tr_b16 v[44:45], v25 offset:0
  v_mfma_f32_16x16x32_bf16 v[152:155], v[72:75], v[84:87], v[152:155]
  ds_read_b64_tr_b16 v[46:47], v25 offset:4096
  v_mfma_f32_16x16x32_bf16 v[168:171], v[72:75], v[88:91], v[168:171]
  v_mfma_f32_16x16x32_bf16 v[184:187], v[72:75], v[92:95], v[184:187]
  v_mfma_f32_16x16x32_bf16 v[188:191], v[76:79], v[92:95], v[188:191]
  v_mfma_f32_16x16x32_bf16 v[172:175], v[76:79], v[88:91], v[172:175]
  v_mfma_f32_16x16x32_bf16 v[156:159], v[76:79], v[84:87], v[156:159]
  v_mfma_f32_16x16x32_bf16 v[140:143], v[76:79], v[80:83], v[140:143]
  s_waitcnt lgkmcnt(0)
  s_sub_u32 s75, s75, 1
  s_cmp_lg_u32 s75, 0
  s_cbranch_scc1 LF_loop
  v_mfma_f32_16x16x32_bf16 v[128:131], v[32:35], v[48:51], v[128:131]
  ds_read_b128 v[80:83], v26 offset:1024
  ds_read_b128 v[84:87], v26 offset:3072
  v_mfma_f32_16x16x32_bf16 v[144:147], v[32:35], v[52:55], v[144:147]
  ds_read_b128 v[88:91], v26 offset:5120
  ds_read_b128 v[92:95], v26 offset:7168
  v_mfma_f32_16x16x32_bf16 v[160:163], v[32:35], v[56:59], v[160:163]
  ds_read_b64_tr_b16 v[64:65], v22 offset:8192
  v_mfma_f32_16x16x32_bf16 v[176:179], v[32:35], v[60:63], v[176:179]
  ds_read_b64_tr_b16 v[66:67], v22 offset:12288
  v_mfma_f32_16x16x32_bf16 v[180:183], v[36:39], v[60:63], v[180:183]
  ds_read_b64_tr_b16 v[68:69], v23 offset:8192
  v_mfma_f32_16x16x32_bf16 v[164:167], v[36:39], v[56:59], v[164:167]
  ds_read_b64_tr_b16 v[70:71], v23 offset:12288
  v_mfma_f32_16x16x32_bf16 v[148:151], v[36:39], v[52:55], v[148:151]
  ds_read_b64_tr_b16 v[72:73], v24 offset:8192
  v_mfma_f32_16x16x32_bf16 v[132:135], v[36:39], v[48:51], v[132:135]
  ds_read_b64_tr_b16 v[74:75], v24 offset:12288
  v_mfma_f32_16x16x32_bf16 v[136:139], v[40:43], v[48:51], v[136:139]
  ds_read_b64_tr_b16 v[76:77], v25 offset:8192
  v_mfma_f32_16x16x32_bf16 v[152:155], v[40:43], v[52:55], v[152:155]
  ds_read_b64_tr_b16 v[78:79], v25 offset:12288
  v_mfma_f32_16x16x32_bf16 v[168:171], v[40:43], v[56:59], v[168:171]
  v_xor_b32 v26, 0x8000, v26
  v_mfma_f32_16x16x32_bf16 v[184:187], v[40:43], v[60:63], v[184:187]
  v_xor_b32 v22, 0x8000, v22
  v_mfma_f32_16x16x32_bf16 v[188:191], v[44:47], v[60:63], v[188:191]
  v_xor_b32 v23, 0x8000, v23
  v_mfma_f32_16x16x32_bf16 v[172:175], v[44:47], v[56:59], v[172:175]
  v_xor_b32 v24, 0x8000, v24
  v_mfma_f32_16x16x32_bf16 v[156:159], v[44:47], v[52:55], v[156:159]
  v_xor_b32 v25, 0x8000, v25
  v_mfma_f32_16x16x32_bf16 v[140:143], v[44:47], v[48:51], v[140:143]
  s_waitcnt lgkmcnt(0)
  s_barrier
  v_mfma_f32_16x16x32_bf16 v[128:131], v[64:67], v[80:83], v[128:131]
  ds_read_b128 v[48:51], v26 offset:0
  ds_read_b128 v[52:55], v26 offset:2048
  v_mfma_f32_16x16x32_bf16 v[144:147], v[64:67], v[84:87], v[144:147]
  ds_read_b128 v[56:59], v26 offset:4096
  ds_read_b128 v[60:63], v26 offset:6144
  v_mfma_f32_16x16x32_bf16 v[160:163], v[64:67], v[88:91], v[160:163]
  ds_read_b64_tr_b16 v[32:33], v22 offset:0
  v_mfma_f32_16x16x32_bf16 v[176:179], v[64:67], v[92:95], v[176:179]
  ds_read_b64_tr_b16 v[34:35], v22 offset:4096
  v_mfma_f32_16x16x32_bf16 v[180:183], v[68:71], v[92:95], v[180:183]
  ds_read_b64_tr_b16 v[36:37], v23 offset:0
  v_mfma_f32_16x16x32_bf16 v[164:167], v[68:71], v[88:91], v[164:167]
  ds_read_b64_tr_b16 v[38:39], v23 offset:4096
  v_mfma_f32_16x16x32_bf16 v[148:151], v[68:71], v[84:87], v[148:151]
  ds_read_b64_tr_b16 v[40:41], v24 offset:0
  v_mfma_f32_16x16x32_bf16 v[132:135], v[68:71], v[80:83], v[132:135]
  ds_read_b64_tr_b16 v[42:43], v24 offset:4096
  v_mfma_f32_16x16x32_bf16 v[136:139], v[72:75], v[80:83], v[136:139]
  ds_read_b64_tr_b16 v[44:45], v25 offset:0
  v_mfma_f32_16x16x32_bf16 v[152:155], v[72:75], v[84:87], v[152:155]
  ds_read_b64_tr_b16 v[46:47], v25 offset:4096
  v_mfma_f32_16x16x32_bf16 v[168:171], v[72:75], v[88:91], v[168:171]
  v_mfma_f32_16x16x32_bf16 v[184:187], v[72:75], v[92:95], v[184:187]
  v_mfma_f32_16x16x32_bf16 v[188:191], v[76:79], v[92:95], v[188:191]
  v_mfma_f32_16x16x32_bf16 v[172:175], v[76:79], v[88:91], v[172:175]
  v_mfma_f32_16x16x32_bf16 v[156:159], v[76:79], v[84:87], v[156:159]
  v_mfma_f32_16x16x32_bf16 v[140:143], v[76:79], v[80:83], v[140:143]
  s_waitcnt lgkmcnt(0)
  v_mfma_f32_16x16x32_bf16 v[128:131], v[32:35], v[48:51], v[128:131]
  ds_read_b128 v[80:83], v26 offset:1024
  ds_read_b128 v[84:87], v26 offset:3072
  v_mfma_f32_16x16x32_bf16 v[144:147], v[32:35], v[52:55], v[144:147]
  ds_read_b128 v[88:91], v26 offset:5120
  ds_read_b128 v[92:95], v26 offset:7168
  v_mfma_f32_16x16x32_bf16 v[160:163], v[32:35], v[56:59], v[160:163]
  ds_read_b64_tr_b16 v[64:65], v22 offset:8192
  v_mfma_f32_16x16x32_bf16 v[176:179], v[32:35], v[60:63], v[176:179]
  ds_read_b64_tr_b16 v[66:67], v22 offset:12288
  v_mfma_f32_16x16x32_bf16 v[180:183], v[36:39], v[60:63], v[180:183]
  ds_read_b64_tr_b16 v[68:69], v23 offset:8192
  v_mfma_f32_16x16x32_bf16 v[164:167], v[36:39], v[56:59], v[164:167]
  ds_read_b64_tr_b16 v[70:71], v23 offset:12288
  v_mfma_f32_16x16x32_bf16 v[148:151], v[36:39], v[52:55], v[148:151]
  ds_read_b64_tr_b16 v[72:73], v24 offset:8192
  v_mfma_f32_16x16x32_bf16 v[132:135], v[36:39], v[48:51], v[132:135]
  ds_read_b64_tr_b16 v[74:75], v24 offset:12288
  v_mfma_f32_16x16x32_bf16 v[136:139], v[40:43], v[48:51], v[136:139]
  ds_read_b64_tr_b16 v[76:77], v25 offset:8192
  v_mfma_f32_16x16x32_bf16 v[152:155], v[40:43], v[52:55], v[152:155]
  ds_read_b64_tr_b16 v[78:79], v25 offset:12288
  v_mfma_f32_16x16x32_bf16 v[168:171], v[40:43], v[56:59], v[168:171]
  s_lshl_b32 s60, s9, 2
  s_add_u32 s60, s60, s6
  v_mfma_f32_16x16x32_bf16 v[184:187], v[40:43], v[60:63], v[184:187]
  s_lshl_b32 s60, s60, 2
  v_mfma_f32_16x16x32_bf16 v[188:191], v[44:47], v[60:63], v[188:191]
  s_add_u32 s60, s60, s59
  v_mfma_f32_16x16x32_bf16 v[172:175], v[44:47], v[56:59], v[172:175]
  s_lshl_b32 s60, s60, 13
  v_mfma_f32_16x16x32_bf16 v[156:159], v[44:47], v[52:55], v[156:159]
  s_add_u32 s61, s60, 4096
  v_mfma_f32_16x16x32_bf16 v[140:143], v[44:47], v[48:51], v[140:143]
  v_add_u32 v16, 147456, v14
  buffer_load_dwordx4 v[192:195], v14, s[44:47], s65 offen offset:0 sc1
  buffer_load_dwordx4 v[196:199], v14, s[44:47], s65 offen offset:1024 sc1
  buffer_load_dwordx4 v[200:203], v14, s[44:47], s66 offen offset:0 sc1
  buffer_load_dwordx4 v[204:207], v14, s[44:47], s66 offen offset:1024 sc1
  buffer_load_dwordx4 v[208:211], v14, s[44:47], s67 offen offset:0 sc1
  buffer_load_dwordx4 v[212:215], v14, s[44:47], s67 offen offset:1024 sc1
  s_waitcnt lgkmcnt(0)
  s_barrier
  s_cmp_eq_u32 s59, s6
  s_cbranch_scc1 LF_own
  v_mfma_f32_16x16x32_bf16 v[128:131], v[64:67], v[80:83], v[128:131]
  v_mfma_f32_16x16x32_bf16 v[132:135], v[68:71], v[80:83], v[132:135]
  v_mfma_f32_16x16x32_bf16 v[136:139], v[72:75], v[80:83], v[136:139]
  v_mfma_f32_16x16x32_bf16 v[140:143], v[76:79], v[80:83], v[140:143]
  v_mfma_f32_16x16x32_bf16 v[156:159], v[76:79], v[84:87], v[156:159]
  v_mfma_f32_16x16x32_bf16 v[152:155], v[72:75], v[84:87], v[152:155]
  v_mfma_f32_16x16x32_bf16 v[148:151], v[68:71], v[84:87], v[148:151]
  s_nop 1
  v_cvt_pk_bf16_f32 v32, v128, v129
  v_cvt_pk_bf16_f32 v33, v130, v131
  v_cvt_pk_bf16_f32 v34, v132, v133
  v_mfma_f32_16x16x32_bf16 v[144:147], v[64:67], v[84:87], v[144:147]
  v_cvt_pk_bf16_f32 v35, v134, v135
  buffer_store_dwordx4 v[32:35], v14, s[44:47], s60 offen offset:0 sc1
  v_mfma_f32_16x16x32_bf16 v[160:163], v[64:67], v[88:91], v[160:163]
  v_cvt_pk_bf16_f32 v36, v136, v137
  v_cvt_pk_bf16_f32 v37, v138, v139
  v_cvt_pk_bf16_f32 v38, v140, v141
  v_mfma_f32_16x16x32_bf16 v[164:167], v[68:71], v[88:91], v[164:167]
  v_cvt_pk_bf16_f32 v39, v142, v143
  buffer_store_dwordx4 v[36:39], v14, s[44:47], s60 offen offset:1024 sc1
  v_mfma_f32_16x16x32_bf16 v[168:171], v[72:75], v[88:91], v[168:171]
  v_cvt_pk_bf16_f32 v40, v144, v145
  v_cvt_pk_bf16_f32 v41, v146, v147
  v_cvt_pk_bf16_f32 v42, v148, v149
  v_mfma_f32_16x16x32_bf16 v[172:175], v[76:79], v[88:91], v[172:175]
  v_cvt_pk_bf16_f32 v43, v150, v151
  buffer_store_dwordx4 v[40:43], v14, s[44:47], s60 offen offset:2048 sc1
  v_mfma_f32_16x16x32_bf16 v[188:191], v[76:79], v[92:95], v[188:191]
  v_cvt_pk_bf16_f32 v44, v152, v153
  v_cvt_pk_bf16_f32 v45, v154, v155
  v_cvt_pk_bf16_f32 v46, v156, v157
  v_mfma_f32_16x16x32_bf16 v[184:187], v[72:75], v[92:95], v[184:187]
  v_cvt_pk_bf16_f32 v47, v158, v159
  buffer_store_dwordx4 v[44:47], v14, s[44:47], s60 offen offset:3072 sc1
  v_mfma_f32_16x16x32_bf16 v[180:183], v[68:71], v[92:95], v[180:183]
  v_cvt_pk_bf16_f32 v48, v160, v161
  v_cvt_pk_bf16_f32 v49, v162, v163
  v_cvt_pk_bf16_f32 v50, v164, v165
  v_cvt_pk_bf16_f32 v51, v166, v167
  buffer_store_dwordx4 v[48:51], v14, s[44:47], s61 offen offset:0 sc1
  v_mfma_f32_16x16x32_bf16 v[176:179], v[64:67], v[92:95], v[176:179]
  v_cvt_pk_bf16_f32 v52, v168, v169
  v_cvt_pk_bf16_f32 v53, v170, v171
  v_cvt_pk_bf16_f32 v54, v172, v173
  v_cvt_pk_bf16_f32 v55, v174, v175
  buffer_store_dwordx4 v[52:55], v14, s[44:47], s61 offen offset:1024 sc1
  s_nop 2
  v_cvt_pk_bf16_f32 v56, v176, v177
  v_cvt_pk_bf16_f32 v57, v178, v179
  v_cvt_pk_bf16_f32 v58, v180, v181
  v_cvt_pk_bf16_f32 v59, v182, v183
  buffer_store_dwordx4 v[56:59], v14, s[44:47], s61 offen offset:2048 sc1
  v_cvt_pk_bf16_f32 v60, v184, v185
  v_cvt_pk_bf16_f32 v61, v186, v187
  v_cvt_pk_bf16_f32 v62, v188, v189
  v_cvt_pk_bf16_f32 v63, v190, v191
  buffer_store_dwordx4 v[60:63], v14, s[44:47], s61 offen offset:3072 sc1
  s_branch LF_sent
LF_own:
  v_mfma_f32_16x16x32_bf16 v[128:131], v[64:67], v[80:83], v[128:131]
  v_mfma_f32_16x16x32_bf16 v[132:135], v[68:71], v[80:83], v[132:135]
  v_mfma_f32_16x16x32_bf16 v[136:139], v[72:75], v[80:83], v[136:139]
  v_mfma_f32_16x16x32_bf16 v[140:143], v[76:79], v[80:83], v[140:143]
  v_mfma_f32_16x16x32_bf16 v[156:159], v[76:79], v[84:87], v[156:159]
  v_mfma_f32_16x16x32_bf16 v[152:155], v[72:75], v[84:87], v[152:155]
  v_mfma_f32_16x16x32_bf16 v[148:151], v[68:71], v[84:87], v[148:151]
  v_mfma_f32_16x16x32_bf16 v[144:147], v[64:67], v[84:87], v[144:147]
  s_nop 0
  ds_write_b128 v16, v[128:131] offset:0
  v_mfma_f32_16x16x32_bf16 v[160:163], v[64:67], v[88:91], v[160:163]
  ds_write_b128 v16, v[132:135] offset:1024
  v_mfma_f32_16x16x32_bf16 v[164:167], v[68:71], v[88:91], v[164:167]
  ds_write_b128 v16, v[136:139] offset:2048
  v_mfma_f32_16x16x32_bf16 v[168:171], v[72:75], v[88:91], v[168:171]
  ds_write_b128 v16, v[140:143] offset:3072
  v_mfma_f32_16x16x32_bf16 v[172:175], v[76:79], v[88:91], v[172:175]
  ds_write_b128 v16, v[144:147] offset:4096
  v_mfma_f32_16x16x32_bf16 v[188:191], v[76:79], v[92:95], v[188:191]
  ds_write_b128 v16, v[148:151] offset:5120
  v_mfma_f32_16x16x32_bf16 v[184:187], v[72:75], v[92:95], v[184:187]
  ds_write_b128 v16, v[152:155] offset:6144
  v_mfma_f32_16x16x32_bf16 v[180:183], v[68:71], v[92:95], v[180:183]
  ds_write_b128 v16, v[156:159] offset:7168
  v_mfma_f32_16x16x32_bf16 v[176:179], v[64:67], v[92:95], v[176:179]
  ds_write_b128 v16, v[160:163] offset:8192
  ds_write_b128 v16, v[164:167] offset:9216
  ds_write_b128 v16, v[168:171] offset:10240
  ds_write_b128 v16, v[172:175] offset:11264
  s_nop 3
  ds_write_b128 v16, v[176:179] offset:12288
  ds_write_b128 v16, v[180:183] offset:13312
  ds_write_b128 v16, v[184:187] offset:14336
  ds_write_b128 v16, v[188:191] offset:15360
  s_waitcnt vmcnt(0) lgkmcnt(0)
LF_sent:
  s_lshl_b32 s62, s59, 12
  s_add_u32 s62, s62, 131072
  v_add_u32 v18, s62, v14
  s_barrier
  ds_read_b128 v[64:67], v18 offset:16384
  ds_read_b128 v[96:99], v18 offset:0
  ds_read_b128 v[68:71], v18 offset:17408
  ds_read_b128 v[100:103], v18 offset:1024
  ds_read_b128 v[72:75], v18 offset:18432
  ds_read_b128 v[104:107], v18 offset:2048
  ds_read_b128 v[76:79], v18 offset:19456
  ds_read_b128 v[108:111], v18 offset:3072
  s_mov_b32 s3, 0x10000
  s_waitcnt vmcnt(8)
  s_branch LF_xchk_t
LF_xchk:
  s_waitcnt vmcnt(0)
LF_xchk_t:
  v_max3_u32 v16, v192, v193, v194
  v_max3_u32 v17, v195, v196, v197
  v_max3_u32 v16, v16, v198, v199
  v_max3_u32 v17, v17, v200, v201
  v_max3_u32 v16, v16, v202, v203
  v_max3_u32 v17, v17, v204, v205
  v_max3_u32 v16, v16, v206, v207
  v_max3_u32 v17, v17, v208, v209
  v_max3_u32 v16, v16, v210, v211
  v_max3_u32 v17, v17, v212, v213
  v_max3_u32 v16, v16, v214, v215
  v_max_u32 v16, v16, v17
  v_cmp_eq_u32 vcc, -1, v16
  s_sub_u32 s3, s3, 1
  s_cbranch_scc1 LF_xchk_ok
  s_cbranch_vccz LF_xchk_ok
  buffer_load_dwordx4 v[192:195], v14, s[44:47], s65 offen offset:0 sc1
  buffer_load_dwordx4 v[196:199], v14, s[44:47], s65 offen offset:1024 sc1
  buffer_load_dwordx4 v[200:203], v14, s[44:47], s66 offen offset:0 sc1
  buffer_load_dwordx4 v[204:207], v14, s[44:47], s66 offen offset:1024 sc1
  buffer_load_dwordx4 v[208:211], v14, s[44:47], s67 offen offset:0 sc1
  buffer_load_dwordx4 v[212:215], v14, s[44:47], s67 offen offset:1024 sc1
  s_branch LF_xchk
LF_xchk_ok:
  v_lshlrev_b32 v80, 16, v192
  v_and_b32 v81, 0xffff0000, v192
  v_lshlrev_b32 v82, 16, v193
  v_and_b32 v83, 0xffff0000, v193
  v_lshlrev_b32 v84, 16, v194
  v_and_b32 v85, 0xffff0000, v194
  v_lshlrev_b32 v86, 16, v195
  v_and_b32 v87, 0xffff0000, v195
  v_lshlrev_b32 v88, 16, v196
  v_and_b32 v89, 0xffff0000, v196
  v_lshlrev_b32 v90, 16, v197
  v_and_b32 v91, 0xffff0000, v197
  v_lshlrev_b32 v92, 16, v198
  v_and_b32 v93, 0xffff0000, v198
  v_lshlrev_b32 v94, 16, v199
  v_and_b32 v95, 0xffff0000, v199
  s_waitcnt lgkmcnt(7)
  v_pk_add_f32 v[64:65], v[64:65], v[80:81]
  v_pk_add_f32 v[66:67], v[66:67], v[82:83]
  s_waitcnt lgkmcnt(5)
  v_pk_add_f32 v[68:69], v[68:69], v[84:85]
  v_pk_add_f32 v[70:71], v[70:71], v[86:87]
  s_waitcnt lgkmcnt(3)
  v_pk_add_f32 v[72:73], v[72:73], v[88:89]
  v_pk_add_f32 v[74:75], v[74:75], v[90:91]
  s_waitcnt lgkmcnt(1)
  v_pk_add_f32 v[76:77], v[76:77], v[92:93]
  v_pk_add_f32 v[78:79], v[78:79], v[94:95]
  v_lshlrev_b32 v80, 16, v200
  v_and_b32 v81, 0xffff0000, v200
  v_lshlrev_b32 v82, 16, v201
  v_and_b32 v83, 0xffff0000, v201
  v_lshlrev_b32 v84, 16, v202
  v_and_b32 v85, 0xffff0000, v202
  v_lshlrev_b32 v86, 16, v203
  v_and_b32 v87, 0xffff0000, v203
  v_lshlrev_b32 v88, 16, v204
  v_and_b32 v89, 0xffff0000, v204
  v_lshlrev_b32 v90, 16, v205
  v_and_b32 v91, 0xffff0000, v205
  v_lshlrev_b32 v92, 16, v206
  v_and_b32 v93, 0xffff0000, v206
  v_lshlrev_b32 v94, 16, v207
  v_and_b32 v95, 0xffff0000, v207
  v_pk_add_f32 v[64:65], v[64:65], v[80:81]
  v_pk_add_f32 v[66:67], v[66:67], v[82:83]
  v_pk_add_f32 v[68:69], v[68:69], v[84:85]
  v_pk_add_f32 v[70:71], v[70:71], v[86:87]
  v_pk_add_f32 v[72:73], v[72:73], v[88:89]
  v_pk_add_f32 v[74:75], v[74:75], v[90:91]
  v_pk_add_f32 v[76:77], v[76:77], v[92:93]
  v_pk_add_f32 v[78:79], v[78:79], v[94:95]
  v_lshlrev_b32 v80, 16, v208
  v_and_b32 v81, 0xffff0000, v208
  v_lshlrev_b32 v82, 16, v209
  v_and_b32 v83, 0xffff0000, v209
  v_lshlrev_b32 v84, 16, v210
  v_and_b32 v85, 0xffff0000, v210
  v_lshlrev_b32 v86, 16, v211
  v_and_b32 v87, 0xffff0000, v211
  v_lshlrev_b32 v88, 16, v212
  v_and_b32 v89, 0xffff0000, v212
  v_lshlrev_b32 v90, 16, v213
  v_and_b32 v91, 0xffff0000, v213
  v_lshlrev_b32 v92, 16, v214
  v_and_b32 v93, 0xffff0000, v214
  v_lshlrev_b32 v94, 16, v215
  v_and_b32 v95, 0xffff0000, v215
  v_pk_add_f32 v[64:65], v[64:65], v[80:81]
  v_pk_add_f32 v[66:67], v[66:67], v[82:83]
  v_pk_add_f32 v[68:69], v[68:69], v[84:85]
  v_pk_add_f32 v[70:71], v[70:71], v[86:87]
  v_pk_add_f32 v[72:73], v[72:73], v[88:89]
  v_pk_add_f32 v[74:75], v[74:75], v[90:91]
  v_pk_add_f32 v[76:77], v[76:77], v[92:93]
  v_pk_add_f32 v[78:79], v[78:79], v[94:95]
  v_pk_fma_f32 v[64:65], v[64:65], v[96:97], v[112:113]
  v_pk_fma_f32 v[66:67], v[66:67], v[98:99], v[114:115]
  v_cvt_pk_bf16_f32 v240, v64, v65
  v_cvt_pk_bf16_f32 v241, v66, v67
  buffer_store_dwordx2 v[240:241], v10, s[48:51], s21 offen offset:0
  v_pk_fma_f32 v[68:69], v[68:69], v[100:101], v[116:117]
  v_pk_fma_f32 v[70:71], v[70:71], v[102:103], v[118:119]
  v_cvt_pk_bf16_f32 v242, v68, v69
  v_cvt_pk_bf16_f32 v243, v70, v71
  buffer_store_dwordx2 v[242:243], v10, s[48:51], s21 offen offset:32
  v_pk_fma_f32 v[72:73], v[72:73], v[104:105], v[120:121]
  v_pk_fma_f32 v[74:75], v[74:75], v[106:107], v[122:123]
  v_cvt_pk_bf16_f32 v244, v72, v73
  v_cvt_pk_bf16_f32 v245, v74, v75
  buffer_store_dwordx2 v[244:245], v10, s[48:51], s21 offen offset:64
  s_waitcnt lgkmcnt(0)
  v_pk_fma_f32 v[76:77], v[76:77], v[108:109], v[124:125]
  v_pk_fma_f32 v[78:79], v[78:79], v[110:111], v[126:127]
  v_cvt_pk_bf16_f32 v246, v76, v77
  v_cvt_pk_bf16_f32 v247, v78, v79
  buffer_store_dwordx2 v[246:247], v10, s[48:51], s21 offen offset:96
L_recurrent_scan__compressed_kv_cla__dense_activation_squared_relu__prompt_kernel_end:
  s_endpgm
.section .rodata,"a"
.p2align 6
.amdhsa_kernel recurrent_scan__compressed_kv_cla__dense_activation_squared_relu__prompt_kernel
  .amdhsa_next_free_vgpr 256
  .amdhsa_next_free_sgpr 102
  .amdhsa_accum_offset 256
  .amdhsa_group_segment_fixed_size 0
  .amdhsa_kernarg_size 112
  .amdhsa_user_sgpr_count 2
  .amdhsa_user_sgpr_kernarg_segment_ptr 1
  .amdhsa_system_sgpr_workgroup_id_x 1
.end_amdhsa_kernel
```
